```python
import torch

def _softmax(x, axis=-1):
    return torch.softmax(x, dim=axis)
def _gelu(x):
    return torch.nn.functional.gelu(x, approximate="tanh")
def _silu(x):
    return torch.nn.functional.silu(x)
def _sigmoid(x):
    return torch.sigmoid(x)
def _layernorm(x, axis=-1, eps=1e-5):
    m = x.mean(dim=axis, keepdim=True)
    v = x.var(dim=axis, keepdim=True, unbiased=False)
    return (x - m) / torch.sqrt(v + eps)
def _scatter_add(tgt, idx, src, axis=0):
    return tgt.clone().index_add_(axis, idx, src)
def _segment_sum(src, seg, n):
    out = torch.zeros((n,) + src.shape[1:], dtype=src.dtype)
    return out.index_add_(0, seg, src)
def _pad(x, pw):
    flat = tuple(v for pair in reversed(pw) for v in pair)
    return torch.nn.functional.pad(x, flat)

kernel_name = 'recurrent_scan__sliding_block_cached__swiglu_ffn__prompt'

def setup_inputs():

    _w = (lambda a: (lambda t: t.to(torch.bfloat16) if t.is_floating_point() else t)(torch.as_tensor(a)))
    def _A_setup():
        B, Sq, D = 1, 2048, 640
        Hq, Hkv, Sk, Dh = 32, 32, 2048, 192
        assert Hq % Hkv == 0, (Hq, Hkv)
        return {
            "x": _w((lambda *s: torch.randn(*s, dtype=torch.bfloat16) * 0.05)(B, Sq, D)),
            "k_cache": _w((lambda *s: torch.randn(*s, dtype=torch.bfloat16) * 0.8)(B, Hkv, Sk, Dh)),
            "v_cache": _w((lambda *s: torch.randn(*s, dtype=torch.bfloat16) * 0.2)(B, Hkv, Sk, Dh)),
            "wq": _w((lambda *s: torch.randn(*s, dtype=torch.bfloat16) * 0.8)(D, Hq * Dh) * (D ** -0.5)),
            "wo": _w((lambda *s: torch.randn(*s, dtype=torch.bfloat16) * 0.2)(Hq * Dh, D) * ((Hq * Dh) ** -0.5)),
        }
    _A_in = _A_setup()

    def _B_setup():
        B, S, D, F = 1, 2048, 640, 1536
        return {
            "x": _w((lambda *s: torch.randn(*s, dtype=torch.bfloat16) * 0.05)(B, S, D)),
            "w_gate": _w((lambda *s: torch.randn(*s, dtype=torch.bfloat16) * 0.1)(D, F)),
            "w_up": _w((lambda *s: torch.randn(*s, dtype=torch.bfloat16) * 0.1)(D, F)),
            "w_down": _w((lambda *s: torch.randn(*s, dtype=torch.bfloat16) * 0.1)(F, D)),
        }
    _B_in = _B_setup()

    return {
        "A_x": _A_in["x"],
        "A_k_cache": _A_in["k_cache"],
        "A_v_cache": _A_in["v_cache"],
        "A_wq": _A_in["wq"],
        "A_wo": _A_in["wo"],
        "B_x": _B_in["x"],
        "B_w_gate": _B_in["w_gate"],
        "B_w_up": _B_in["w_up"],
        "B_w_down": _B_in["w_down"],
    }

def reference(A_x, A_k_cache, A_v_cache, A_wq, A_wo, B_x, B_w_gate, B_w_up, B_w_down):
    def _A_ref(x, k_cache, v_cache, wq, wo):
        B, Sq, D = x.shape
        Hq, Dh = 32, 192
        Hkv, Sk = k_cache.shape[1], k_cache.shape[2]
        W = min(4096, max(256, Sk // 4))
        rep = Hq // Hkv
        q = (lambda x, *d: x.permute(*d))((x @ wq).reshape(B, Sq, Hq, Dh), 0, 2, 1, 3)
        k = (lambda x, n, axis: torch.repeat_interleave(x, n, dim=axis))(k_cache[:, :, Sk - W:, :], rep, axis=1)
        v = (lambda x, n, axis: torch.repeat_interleave(x, n, dim=axis))(v_cache[:, :, Sk - W:, :], rep, axis=1)
        scores = torch.einsum("bhqd,bhkd->bhqk", q, k) * (Dh ** -0.5)
        p = _softmax(scores, axis=-1)
        o = torch.einsum("bhqk,bhkd->bhqd", p, v)
        return (lambda x, *d: x.permute(*d))(o, 0, 2, 1, 3).reshape(B, Sq, Hq * Dh) @ wo

    def _B_ref(x, w_gate, w_up, w_down):
        g = _silu(x @ w_gate)
        u = x @ w_up
        return (g * u) @ w_down

    x = A_x
    xn = _layernorm(x, axis=-1)
    s = _A_ref(xn, A_k_cache, A_v_cache, A_wq, A_wo)
    g = _silu(_B_ref(xn, B_w_gate, B_w_up, B_w_down))
    return x + s * g
```

```asm
; @launch grid=(256,1,1) block=(256,1,1) lds=163840
.amdgcn_target "amdgcn-amd-amdhsa--gfx950"
.text
.globl recurrent_scan__sliding_block_cached__swiglu_ffn__prompt_kernel
.p2align 8
.type recurrent_scan__sliding_block_cached__swiglu_ffn__prompt_kernel,@function
recurrent_scan__sliding_block_cached__swiglu_ffn__prompt_kernel:
s_cmp_lt_u32 s2, 256
s_cbranch_scc1 L_go
s_endpgm
L_go:
s_load_dwordx2 s[36:37], s[0:1], 0
s_load_dwordx2 s[4:5], s[0:1], 88
s_getpc_b64 s[44:45]
L_pc:
s_mov_b32 s46, L_codeend-L_pc
s_mov_b32 s47, 0x20000
s_lshr_b32 s94, s2, 3
s_sub_u32 s94, s94, 992
v_lshl_add_u32 v1, v0, 5, s94
v_max_i32 v1, v0, v1
v_lshlrev_b32 v1, 7, v1
buffer_load_dword v60, v1, s[44:47], 0 offen
s_load_dwordx2 s[8:9], s[0:1], 24
s_load_dwordx2 s[12:13], s[0:1], 48
s_load_dwordx2 s[16:17], s[0:1], 56
s_load_dwordx2 s[20:21], s[0:1], 8
s_load_dwordx2 s[24:25], s[0:1], 16
s_load_dwordx2 s[28:29], s[0:1], 32
s_load_dwordx2 s[32:33], s[0:1], 64
s_load_dwordx2 s[40:41], s[0:1], 72
v_lshrrev_b32 v1, 6, v0
v_and_b32 v2, 7, v0
v_lshrrev_b32 v5, 3, v0
v_readfirstlane_b32 s48, v1
s_mul_i32 s94, s2, 10240
v_mul_u32_u24 v6, 1280, v2
v_lshl_add_u32 v4, v5, 4, v6
s_mov_b32 s38, 2621440
s_mov_b32 s39, 0x20000
s_cmp_lt_u32 s48, 2
s_cselect_b32 s95, 0, 1073741824
s_cselect_b32 s96, 1.0, 0
s_add_u32 s97, s94, s95
s_mov_b32 s6, 268435456
s_mov_b32 s7, 0x20000
s_lshr_b32 s51, s2, 5
s_lshl_b32 s93, s51, 8
s_add_u32 s93, s93, 83886080
s_waitcnt lgkmcnt(0)
buffer_load_ushort v20, v6, s[36:39], s94 offen
buffer_load_dwordx4 v[8:11], v4, s[36:39], s94 offen
buffer_load_dwordx4 v[12:15], v4, s[36:39], s94 offen offset:512
buffer_load_dwordx4 v[16:19], v4, s[36:39], s97 offen offset:1024
s_waitcnt lgkmcnt(0)
buffer_load_dword v251, off, s[4:7], s93 sc1
v_mov_b32 v7, 1073741824
v_lshlrev_b32 v3, 4, v0
v_cmp_gt_u32 vcc, 8, v0
s_lshl_b32 s92, s2, 7
s_add_u32 s92, s92, 83890176
v_cndmask_b32 v61, v7, v3, vcc
v_and_b32 v207, 63, v0
s_and_b32 s49, s2, 3
s_bfe_u32 s50, s2, 0x10002
s_lshl1_add_u32 s49, s49, s50
s_bfe_u32 s50, s2, 0x20003
s_lshl2_add_u32 s52, s49, s50
s_lshl2_add_u32 s51, s51, s48
s_lshr_b32 s97, s49, 1
s_xor_b32 s97, s97, 3
s_mul_i32 s58, s51, 81920
s_and_b32 s98, s48, 1
s_lshl_b32 s98, s98, 4
s_lshr_b32 s99, s48, 1
s_lshl2_add_u32 s98, s99, s98
s_mul_i32 s57, s98, 3072
s_mul_i32 s99, s52, 96
s_add_u32 s57, s57, s99
s_lshl_b32 s56, s57, 2
s_mul_i32 s53, s48, 3072
s_lshl_b32 s54, s48, 10
s_mov_b32 s14, 1966080
s_mov_b32 s15, 0x20000
s_mov_b32 s18, 1966080
s_mov_b32 s19, 0x20000
s_mov_b32 s10, 7864320
s_mov_b32 s11, 0x20000
v_lshrrev_b32 v211, 3, v207
v_xor_b32 v212, v211, v2
v_mul_u32_u24 v211, 1280, v211
v_lshl_add_u32 v72, v212, 4, v211
v_add_u32 v73, 9216, v72
s_lshl2_add_u32 s98, s48, s97
s_lshl_b32 s98, s98, 11
s_add_u32 s86, s98, 49152
s_xor_b32 m0, s86, 0
s_nop 0
buffer_load_dwordx4 v72, s[36:39], s58 offen lds
s_xor_b32 m0, s86, 0
s_nop 0
buffer_load_dwordx4 v73, s[36:39], s58 offen offset:1024 lds
s_xor_b32 m0, s86, 2048
s_add_u32 s3, s58, 20480
buffer_load_dwordx4 v72, s[36:39], s3 offen lds
s_xor_b32 m0, s86, 2048
s_add_u32 s3, s58, 20480
buffer_load_dwordx4 v73, s[36:39], s3 offen offset:1024 lds
v_add_u32 v214, 0, v207
v_mul_u32_u24 v215, 2731, v214
v_lshrrev_b32 v215, 16, v215
v_mul_u32_u24 v211, 24, v215
v_sub_u32 v199, v214, v211
v_bfe_u32 v211, v215, 1, 1
v_lshlrev_b32 v211, 2, v211
v_xor_b32 v211, v211, v199
v_and_b32 v212, 4, v215
v_add_u32 v212, v212, v215
v_mul_u32_u24 v212, 12288, v212
v_lshl_add_u32 v195, v211, 4, v212
v_add_u32 v214, 64, v207
v_mul_u32_u24 v215, 2731, v214
v_lshrrev_b32 v215, 16, v215
v_mul_u32_u24 v211, 24, v215
v_sub_u32 v199, v214, v211
v_bfe_u32 v211, v215, 1, 1
v_lshlrev_b32 v211, 2, v211
v_xor_b32 v211, v211, v199
v_and_b32 v212, 4, v215
v_add_u32 v212, v212, v215
v_mul_u32_u24 v212, 12288, v212
v_lshl_add_u32 v196, v211, 4, v212
v_subrev_u32 v196, 1024, v196
v_add_u32 v214, 128, v207
v_mul_u32_u24 v215, 2731, v214
v_lshrrev_b32 v215, 16, v215
v_mul_u32_u24 v211, 24, v215
v_sub_u32 v199, v214, v211
v_bfe_u32 v211, v215, 1, 1
v_lshlrev_b32 v211, 2, v211
v_xor_b32 v211, v211, v199
v_and_b32 v212, 4, v215
v_add_u32 v212, v212, v215
v_mul_u32_u24 v212, 12288, v212
v_lshl_add_u32 v197, v211, 4, v212
v_subrev_u32 v197, 2048, v197
v_mul_u32_u24 v215, 10923, v207
v_lshrrev_b32 v215, 16, v215
v_mul_u32_u24 v211, 6, v215
v_sub_u32 v199, v207, v211
s_and_b32 s98, s52, 1
s_lshl_b32 s98, s98, 1
v_add_u32 v199, s98, v199
v_subrev_u32 v211, 6, v199
v_min_u32 v199, v199, v211
v_and_b32 v212, 4, v215
v_add_u32 v212, v212, v215
v_mul_u32_u24 v212, 3072, v212
v_lshl_add_u32 v212, v199, 4, v212
v_cmp_gt_u32 vcc, 48, v207
s_nop 1
v_cndmask_b32 v198, v7, v212, vcc
s_lshl2_add_u32 s98, s51, s50
s_mul_i32 s99, s49, 384
s_mul_i32 s85, s98, 6144
s_add_u32 s85, s85, s99
s_mul_i32 s98, s98, 12288
s_lshl2_add_u32 s84, s99, s98
v_lshrrev_b32 v211, 2, v207
v_min_u32 v253, 11, v211
v_lshlrev_b32 v253, 7, v253
v_min_u32 v211, 5, v211
v_mul_u32_u24 v254, 86, v211
v_lshrrev_b32 v254, 8, v254
v_mul_u32_u24 v254, 2688, v254
v_lshl_add_u32 v254, v211, 7, v254
s_add_u32 s3, s85, 0
s_waitcnt lgkmcnt(0)
buffer_load_dword v249, v254, s[12:15], s3 offen
s_add_u32 s3, s85, 0
s_waitcnt lgkmcnt(0)
buffer_load_dword v249, v254, s[16:19], s3 offen
s_add_u32 s3, s84, 0
buffer_load_dword v249, v253, s[8:11], s3 offen
s_mov_b64 exec, 0
s_cmp_eq_u32 s48, 0
s_cbranch_scc1 L_walk1_0
s_cmp_eq_u32 s48, 1
s_cbranch_scc1 L_walk1_1
s_cmp_eq_u32 s48, 2
s_cbranch_scc1 L_walk1_2
s_branch L_walk1_3
L_ret1:
s_mov_b64 exec, -1
v_lshlrev_b32 v250, 4, v207
s_lshr_b32 s90, s2, 3
s_mul_i32 s90, s90, 81920
s_bfe_u32 s98, s2, 0x20001
s_lshl_b32 s98, s98, 10
s_add_u32 s90, s90, s98
s_and_b32 s98, s2, 1
s_lshl_b32 s98, s98, 7
s_add_u32 s90, s90, s98
s_lshl_b32 s98, s48, 13
s_add_u32 s90, s90, s98
s_add_u32 s91, s90, 32768
s_add_u32 s89, s90, 65536
s_add_u32 s89, s89, s95
v_lshrrev_b32 v3, 5, v207
v_lshlrev_b32 v5, 12, v3
v_bfe_u32 v6, v0, 3, 2
v_lshl_add_u32 v5, v6, 8, v5
v_lshl_add_u32 v5, v2, 4, v5
v_lshlrev_b32 v6, 4, v2
v_add_u32 v6, 135168, v6
v_lshl_add_u32 v7, v1, 2, v6
v_lshl_add_u32 v7, v3, 7, v7
s_branch L_main
L_pollx:
buffer_load_dwordx3 v[244:246], v247, s[4:7], s86 offen sc1
s_waitcnt vmcnt(1)
v_cmp_ne_u32 vcc, v205, v251
v_mov_b32 v80, v204
v_mov_b32 v81, v206
v_mov_b32 v84, v204
v_mov_b32 v85, v206
s_cbranch_vccz L_polled
s_mov_b32 s89, 20000
L_pollx2:
buffer_load_dwordx3 v[204:206], v247, s[4:7], s86 offen sc1
s_waitcnt vmcnt(1)
v_cmp_ne_u32 vcc, v245, v251
v_mov_b32 v80, v244
v_mov_b32 v81, v246
v_mov_b32 v84, v244
v_mov_b32 v85, v246
s_cbranch_vccz L_polled
buffer_load_dwordx3 v[244:246], v247, s[4:7], s86 offen sc1
s_waitcnt vmcnt(1)
v_cmp_ne_u32 vcc, v205, v251
v_mov_b32 v80, v204
v_mov_b32 v81, v206
v_mov_b32 v84, v204
v_mov_b32 v85, v206
s_cbranch_vccz L_polled
s_sub_u32 s89, s89, 1
s_cmp_eq_u32 s89, 0
s_cbranch_scc0 L_pollx2
s_branch L_polled
L_spin_x:
s_mov_b32 s89, 20000
L_spin2_x:
buffer_load_dword v248, v247, s[4:7], s86 offen offset:12 sc1
s_sub_u32 s89, s89, 1
s_cmp_eq_u32 s89, 0
s_waitcnt vmcnt(0)
s_cbranch_scc1 L_back_x
v_cmp_ne_u32 vcc, v248, v251
s_cbranch_vccnz L_spin2_x
s_branch L_back_x
L_spin_y:
s_mov_b32 s89, 20000
L_spin2_y:
buffer_load_dword v254, v253, s[4:7], s82 offen offset:12 sc1
s_sub_u32 s89, s89, 1
s_cmp_eq_u32 s89, 0
s_waitcnt vmcnt(0)
s_cbranch_scc1 L_back_y
v_sub_u32 v254, v251, v254
v_cmp_lt_u32 vcc, 1, v254
s_cbranch_vccnz L_spin2_y
s_branch L_back_y
L_spin_0:
s_mov_b32 s89, 20000
L_spin2_0:
buffer_load_dword v254, v253, s[4:7], s64 offen offset:12 sc1
s_sub_u32 s89, s89, 1
s_cmp_eq_u32 s89, 0
s_waitcnt vmcnt(0)
s_cbranch_scc1 L_back_0
v_sub_u32 v254, v251, v254
v_cmp_lt_u32 vcc, 1, v254
s_cbranch_vccnz L_spin2_0
s_branch L_back_0
L_spin_1:
s_mov_b32 s89, 20000
L_spin2_1:
buffer_load_dword v254, v253, s[4:7], s71 offen offset:132 sc1
s_sub_u32 s89, s89, 1
s_cmp_eq_u32 s89, 0
s_waitcnt vmcnt(0)
s_cbranch_scc1 L_back_1
v_cmp_ne_u32 vcc, v254, v251
s_cbranch_vccnz L_spin2_1
s_branch L_back_1
L_spin_2:
s_mov_b32 s89, 20000
L_spin2_2:
buffer_load_dword v254, v253, s[4:7], s71 offen offset:260 sc1
s_sub_u32 s89, s89, 1
s_cmp_eq_u32 s89, 0
s_waitcnt vmcnt(0)
s_cbranch_scc1 L_back_2
v_cmp_ne_u32 vcc, v254, v251
s_cbranch_vccnz L_spin2_2
s_branch L_back_2
L_spin_3:
s_mov_b32 s89, 20000
L_spin2_3:
buffer_load_dword v254, v253, s[4:7], s71 offen offset:388 sc1
s_sub_u32 s89, s89, 1
s_cmp_eq_u32 s89, 0
s_waitcnt vmcnt(0)
s_cbranch_scc1 L_back_3
v_cmp_ne_u32 vcc, v254, v251
s_cbranch_vccnz L_spin2_3
s_branch L_back_3
L_spin_4:
s_mov_b32 s89, 20000
L_spin2_4:
buffer_load_dword v254, v253, s[4:7], s71 offen offset:516 sc1
s_sub_u32 s89, s89, 1
s_cmp_eq_u32 s89, 0
s_waitcnt vmcnt(0)
s_cbranch_scc1 L_back_4
v_cmp_ne_u32 vcc, v254, v251
s_cbranch_vccnz L_spin2_4
s_branch L_back_4
L_spin_5:
s_mov_b32 s89, 20000
L_spin2_5:
buffer_load_dword v254, v253, s[4:7], s70 offen offset:644 sc1
s_sub_u32 s89, s89, 1
s_cmp_eq_u32 s89, 0
s_waitcnt vmcnt(0)
s_cbranch_scc1 L_back_5
v_cmp_ne_u32 vcc, v254, v251
s_cbranch_vccnz L_spin2_5
s_branch L_back_5
L_spin_6:
s_mov_b32 s89, 20000
L_spin2_6:
buffer_load_dword v254, v253, s[4:7], s70 offen offset:772 sc1
s_sub_u32 s89, s89, 1
s_cmp_eq_u32 s89, 0
s_waitcnt vmcnt(0)
s_cbranch_scc1 L_back_6
v_cmp_ne_u32 vcc, v254, v251
s_cbranch_vccnz L_spin2_6
s_branch L_back_6
L_spin_k2:
s_mov_b32 s89, 20000
s_xor_b32 s94, s76, 786432
L_spin2_k2:
buffer_load_dwordx4 v[4:7], v250, s[4:7], s94 offen offset:3072 sc1
buffer_load_dwordx4 v[100:103], v250, s[4:7], s94 offen offset:1024 sc1
buffer_load_dwordx4 v[80:83], v250, s[4:7], s94 offen offset:2048 sc1
s_sub_u32 s89, s89, 1
s_cmp_eq_u32 s89, 0
s_waitcnt vmcnt(0)
s_cbranch_scc1 L_back_k2
v_max3_u32 v254, v5, v101, v81
v_cmp_ge_u32 vcc, v254, v251
s_cbranch_vccnz L_spin2_k2
s_branch L_back_k2
L_spin_k3:
s_mov_b32 s89, 20000
s_xor_b32 s94, s76, 1048576
L_spin2_k3:
buffer_load_dwordx4 v[132:135], v250, s[4:7], s94 offen offset:3072 sc1
buffer_load_dwordx4 v[112:115], v250, s[4:7], s94 offen offset:1024 sc1
buffer_load_dwordx4 v[116:119], v250, s[4:7], s94 offen offset:2048 sc1
s_sub_u32 s89, s89, 1
s_cmp_eq_u32 s89, 0
s_waitcnt vmcnt(0)
s_cbranch_scc1 L_back_k3
v_max3_u32 v254, v133, v113, v117
v_cmp_ge_u32 vcc, v254, v251
s_cbranch_vccnz L_spin2_k3
s_branch L_back_k3
L_spin_k4:
s_mov_b32 s89, 20000
s_xor_b32 s94, s76, 1310720
L_spin2_k4:
buffer_load_dwordx4 v[68:71], v250, s[4:7], s94 offen offset:1024 sc1
buffer_load_dwordx4 v[64:67], v235, s[4:7], s94 offen offset:3072 sc1
s_sub_u32 s89, s89, 1
s_cmp_eq_u32 s89, 0
s_waitcnt vmcnt(0)
s_cbranch_scc1 L_back_k4
v_max3_u32 v254, v69, v65, v65
v_cmp_ge_u32 vcc, v254, v251
s_cbranch_vccnz L_spin2_k4
s_branch L_back_k4
.p2align 12
L_main:
s_waitcnt vmcnt(11)
v_lshlrev_b32 v52, 16, v20
v_mov_b32 v53, v52
v_mul_f32 v54, s96, v52
v_mov_b32 v55, v54
s_waitcnt vmcnt(10)
v_lshlrev_b32 v24, 16, v8
v_and_b32 v25, 0xffff0000, v8
v_pk_add_f32 v[24:25], v[24:25], v[52:53] neg_lo:[0,1] neg_hi:[0,1]
v_lshlrev_b32 v26, 16, v9
v_and_b32 v27, 0xffff0000, v9
v_pk_add_f32 v[26:27], v[26:27], v[52:53] neg_lo:[0,1] neg_hi:[0,1]
v_pk_mul_f32 v[22:23], v[24:25], v[24:25]
v_lshlrev_b32 v28, 16, v10
v_and_b32 v29, 0xffff0000, v10
v_pk_add_f32 v[20:21], v[24:25], v[26:27]
v_pk_add_f32 v[28:29], v[28:29], v[52:53] neg_lo:[0,1] neg_hi:[0,1]
v_pk_fma_f32 v[22:23], v[26:27], v[26:27], v[22:23]
v_lshlrev_b32 v30, 16, v11
v_and_b32 v31, 0xffff0000, v11
v_pk_add_f32 v[20:21], v[20:21], v[28:29]
v_pk_add_f32 v[30:31], v[30:31], v[52:53] neg_lo:[0,1] neg_hi:[0,1]
v_pk_fma_f32 v[22:23], v[28:29], v[28:29], v[22:23]
s_waitcnt vmcnt(9)
v_lshlrev_b32 v32, 16, v12
v_and_b32 v33, 0xffff0000, v12
v_pk_add_f32 v[20:21], v[20:21], v[30:31]
v_pk_add_f32 v[32:33], v[32:33], v[52:53] neg_lo:[0,1] neg_hi:[0,1]
v_pk_fma_f32 v[22:23], v[30:31], v[30:31], v[22:23]
v_lshlrev_b32 v34, 16, v13
v_and_b32 v35, 0xffff0000, v13
v_pk_add_f32 v[20:21], v[20:21], v[32:33]
v_pk_add_f32 v[34:35], v[34:35], v[52:53] neg_lo:[0,1] neg_hi:[0,1]
v_pk_fma_f32 v[22:23], v[32:33], v[32:33], v[22:23]
v_lshlrev_b32 v36, 16, v14
v_and_b32 v37, 0xffff0000, v14
v_pk_add_f32 v[20:21], v[20:21], v[34:35]
v_pk_add_f32 v[36:37], v[36:37], v[52:53] neg_lo:[0,1] neg_hi:[0,1]
v_pk_fma_f32 v[22:23], v[34:35], v[34:35], v[22:23]
v_lshlrev_b32 v38, 16, v15
v_and_b32 v39, 0xffff0000, v15
v_pk_add_f32 v[20:21], v[20:21], v[36:37]
v_pk_add_f32 v[38:39], v[38:39], v[52:53] neg_lo:[0,1] neg_hi:[0,1]
v_pk_fma_f32 v[22:23], v[36:37], v[36:37], v[22:23]
s_waitcnt vmcnt(8)
v_lshlrev_b32 v40, 16, v16
v_and_b32 v41, 0xffff0000, v16
v_pk_add_f32 v[20:21], v[20:21], v[38:39]
v_pk_add_f32 v[40:41], v[40:41], v[54:55] neg_lo:[0,1] neg_hi:[0,1]
v_pk_fma_f32 v[22:23], v[38:39], v[38:39], v[22:23]
v_lshlrev_b32 v42, 16, v17
v_and_b32 v43, 0xffff0000, v17
v_pk_add_f32 v[20:21], v[20:21], v[40:41]
v_pk_add_f32 v[42:43], v[42:43], v[54:55] neg_lo:[0,1] neg_hi:[0,1]
v_pk_fma_f32 v[22:23], v[40:41], v[40:41], v[22:23]
v_lshlrev_b32 v44, 16, v18
v_and_b32 v45, 0xffff0000, v18
v_pk_add_f32 v[20:21], v[20:21], v[42:43]
v_pk_add_f32 v[44:45], v[44:45], v[54:55] neg_lo:[0,1] neg_hi:[0,1]
v_pk_fma_f32 v[22:23], v[42:43], v[42:43], v[22:23]
v_lshlrev_b32 v46, 16, v19
v_and_b32 v47, 0xffff0000, v19
v_pk_add_f32 v[20:21], v[20:21], v[44:45]
v_pk_add_f32 v[46:47], v[46:47], v[54:55] neg_lo:[0,1] neg_hi:[0,1]
v_pk_fma_f32 v[22:23], v[44:45], v[44:45], v[22:23]
v_pk_add_f32 v[20:21], v[20:21], v[46:47]
v_pk_fma_f32 v[22:23], v[46:47], v[46:47], v[22:23]
v_add_f32 v20, v20, v21
v_add_f32 v22, v22, v23
s_nop 1
v_permlane32_swap_b32 v20, v22
v_add_f32 v20, v20, v22
s_nop 1
v_add_f32_dpp v20, v20, v20 row_ror:8 row_mask:0xf bank_mask:0xf
v_mov_b32 v21, v20
s_nop 1
v_permlane16_swap_b32 v21, v20
v_add_f32 v20, v21, v20
ds_write_b32 v7, v20
s_xor_b32 m0, s86, 4096
s_add_u32 s3, s58, 40960
buffer_load_dwordx4 v72, s[36:39], s3 offen lds
s_xor_b32 m0, s86, 4096
s_add_u32 s3, s58, 40960
buffer_load_dwordx4 v73, s[36:39], s3 offen offset:1024 lds
s_waitcnt lgkmcnt(0)
s_barrier
ds_read_b128 v[48:51], v6
ds_read_b128 v[56:59], v6 offset:128
s_xor_b32 m0, s86, 6144
s_add_u32 s3, s58, 61440
buffer_load_dwordx4 v72, s[36:39], s3 offen lds
s_xor_b32 m0, s86, 6144
s_add_u32 s3, s58, 61440
buffer_load_dwordx4 v73, s[36:39], s3 offen offset:1024 lds
s_mov_b32 s98, 747796405
s_waitcnt vmcnt(11)
v_or_b32 v251, 1, v251
v_mul_lo_u32 v251, v251, s98
v_or_b32 v251, 0xff800000, v251
s_mov_b32 s98, 0x3acccccd
s_waitcnt lgkmcnt(1)
v_pk_add_f32 v[20:21], v[48:49], v[50:51]
v_add_f32 v20, v20, v21
v_mul_f32 v20, s98, v20
s_waitcnt lgkmcnt(0)
v_pk_add_f32 v[22:23], v[56:57], v[58:59]
v_mul_f32 v21, v20, v20
v_add_f32 v22, v22, v23
v_add_f32 v53, v52, v20
v_fma_f32 v22, v22, s98, -v21
v_max_f32 v22, 0, v22
v_cvt_pk_bf16_f32 v22, v22, v22
v_and_b32 v22, 0xffff0000, v22
v_add_f32 v22, 0x3727c5ac, v22
v_cvt_pk_bf16_f32 v22, v22, v22
v_and_b32 v22, 0xffff0000, v22
v_sqrt_f32 v22, v22
v_cvt_pk_bf16_f32 v53, v53, v53
v_and_b32 v53, 0xffff0000, v53
v_cvt_pk_bf16_f32 v22, v22, v22
v_and_b32 v22, 0xffff0000, v22
v_rcp_f32 v22, v22
v_sub_f32 v54, v52, v53
v_mov_b32 v21, v251
v_mov_b32 v23, 0
v_mul_f32 v22, 0x3dd53bff, v22
v_and_b32 v22, 0xffffff00, v22
v_mul_f32 v20, -v53, v22
buffer_store_dwordx4 v[20:23], v61, s[4:7], s92 offen sc1
v_mul_f32 v54, v54, v22
v_pk_fma_f32 v[24:25], v[24:25], v[22:23], v[54:55] op_sel_hi:[1,0,0]
v_pk_fma_f32 v[26:27], v[26:27], v[22:23], v[54:55] op_sel_hi:[1,0,0]
v_cvt_pk_bf16_f32 v8, v24, v25
v_pk_fma_f32 v[28:29], v[28:29], v[22:23], v[54:55] op_sel_hi:[1,0,0]
v_cvt_pk_bf16_f32 v9, v26, v27
v_pk_fma_f32 v[30:31], v[30:31], v[22:23], v[54:55] op_sel_hi:[1,0,0]
v_cvt_pk_bf16_f32 v10, v28, v29
v_pk_fma_f32 v[32:33], v[32:33], v[22:23], v[54:55] op_sel_hi:[1,0,0]
v_cvt_pk_bf16_f32 v11, v30, v31
buffer_store_dwordx4 v[8:11], v5, s[4:7], s90 offen sc1
v_pk_fma_f32 v[34:35], v[34:35], v[22:23], v[54:55] op_sel_hi:[1,0,0]
v_cvt_pk_bf16_f32 v12, v32, v33
v_pk_fma_f32 v[36:37], v[36:37], v[22:23], v[54:55] op_sel_hi:[1,0,0]
v_cvt_pk_bf16_f32 v13, v34, v35
v_pk_fma_f32 v[38:39], v[38:39], v[22:23], v[54:55] op_sel_hi:[1,0,0]
v_cvt_pk_bf16_f32 v14, v36, v37
v_pk_fma_f32 v[40:41], v[40:41], v[22:23], v[54:55] op_sel_hi:[1,0,0]
v_cvt_pk_bf16_f32 v15, v38, v39
buffer_store_dwordx4 v[12:15], v5, s[4:7], s91 offen sc1
v_pk_fma_f32 v[42:43], v[42:43], v[22:23], v[54:55] op_sel_hi:[1,0,0]
v_cvt_pk_bf16_f32 v16, v40, v41
v_pk_fma_f32 v[44:45], v[44:45], v[22:23], v[54:55] op_sel_hi:[1,0,0]
v_cvt_pk_bf16_f32 v17, v42, v43
v_pk_fma_f32 v[46:47], v[46:47], v[22:23], v[54:55] op_sel_hi:[1,0,0]
v_cvt_pk_bf16_f32 v18, v44, v45
v_cvt_pk_bf16_f32 v19, v46, v47
buffer_store_dwordx4 v[16:19], v5, s[4:7], s89 offen sc1
s_add_u32 m0, s54, 102400
s_nop 0
buffer_load_dwordx4 v198, s[12:15], s57 offen lds
s_add_u32 m0, s54, 106496
s_nop 0
buffer_load_dwordx4 v198, s[16:19], s57 offen lds
s_add_u32 s57, s57, 98304
s_add_u32 m0, s54, 110592
s_nop 0
buffer_load_dwordx4 v198, s[12:15], s57 offen lds
s_add_u32 m0, s54, 114688
s_nop 0
buffer_load_dwordx4 v198, s[16:19], s57 offen lds
s_add_u32 m0, s53, 24576
s_nop 0
buffer_load_dwordx4 v195, s[8:11], s56 offen lds
buffer_load_dwordx4 v196, s[8:11], s56 offen offset:1024 lds
buffer_load_dwordx4 v197, s[8:11], s56 offen offset:2048 lds
s_add_u32 s56, s56, 393216
s_add_u32 m0, s53, 36864
s_nop 0
buffer_load_dwordx4 v195, s[8:11], s56 offen lds
buffer_load_dwordx4 v196, s[8:11], s56 offen offset:1024 lds
buffer_load_dwordx4 v197, s[8:11], s56 offen offset:2048 lds
v_lshrrev_b32 v208, 4, v207
v_and_b32 v211, 15, v207
v_lshlrev_b32 v211, 7, v211
s_lshl_b32 s98, s48, 13
s_add_u32 s98, s98, 49152
v_lshl_or_b32 v74, v2, 4, v211
v_add_u32 v74, s98, v74
v_lshlrev_b32 v211, 4, v208
v_xor_b32 v75, v74, v211
v_xor_b32 v76, 64, v75
s_lshl_b32 s86, s51, 10
s_add_u32 s86, s86, 83890176
s_lshl_b32 s98, s97, 8
v_xor_b32 v247, s98, v250
v_and_b32 v209, 3, v207
v_lshrrev_b32 v210, 2, v207
v_mul_u32_u24 v211, 384, v210
v_lshl_add_u32 v212, v209, 4, v211
v_bfe_u32 v213, v210, 1, 1
v_lshlrev_b32 v213, 6, v213
v_add_u32 v192, v212, v213
v_sub_u32 v193, v212, v213
v_and_b32 v211, 7, v210
v_mul_u32_u24 v211, 96, v211
v_lshl_add_u32 v211, v3, 10, v211
v_lshl_add_u32 v211, v209, 3, v211
v_add_u32 v194, 102400, v211
s_lshl_b32 s98, s97, 10
v_or_b32 v200, s98, v250
v_xor_b32 v201, 1024, v200
v_xor_b32 v202, 2048, v200
v_xor_b32 v203, 3072, v200
s_add_u32 s58, s58, 4096
buffer_load_dwordx3 v[244:246], v247, s[4:7], s86 offen sc1
s_waitcnt vmcnt(15)
ds_read_b128 v[160:163], v75 offset:0
ds_read_b128 v[176:179], v76 offset:0
ds_read_b128 v[164:167], v75 offset:2048
ds_read_b128 v[180:183], v76 offset:2048
ds_read_b128 v[168:171], v75 offset:4096
ds_read_b128 v[184:187], v76 offset:4096
ds_read_b128 v[172:175], v75 offset:6144
ds_read_b128 v[188:191], v76 offset:6144
v_mov_b32 v23, v251
s_waitcnt vmcnt(7)
s_barrier
buffer_store_dwordx4 v[20:23], v61, s[4:7], s92 offen sc1
ds_read_b64_tr_b16 a[192:193], v194 offset:0
ds_read_b64_tr_b16 a[194:195], v194 offset:2048
ds_read_b64_tr_b16 a[196:197], v194 offset:8192
ds_read_b64_tr_b16 a[198:199], v194 offset:10240
ds_read_b64_tr_b16 a[200:201], v194 offset:4096
ds_read_b64_tr_b16 a[202:203], v194 offset:6144
ds_read_b64_tr_b16 a[204:205], v194 offset:12288
ds_read_b64_tr_b16 a[206:207], v194 offset:14336
ds_read_b64_tr_b16 a[208:209], v194 offset:32
ds_read_b64_tr_b16 a[210:211], v194 offset:2080
ds_read_b64_tr_b16 a[212:213], v194 offset:8224
ds_read_b64_tr_b16 a[214:215], v194 offset:10272
ds_read_b64_tr_b16 a[216:217], v194 offset:4128
ds_read_b64_tr_b16 a[218:219], v194 offset:6176
ds_read_b64_tr_b16 a[220:221], v194 offset:12320
ds_read_b64_tr_b16 a[222:223], v194 offset:14368
ds_read_b64_tr_b16 a[224:225], v194 offset:64
ds_read_b64_tr_b16 a[226:227], v194 offset:2112
ds_read_b64_tr_b16 a[228:229], v194 offset:8256
ds_read_b64_tr_b16 a[230:231], v194 offset:10304
ds_read_b64_tr_b16 a[232:233], v194 offset:4160
ds_read_b64_tr_b16 a[234:235], v194 offset:6208
ds_read_b64_tr_b16 a[236:237], v194 offset:12352
ds_read_b64_tr_b16 a[238:239], v194 offset:14400
s_waitcnt lgkmcnt(14)
v_lshlrev_b32 v96, 16, v160
v_and_b32 v97, 0xffff0000, v160
v_lshlrev_b32 v98, 16, v161
v_and_b32 v99, 0xffff0000, v161
v_lshlrev_b32 v100, 16, v162
v_and_b32 v101, 0xffff0000, v162
v_lshlrev_b32 v102, 16, v163
v_and_b32 v103, 0xffff0000, v163
s_waitcnt lgkmcnt(14)
v_lshlrev_b32 v104, 16, v176
v_and_b32 v105, 0xffff0000, v176
v_lshlrev_b32 v106, 16, v177
v_and_b32 v107, 0xffff0000, v177
v_lshlrev_b32 v108, 16, v178
v_and_b32 v109, 0xffff0000, v178
v_lshlrev_b32 v110, 16, v179
v_and_b32 v111, 0xffff0000, v179
s_waitcnt lgkmcnt(14)
v_lshlrev_b32 v112, 16, v164
v_and_b32 v113, 0xffff0000, v164
v_lshlrev_b32 v114, 16, v165
v_and_b32 v115, 0xffff0000, v165
v_lshlrev_b32 v116, 16, v166
v_and_b32 v117, 0xffff0000, v166
v_lshlrev_b32 v118, 16, v167
v_and_b32 v119, 0xffff0000, v167
s_waitcnt lgkmcnt(14)
v_lshlrev_b32 v120, 16, v180
v_and_b32 v121, 0xffff0000, v180
v_lshlrev_b32 v122, 16, v181
v_and_b32 v123, 0xffff0000, v181
v_lshlrev_b32 v124, 16, v182
v_and_b32 v125, 0xffff0000, v182
v_lshlrev_b32 v126, 16, v183
v_and_b32 v127, 0xffff0000, v183
s_waitcnt lgkmcnt(14)
v_lshlrev_b32 v128, 16, v168
v_and_b32 v129, 0xffff0000, v168
v_lshlrev_b32 v130, 16, v169
v_and_b32 v131, 0xffff0000, v169
v_lshlrev_b32 v132, 16, v170
v_and_b32 v133, 0xffff0000, v170
v_lshlrev_b32 v134, 16, v171
v_and_b32 v135, 0xffff0000, v171
s_waitcnt lgkmcnt(14)
v_lshlrev_b32 v136, 16, v184
v_and_b32 v137, 0xffff0000, v184
v_lshlrev_b32 v138, 16, v185
v_and_b32 v139, 0xffff0000, v185
v_lshlrev_b32 v140, 16, v186
v_and_b32 v141, 0xffff0000, v186
v_lshlrev_b32 v142, 16, v187
v_and_b32 v143, 0xffff0000, v187
s_waitcnt lgkmcnt(14)
v_lshlrev_b32 v144, 16, v172
v_and_b32 v145, 0xffff0000, v172
v_lshlrev_b32 v146, 16, v173
v_and_b32 v147, 0xffff0000, v173
v_lshlrev_b32 v148, 16, v174
v_and_b32 v149, 0xffff0000, v174
v_lshlrev_b32 v150, 16, v175
v_and_b32 v151, 0xffff0000, v175
s_waitcnt lgkmcnt(14)
v_lshlrev_b32 v152, 16, v188
v_and_b32 v153, 0xffff0000, v188
v_lshlrev_b32 v154, 16, v189
v_and_b32 v155, 0xffff0000, v189
v_lshlrev_b32 v156, 16, v190
v_and_b32 v157, 0xffff0000, v190
v_lshlrev_b32 v158, 16, v191
v_and_b32 v159, 0xffff0000, v191
buffer_load_dwordx3 v[204:206], v247, s[4:7], s86 offen sc1
s_waitcnt vmcnt(2)
v_cmp_ne_u32 vcc, v245, v251
v_mov_b32 v80, v244
v_mov_b32 v81, v246
v_mov_b32 v84, v244
v_mov_b32 v85, v246
s_cbranch_vccnz L_pollx
L_polled:
s_nop 0
v_permlane32_swap_b32 v80, v84
v_permlane32_swap_b32 v81, v85
v_mov_b32 v82, v80
v_mov_b32 v83, v81
v_mov_b32 v86, v84
v_mov_b32 v87, v85
v_permlane16_swap_b32 v80, v82
v_permlane16_swap_b32 v81, v83
v_permlane16_swap_b32 v84, v86
v_permlane16_swap_b32 v85, v87
s_add_u32 s3, s84, 1572864
buffer_load_dword v249, v253, s[8:11], s3 offen
v_pk_fma_f32 v[96:97], v[96:97], v[80:81], v[80:81] op_sel:[0,1,0] op_sel_hi:[1,1,0]
v_pk_fma_f32 v[98:99], v[98:99], v[80:81], v[80:81] op_sel:[0,1,0] op_sel_hi:[1,1,0]
v_pk_fma_f32 v[100:101], v[100:101], v[80:81], v[80:81] op_sel:[0,1,0] op_sel_hi:[1,1,0]
v_pk_fma_f32 v[102:103], v[102:103], v[80:81], v[80:81] op_sel:[0,1,0] op_sel_hi:[1,1,0]
v_cvt_pk_bf16_f32 v212, v96, v97
v_cvt_pk_bf16_f32 v213, v98, v99
v_cvt_pk_bf16_f32 v214, v100, v101
v_cvt_pk_bf16_f32 v215, v102, v103
v_pk_fma_f32 v[104:105], v[104:105], v[80:81], v[80:81] op_sel:[0,1,0] op_sel_hi:[1,1,0]
v_pk_fma_f32 v[106:107], v[106:107], v[80:81], v[80:81] op_sel:[0,1,0] op_sel_hi:[1,1,0]
v_pk_fma_f32 v[108:109], v[108:109], v[80:81], v[80:81] op_sel:[0,1,0] op_sel_hi:[1,1,0]
v_pk_fma_f32 v[110:111], v[110:111], v[80:81], v[80:81] op_sel:[0,1,0] op_sel_hi:[1,1,0]
v_cvt_pk_bf16_f32 v228, v104, v105
v_cvt_pk_bf16_f32 v229, v106, v107
v_cvt_pk_bf16_f32 v230, v108, v109
v_cvt_pk_bf16_f32 v231, v110, v111
s_waitcnt lgkmcnt(14)
v_mfma_f32_16x16x32_bf16 a[96:99], a[192:195], v[212:215], 0
s_waitcnt lgkmcnt(14)
v_fma_f32 v112, v112, v83, v82
v_fma_f32 v113, v113, v83, v82
v_mfma_f32_16x16x32_bf16 a[96:99], a[196:199], v[228:231], a[96:99]
s_waitcnt lgkmcnt(14)
s_add_u32 m0, s54, 118784
s_add_u32 s57, s57, 98304
v_fma_f32 v114, v114, v83, v82
v_fma_f32 v115, v115, v83, v82
v_mfma_f32_16x16x32_bf16 a[144:147], a[200:203], v[212:215], 0
s_waitcnt lgkmcnt(14)
buffer_load_dwordx4 v198, s[12:15], s57 offen lds
v_mfma_f32_16x16x32_bf16 a[144:147], a[204:207], v[228:231], a[144:147]
s_waitcnt lgkmcnt(14)
v_fma_f32 v116, v116, v83, v82
v_fma_f32 v117, v117, v83, v82
v_mfma_f32_16x16x32_bf16 a[112:115], a[208:211], v[212:215], 0
s_waitcnt lgkmcnt(12)
v_fma_f32 v118, v118, v83, v82
v_fma_f32 v119, v119, v83, v82
v_mfma_f32_16x16x32_bf16 a[112:115], a[212:215], v[228:231], a[112:115]
s_waitcnt lgkmcnt(10)
v_cvt_pk_bf16_f32 v216, v112, v113
v_cvt_pk_bf16_f32 v217, v114, v115
v_mfma_f32_16x16x32_bf16 a[160:163], a[216:219], v[212:215], 0
s_waitcnt lgkmcnt(8)
s_add_u32 m0, s54, 122880
v_cvt_pk_bf16_f32 v218, v116, v117
v_cvt_pk_bf16_f32 v219, v118, v119
v_mfma_f32_16x16x32_bf16 a[160:163], a[220:223], v[228:231], a[160:163]
s_waitcnt lgkmcnt(6)
buffer_load_dwordx4 v198, s[16:19], s57 offen lds
v_mfma_f32_16x16x32_bf16 a[128:131], a[224:227], v[212:215], 0
s_waitcnt lgkmcnt(4)
v_fma_f32 v120, v120, v83, v82
v_fma_f32 v121, v121, v83, v82
v_mfma_f32_16x16x32_bf16 a[128:131], a[228:231], v[228:231], a[128:131]
s_waitcnt lgkmcnt(2)
v_fma_f32 v122, v122, v83, v82
v_fma_f32 v123, v123, v83, v82
v_mfma_f32_16x16x32_bf16 a[176:179], a[232:235], v[212:215], 0
s_waitcnt lgkmcnt(0)
v_fma_f32 v124, v124, v83, v82
v_fma_f32 v125, v125, v83, v82
v_mfma_f32_16x16x32_bf16 a[176:179], a[236:239], v[228:231], a[176:179]
s_add_u32 m0, s54, 126976
s_add_u32 s57, s57, 98304
v_fma_f32 v126, v126, v83, v82
v_fma_f32 v127, v127, v83, v82
v_cvt_pk_bf16_f32 v232, v120, v121
v_cvt_pk_bf16_f32 v233, v122, v123
v_cvt_pk_bf16_f32 v234, v124, v125
v_cvt_pk_bf16_f32 v235, v126, v127
v_mfma_f32_16x16x32_bf16 a[100:103], a[192:195], v[216:219], 0
buffer_load_dwordx4 v198, s[12:15], s57 offen lds
v_mfma_f32_16x16x32_bf16 a[100:103], a[196:199], v[232:235], a[100:103]
v_fma_f32 v128, v128, v85, v84
v_fma_f32 v129, v129, v85, v84
v_mfma_f32_16x16x32_bf16 a[148:151], a[200:203], v[216:219], 0
v_fma_f32 v130, v130, v85, v84
v_fma_f32 v131, v131, v85, v84
v_mfma_f32_16x16x32_bf16 a[148:151], a[204:207], v[232:235], a[148:151]
v_fma_f32 v132, v132, v85, v84
v_fma_f32 v133, v133, v85, v84
v_mfma_f32_16x16x32_bf16 a[116:119], a[208:211], v[216:219], 0
s_add_u32 m0, s54, 131072
v_fma_f32 v134, v134, v85, v84
v_fma_f32 v135, v135, v85, v84
v_mfma_f32_16x16x32_bf16 a[116:119], a[212:215], v[232:235], a[116:119]
buffer_load_dwordx4 v198, s[16:19], s57 offen lds
v_mfma_f32_16x16x32_bf16 a[164:167], a[216:219], v[216:219], 0
v_cvt_pk_bf16_f32 v220, v128, v129
v_cvt_pk_bf16_f32 v221, v130, v131
v_mfma_f32_16x16x32_bf16 a[164:167], a[220:223], v[232:235], a[164:167]
v_cvt_pk_bf16_f32 v222, v132, v133
v_cvt_pk_bf16_f32 v223, v134, v135
v_mfma_f32_16x16x32_bf16 a[132:135], a[224:227], v[216:219], 0
s_add_u32 m0, s53, 0
v_fma_f32 v136, v136, v85, v84
v_fma_f32 v137, v137, v85, v84
v_mfma_f32_16x16x32_bf16 a[132:135], a[228:231], v[232:235], a[132:135]
s_add_u32 s56, s56, 393216
v_fma_f32 v138, v138, v85, v84
v_fma_f32 v139, v139, v85, v84
v_mfma_f32_16x16x32_bf16 a[180:183], a[232:235], v[216:219], 0
buffer_load_dwordx4 v195, s[8:11], s56 offen lds
v_mfma_f32_16x16x32_bf16 a[180:183], a[236:239], v[232:235], a[180:183]
v_fma_f32 v140, v140, v85, v84
v_fma_f32 v141, v141, v85, v84
v_fma_f32 v142, v142, v85, v84
v_fma_f32 v143, v143, v85, v84
v_cvt_pk_bf16_f32 v236, v136, v137
v_cvt_pk_bf16_f32 v237, v138, v139
v_cvt_pk_bf16_f32 v238, v140, v141
v_cvt_pk_bf16_f32 v239, v142, v143
v_mfma_f32_16x16x32_bf16 a[104:107], a[192:195], v[220:223], 0
v_fma_f32 v144, v144, v87, v86
v_fma_f32 v145, v145, v87, v86
v_mfma_f32_16x16x32_bf16 a[104:107], a[196:199], v[236:239], a[104:107]
v_fma_f32 v146, v146, v87, v86
v_fma_f32 v147, v147, v87, v86
v_mfma_f32_16x16x32_bf16 a[152:155], a[200:203], v[220:223], 0
v_fma_f32 v148, v148, v87, v86
v_fma_f32 v149, v149, v87, v86
v_mfma_f32_16x16x32_bf16 a[152:155], a[204:207], v[236:239], a[152:155]
buffer_load_dwordx4 v196, s[8:11], s56 offen offset:1024 lds
v_mfma_f32_16x16x32_bf16 a[120:123], a[208:211], v[220:223], 0
v_fma_f32 v150, v150, v87, v86
v_fma_f32 v151, v151, v87, v86
v_mfma_f32_16x16x32_bf16 a[120:123], a[212:215], v[236:239], a[120:123]
v_cvt_pk_bf16_f32 v224, v144, v145
v_cvt_pk_bf16_f32 v225, v146, v147
v_mfma_f32_16x16x32_bf16 a[168:171], a[216:219], v[220:223], 0
v_cvt_pk_bf16_f32 v226, v148, v149
v_cvt_pk_bf16_f32 v227, v150, v151
v_mfma_f32_16x16x32_bf16 a[168:171], a[220:223], v[236:239], a[168:171]
v_fma_f32 v152, v152, v87, v86
v_fma_f32 v153, v153, v87, v86
v_mfma_f32_16x16x32_bf16 a[136:139], a[224:227], v[220:223], 0
buffer_load_dwordx4 v197, s[8:11], s56 offen offset:2048 lds
v_mfma_f32_16x16x32_bf16 a[136:139], a[228:231], v[236:239], a[136:139]
v_fma_f32 v154, v154, v87, v86
v_fma_f32 v155, v155, v87, v86
v_mfma_f32_16x16x32_bf16 a[184:187], a[232:235], v[220:223], 0
s_add_u32 m0, s53, 12288
v_fma_f32 v156, v156, v87, v86
v_fma_f32 v157, v157, v87, v86
v_mfma_f32_16x16x32_bf16 a[184:187], a[236:239], v[236:239], a[184:187]
v_fma_f32 v158, v158, v87, v86
v_fma_f32 v159, v159, v87, v86
v_cvt_pk_bf16_f32 v240, v152, v153
v_cvt_pk_bf16_f32 v241, v154, v155
v_cvt_pk_bf16_f32 v242, v156, v157
v_cvt_pk_bf16_f32 v243, v158, v159
s_barrier
v_mfma_f32_16x16x32_bf16 a[108:111], a[192:195], v[224:227], 0
s_add_u32 s56, s56, 393216
ds_read_b64_tr_b16 a[64:65], v192 offset:24576
v_mfma_f32_16x16x32_bf16 a[108:111], a[196:199], v[240:243], a[108:111]
buffer_load_dwordx4 v195, s[8:11], s56 offen lds
v_mfma_f32_16x16x32_bf16 a[156:159], a[200:203], v[224:227], 0
ds_read_b64_tr_b16 a[66:67], v192 offset:30720
v_mfma_f32_16x16x32_bf16 a[156:159], a[204:207], v[240:243], a[156:159]
ds_read_b64_tr_b16 a[68:69], v192 offset:36864
ds_read_b64_tr_b16 a[70:71], v192 offset:43008
v_mfma_f32_16x16x32_bf16 a[124:127], a[208:211], v[224:227], 0
ds_read_b64_tr_b16 a[72:73], v192 offset:24584
v_mfma_f32_16x16x32_bf16 a[124:127], a[212:215], v[240:243], a[124:127]
ds_read_b64_tr_b16 a[74:75], v192 offset:30728
v_mfma_f32_16x16x32_bf16 a[172:175], a[216:219], v[224:227], 0
buffer_load_dwordx4 v196, s[8:11], s56 offen offset:1024 lds
v_mfma_f32_16x16x32_bf16 a[172:175], a[220:223], v[240:243], a[172:175]
ds_read_b64_tr_b16 a[76:77], v192 offset:36872
v_mfma_f32_16x16x32_bf16 a[140:143], a[224:227], v[224:227], 0
ds_read_b64_tr_b16 a[78:79], v192 offset:43016
v_mfma_f32_16x16x32_bf16 a[140:143], a[228:231], v[240:243], a[140:143]
ds_read_b64_tr_b16 a[80:81], v193 offset:24640
v_mfma_f32_16x16x32_bf16 a[188:191], a[232:235], v[224:227], 0
ds_read_b64_tr_b16 a[82:83], v193 offset:30784
v_mfma_f32_16x16x32_bf16 a[188:191], a[236:239], v[240:243], a[188:191]
s_waitcnt lgkmcnt(8)
buffer_load_dwordx4 v197, s[8:11], s56 offen offset:2048 lds
v_mfma_f32_16x16x32_bf16 v[0:3], a[64:67], v[212:215], 0
s_waitcnt lgkmcnt(6)
ds_read_b64_tr_b16 a[84:85], v193 offset:36928
v_mfma_f32_16x16x32_bf16 v[0:3], a[68:71], v[228:231], v[0:3]
ds_read_b64_tr_b16 a[86:87], v193 offset:43072
v_mfma_f32_16x16x32_bf16 v[4:7], a[68:71], v[232:235], 0
ds_read_b64_tr_b16 a[88:89], v193 offset:24648
v_mfma_f32_16x16x32_bf16 v[4:7], a[64:67], v[216:219], v[4:7]
ds_read_b64_tr_b16 a[90:91], v193 offset:30792
v_mfma_f32_16x16x32_bf16 v[8:11], a[64:67], v[220:223], 0
buffer_load_dword v248, v247, s[4:7], s86 offen offset:12 sc1
v_mfma_f32_16x16x32_bf16 v[8:11], a[68:71], v[236:239], v[8:11]
s_add_u32 m0, s54, 135168
ds_read_b64_tr_b16 a[92:93], v193 offset:36936
v_mfma_f32_16x16x32_bf16 v[12:15], a[68:71], v[240:243], 0
s_add_u32 s57, s57, 98304
ds_read_b64_tr_b16 a[94:95], v193 offset:43080
v_mfma_f32_16x16x32_bf16 v[12:15], a[64:67], v[224:227], v[12:15]
s_waitcnt lgkmcnt(10)
ds_read_b64_tr_b16 a[64:65], v192 offset:24704
v_mfma_f32_16x16x32_bf16 v[96:99], a[72:75], v[212:215], 0
s_waitcnt lgkmcnt(9)
ds_read_b64_tr_b16 a[66:67], v192 offset:30848
v_mfma_f32_16x16x32_bf16 v[96:99], a[76:79], v[228:231], v[96:99]
buffer_load_dwordx4 v198, s[12:15], s57 offen lds
v_mfma_f32_16x16x32_bf16 v[100:103], a[76:79], v[232:235], 0
ds_read_b64_tr_b16 a[68:69], v192 offset:36992
v_mfma_f32_16x16x32_bf16 v[100:103], a[72:75], v[216:219], v[100:103]
ds_read_b64_tr_b16 a[70:71], v192 offset:43136
v_mfma_f32_16x16x32_bf16 v[104:107], a[72:75], v[220:223], 0
v_mfma_f32_16x16x32_bf16 v[104:107], a[76:79], v[236:239], v[104:107]
s_add_u32 m0, s54, 139264
v_mfma_f32_16x16x32_bf16 v[108:111], a[76:79], v[240:243], 0
buffer_load_dwordx4 v198, s[16:19], s57 offen lds
v_mfma_f32_16x16x32_bf16 v[108:111], a[72:75], v[224:227], v[108:111]
s_waitcnt lgkmcnt(10)
ds_read_b64_tr_b16 a[72:73], v192 offset:24712
v_mfma_f32_16x16x32_bf16 v[28:31], a[80:83], v[224:227], 0
s_waitcnt lgkmcnt(9)
ds_read_b64_tr_b16 a[74:75], v192 offset:30856
v_mfma_f32_16x16x32_bf16 v[28:31], a[84:87], v[240:243], v[28:31]
s_add_u32 m0, s54, 143360
ds_read_b64_tr_b16 a[76:77], v192 offset:37000
v_mfma_f32_16x16x32_bf16 v[24:27], a[84:87], v[236:239], 0
s_add_u32 s57, s57, 98304
ds_read_b64_tr_b16 a[78:79], v192 offset:43144
v_mfma_f32_16x16x32_bf16 v[24:27], a[80:83], v[220:223], v[24:27]
buffer_load_dwordx4 v198, s[12:15], s57 offen lds
v_mfma_f32_16x16x32_bf16 v[20:23], a[80:83], v[216:219], 0
v_mfma_f32_16x16x32_bf16 v[20:23], a[84:87], v[232:235], v[20:23]
v_mfma_f32_16x16x32_bf16 v[16:19], a[84:87], v[228:231], 0
s_add_u32 m0, s54, 147456
ds_read_b64_tr_b16 a[84:85], v193 offset:37056
v_mfma_f32_16x16x32_bf16 v[16:19], a[80:83], v[212:215], v[16:19]
s_waitcnt lgkmcnt(11)
ds_read_b64_tr_b16 a[80:81], v193 offset:24768
v_mfma_f32_16x16x32_bf16 v[112:115], a[88:91], v[212:215], 0
s_waitcnt lgkmcnt(10)
buffer_load_dwordx4 v198, s[16:19], s57 offen lds
v_mfma_f32_16x16x32_bf16 v[112:115], a[92:95], v[228:231], v[112:115]
ds_read_b64_tr_b16 a[82:83], v193 offset:30912
v_mfma_f32_16x16x32_bf16 v[116:119], a[92:95], v[232:235], 0
ds_read_b64_tr_b16 a[86:87], v193 offset:43200
v_mfma_f32_16x16x32_bf16 v[116:119], a[88:91], v[216:219], v[116:119]
s_add_u32 m0, s54, 102400
v_mfma_f32_16x16x32_bf16 v[120:123], a[88:91], v[220:223], 0
s_add_u32 s57, s57, 98304
v_mfma_f32_16x16x32_bf16 v[120:123], a[92:95], v[236:239], v[120:123]
L_walk1_0:
s_cbranch_execz L_walk1_4
buffer_load_dwordx4 v198, s[12:15], s57 offen lds
v_mfma_f32_16x16x32_bf16 v[124:127], a[92:95], v[240:243], 0
ds_read_b64_tr_b16 a[92:93], v193 offset:37064
v_mfma_f32_16x16x32_bf16 v[124:127], a[88:91], v[224:227], v[124:127]
s_waitcnt lgkmcnt(11)
ds_read_b64_tr_b16 a[88:89], v193 offset:24776
v_mfma_f32_16x16x32_bf16 v[44:47], a[64:67], v[224:227], 0
s_waitcnt lgkmcnt(10)
ds_read_b64_tr_b16 a[90:91], v193 offset:30920
v_mfma_f32_16x16x32_bf16 v[44:47], a[68:71], v[240:243], v[44:47]
s_add_u32 m0, s54, 106496
ds_read_b64_tr_b16 a[94:95], v193 offset:43208
v_mfma_f32_16x16x32_bf16 v[40:43], a[68:71], v[236:239], 0
buffer_load_dwordx4 v198, s[16:19], s57 offen lds
v_mfma_f32_16x16x32_bf16 v[40:43], a[64:67], v[220:223], v[40:43]
v_mfma_f32_16x16x32_bf16 v[36:39], a[64:67], v[216:219], 0
v_mfma_f32_16x16x32_bf16 v[36:39], a[68:71], v[232:235], v[36:39]
s_add_u32 s58, s58, 4096
v_mfma_f32_16x16x32_bf16 v[32:35], a[68:71], v[228:231], 0
s_waitcnt vmcnt(6)
ds_read_b64_tr_b16 a[68:69], v192 offset:37120
v_cmp_ne_u32 vcc, v248, v251
v_mfma_f32_16x16x32_bf16 v[32:35], a[64:67], v[212:215], v[32:35]
s_cbranch_vccnz L_spin_x
L_back_x:
ds_read_b64_tr_b16 a[64:65], v192 offset:24832
s_waitcnt lgkmcnt(12)
v_mfma_f32_16x16x32_bf16 v[128:131], a[72:75], v[212:215], 0
s_waitcnt lgkmcnt(10)
buffer_load_dwordx4 a[32:35], v200, s[4:7], s58 offen sc1
v_mfma_f32_16x16x32_bf16 v[128:131], a[76:79], v[228:231], v[128:131]
ds_read_b64_tr_b16 a[66:67], v192 offset:30976
v_cmp_gt_u32 vcc, 8, v207
v_mfma_f32_16x16x32_bf16 v[132:135], a[76:79], v[232:235], 0
ds_read_b64_tr_b16 a[70:71], v192 offset:43264
v_mov_b32 v211, 1073741824
v_mfma_f32_16x16x32_bf16 v[132:135], a[72:75], v[216:219], v[132:135]
s_and_b32 s98, s2, 31
v_cndmask_b32 v252, v211, v250, vcc
v_mfma_f32_16x16x32_bf16 v[136:139], a[72:75], v[220:223], 0
buffer_load_dwordx4 a[36:39], v201, s[4:7], s58 offen sc1
v_mfma_f32_16x16x32_bf16 v[136:139], a[76:79], v[236:239], v[136:139]
s_or_b32 s98, s98, s48
s_lshr_b32 s99, s52, 1
v_mfma_f32_16x16x32_bf16 v[140:143], a[76:79], v[240:243], 0
ds_read_b64_tr_b16 a[76:77], v192 offset:37128
v_cmp_gt_u32 vcc, 16, v207
v_mfma_f32_16x16x32_bf16 v[140:143], a[72:75], v[224:227], v[140:143]
s_waitcnt lgkmcnt(10)
ds_read_b64_tr_b16 a[72:73], v192 offset:24840
v_and_b32 v211, 0x70, v250
v_mfma_f32_16x16x32_bf16 v[60:63], a[80:83], v[224:227], 0
s_waitcnt lgkmcnt(10)
ds_read_b64_tr_b16 a[74:75], v192 offset:30984
v_lshrrev_b32 v199, 3, v207
v_mfma_f32_16x16x32_bf16 v[60:63], a[84:87], v[240:243], v[60:63]
buffer_load_dwordx4 a[40:43], v202, s[4:7], s58 offen sc1
v_mfma_f32_16x16x32_bf16 v[56:59], a[84:87], v[236:239], 0
ds_read_b64_tr_b16 a[78:79], v192 offset:43272
v_lshl_add_u32 v211, v199, 13, v211
v_mfma_f32_16x16x32_bf16 v[56:59], a[80:83], v[220:223], v[56:59]
s_min_u32 s98, s98, 1
s_mul_i32 s99, s99, 12288
v_mfma_f32_16x16x32_bf16 v[52:55], a[80:83], v[216:219], 0
s_lshl_b32 s98, s98, 30
s_and_b32 s94, s52, 1
v_mfma_f32_16x16x32_bf16 v[52:55], a[84:87], v[232:235], v[52:55]
s_or_b32 s93, s93, s98
s_lshl_b32 s95, s94, 13
v_mfma_f32_16x16x32_bf16 v[48:51], a[84:87], v[228:231], 0
buffer_load_dwordx4 a[44:47], v203, s[4:7], s58 offen sc1
v_mfma_f32_16x16x32_bf16 v[48:51], a[80:83], v[212:215], v[48:51]
s_waitcnt lgkmcnt(9)
ds_read_b64_tr_b16 a[80:81], v193 offset:24896
v_mov_b32 v199, 1073741824
v_mfma_f32_16x16x32_bf16 v[144:147], a[88:91], v[212:215], 0
s_waitcnt lgkmcnt(9)
ds_read_b64_tr_b16 a[82:83], v193 offset:31040
v_cndmask_b32 v204, v199, v211, vcc
v_mfma_f32_16x16x32_bf16 v[144:147], a[92:95], v[228:231], v[144:147]
ds_read_b64_tr_b16 a[84:85], v193 offset:37184
v_lshrrev_b32 v205, 2, v207
v_mfma_f32_16x16x32_bf16 v[148:151], a[92:95], v[232:235], 0
s_add_u32 s58, s58, 4096
ds_read_b64_tr_b16 a[86:87], v193 offset:43328
v_lshlrev_b32 v205, 7, v205
v_mfma_f32_16x16x32_bf16 v[148:151], a[88:91], v[216:219], v[148:151]
buffer_load_dwordx4 a[48:51], v200, s[4:7], s58 offen sc1
v_mfma_f32_16x16x32_bf16 v[152:155], a[88:91], v[220:223], 0
s_mul_i32 s98, s51, 196608
s_lshl_b32 s94, s94, 9
v_mfma_f32_16x16x32_bf16 v[152:155], a[92:95], v[236:239], v[152:155]
s_add_u32 s98, s98, 4194304
s_lshl_b32 s69, s51, 21
v_mfma_f32_16x16x32_bf16 v[156:159], a[92:95], v[240:243], 0
ds_read_b64_tr_b16 a[92:93], v193 offset:37192
s_add_u32 s99, s99, s98
v_mfma_f32_16x16x32_bf16 v[156:159], a[88:91], v[224:227], v[156:159]
s_waitcnt lgkmcnt(10)
ds_read_b64_tr_b16 a[88:89], v193 offset:24904
s_add_u32 s62, s99, s95
v_mfma_f32_16x16x32_bf16 v[76:79], a[64:67], v[224:227], 0
s_waitcnt lgkmcnt(10)
buffer_load_dwordx4 a[52:55], v201, s[4:7], s58 offen sc1
v_mfma_f32_16x16x32_bf16 v[76:79], a[68:71], v[240:243], v[76:79]
ds_read_b64_tr_b16 a[90:91], v193 offset:31048
s_add_u32 s99, s99, s94
v_mfma_f32_16x16x32_bf16 v[72:75], a[68:71], v[236:239], 0
ds_read_b64_tr_b16 a[94:95], v193 offset:43336
s_lshr_b32 s94, s49, 1
v_mfma_f32_16x16x32_bf16 v[72:75], a[64:67], v[220:223], v[72:75]
s_add_u32 s63, s99, 4096
s_lshl_b32 s95, s94, 10
v_mfma_f32_16x16x32_bf16 v[68:71], a[64:67], v[216:219], 0
s_add_u32 s65, s98, s95
s_and_b32 s94, s48, 2
v_mfma_f32_16x16x32_bf16 v[68:71], a[68:71], v[232:235], v[68:71]
buffer_load_dwordx4 a[56:59], v202, s[4:7], s58 offen sc1
v_mfma_f32_16x16x32_bf16 v[64:67], a[68:71], v[228:231], 0
s_and_b32 s98, s48, 1
s_mov_b32 s22, 196608
v_mfma_f32_16x16x32_bf16 v[64:67], a[64:67], v[212:215], v[64:67]
s_waitcnt lgkmcnt(9)
s_lshl_b32 s98, s98, 12
s_mov_b32 s23, 0x20000
v_mfma_f32_16x16x32_bf16 v[160:163], a[72:75], v[212:215], 0
s_waitcnt lgkmcnt(8)
s_lshl_b32 s95, s94, 12
s_add_u32 s69, s69, s98
v_mfma_f32_16x16x32_bf16 v[160:163], a[76:79], v[228:231], v[160:163]
s_add_u32 s69, s69, 18612224
s_lshr_b32 s98, s49, 1
v_mfma_f32_16x16x32_bf16 v[164:167], a[76:79], v[232:235], 0
buffer_load_dwordx4 a[60:63], v203, s[4:7], s58 offen sc1
v_mfma_f32_16x16x32_bf16 v[164:167], a[72:75], v[216:219], v[164:167]
s_add_u32 s65, s65, s95
s_lshl2_add_u32 s98, s98, s50
v_mfma_f32_16x16x32_bf16 v[168:171], a[72:75], v[220:223], 0
s_mul_i32 s95, s94, 393216
s_lshl_b32 s98, s98, 14
v_mfma_f32_16x16x32_bf16 v[168:171], a[76:79], v[236:239], v[168:171]
s_add_u32 m0, s54, 110592
s_sub_u32 s66, s65, s95
s_add_u32 s78, s69, s98
v_mfma_f32_16x16x32_bf16 v[172:175], a[76:79], v[240:243], 0
s_add_u32 s57, s57, 98304
s_and_b32 s98, s49, 1
s_lshl_b32 s94, s51, 2
v_mfma_f32_16x16x32_bf16 v[172:175], a[72:75], v[224:227], v[172:175]
s_waitcnt lgkmcnt(6)
buffer_load_dwordx4 v198, s[12:15], s57 offen lds
v_mfma_f32_16x16x32_bf16 v[92:95], a[80:83], v[224:227], 0
s_waitcnt lgkmcnt(4)
s_lshl_b32 s99, s98, 13
s_lshr_b32 s95, s49, 1
v_mfma_f32_16x16x32_bf16 v[92:95], a[84:87], v[240:243], v[92:95]
s_add_u32 s68, s78, s99
s_lshl_b32 s98, s98, 7
v_mfma_f32_16x16x32_bf16 v[88:91], a[84:87], v[236:239], 0
s_add_u32 s78, s78, s98
s_lshl_b32 s99, s2, 25
v_mfma_f32_16x16x32_bf16 v[88:91], a[80:83], v[220:223], v[88:91]
s_waitcnt lgkmcnt(0)
s_barrier
v_mfma_f32_16x16x32_bf16 v[84:87], a[80:83], v[216:219], 0
s_lshr_b32 s98, s2, 6
ds_read_b64_tr_b16 a[64:65], v194 offset:16384
v_mfma_f32_16x16x32_bf16 v[84:87], a[84:87], v[232:235], v[84:87]
s_add_u32 m0, s54, 114688
s_lshl2_add_u32 s98, s52, s98
ds_read_b64_tr_b16 a[66:67], v194 offset:18432
v_mfma_f32_16x16x32_bf16 v[80:83], a[84:87], v[228:231], 0
buffer_load_dwordx4 v198, s[16:19], s57 offen lds
v_mfma_f32_16x16x32_bf16 v[80:83], a[80:83], v[212:215], v[80:83]
ds_read_b64_tr_b16 a[68:69], v194 offset:24576
ds_read_b64_tr_b16 a[70:71], v194 offset:26624
v_mfma_f32_16x16x32_bf16 v[176:179], a[88:91], v[212:215], 0
s_lshl2_add_u32 s98, s98, s48
ds_read_b64_tr_b16 a[72:73], v194 offset:20480
v_mfma_f32_16x16x32_bf16 v[176:179], a[92:95], v[228:231], v[176:179]
ds_read_b64_tr_b16 a[74:75], v194 offset:22528
v_add_u32 v214, 0, v207
v_mfma_f32_16x16x32_bf16 v[180:183], a[92:95], v[232:235], 0
s_add_u32 s3, s85, 786432
ds_read_b64_tr_b16 a[76:77], v194 offset:28672
v_mul_u32_u24 v215, 2731, v214
v_mfma_f32_16x16x32_bf16 v[180:183], a[88:91], v[216:219], v[180:183]
buffer_load_dword v206, v254, s[12:15], s3 offen
v_mfma_f32_16x16x32_bf16 v[184:187], a[88:91], v[220:223], 0
ds_read_b64_tr_b16 a[78:79], v194 offset:30720
v_lshrrev_b32 v215, 16, v215
v_mfma_f32_16x16x32_bf16 v[184:187], a[92:95], v[236:239], v[184:187]
ds_read_b64_tr_b16 a[80:81], v194 offset:16416
v_mul_u32_u24 v211, 24, v215
v_mfma_f32_16x16x32_bf16 v[188:191], a[92:95], v[240:243], 0
s_add_u32 s3, s85, 786432
ds_read_b64_tr_b16 a[82:83], v194 offset:18464
v_sub_u32 v199, v214, v211
v_mfma_f32_16x16x32_bf16 v[188:191], a[88:91], v[224:227], v[188:191]
s_waitcnt vmcnt(10) lgkmcnt(8)
ds_read_b64_tr_b16 a[84:85], v194 offset:24608
v_mul_u32_u24 v212, 384, v215
v_mfma_f32_16x16x32_bf16 a[96:99], a[64:67], a[32:35], a[96:99]
s_waitcnt vmcnt(6) lgkmcnt(7)
ds_read_b64_tr_b16 a[86:87], v194 offset:26656
v_lshrrev_b32 v213, 1, v215
v_mfma_f32_16x16x32_bf16 a[96:99], a[68:71], a[48:51], a[96:99]
s_waitcnt vmcnt(5)
buffer_load_dword v206, v254, s[16:19], s3 offen
v_mfma_f32_16x16x32_bf16 a[100:103], a[68:71], a[52:55], a[100:103]
ds_read_b64_tr_b16 a[88:89], v194 offset:20512
v_add_u32 v214, 64, v207
v_mfma_f32_16x16x32_bf16 a[100:103], a[64:67], a[36:39], a[100:103]
s_add_u32 m0, s53, 73728
ds_read_b64_tr_b16 a[90:91], v194 offset:22560
v_mul_u32_u24 v215, 2731, v214
v_mfma_f32_16x16x32_bf16 a[104:107], a[64:67], a[40:43], a[104:107]
s_waitcnt vmcnt(5)
ds_read_b64_tr_b16 a[92:93], v194 offset:28704
v_lshrrev_b32 v215, 16, v215
v_mfma_f32_16x16x32_bf16 a[104:107], a[68:71], a[56:59], a[104:107]
s_waitcnt vmcnt(4)
ds_read_b64_tr_b16 a[94:95], v194 offset:30752
v_mov_b32 v228, 0
v_mfma_f32_16x16x32_bf16 a[108:111], a[68:71], a[60:63], a[108:111]
s_add_u32 s56, s56, 393216
ds_read_b64_tr_b16 a[68:69], v194 offset:24640
v_mov_b32 v229, 0
v_mfma_f32_16x16x32_bf16 a[108:111], a[64:67], a[44:47], a[108:111]
s_waitcnt lgkmcnt(11)
buffer_load_dwordx4 v195, s[8:11], s56 offen lds
v_mfma_f32_16x16x32_bf16 a[144:147], a[72:75], a[32:35], a[144:147]
s_waitcnt lgkmcnt(9)
ds_read_b64_tr_b16 a[64:65], v194 offset:16448
v_mov_b32 v230, 0
v_mfma_f32_16x16x32_bf16 a[144:147], a[76:79], a[48:51], a[144:147]
ds_read_b64_tr_b16 a[66:67], v194 offset:18496
v_mov_b32 v231, 0
v_mfma_f32_16x16x32_bf16 a[148:151], a[76:79], a[52:55], a[148:151]
s_mul_i32 s98, s98, 2048
ds_read_b64_tr_b16 a[70:71], v194 offset:26688
v_mfma_f32_16x16x32_bf16 a[148:151], a[72:75], a[36:39], a[148:151]
s_and_b32 s99, s99, 1073741824
s_add_u32 s94, s94, s95
v_mfma_f32_16x16x32_bf16 a[152:155], a[72:75], a[40:43], a[152:155]
s_or_b32 s0, s98, s99
s_mul_i32 s94, s94, 20480
v_mfma_f32_16x16x32_bf16 a[152:155], a[76:79], a[56:59], a[152:155]
buffer_load_dwordx4 v196, s[8:11], s56 offen offset:1024 lds
v_mfma_f32_16x16x32_bf16 a[156:159], a[76:79], a[60:63], a[156:159]
s_lshl_b32 s98, s52, 5
ds_read_b64_tr_b16 a[76:77], v194 offset:28736
v_mfma_f32_16x16x32_bf16 a[156:159], a[72:75], a[44:47], a[156:159]
s_waitcnt lgkmcnt(11)
s_xor_b32 s1, s0, 1073741824
ds_read_b64_tr_b16 a[72:73], v194 offset:20544
v_mfma_f32_16x16x32_bf16 a[124:127], a[80:83], a[44:47], a[124:127]
s_waitcnt lgkmcnt(10)
s_add_u32 s98, s98, s51
ds_read_b64_tr_b16 a[74:75], v194 offset:22592
v_mfma_f32_16x16x32_bf16 a[124:127], a[84:87], a[60:63], a[124:127]
s_mul_i32 s0, s98, 2048
ds_read_b64_tr_b16 a[78:79], v194 offset:30784
v_mfma_f32_16x16x32_bf16 a[120:123], a[84:87], a[56:59], a[120:123]
s_mul_i32 s98, s52, 786432
s_and_b32 s99, s49, 1
v_mfma_f32_16x16x32_bf16 a[120:123], a[80:83], a[40:43], a[120:123]
buffer_load_dwordx4 v197, s[8:11], s56 offen offset:2048 lds
v_mfma_f32_16x16x32_bf16 a[116:119], a[80:83], a[36:39], a[116:119]
s_add_u32 s98, s98, 589824
s_mul_i32 s99, s99, 160
v_mfma_f32_16x16x32_bf16 a[116:119], a[84:87], a[52:55], a[116:119]
s_add_u32 m0, s53, 86016
s_add_u32 s20, s20, s98
s_addc_u32 s21, s21, 0
s_add_u32 s24, s24, s98
s_addc_u32 s25, s25, 0
v_mfma_f32_16x16x32_bf16 a[112:115], a[84:87], a[48:51], a[112:115]
s_add_u32 s56, s56, 393216
s_lshl_b32 s98, s48, 2
ds_read_b64_tr_b16 a[84:85], v192 offset:12288
v_mfma_f32_16x16x32_bf16 a[112:115], a[80:83], a[32:35], a[112:115]
s_waitcnt lgkmcnt(11)
ds_read_b64_tr_b16 a[80:81], v192 offset:0
v_add_u32 v211, s98, v213
v_mfma_f32_16x16x32_bf16 a[160:163], a[88:91], a[32:35], a[160:163]
s_waitcnt lgkmcnt(10)
ds_read_b64_tr_b16 a[82:83], v192 offset:6144
v_and_b32 v211, 7, v211
v_mfma_f32_16x16x32_bf16 a[160:163], a[92:95], a[48:51], a[160:163]
buffer_load_dwordx4 v195, s[8:11], s56 offen lds
v_mfma_f32_16x16x32_bf16 a[164:167], a[92:95], a[52:55], a[164:167]
ds_read_b64_tr_b16 a[86:87], v192 offset:18432
v_xor_b32 v211, v211, v199
v_mfma_f32_16x16x32_bf16 a[164:167], a[88:91], a[36:39], a[164:167]
v_lshl_add_u32 v236, v211, 4, v212
v_lshlrev_b32 v211, 1, v213
v_mfma_f32_16x16x32_bf16 a[168:171], a[88:91], a[40:43], a[168:171]
v_xor_b32 v211, v211, v199
v_lshl_add_u32 v239, v211, 4, v212
v_mfma_f32_16x16x32_bf16 a[168:171], a[92:95], a[56:59], a[168:171]
v_mul_u32_u24 v211, 24, v215
v_sub_u32 v199, v214, v211
v_mfma_f32_16x16x32_bf16 a[172:175], a[92:95], a[60:63], a[172:175]
ds_read_b64_tr_b16 a[92:93], v192 offset:12296
v_mul_u32_u24 v212, 384, v215
v_mfma_f32_16x16x32_bf16 a[172:175], a[88:91], a[44:47], a[172:175]
s_waitcnt lgkmcnt(10)
buffer_load_dwordx4 v196, s[8:11], s56 offen offset:1024 lds
v_mfma_f32_16x16x32_bf16 a[140:143], a[64:67], a[44:47], a[140:143]
s_waitcnt lgkmcnt(9)
ds_read_b64_tr_b16 a[88:89], v192 offset:8
v_lshrrev_b32 v213, 1, v215
v_mfma_f32_16x16x32_bf16 a[140:143], a[68:71], a[60:63], a[140:143]
ds_read_b64_tr_b16 a[90:91], v192 offset:6152
v_subrev_u32 v212, 1024, v212
v_mfma_f32_16x16x32_bf16 a[136:139], a[68:71], a[56:59], a[136:139]
ds_read_b64_tr_b16 a[94:95], v192 offset:18440
v_add_u32 v211, s98, v213
v_mfma_f32_16x16x32_bf16 a[136:139], a[64:67], a[40:43], a[136:139]
v_and_b32 v211, 7, v211
v_xor_b32 v211, v211, v199
v_mfma_f32_16x16x32_bf16 a[132:135], a[64:67], a[36:39], a[132:135]
v_lshl_add_u32 v237, v211, 4, v212
v_lshlrev_b32 v211, 1, v213
v_mfma_f32_16x16x32_bf16 a[132:135], a[68:71], a[52:55], a[132:135]
buffer_load_dwordx4 v197, s[8:11], s56 offen offset:2048 lds
v_mfma_f32_16x16x32_bf16 a[128:131], a[68:71], a[48:51], a[128:131]
ds_read_b64_tr_b16 a[68:69], v193 offset:12352
v_xor_b32 v211, v211, v199
v_mfma_f32_16x16x32_bf16 a[128:131], a[64:67], a[32:35], a[128:131]
s_waitcnt lgkmcnt(10)
ds_read_b64_tr_b16 a[64:65], v193 offset:64
v_lshl_add_u32 v240, v211, 4, v212
v_mfma_f32_16x16x32_bf16 a[176:179], a[72:75], a[32:35], a[176:179]
s_waitcnt lgkmcnt(10)
ds_read_b64_tr_b16 a[66:67], v193 offset:6208
v_add_u32 v214, 128, v207
v_mfma_f32_16x16x32_bf16 a[176:179], a[76:79], a[48:51], a[176:179]
ds_read_b64_tr_b16 a[70:71], v193 offset:18496
v_mul_u32_u24 v215, 2731, v214
v_mfma_f32_16x16x32_bf16 a[180:183], a[76:79], a[52:55], a[180:183]
s_add_u32 s58, s58, 4096
v_lshrrev_b32 v215, 16, v215
v_mul_u32_u24 v211, 24, v215
v_mfma_f32_16x16x32_bf16 a[180:183], a[72:75], a[36:39], a[180:183]
buffer_load_dwordx4 a[192:195], v200, s[4:7], s58 offen sc1
v_mfma_f32_16x16x32_bf16 a[184:187], a[72:75], a[40:43], a[184:187]
v_sub_u32 v199, v214, v211
v_lshrrev_b32 v213, 1, v215
v_mfma_f32_16x16x32_bf16 a[184:187], a[76:79], a[56:59], a[184:187]
s_add_u32 s66, s66, 393216
v_add_u32 v211, s98, v213
v_mfma_f32_16x16x32_bf16 a[188:191], a[76:79], a[60:63], a[188:191]
ds_read_b64_tr_b16 a[76:77], v193 offset:12360
v_mul_u32_u24 v212, 384, v215
v_mfma_f32_16x16x32_bf16 a[188:191], a[72:75], a[44:47], a[188:191]
s_waitcnt lgkmcnt(10)
ds_read_b64_tr_b16 a[72:73], v193 offset:72
v_subrev_u32 v212, 2048, v212
v_mfma_f32_16x16x32_bf16 v[0:3], a[80:83], a[32:35], v[0:3]
s_waitcnt lgkmcnt(10)
ds_read_b64_tr_b16 a[74:75], v193 offset:6216
v_and_b32 v211, 7, v211
v_mfma_f32_16x16x32_bf16 v[0:3], a[84:87], a[48:51], v[0:3]
buffer_load_dwordx4 a[196:199], v201, s[4:7], s58 offen sc1
v_mfma_f32_16x16x32_bf16 v[4:7], a[84:87], a[52:55], v[4:7]
ds_read_b64_tr_b16 a[78:79], v193 offset:18504
v_xor_b32 v211, v211, v199
v_mfma_f32_16x16x32_bf16 v[4:7], a[80:83], a[36:39], v[4:7]
s_lshr_b32 s98, s2, 3
s_mul_i32 s61, s48, 40960
v_mfma_f32_16x16x32_bf16 v[8:11], a[80:83], a[40:43], v[8:11]
s_lshl_b32 s98, s98, 2
v_lshl_add_u32 v238, v211, 4, v212
v_mfma_f32_16x16x32_bf16 v[8:11], a[84:87], a[56:59], v[8:11]
s_add_u32 s98, s98, s48
v_lshlrev_b32 v211, 1, v213
v_mfma_f32_16x16x32_bf16 v[12:15], a[84:87], a[60:63], v[12:15]
ds_read_b64_tr_b16 a[84:85], v192 offset:12416
v_xor_b32 v211, v211, v199
v_mfma_f32_16x16x32_bf16 v[12:15], a[80:83], a[44:47], v[12:15]
s_waitcnt lgkmcnt(10)
buffer_load_dwordx4 a[200:203], v202, s[4:7], s58 offen sc1
v_mfma_f32_16x16x32_bf16 v[96:99], a[88:91], a[32:35], v[96:99]
s_waitcnt lgkmcnt(9)
ds_read_b64_tr_b16 a[80:81], v192 offset:128
v_lshl_add_u32 v241, v211, 4, v212
v_mfma_f32_16x16x32_bf16 v[96:99], a[92:95], a[48:51], v[96:99]
ds_read_b64_tr_b16 a[82:83], v192 offset:6272
v_mul_u32_u24 v211, 384, v210
v_mfma_f32_16x16x32_bf16 v[100:103], a[92:95], a[52:55], v[100:103]
ds_read_b64_tr_b16 a[86:87], v192 offset:18560
v_lshl_add_u32 v212, v209, 3, v211
v_mfma_f32_16x16x32_bf16 v[100:103], a[88:91], a[36:39], v[100:103]
s_mul_i32 s98, s98, 7680
v_bfe_u32 v213, v210, 1, 2
v_mfma_f32_16x16x32_bf16 v[104:107], a[88:91], a[40:43], v[104:107]
s_mul_i32 s98, s50, 320
v_xor_b32 v214, 0, v213
v_mfma_f32_16x16x32_bf16 v[104:107], a[92:95], a[56:59], v[104:107]
buffer_load_dwordx4 a[204:207], v203, s[4:7], s58 offen sc1
v_mfma_f32_16x16x32_bf16 v[108:111], a[92:95], a[60:63], v[108:111]
ds_read_b64_tr_b16 a[92:93], v192 offset:12424
v_lshl_add_u32 v232, v214, 5, v212
v_mfma_f32_16x16x32_bf16 v[108:111], a[88:91], a[44:47], v[108:111]
s_waitcnt lgkmcnt(10)
ds_read_b64_tr_b16 a[88:89], v192 offset:136
v_xor_b32 v214, 1, v213
v_mfma_f32_16x16x32_bf16 v[28:31], a[64:67], a[44:47], v[28:31]
s_waitcnt lgkmcnt(10)
ds_read_b64_tr_b16 a[90:91], v192 offset:6280
v_lshl_add_u32 v233, v214, 5, v212
v_mfma_f32_16x16x32_bf16 v[28:31], a[68:71], a[60:63], v[28:31]
ds_read_b64_tr_b16 a[94:95], v192 offset:18568
v_xor_b32 v214, 2, v213
v_mfma_f32_16x16x32_bf16 v[24:27], a[68:71], a[56:59], v[24:27]
s_add_u32 s58, s58, 4096
s_add_u32 s99, s99, s98
v_lshl_add_u32 v234, v214, 5, v212
v_mfma_f32_16x16x32_bf16 v[24:27], a[64:67], a[40:43], v[24:27]
buffer_load_dwordx4 a[208:211], v200, s[4:7], s58 offen sc1
v_mfma_f32_16x16x32_bf16 v[20:23], a[64:67], a[36:39], v[20:23]
s_add_u32 s61, s61, s99
s_add_u32 s88, s94, s99
v_mfma_f32_16x16x32_bf16 v[20:23], a[68:71], a[52:55], v[20:23]
s_lshr_b32 s94, s49, 1
v_xor_b32 v214, 3, v213
v_mfma_f32_16x16x32_bf16 v[16:19], a[68:71], a[48:51], v[16:19]
ds_read_b64_tr_b16 a[68:69], v193 offset:12480
v_lshl_add_u32 v235, v214, 5, v212
v_mfma_f32_16x16x32_bf16 v[16:19], a[64:67], a[32:35], v[16:19]
s_waitcnt lgkmcnt(10)
ds_read_b64_tr_b16 a[64:65], v193 offset:192
v_and_b32 v211, 15, v207
v_mfma_f32_16x16x32_bf16 v[112:115], a[72:75], a[32:35], v[112:115]
s_waitcnt lgkmcnt(10)
ds_read_b64_tr_b16 a[66:67], v193 offset:6336
v_lshrrev_b32 v212, 1, v211
v_mfma_f32_16x16x32_bf16 v[112:115], a[76:79], a[48:51], v[112:115]
buffer_load_dwordx4 a[212:215], v201, s[4:7], s58 offen sc1
v_mfma_f32_16x16x32_bf16 v[116:119], a[76:79], a[52:55], v[116:119]
ds_read_b64_tr_b16 a[70:71], v193 offset:18624
v_mul_u32_u24 v213, 384, v211
v_mfma_f32_16x16x32_bf16 v[116:119], a[72:75], a[36:39], v[116:119]
s_lshl_b32 s82, s94, 16
s_mul_i32 s95, s94, 49152
v_mfma_f32_16x16x32_bf16 v[120:123], a[72:75], a[40:43], v[120:123]
s_add_u32 s65, s65, s95
s_add_u32 s66, s66, s95
v_mfma_f32_16x16x32_bf16 v[120:123], a[76:79], a[56:59], v[120:123]
s_mul_i32 s95, s95, 10
v_and_b32 v211, 8, v210
v_mfma_f32_16x16x32_bf16 v[124:127], a[76:79], a[60:63], v[124:127]
ds_read_b64_tr_b16 a[76:77], v193 offset:12488
v_add_u32 v211, v211, v210
v_mfma_f32_16x16x32_bf16 v[124:127], a[72:75], a[44:47], v[124:127]
s_waitcnt lgkmcnt(10)
buffer_load_dwordx4 a[216:219], v202, s[4:7], s58 offen sc1
v_mfma_f32_16x16x32_bf16 v[44:47], a[80:83], a[44:47], v[44:47]
s_waitcnt lgkmcnt(9)
ds_read_b64_tr_b16 a[72:73], v193 offset:200
v_mul_u32_u24 v211, 160, v211
v_mfma_f32_16x16x32_bf16 v[44:47], a[84:87], a[60:63], v[44:47]
ds_read_b64_tr_b16 a[74:75], v193 offset:6344
v_lshl_add_u32 v211, v209, 3, v211
v_mfma_f32_16x16x32_bf16 v[40:43], a[84:87], a[56:59], v[40:43]
ds_read_b64_tr_b16 a[78:79], v193 offset:18632
v_xor_b32 v212, v212, v208
v_mfma_f32_16x16x32_bf16 v[40:43], a[80:83], a[40:43], v[40:43]
s_mov_b32 s1, s0
s_add_u32 s61, s61, s95
v_mfma_f32_16x16x32_bf16 v[36:39], a[80:83], a[36:39], v[36:39]
s_mov_b32 s26, 196608
s_xor_b32 s95, s94, 1
v_mfma_f32_16x16x32_bf16 v[36:39], a[84:87], a[52:55], v[36:39]
buffer_load_dwordx4 a[220:223], v203, s[4:7], s58 offen sc1
v_mfma_f32_16x16x32_bf16 v[32:35], a[84:87], a[48:51], v[32:35]
ds_read_b64_tr_b16 a[84:85], v192 offset:12544
v_lshlrev_b32 v212, 4, v212
v_mfma_f32_16x16x32_bf16 v[32:35], a[80:83], a[32:35], v[32:35]
s_waitcnt lgkmcnt(10)
ds_read_b64_tr_b16 a[80:81], v192 offset:256
v_add_u32 v213, 49152, v213
v_mfma_f32_16x16x32_bf16 v[128:131], a[88:91], a[32:35], v[128:131]
s_waitcnt lgkmcnt(10)
ds_read_b64_tr_b16 a[82:83], v192 offset:6400
v_add_u32 v248, v213, v212
v_mfma_f32_16x16x32_bf16 v[128:131], a[92:95], a[48:51], v[128:131]
ds_read_b64_tr_b16 a[86:87], v192 offset:18688
v_xor_b32 v212, 64, v212
v_mfma_f32_16x16x32_bf16 v[132:135], a[92:95], a[52:55], v[132:135]
s_add_u32 s58, s58, 4096
s_mov_b32 s27, 0x20000
s_sub_u32 s95, s95, s94
v_mfma_f32_16x16x32_bf16 v[132:135], a[88:91], a[36:39], v[132:135]
buffer_load_dwordx4 a[224:227], v200, s[4:7], s58 offen sc1
v_mfma_f32_16x16x32_bf16 v[136:139], a[88:91], a[40:43], v[136:139]
s_mov_b32 s59, s53
s_mul_i32 s80, s95, 49152
v_mfma_f32_16x16x32_bf16 v[136:139], a[92:95], a[56:59], v[136:139]
s_mov_b32 s34, 1966080
s_mul_i32 s95, s95, 491520
v_mfma_f32_16x16x32_bf16 v[140:143], a[92:95], a[60:63], v[140:143]
ds_read_b64_tr_b16 a[92:93], v192 offset:12552
v_add_u32 v249, v213, v212
v_mfma_f32_16x16x32_bf16 v[140:143], a[88:91], a[44:47], v[140:143]
s_waitcnt lgkmcnt(10)
ds_read_b64_tr_b16 a[88:89], v192 offset:264
v_add_u32 v214, 0, v207
v_mfma_f32_16x16x32_bf16 v[60:63], a[64:67], a[44:47], v[60:63]
s_waitcnt lgkmcnt(10)
ds_read_b64_tr_b16 a[90:91], v192 offset:6408
v_mul_u32_u24 v215, 6554, v214
v_mfma_f32_16x16x32_bf16 v[60:63], a[68:71], a[60:63], v[60:63]
buffer_load_dwordx4 a[228:231], v201, s[4:7], s58 offen sc1
v_mfma_f32_16x16x32_bf16 v[56:59], a[68:71], a[56:59], v[56:59]
ds_read_b64_tr_b16 a[94:95], v192 offset:18696
v_xor_b32 v192, 32768, v192
v_mfma_f32_16x16x32_bf16 v[56:59], a[64:67], a[40:43], v[56:59]
s_mov_b32 s35, 0x20000
s_sub_u32 s44, s95, 327680
v_mfma_f32_16x16x32_bf16 v[52:55], a[64:67], a[36:39], v[52:55]
s_xor_b32 s95, s94, 2
s_and_b32 s47, s49, 1
v_mfma_f32_16x16x32_bf16 v[52:55], a[68:71], a[52:55], v[52:55]
s_sub_u32 s95, s95, s94
s_lshl_b32 s47, s47, 5
v_mfma_f32_16x16x32_bf16 v[48:51], a[68:71], a[48:51], v[48:51]
ds_read_b64_tr_b16 a[68:69], v193 offset:12608
v_lshrrev_b32 v215, 16, v215
v_mfma_f32_16x16x32_bf16 v[48:51], a[64:67], a[32:35], v[48:51]
s_waitcnt lgkmcnt(10)
buffer_load_dwordx4 a[232:235], v202, s[4:7], s58 offen sc1
v_mfma_f32_16x16x32_bf16 v[144:147], a[72:75], a[32:35], v[144:147]
s_waitcnt lgkmcnt(9)
ds_read_b64_tr_b16 a[64:65], v193 offset:320
v_lshl_add_u32 v212, v214, 4, s47
v_mfma_f32_16x16x32_bf16 v[144:147], a[76:79], a[48:51], v[144:147]
s_mul_i32 s81, s95, 49152
ds_read_b64_tr_b16 a[66:67], v193 offset:6464
v_mfma_f32_16x16x32_bf16 v[148:151], a[76:79], a[52:55], v[148:151]
s_mul_i32 s95, s95, 491520
ds_read_b64_tr_b16 a[70:71], v193 offset:18752
v_mfma_f32_16x16x32_bf16 v[148:151], a[72:75], a[36:39], v[148:151]
s_sub_u32 s45, s95, 327680
s_mul_i32 s94, s48, 20480
v_mfma_f32_16x16x32_bf16 v[152:155], a[72:75], a[40:43], v[152:155]
s_add_u32 s94, s94, s98
s_mul_i32 s95, s52, 245760
v_mfma_f32_16x16x32_bf16 v[152:155], a[76:79], a[56:59], v[152:155]
buffer_load_dwordx4 a[236:239], v203, s[4:7], s58 offen sc1
v_mfma_f32_16x16x32_bf16 v[156:159], a[76:79], a[60:63], v[156:159]
s_add_u32 s72, s95, s94
ds_read_b64_tr_b16 a[76:77], v193 offset:12616
v_mfma_f32_16x16x32_bf16 v[156:159], a[72:75], a[44:47], v[156:159]
s_waitcnt lgkmcnt(10)
s_and_b32 s95, s48, 2
ds_read_b64_tr_b16 a[72:73], v193 offset:328
v_mfma_f32_16x16x32_bf16 v[76:79], a[80:83], a[44:47], v[76:79]
s_waitcnt lgkmcnt(10)
s_xor_b32 s95, s95, 3
ds_read_b64_tr_b16 a[74:75], v193 offset:6472
v_mfma_f32_16x16x32_bf16 v[76:79], a[84:87], a[60:63], v[76:79]
ds_read_b64_tr_b16 a[78:79], v193 offset:18760
v_xor_b32 v193, 32768, v193
v_mfma_f32_16x16x32_bf16 v[72:75], a[84:87], a[56:59], v[72:75]
s_add_u32 s3, s84, 3145728
s_xor_b32 s95, s95, s52
s_mov_b32 s92, 0x3c319c33
v_mfma_f32_16x16x32_bf16 v[72:75], a[80:83], a[40:43], v[72:75]
buffer_load_dword v206, v253, s[8:11], s3 offen
v_mfma_f32_16x16x32_bf16 v[68:71], a[80:83], a[36:39], v[68:71]
s_mov_b32 s60, s53
s_mul_i32 s95, s95, 245760
v_mfma_f32_16x16x32_bf16 v[68:71], a[84:87], a[52:55], v[68:71]
s_mul_i32 s55, s48, 5120
s_add_u32 s74, s95, s94
v_mfma_f32_16x16x32_bf16 v[64:67], a[84:87], a[48:51], v[64:67]
s_add_u32 s58, s58, 4096
s_andn2_b32 s64, s69, 4194304
s_and_b32 s94, s48, 1
v_mfma_f32_16x16x32_bf16 v[64:67], a[80:83], a[32:35], v[64:67]
s_waitcnt lgkmcnt(9)
s_add_u32 s82, s82, s64
s_mul_i32 s94, s94, 20480
v_mfma_f32_16x16x32_bf16 v[160:163], a[88:91], a[32:35], v[160:163]
s_waitcnt lgkmcnt(8)
s_mov_b32 s30, 7864320
s_add_u32 s98, s98, s94
v_mfma_f32_16x16x32_bf16 v[160:163], a[92:95], a[48:51], v[160:163]
buffer_load_dwordx4 a[240:243], v200, s[4:7], s58 offen sc1
v_mfma_f32_16x16x32_bf16 v[164:167], a[92:95], a[52:55], v[164:167]
s_mov_b32 s31, 0x20000
s_lshr_b32 s94, s48, 1
v_mfma_f32_16x16x32_bf16 v[164:167], a[88:91], a[36:39], v[164:167]
s_mul_i32 s91, s49, 983040
s_add_u32 s95, s94, 1
v_mfma_f32_16x16x32_bf16 v[168:171], a[88:91], a[40:43], v[168:171]
s_sub_u32 s46, 4294311936, s44
s_xor_b32 s95, s95, s52
v_mfma_f32_16x16x32_bf16 v[168:171], a[92:95], a[56:59], v[168:171]
s_xor_b32 s67, s48, 2
s_mul_i32 s95, s95, 245760
v_mfma_f32_16x16x32_bf16 v[172:175], a[92:95], a[60:63], v[172:175]
s_lshl_b32 s67, s67, 10
s_add_u32 s73, s95, s98
v_mfma_f32_16x16x32_bf16 v[172:175], a[88:91], a[44:47], v[172:175]
s_waitcnt lgkmcnt(5)
buffer_load_dwordx4 a[244:247], v201, s[4:7], s58 offen sc1
v_mfma_f32_16x16x32_bf16 v[92:95], a[64:67], a[44:47], v[92:95]
s_waitcnt lgkmcnt(4)
s_mov_b32 s42, 2621440
s_add_u32 s95, s94, 2
v_mfma_f32_16x16x32_bf16 v[92:95], a[68:71], a[60:63], v[92:95]
s_xor_b32 s95, s95, s52
s_and_b32 s94, s48, 2
L_walk1_1:
s_cbranch_execz L_walk1_5
v_mfma_f32_16x16x32_bf16 v[88:91], a[68:71], a[56:59], v[88:91]
s_mul_i32 s95, s95, 245760
s_mul_i32 s94, s94, 5120
v_mfma_f32_16x16x32_bf16 v[88:91], a[64:67], a[40:43], v[88:91]
s_waitcnt vmcnt(15) lgkmcnt(0)
s_barrier
v_mfma_f32_16x16x32_bf16 v[84:87], a[64:67], a[36:39], v[84:87]
s_add_u32 s94, s94, 102400
ds_read_b64_tr_b16 a[80:81], v194 offset:32768
v_mfma_f32_16x16x32_bf16 v[84:87], a[68:71], a[52:55], v[84:87]
ds_read_b64_tr_b16 a[82:83], v194 offset:34816
v_add_u32 v247, s94, v211
v_mfma_f32_16x16x32_bf16 v[80:83], a[68:71], a[48:51], v[80:83]
buffer_load_dwordx4 a[248:251], v202, s[4:7], s58 offen sc1
v_mfma_f32_16x16x32_bf16 v[80:83], a[64:67], a[32:35], v[80:83]
ds_read_b64_tr_b16 a[84:85], v194 offset:40960
ds_read_b64_tr_b16 a[86:87], v194 offset:43008
v_mfma_f32_16x16x32_bf16 v[176:179], a[72:75], a[32:35], v[176:179]
ds_read_b64_tr_b16 a[88:89], v194 offset:36864
v_mul_u32_u24 v211, 160, v215
v_mfma_f32_16x16x32_bf16 v[176:179], a[76:79], a[48:51], v[176:179]
ds_read_b64_tr_b16 a[90:91], v194 offset:38912
v_sub_u32 v211, v212, v211
v_mfma_f32_16x16x32_bf16 v[180:183], a[76:79], a[52:55], v[180:183]
ds_read_b64_tr_b16 a[92:93], v194 offset:45056
v_subrev_u32 v212, 160, v211
v_mfma_f32_16x16x32_bf16 v[180:183], a[72:75], a[36:39], v[180:183]
buffer_load_dwordx4 a[252:255], v203, s[4:7], s58 offen sc1
v_mfma_f32_16x16x32_bf16 v[184:187], a[72:75], a[40:43], v[184:187]
ds_read_b64_tr_b16 a[94:95], v194 offset:47104
v_min_u32 v211, v211, v212
v_mfma_f32_16x16x32_bf16 v[184:187], a[76:79], a[56:59], v[184:187]
ds_read_b64_tr_b16 a[64:65], v194 offset:32800
v_mul_u32_u24 v212, 1280, v215
v_mfma_f32_16x16x32_bf16 v[188:191], a[76:79], a[60:63], v[188:191]
ds_read_b64_tr_b16 a[66:67], v194 offset:34848
v_add_u32 v242, v211, v212
v_mfma_f32_16x16x32_bf16 v[188:191], a[72:75], a[44:47], v[188:191]
s_waitcnt vmcnt(16) lgkmcnt(8)
buffer_store_dword v251, v252, s[4:7], s93 offen sc1
v_mfma_f32_16x16x32_bf16 a[96:99], a[80:83], a[192:195], a[96:99]
s_waitcnt vmcnt(13) lgkmcnt(6)
ds_read_b64_tr_b16 a[68:69], v194 offset:40992
v_lshrrev_b32 v215, 1, v215
v_mfma_f32_16x16x32_bf16 a[96:99], a[84:87], a[208:211], a[96:99]
s_waitcnt vmcnt(12)
ds_read_b64_tr_b16 a[70:71], v194 offset:43040
v_mul_u32_u24 v211, 20, v215
v_mfma_f32_16x16x32_bf16 a[100:103], a[84:87], a[212:215], a[100:103]
s_add_u32 m0, s54, 118784
s_add_u32 s57, s57, 98304
ds_read_b64_tr_b16 a[72:73], v194 offset:36896
v_sub_u32 v199, v214, v211
v_mfma_f32_16x16x32_bf16 a[100:103], a[80:83], a[196:199], a[100:103]
buffer_load_dwordx4 v198, s[12:15], s57 offen lds
v_mfma_f32_16x16x32_bf16 a[104:107], a[80:83], a[200:203], a[104:107]
s_waitcnt vmcnt(12)
ds_read_b64_tr_b16 a[74:75], v194 offset:38944
v_bfe_u32 v211, v215, 2, 1
v_mfma_f32_16x16x32_bf16 a[104:107], a[84:87], a[216:219], a[104:107]
s_waitcnt vmcnt(11)
ds_read_b64_tr_b16 a[76:77], v194 offset:45088
v_lshlrev_b32 v211, 1, v211
v_mfma_f32_16x16x32_bf16 a[108:111], a[84:87], a[220:223], a[108:111]
s_add_u32 m0, s54, 122880
ds_read_b64_tr_b16 a[78:79], v194 offset:47136
v_xor_b32 v211, v211, v199
v_mfma_f32_16x16x32_bf16 a[108:111], a[80:83], a[204:207], a[108:111]
s_waitcnt lgkmcnt(10)
buffer_load_dwordx4 v198, s[16:19], s57 offen lds
v_mfma_f32_16x16x32_bf16 a[144:147], a[88:91], a[192:195], a[144:147]
s_waitcnt lgkmcnt(8)
ds_read_b64_tr_b16 a[80:81], v194 offset:32832
v_add_u32 v214, 64, v207
v_mfma_f32_16x16x32_bf16 a[144:147], a[92:95], a[208:211], a[144:147]
s_add_u32 s75, s95, s98
ds_read_b64_tr_b16 a[82:83], v194 offset:34880
v_mfma_f32_16x16x32_bf16 a[148:151], a[92:95], a[212:215], a[148:151]
s_and_b32 s98, s49, 1
ds_read_b64_tr_b16 a[84:85], v194 offset:41024
v_mfma_f32_16x16x32_bf16 a[148:151], a[88:91], a[196:199], a[148:151]
s_add_u32 m0, s54, 126976
s_xor_b32 s98, s98, 1
ds_read_b64_tr_b16 a[86:87], v194 offset:43072
v_mfma_f32_16x16x32_bf16 a[152:155], a[88:91], a[200:203], a[152:155]
s_add_u32 s57, s57, 98304
s_mov_b32 s43, 0x20000
s_mul_i32 s98, s98, 10
v_mfma_f32_16x16x32_bf16 a[152:155], a[92:95], a[216:219], a[152:155]
buffer_load_dwordx4 v198, s[12:15], s57 offen lds
v_mfma_f32_16x16x32_bf16 a[156:159], a[92:95], a[220:223], a[156:159]
ds_read_b64_tr_b16 a[92:93], v194 offset:45120
v_add_u32 v211, s98, v211
v_mfma_f32_16x16x32_bf16 a[156:159], a[88:91], a[204:207], a[156:159]
s_waitcnt lgkmcnt(11)
ds_read_b64_tr_b16 a[88:89], v194 offset:36928
v_subrev_u32 v212, 20, v211
v_mfma_f32_16x16x32_bf16 a[124:127], a[64:67], a[204:207], a[124:127]
s_waitcnt lgkmcnt(10)
ds_read_b64_tr_b16 a[90:91], v194 offset:38976
v_min_u32 v211, v211, v212
v_mfma_f32_16x16x32_bf16 a[124:127], a[68:71], a[220:223], a[124:127]
ds_read_b64_tr_b16 a[94:95], v194 offset:47168
v_cmp_gt_u32 vcc, 10, v211
v_mfma_f32_16x16x32_bf16 a[120:123], a[68:71], a[216:219], a[120:123]
s_add_u32 m0, s54, 131072
v_subrev_u32 v212, 18, v211
v_subrev_u32 v213, 8, v211
v_mfma_f32_16x16x32_bf16 a[120:123], a[64:67], a[200:203], a[120:123]
buffer_load_dwordx4 v198, s[16:19], s57 offen lds
v_mfma_f32_16x16x32_bf16 a[116:119], a[64:67], a[196:199], a[116:119]
v_min_u32 v212, v212, v213
v_add_u32 v212, 10, v212
v_mfma_f32_16x16x32_bf16 a[116:119], a[68:71], a[212:215], a[116:119]
s_add_u32 m0, s53, 24576
v_cndmask_b32 v211, v212, v211, vcc
v_mul_u32_u24 v212, 1280, v215
v_mfma_f32_16x16x32_bf16 a[112:115], a[68:71], a[208:211], a[112:115]
s_add_u32 s56, s56, 393216
ds_read_b64_tr_b16 a[68:69], v194 offset:8192
v_lshl_add_u32 v222, v211, 4, v212
v_mfma_f32_16x16x32_bf16 a[112:115], a[64:67], a[192:195], a[112:115]
s_waitcnt lgkmcnt(11)
ds_read_b64_tr_b16 a[64:65], v194 offset:0
v_mul_u32_u24 v215, 6554, v214
v_mfma_f32_16x16x32_bf16 a[160:163], a[72:75], a[192:195], a[160:163]
s_waitcnt lgkmcnt(10)
ds_read_b64_tr_b16 a[66:67], v194 offset:2048
v_lshrrev_b32 v215, 16, v215
v_mfma_f32_16x16x32_bf16 a[160:163], a[76:79], a[208:211], a[160:163]
buffer_load_dwordx4 v195, s[8:11], s56 offen lds
v_mfma_f32_16x16x32_bf16 a[164:167], a[76:79], a[212:215], a[164:167]
ds_read_b64_tr_b16 a[70:71], v194 offset:10240
v_mul_u32_u24 v211, 160, v215
v_mfma_f32_16x16x32_bf16 a[164:167], a[72:75], a[196:199], a[164:167]
v_lshl_add_u32 v212, v214, 4, s47
v_sub_u32 v211, v212, v211
v_mfma_f32_16x16x32_bf16 a[168:171], a[72:75], a[200:203], a[168:171]
v_subrev_u32 v212, 160, v211
v_min_u32 v211, v211, v212
v_mfma_f32_16x16x32_bf16 a[168:171], a[76:79], a[216:219], a[168:171]
v_mul_u32_u24 v212, 1280, v215
v_add_u32 v243, v211, v212
v_mfma_f32_16x16x32_bf16 a[172:175], a[76:79], a[220:223], a[172:175]
ds_read_b64_tr_b16 a[76:77], v194 offset:12288
v_lshrrev_b32 v215, 1, v215
v_mfma_f32_16x16x32_bf16 a[172:175], a[72:75], a[204:207], a[172:175]
s_waitcnt lgkmcnt(11)
buffer_load_dwordx4 v196, s[8:11], s56 offen offset:1024 lds
v_mfma_f32_16x16x32_bf16 a[140:143], a[80:83], a[204:207], a[140:143]
s_waitcnt lgkmcnt(9)
ds_read_b64_tr_b16 a[72:73], v194 offset:4096
v_mul_u32_u24 v211, 20, v215
v_mfma_f32_16x16x32_bf16 a[140:143], a[84:87], a[220:223], a[140:143]
ds_read_b64_tr_b16 a[74:75], v194 offset:6144
v_sub_u32 v199, v214, v211
v_mfma_f32_16x16x32_bf16 a[136:139], a[84:87], a[216:219], a[136:139]
ds_read_b64_tr_b16 a[78:79], v194 offset:14336
v_bfe_u32 v211, v215, 2, 1
v_mfma_f32_16x16x32_bf16 a[136:139], a[80:83], a[200:203], a[136:139]
v_lshlrev_b32 v211, 1, v211
v_xor_b32 v211, v211, v199
v_mfma_f32_16x16x32_bf16 a[132:135], a[80:83], a[196:199], a[132:135]
v_add_u32 v211, s98, v211
v_subrev_u32 v212, 20, v211
v_mfma_f32_16x16x32_bf16 a[132:135], a[84:87], a[212:215], a[132:135]
buffer_load_dwordx4 v197, s[8:11], s56 offen offset:2048 lds
v_mfma_f32_16x16x32_bf16 a[128:131], a[84:87], a[208:211], a[128:131]
ds_read_b64_tr_b16 a[84:85], v194 offset:8224
v_min_u32 v211, v211, v212
v_mfma_f32_16x16x32_bf16 a[128:131], a[80:83], a[192:195], a[128:131]
s_waitcnt lgkmcnt(10)
ds_read_b64_tr_b16 a[80:81], v194 offset:32
v_cmp_gt_u32 vcc, 10, v211
v_mfma_f32_16x16x32_bf16 a[176:179], a[88:91], a[192:195], a[176:179]
s_waitcnt lgkmcnt(10)
ds_read_b64_tr_b16 a[82:83], v194 offset:2080
v_subrev_u32 v212, 18, v211
v_mfma_f32_16x16x32_bf16 a[176:179], a[92:95], a[208:211], a[176:179]
s_add_u32 m0, s53, 36864
ds_read_b64_tr_b16 a[86:87], v194 offset:10272
v_subrev_u32 v213, 8, v211
v_mfma_f32_16x16x32_bf16 a[180:183], a[92:95], a[212:215], a[180:183]
s_add_u32 s56, s56, 393216
v_min_u32 v212, v212, v213
v_add_u32 v212, 10, v212
v_mfma_f32_16x16x32_bf16 a[180:183], a[88:91], a[196:199], a[180:183]
buffer_load_dwordx4 v195, s[8:11], s56 offen lds
v_mfma_f32_16x16x32_bf16 a[184:187], a[88:91], a[200:203], a[184:187]
v_cndmask_b32 v211, v212, v211, vcc
v_mul_u32_u24 v212, 1280, v215
v_mfma_f32_16x16x32_bf16 a[184:187], a[92:95], a[216:219], a[184:187]
v_lshl_add_u32 v223, v211, 4, v212
v_add_u32 v214, 128, v207
v_mfma_f32_16x16x32_bf16 a[188:191], a[92:95], a[220:223], a[188:191]
ds_read_b64_tr_b16 a[92:93], v194 offset:12320
v_mul_u32_u24 v215, 6554, v214
v_mfma_f32_16x16x32_bf16 a[188:191], a[88:91], a[204:207], a[188:191]
s_waitcnt vmcnt(17) lgkmcnt(10)
ds_read_b64_tr_b16 a[88:89], v194 offset:4128
v_lshrrev_b32 v215, 16, v215
v_mfma_f32_16x16x32_bf16 a[96:99], a[64:67], a[224:227], a[96:99]
s_waitcnt vmcnt(12) lgkmcnt(10)
ds_read_b64_tr_b16 a[90:91], v194 offset:6176
v_mul_u32_u24 v211, 160, v215
v_mfma_f32_16x16x32_bf16 a[96:99], a[68:71], a[240:243], a[96:99]
s_waitcnt vmcnt(11)
buffer_load_dwordx4 v196, s[8:11], s56 offen offset:1024 lds
v_mfma_f32_16x16x32_bf16 a[100:103], a[68:71], a[244:247], a[100:103]
ds_read_b64_tr_b16 a[94:95], v194 offset:14368
v_lshl_add_u32 v212, v214, 4, s47
v_mfma_f32_16x16x32_bf16 a[100:103], a[64:67], a[228:231], a[100:103]
v_sub_u32 v211, v212, v211
v_subrev_u32 v212, 160, v211
v_mfma_f32_16x16x32_bf16 a[104:107], a[64:67], a[232:235], a[104:107]
s_waitcnt vmcnt(11)
v_min_u32 v211, v211, v212
v_mul_u32_u24 v212, 1280, v215
v_mfma_f32_16x16x32_bf16 a[104:107], a[68:71], a[248:251], a[104:107]
s_waitcnt vmcnt(10)
v_add_u32 v244, v211, v212
v_lshrrev_b32 v215, 1, v215
v_mfma_f32_16x16x32_bf16 a[108:111], a[68:71], a[252:255], a[108:111]
ds_read_b64_tr_b16 a[68:69], v194 offset:8256
v_mul_u32_u24 v211, 20, v215
v_mfma_f32_16x16x32_bf16 a[108:111], a[64:67], a[236:239], a[108:111]
s_waitcnt lgkmcnt(10)
buffer_load_dwordx4 v197, s[8:11], s56 offen offset:2048 lds
v_mfma_f32_16x16x32_bf16 a[144:147], a[72:75], a[224:227], a[144:147]
s_waitcnt lgkmcnt(9)
ds_read_b64_tr_b16 a[64:65], v194 offset:64
v_sub_u32 v199, v214, v211
v_mfma_f32_16x16x32_bf16 a[144:147], a[76:79], a[240:243], a[144:147]
ds_read_b64_tr_b16 a[66:67], v194 offset:2112
v_bfe_u32 v211, v215, 2, 1
v_mfma_f32_16x16x32_bf16 a[148:151], a[76:79], a[244:247], a[148:151]
ds_read_b64_tr_b16 a[70:71], v194 offset:10304
v_lshlrev_b32 v211, 1, v211
v_mfma_f32_16x16x32_bf16 a[148:151], a[72:75], a[228:231], a[148:151]
v_xor_b32 v211, v211, v199
v_add_u32 v211, s98, v211
v_mfma_f32_16x16x32_bf16 a[152:155], a[72:75], a[232:235], a[152:155]
s_add_u32 s58, s58, 4096
v_subrev_u32 v212, 20, v211
v_min_u32 v211, v211, v212
v_mfma_f32_16x16x32_bf16 a[152:155], a[76:79], a[248:251], a[152:155]
buffer_load_dwordx4 a[0:3], v200, s[4:7], s58 offen sc1
v_mfma_f32_16x16x32_bf16 a[156:159], a[76:79], a[252:255], a[156:159]
ds_read_b64_tr_b16 a[76:77], v194 offset:12352
v_cmp_gt_u32 vcc, 10, v211
v_mfma_f32_16x16x32_bf16 a[156:159], a[72:75], a[236:239], a[156:159]
s_waitcnt lgkmcnt(10)
ds_read_b64_tr_b16 a[72:73], v194 offset:4160
v_subrev_u32 v212, 18, v211
v_mfma_f32_16x16x32_bf16 a[124:127], a[80:83], a[236:239], a[124:127]
s_waitcnt lgkmcnt(10)
ds_read_b64_tr_b16 a[74:75], v194 offset:6208
v_subrev_u32 v213, 8, v211
v_mfma_f32_16x16x32_bf16 a[124:127], a[84:87], a[252:255], a[124:127]
ds_read_b64_tr_b16 a[78:79], v194 offset:14400
v_min_u32 v212, v212, v213
v_mfma_f32_16x16x32_bf16 a[120:123], a[84:87], a[248:251], a[120:123]
v_add_u32 v212, 10, v212
v_cndmask_b32 v211, v212, v211, vcc
v_mfma_f32_16x16x32_bf16 a[120:123], a[80:83], a[232:235], a[120:123]
buffer_load_dwordx4 a[4:7], v201, s[4:7], s58 offen sc1
v_mfma_f32_16x16x32_bf16 a[116:119], a[80:83], a[228:231], a[116:119]
v_mul_u32_u24 v212, 1280, v215
v_lshl_add_u32 v224, v211, 4, v212
v_mfma_f32_16x16x32_bf16 a[116:119], a[84:87], a[244:247], a[116:119]
v_add_u32 v214, 192, v207
v_mul_u32_u24 v215, 6554, v214
v_mfma_f32_16x16x32_bf16 a[112:115], a[84:87], a[240:243], a[112:115]
ds_read_b64_tr_b16 a[84:85], v192 offset:53248
v_lshrrev_b32 v215, 16, v215
v_mfma_f32_16x16x32_bf16 a[112:115], a[80:83], a[224:227], a[112:115]
s_waitcnt lgkmcnt(10)
ds_read_b64_tr_b16 a[80:81], v192 offset:40960
v_mul_u32_u24 v211, 160, v215
v_mfma_f32_16x16x32_bf16 a[160:163], a[88:91], a[224:227], a[160:163]
s_waitcnt lgkmcnt(10)
ds_read_b64_tr_b16 a[82:83], v192 offset:47104
v_lshl_add_u32 v212, v214, 4, s47
v_mfma_f32_16x16x32_bf16 a[160:163], a[92:95], a[240:243], a[160:163]
buffer_load_dwordx4 a[8:11], v202, s[4:7], s58 offen sc1
v_mfma_f32_16x16x32_bf16 a[164:167], a[92:95], a[244:247], a[164:167]
ds_read_b64_tr_b16 a[86:87], v192 offset:59392
v_sub_u32 v211, v212, v211
v_mfma_f32_16x16x32_bf16 a[164:167], a[88:91], a[228:231], a[164:167]
v_subrev_u32 v212, 160, v211
v_min_u32 v211, v211, v212
v_mfma_f32_16x16x32_bf16 a[168:171], a[88:91], a[232:235], a[168:171]
v_mul_u32_u24 v212, 1280, v215
v_add_u32 v245, v211, v212
v_mfma_f32_16x16x32_bf16 a[168:171], a[92:95], a[248:251], a[168:171]
v_lshrrev_b32 v215, 1, v215
v_mul_u32_u24 v211, 20, v215
v_mfma_f32_16x16x32_bf16 a[172:175], a[92:95], a[252:255], a[172:175]
ds_read_b64_tr_b16 a[92:93], v192 offset:53256
v_sub_u32 v199, v214, v211
v_mfma_f32_16x16x32_bf16 a[172:175], a[88:91], a[236:239], a[172:175]
s_waitcnt lgkmcnt(10)
buffer_load_dwordx4 a[12:15], v203, s[4:7], s58 offen sc1
v_mfma_f32_16x16x32_bf16 a[140:143], a[64:67], a[236:239], a[140:143]
s_waitcnt lgkmcnt(9)
ds_read_b64_tr_b16 a[88:89], v192 offset:40968
v_bfe_u32 v211, v215, 2, 1
v_mfma_f32_16x16x32_bf16 a[140:143], a[68:71], a[252:255], a[140:143]
ds_read_b64_tr_b16 a[90:91], v192 offset:47112
v_lshlrev_b32 v211, 1, v211
v_mfma_f32_16x16x32_bf16 a[136:139], a[68:71], a[248:251], a[136:139]
ds_read_b64_tr_b16 a[94:95], v192 offset:59400
v_xor_b32 v211, v211, v199
v_mfma_f32_16x16x32_bf16 a[136:139], a[64:67], a[232:235], a[136:139]
v_add_u32 v211, s98, v211
v_subrev_u32 v212, 20, v211
v_mfma_f32_16x16x32_bf16 a[132:135], a[64:67], a[228:231], a[132:135]
s_add_u32 s3, s84, 4718592
v_min_u32 v211, v211, v212
v_cmp_gt_u32 vcc, 10, v211
v_mfma_f32_16x16x32_bf16 a[132:135], a[68:71], a[244:247], a[132:135]
buffer_load_dword v206, v253, s[8:11], s3 offen
v_mfma_f32_16x16x32_bf16 a[128:131], a[68:71], a[240:243], a[128:131]
ds_read_b64_tr_b16 a[68:69], v193 offset:53312
v_subrev_u32 v212, 18, v211
v_mfma_f32_16x16x32_bf16 a[128:131], a[64:67], a[224:227], a[128:131]
s_waitcnt lgkmcnt(10)
ds_read_b64_tr_b16 a[64:65], v193 offset:41024
v_subrev_u32 v213, 8, v211
v_mfma_f32_16x16x32_bf16 a[176:179], a[72:75], a[224:227], a[176:179]
s_waitcnt lgkmcnt(10)
ds_read_b64_tr_b16 a[66:67], v193 offset:47168
v_min_u32 v212, v212, v213
v_mfma_f32_16x16x32_bf16 a[176:179], a[76:79], a[240:243], a[176:179]
ds_read_b64_tr_b16 a[70:71], v193 offset:59456
v_add_u32 v212, 10, v212
v_mfma_f32_16x16x32_bf16 a[180:183], a[76:79], a[244:247], a[180:183]
s_add_u32 s58, s58, 4096
v_cndmask_b32 v211, v212, v211, vcc
v_mul_u32_u24 v212, 1280, v215
v_mfma_f32_16x16x32_bf16 a[180:183], a[72:75], a[228:231], a[180:183]
buffer_load_dwordx4 a[16:19], v200, s[4:7], s58 offen sc1
v_mfma_f32_16x16x32_bf16 a[184:187], a[72:75], a[232:235], a[184:187]
v_lshl_add_u32 v225, v211, 4, v212
v_add_u32 v214, 256, v207
v_mfma_f32_16x16x32_bf16 a[184:187], a[76:79], a[248:251], a[184:187]
v_mul_u32_u24 v215, 6554, v214
v_lshrrev_b32 v215, 16, v215
v_mfma_f32_16x16x32_bf16 a[188:191], a[76:79], a[252:255], a[188:191]
ds_read_b64_tr_b16 a[76:77], v193 offset:53320
v_mul_u32_u24 v211, 160, v215
v_mfma_f32_16x16x32_bf16 a[188:191], a[72:75], a[236:239], a[188:191]
s_waitcnt lgkmcnt(10)
ds_read_b64_tr_b16 a[72:73], v193 offset:41032
v_lshl_add_u32 v212, v214, 4, s47
v_mfma_f32_16x16x32_bf16 v[0:3], a[80:83], a[192:195], v[0:3]
s_waitcnt lgkmcnt(10)
ds_read_b64_tr_b16 a[74:75], v193 offset:47176
v_sub_u32 v211, v212, v211
v_mfma_f32_16x16x32_bf16 v[0:3], a[84:87], a[208:211], v[0:3]
buffer_load_dwordx4 a[20:23], v201, s[4:7], s58 offen sc1
v_mfma_f32_16x16x32_bf16 v[4:7], a[84:87], a[212:215], v[4:7]
ds_read_b64_tr_b16 a[78:79], v193 offset:59464
v_subrev_u32 v212, 160, v211
v_mfma_f32_16x16x32_bf16 v[4:7], a[80:83], a[196:199], v[4:7]
v_min_u32 v211, v211, v212
v_mul_u32_u24 v212, 1280, v215
v_mfma_f32_16x16x32_bf16 v[8:11], a[80:83], a[200:203], v[8:11]
v_add_u32 v246, v211, v212
v_lshrrev_b32 v215, 1, v215
v_mfma_f32_16x16x32_bf16 v[8:11], a[84:87], a[216:219], v[8:11]
v_mul_u32_u24 v211, 20, v215
v_sub_u32 v199, v214, v211
v_mfma_f32_16x16x32_bf16 v[12:15], a[84:87], a[220:223], v[12:15]
ds_read_b64_tr_b16 a[84:85], v192 offset:53376
v_bfe_u32 v211, v215, 2, 1
v_mfma_f32_16x16x32_bf16 v[12:15], a[80:83], a[204:207], v[12:15]
s_waitcnt lgkmcnt(10)
buffer_load_dwordx4 a[24:27], v202, s[4:7], s58 offen sc1
v_mfma_f32_16x16x32_bf16 v[96:99], a[88:91], a[192:195], v[96:99]
s_waitcnt lgkmcnt(9)
ds_read_b64_tr_b16 a[80:81], v192 offset:41088
v_lshlrev_b32 v211, 1, v211
v_mfma_f32_16x16x32_bf16 v[96:99], a[92:95], a[208:211], v[96:99]
ds_read_b64_tr_b16 a[82:83], v192 offset:47232
v_xor_b32 v211, v211, v199
v_mfma_f32_16x16x32_bf16 v[100:103], a[92:95], a[212:215], v[100:103]
ds_read_b64_tr_b16 a[86:87], v192 offset:59520
v_add_u32 v211, s98, v211
v_mfma_f32_16x16x32_bf16 v[100:103], a[88:91], a[196:199], v[100:103]
v_subrev_u32 v212, 20, v211
v_min_u32 v211, v211, v212
v_mfma_f32_16x16x32_bf16 v[104:107], a[88:91], a[200:203], v[104:107]
v_subrev_u32 v212, 18, v211
v_cmp_gt_u32 vcc, 10, v211
v_mfma_f32_16x16x32_bf16 v[104:107], a[92:95], a[216:219], v[104:107]
buffer_load_dwordx4 a[28:31], v203, s[4:7], s58 offen sc1
v_mfma_f32_16x16x32_bf16 v[108:111], a[92:95], a[220:223], v[108:111]
ds_read_b64_tr_b16 a[92:93], v192 offset:53384
v_subrev_u32 v213, 8, v211
v_mfma_f32_16x16x32_bf16 v[108:111], a[88:91], a[204:207], v[108:111]
s_waitcnt lgkmcnt(10)
ds_read_b64_tr_b16 a[88:89], v192 offset:41096
v_min_u32 v212, v212, v213
v_mfma_f32_16x16x32_bf16 v[28:31], a[64:67], a[204:207], v[28:31]
s_waitcnt lgkmcnt(10)
ds_read_b64_tr_b16 a[90:91], v192 offset:47240
v_add_u32 v212, 10, v212
v_mfma_f32_16x16x32_bf16 v[28:31], a[68:71], a[220:223], v[28:31]
s_add_u32 m0, s53, 0
ds_read_b64_tr_b16 a[94:95], v192 offset:59528
v_cndmask_b32 v211, v212, v211, vcc
v_mfma_f32_16x16x32_bf16 v[24:27], a[68:71], a[216:219], v[24:27]
s_add_u32 s56, s56, 393216
v_mul_u32_u24 v212, 1280, v215
v_lshl_add_u32 v226, v211, 4, v212
v_mfma_f32_16x16x32_bf16 v[24:27], a[64:67], a[200:203], v[24:27]
buffer_load_dwordx4 v195, s[8:11], s56 offen lds
v_mfma_f32_16x16x32_bf16 v[20:23], a[64:67], a[196:199], v[20:23]
v_mul_u32_u24 v211, 320, v210
v_lshl_add_u32 v211, v209, 3, v211
v_mfma_f32_16x16x32_bf16 v[20:23], a[68:71], a[212:215], v[20:23]
v_bfe_u32 v213, v210, 2, 1
v_lshlrev_b32 v213, 5, v213
v_mfma_f32_16x16x32_bf16 v[16:19], a[68:71], a[208:211], v[16:19]
ds_read_b64_tr_b16 a[68:69], v193 offset:53440
v_add_u32 v216, v211, v213
v_mfma_f32_16x16x32_bf16 v[16:19], a[64:67], a[192:195], v[16:19]
s_waitcnt lgkmcnt(10)
ds_read_b64_tr_b16 a[64:65], v193 offset:41152
v_sub_u32 v217, v211, v213
v_mfma_f32_16x16x32_bf16 v[112:115], a[72:75], a[192:195], v[112:115]
s_waitcnt lgkmcnt(10)
ds_read_b64_tr_b16 a[66:67], v193 offset:47296
v_add_u32 v218, 61440, v216
v_mfma_f32_16x16x32_bf16 v[112:115], a[76:79], a[208:211], v[112:115]
buffer_load_dwordx4 v196, s[8:11], s56 offen offset:1024 lds
v_mfma_f32_16x16x32_bf16 v[116:119], a[76:79], a[212:215], v[116:119]
ds_read_b64_tr_b16 a[70:71], v193 offset:59584
v_add_u32 v219, 61440, v217
v_mfma_f32_16x16x32_bf16 v[116:119], a[72:75], a[196:199], v[116:119]
v_add_u32 v220, 122880, v216
v_add_u32 v211, 98304, v250
v_mfma_f32_16x16x32_bf16 v[120:123], a[72:75], a[200:203], v[120:123]
ds_write_b128 v211, v[216:219] offset:0
v_add_u32 v221, 122880, v217
v_mfma_f32_16x16x32_bf16 v[120:123], a[76:79], a[216:219], v[120:123]
v_subrev_u32 v223, 1024, v223
v_subrev_u32 v224, 2048, v224
v_mfma_f32_16x16x32_bf16 v[124:127], a[76:79], a[220:223], v[124:127]
ds_read_b64_tr_b16 a[76:77], v193 offset:53448
v_subrev_u32 v225, 3072, v225
v_mfma_f32_16x16x32_bf16 v[124:127], a[72:75], a[204:207], v[124:127]
s_waitcnt lgkmcnt(11)
buffer_load_dwordx4 v197, s[8:11], s56 offen offset:2048 lds
v_mfma_f32_16x16x32_bf16 v[44:47], a[80:83], a[204:207], v[44:47]
s_waitcnt lgkmcnt(10)
ds_read_b64_tr_b16 a[72:73], v193 offset:41160
v_and_b32 v219, 512, v250
v_mfma_f32_16x16x32_bf16 v[44:47], a[84:87], a[220:223], v[44:47]
ds_read_b64_tr_b16 a[74:75], v193 offset:47304
v_mul_u32_u24 v219, 3, v219
v_mfma_f32_16x16x32_bf16 v[40:43], a[84:87], a[216:219], v[40:43]
ds_read_b64_tr_b16 a[78:79], v193 offset:59592
v_xor_b32 v219, v219, v200
v_mfma_f32_16x16x32_bf16 v[40:43], a[80:83], a[200:203], v[40:43]
s_add_u32 m0, s53, 12288
ds_write_b128 v211, v[220:223] offset:1024
v_subrev_u32 v243, 1024, v243
v_mfma_f32_16x16x32_bf16 v[36:39], a[80:83], a[196:199], v[36:39]
s_add_u32 s56, s56, 393216
ds_write_b128 v211, v[224:227] offset:2048
v_subrev_u32 v244, 2048, v244
v_mfma_f32_16x16x32_bf16 v[36:39], a[84:87], a[212:215], v[36:39]
buffer_load_dwordx4 v195, s[8:11], s56 offen lds
v_mfma_f32_16x16x32_bf16 v[32:35], a[84:87], a[208:211], v[32:35]
ds_read_b64_tr_b16 a[84:85], v192 offset:53504
v_subrev_u32 v245, 3072, v245
v_mfma_f32_16x16x32_bf16 v[32:35], a[80:83], a[192:195], v[32:35]
s_waitcnt lgkmcnt(13)
ds_read_b64_tr_b16 a[80:81], v192 offset:41216
v_mfma_f32_16x16x32_bf16 v[128:131], a[88:91], a[192:195], v[128:131]
s_waitcnt lgkmcnt(13)
ds_read_b64_tr_b16 a[82:83], v192 offset:47360
v_mfma_f32_16x16x32_bf16 v[128:131], a[92:95], a[208:211], v[128:131]
ds_read_b64_tr_b16 a[86:87], v192 offset:59648
v_mfma_f32_16x16x32_bf16 v[132:135], a[92:95], a[212:215], v[132:135]
v_mfma_f32_16x16x32_bf16 v[132:135], a[88:91], a[196:199], v[132:135]
buffer_load_dwordx4 v196, s[8:11], s56 offen offset:1024 lds
v_mfma_f32_16x16x32_bf16 v[136:139], a[88:91], a[200:203], v[136:139]
v_mfma_f32_16x16x32_bf16 v[136:139], a[92:95], a[216:219], v[136:139]
v_mfma_f32_16x16x32_bf16 v[140:143], a[92:95], a[220:223], v[140:143]
ds_read_b64_tr_b16 a[92:93], v192 offset:53512
v_mfma_f32_16x16x32_bf16 v[140:143], a[88:91], a[204:207], v[140:143]
s_waitcnt lgkmcnt(13)
ds_read_b64_tr_b16 a[88:89], v192 offset:41224
v_mfma_f32_16x16x32_bf16 v[60:63], a[64:67], a[204:207], v[60:63]
s_waitcnt lgkmcnt(13)
ds_read_b64_tr_b16 a[90:91], v192 offset:47368
v_mfma_f32_16x16x32_bf16 v[60:63], a[68:71], a[220:223], v[60:63]
buffer_load_dwordx4 v197, s[8:11], s56 offen offset:2048 lds
v_mfma_f32_16x16x32_bf16 v[56:59], a[68:71], a[216:219], v[56:59]
ds_read_b64_tr_b16 a[94:95], v192 offset:59656
v_xor_b32 v192, 32768, v192
v_mfma_f32_16x16x32_bf16 v[56:59], a[64:67], a[200:203], v[56:59]
v_mfma_f32_16x16x32_bf16 v[52:55], a[64:67], a[196:199], v[52:55]
v_mfma_f32_16x16x32_bf16 v[52:55], a[68:71], a[212:215], v[52:55]
v_mfma_f32_16x16x32_bf16 v[48:51], a[68:71], a[208:211], v[48:51]
s_add_u32 s58, s58, 4096
ds_read_b64_tr_b16 a[68:69], v193 offset:53568
v_mfma_f32_16x16x32_bf16 v[48:51], a[64:67], a[192:195], v[48:51]
s_waitcnt lgkmcnt(12)
buffer_load_dwordx4 a[32:35], v200, s[4:7], s58 offen sc1
v_mfma_f32_16x16x32_bf16 v[144:147], a[72:75], a[192:195], v[144:147]
s_waitcnt lgkmcnt(11)
ds_read_b64_tr_b16 a[64:65], v193 offset:41280
v_mfma_f32_16x16x32_bf16 v[144:147], a[76:79], a[208:211], v[144:147]
ds_read_b64_tr_b16 a[66:67], v193 offset:47424
v_mfma_f32_16x16x32_bf16 v[148:151], a[76:79], a[212:215], v[148:151]
ds_read_b64_tr_b16 a[70:71], v193 offset:59712
v_mfma_f32_16x16x32_bf16 v[148:151], a[72:75], a[196:199], v[148:151]
v_mfma_f32_16x16x32_bf16 v[152:155], a[72:75], a[200:203], v[152:155]
v_mfma_f32_16x16x32_bf16 v[152:155], a[76:79], a[216:219], v[152:155]
buffer_load_dwordx4 a[36:39], v201, s[4:7], s58 offen sc1
v_mfma_f32_16x16x32_bf16 v[156:159], a[76:79], a[220:223], v[156:159]
ds_read_b64_tr_b16 a[76:77], v193 offset:53576
v_mfma_f32_16x16x32_bf16 v[156:159], a[72:75], a[204:207], v[156:159]
s_waitcnt lgkmcnt(10)
ds_read_b64_tr_b16 a[72:73], v193 offset:41288
v_mfma_f32_16x16x32_bf16 v[76:79], a[80:83], a[204:207], v[76:79]
s_waitcnt lgkmcnt(10)
ds_read_b64_tr_b16 a[74:75], v193 offset:47432
v_mfma_f32_16x16x32_bf16 v[76:79], a[84:87], a[220:223], v[76:79]
ds_read_b64_tr_b16 a[78:79], v193 offset:59720
v_xor_b32 v193, 32768, v193
v_mfma_f32_16x16x32_bf16 v[72:75], a[84:87], a[216:219], v[72:75]
v_mfma_f32_16x16x32_bf16 v[72:75], a[80:83], a[200:203], v[72:75]
buffer_load_dwordx4 a[40:43], v202, s[4:7], s58 offen sc1
v_mfma_f32_16x16x32_bf16 v[68:71], a[80:83], a[196:199], v[68:71]
v_mfma_f32_16x16x32_bf16 v[68:71], a[84:87], a[212:215], v[68:71]
v_mfma_f32_16x16x32_bf16 v[64:67], a[84:87], a[208:211], v[64:67]
v_mfma_f32_16x16x32_bf16 v[64:67], a[80:83], a[192:195], v[64:67]
s_waitcnt lgkmcnt(9)
v_mfma_f32_16x16x32_bf16 v[160:163], a[88:91], a[192:195], v[160:163]
s_waitcnt lgkmcnt(8)
v_mfma_f32_16x16x32_bf16 v[160:163], a[92:95], a[208:211], v[160:163]
buffer_load_dwordx4 a[44:47], v203, s[4:7], s58 offen sc1
v_mfma_f32_16x16x32_bf16 v[164:167], a[92:95], a[212:215], v[164:167]
v_mfma_f32_16x16x32_bf16 v[164:167], a[88:91], a[196:199], v[164:167]
v_mfma_f32_16x16x32_bf16 v[168:171], a[88:91], a[200:203], v[168:171]
v_mfma_f32_16x16x32_bf16 v[168:171], a[92:95], a[216:219], v[168:171]
v_mfma_f32_16x16x32_bf16 v[172:175], a[92:95], a[220:223], v[172:175]
s_add_u32 s58, s58, 4096
v_mfma_f32_16x16x32_bf16 v[172:175], a[88:91], a[204:207], v[172:175]
s_waitcnt lgkmcnt(5)
buffer_load_dwordx4 a[48:51], v200, s[4:7], s58 offen sc1
v_mfma_f32_16x16x32_bf16 v[92:95], a[64:67], a[204:207], v[92:95]
s_waitcnt lgkmcnt(4)
v_mfma_f32_16x16x32_bf16 v[92:95], a[68:71], a[220:223], v[92:95]
v_mfma_f32_16x16x32_bf16 v[88:91], a[68:71], a[216:219], v[88:91]
v_mfma_f32_16x16x32_bf16 v[88:91], a[64:67], a[200:203], v[88:91]
s_waitcnt vmcnt(20) lgkmcnt(0)
s_barrier
v_mfma_f32_16x16x32_bf16 v[84:87], a[64:67], a[196:199], v[84:87]
ds_read_b64_tr_b16 a[80:81], v194 offset:16384
v_mfma_f32_16x16x32_bf16 v[84:87], a[68:71], a[212:215], v[84:87]
ds_read_b64_tr_b16 a[82:83], v194 offset:18432
v_mfma_f32_16x16x32_bf16 v[80:83], a[68:71], a[208:211], v[80:83]
buffer_load_dwordx4 a[52:55], v201, s[4:7], s58 offen sc1
v_mfma_f32_16x16x32_bf16 v[80:83], a[64:67], a[192:195], v[80:83]
ds_read_b64_tr_b16 a[84:85], v194 offset:24576
ds_read_b64_tr_b16 a[86:87], v194 offset:26624
v_mfma_f32_16x16x32_bf16 v[176:179], a[72:75], a[192:195], v[176:179]
ds_read_b64_tr_b16 a[88:89], v194 offset:20480
v_mfma_f32_16x16x32_bf16 v[176:179], a[76:79], a[208:211], v[176:179]
ds_read_b64_tr_b16 a[90:91], v194 offset:22528
v_mfma_f32_16x16x32_bf16 v[180:183], a[76:79], a[212:215], v[180:183]
ds_read_b64_tr_b16 a[92:93], v194 offset:28672
v_mfma_f32_16x16x32_bf16 v[180:183], a[72:75], a[196:199], v[180:183]
buffer_load_dwordx4 a[56:59], v202, s[4:7], s58 offen sc1
v_mfma_f32_16x16x32_bf16 v[184:187], a[72:75], a[200:203], v[184:187]
ds_read_b64_tr_b16 a[94:95], v194 offset:30720
v_mfma_f32_16x16x32_bf16 v[184:187], a[76:79], a[216:219], v[184:187]
L_walk1_2:
s_cbranch_execz L_walk1_6
ds_read_b64_tr_b16 a[64:65], v194 offset:16416
v_mfma_f32_16x16x32_bf16 v[188:191], a[76:79], a[220:223], v[188:191]
ds_read_b64_tr_b16 a[66:67], v194 offset:18464
v_mfma_f32_16x16x32_bf16 v[188:191], a[72:75], a[204:207], v[188:191]
s_waitcnt vmcnt(21) lgkmcnt(8)
ds_read_b64_tr_b16 a[68:69], v194 offset:24608
v_mfma_f32_16x16x32_bf16 a[96:99], a[80:83], a[0:3], a[96:99]
s_waitcnt vmcnt(16) lgkmcnt(7)
s_and_b32 s94, s48, 1
ds_read_b64_tr_b16 a[70:71], v194 offset:26656
v_mfma_f32_16x16x32_bf16 a[96:99], a[84:87], a[16:19], a[96:99]
s_waitcnt vmcnt(15)
buffer_load_dwordx4 a[60:63], v203, s[4:7], s58 offen sc1
v_mfma_f32_16x16x32_bf16 a[100:103], a[84:87], a[20:23], a[100:103]
s_lshl_b32 s94, s94, 6
ds_read_b64_tr_b16 a[72:73], v194 offset:20512
v_mfma_f32_16x16x32_bf16 a[100:103], a[80:83], a[4:7], a[100:103]
ds_read_b64_tr_b16 a[74:75], v194 offset:22560
v_mfma_f32_16x16x32_bf16 a[104:107], a[80:83], a[8:11], a[104:107]
s_waitcnt vmcnt(15)
ds_read_b64_tr_b16 a[76:77], v194 offset:28704
v_mfma_f32_16x16x32_bf16 a[104:107], a[84:87], a[24:27], a[104:107]
s_waitcnt vmcnt(14)
buffer_store_dwordx4 v[202:205], v204, s[4:7], s78 offen offset:2048 sc1
v_mfma_f32_16x16x32_bf16 a[108:111], a[84:87], a[28:31], a[108:111]
s_add_u32 s57, s57, 98304
s_add_u32 s78, s78, s94
ds_read_b64_tr_b16 a[78:79], v194 offset:30752
v_mfma_f32_16x16x32_bf16 a[108:111], a[80:83], a[12:15], a[108:111]
s_waitcnt lgkmcnt(10)
s_and_b32 s94, s50, 1
ds_read_b64_tr_b16 a[80:81], v194 offset:16448
v_mfma_f32_16x16x32_bf16 a[144:147], a[88:91], a[0:3], a[144:147]
s_waitcnt lgkmcnt(9)
s_add_u32 m0, s54, 135168
s_mul_i32 s94, s94, 8256
ds_read_b64_tr_b16 a[82:83], v194 offset:18496
v_mfma_f32_16x16x32_bf16 a[144:147], a[92:95], a[16:19], a[144:147]
buffer_load_dwordx4 v198, s[12:15], s57 offen lds
v_mfma_f32_16x16x32_bf16 a[148:151], a[92:95], a[20:23], a[148:151]
s_xor_b32 s78, s78, s94
ds_read_b64_tr_b16 a[84:85], v194 offset:24640
v_mfma_f32_16x16x32_bf16 a[148:151], a[88:91], a[4:7], a[148:151]
s_xor_b32 s94, s78, 8256
ds_read_b64_tr_b16 a[86:87], v194 offset:26688
v_mfma_f32_16x16x32_bf16 a[152:155], a[88:91], a[8:11], a[152:155]
s_add_u32 m0, s54, 139264
v_mfma_f32_16x16x32_bf16 a[152:155], a[92:95], a[24:27], a[152:155]
buffer_load_dwordx4 v198, s[16:19], s57 offen lds
v_mfma_f32_16x16x32_bf16 a[156:159], a[92:95], a[28:31], a[156:159]
ds_read_b64_tr_b16 a[92:93], v194 offset:28736
v_mfma_f32_16x16x32_bf16 a[156:159], a[88:91], a[12:15], a[156:159]
s_waitcnt lgkmcnt(11)
ds_read_b64_tr_b16 a[88:89], v194 offset:20544
v_mfma_f32_16x16x32_bf16 a[124:127], a[64:67], a[12:15], a[124:127]
s_waitcnt lgkmcnt(10)
ds_read_b64_tr_b16 a[90:91], v194 offset:22592
v_mfma_f32_16x16x32_bf16 a[124:127], a[68:71], a[28:31], a[124:127]
s_add_u32 m0, s54, 143360
ds_read_b64_tr_b16 a[94:95], v194 offset:30784
v_mfma_f32_16x16x32_bf16 a[120:123], a[68:71], a[24:27], a[120:123]
s_add_u32 s57, s57, 98304
v_mfma_f32_16x16x32_bf16 a[120:123], a[64:67], a[8:11], a[120:123]
buffer_load_dwordx4 v198, s[12:15], s57 offen lds
v_mfma_f32_16x16x32_bf16 a[116:119], a[64:67], a[4:7], a[116:119]
v_mfma_f32_16x16x32_bf16 a[116:119], a[68:71], a[20:23], a[116:119]
v_mfma_f32_16x16x32_bf16 a[112:115], a[68:71], a[16:19], a[112:115]
s_add_u32 m0, s54, 147456
ds_read_b64_tr_b16 a[68:69], v192 offset:36864
v_mfma_f32_16x16x32_bf16 a[112:115], a[64:67], a[0:3], a[112:115]
s_waitcnt lgkmcnt(11)
ds_read_b64_tr_b16 a[64:65], v192 offset:24576
v_mfma_f32_16x16x32_bf16 a[160:163], a[72:75], a[0:3], a[160:163]
s_waitcnt lgkmcnt(10)
ds_read_b64_tr_b16 a[66:67], v192 offset:30720
v_mfma_f32_16x16x32_bf16 a[160:163], a[76:79], a[16:19], a[160:163]
buffer_load_dwordx4 v198, s[16:19], s57 offen lds
v_mfma_f32_16x16x32_bf16 a[164:167], a[76:79], a[20:23], a[164:167]
ds_read_b64_tr_b16 a[70:71], v192 offset:43008
v_mfma_f32_16x16x32_bf16 a[164:167], a[72:75], a[4:7], a[164:167]
v_mfma_f32_16x16x32_bf16 a[168:171], a[72:75], a[8:11], a[168:171]
v_mfma_f32_16x16x32_bf16 a[168:171], a[76:79], a[24:27], a[168:171]
s_add_u32 m0, s54, 102400
v_mfma_f32_16x16x32_bf16 a[172:175], a[76:79], a[28:31], a[172:175]
s_add_u32 s57, s57, 98304
ds_read_b64_tr_b16 a[76:77], v192 offset:36872
v_mfma_f32_16x16x32_bf16 a[172:175], a[72:75], a[12:15], a[172:175]
s_waitcnt lgkmcnt(11)
buffer_load_dwordx4 v198, s[12:15], s57 offen lds
v_mfma_f32_16x16x32_bf16 a[140:143], a[80:83], a[12:15], a[140:143]
s_waitcnt lgkmcnt(9)
ds_read_b64_tr_b16 a[72:73], v192 offset:24584
v_mfma_f32_16x16x32_bf16 a[140:143], a[84:87], a[28:31], a[140:143]
ds_read_b64_tr_b16 a[74:75], v192 offset:30728
v_mfma_f32_16x16x32_bf16 a[136:139], a[84:87], a[24:27], a[136:139]
ds_read_b64_tr_b16 a[78:79], v192 offset:43016
v_mfma_f32_16x16x32_bf16 a[136:139], a[80:83], a[8:11], a[136:139]
v_mfma_f32_16x16x32_bf16 a[132:135], a[80:83], a[4:7], a[132:135]
s_add_u32 m0, s54, 106496
v_mfma_f32_16x16x32_bf16 a[132:135], a[84:87], a[20:23], a[132:135]
buffer_load_dwordx4 v198, s[16:19], s57 offen lds
v_mfma_f32_16x16x32_bf16 a[128:131], a[84:87], a[16:19], a[128:131]
ds_read_b64_tr_b16 a[84:85], v193 offset:36928
v_mfma_f32_16x16x32_bf16 a[128:131], a[80:83], a[0:3], a[128:131]
s_waitcnt lgkmcnt(10)
ds_read_b64_tr_b16 a[80:81], v193 offset:24640
v_mfma_f32_16x16x32_bf16 a[176:179], a[88:91], a[0:3], a[176:179]
s_waitcnt lgkmcnt(10)
ds_read_b64_tr_b16 a[82:83], v193 offset:30784
v_mfma_f32_16x16x32_bf16 a[176:179], a[92:95], a[16:19], a[176:179]
s_add_u32 m0, s54, 110592
ds_read_b64_tr_b16 a[86:87], v193 offset:43072
v_mfma_f32_16x16x32_bf16 a[180:183], a[92:95], a[20:23], a[180:183]
s_add_u32 s57, s57, 98304
v_mfma_f32_16x16x32_bf16 a[180:183], a[88:91], a[4:7], a[180:183]
buffer_load_dwordx4 v198, s[12:15], s57 offen lds
v_mfma_f32_16x16x32_bf16 a[184:187], a[88:91], a[8:11], a[184:187]
v_mfma_f32_16x16x32_bf16 a[184:187], a[92:95], a[24:27], a[184:187]
v_mfma_f32_16x16x32_bf16 a[188:191], a[92:95], a[28:31], a[188:191]
s_add_u32 m0, s54, 114688
ds_read_b64_tr_b16 a[92:93], v193 offset:36936
v_mfma_f32_16x16x32_bf16 a[188:191], a[88:91], a[12:15], a[188:191]
s_waitcnt lgkmcnt(10)
ds_read_b64_tr_b16 a[88:89], v193 offset:24648
v_mfma_f32_16x16x32_bf16 v[0:3], a[64:67], a[224:227], v[0:3]
s_waitcnt lgkmcnt(10)
ds_read_b64_tr_b16 a[90:91], v193 offset:30792
v_mfma_f32_16x16x32_bf16 v[0:3], a[68:71], a[240:243], v[0:3]
buffer_load_dwordx4 v198, s[16:19], s57 offen lds
v_mfma_f32_16x16x32_bf16 v[4:7], a[68:71], a[244:247], v[4:7]
ds_read_b64_tr_b16 a[94:95], v193 offset:43080
v_mfma_f32_16x16x32_bf16 v[4:7], a[64:67], a[228:231], v[4:7]
v_mfma_f32_16x16x32_bf16 v[8:11], a[64:67], a[232:235], v[8:11]
v_mfma_f32_16x16x32_bf16 v[8:11], a[68:71], a[248:251], v[8:11]
v_mfma_f32_16x16x32_bf16 v[12:15], a[68:71], a[252:255], v[12:15]
s_add_u32 s58, s58, 4096
ds_read_b64_tr_b16 a[68:69], v192 offset:36992
v_mfma_f32_16x16x32_bf16 v[12:15], a[64:67], a[236:239], v[12:15]
s_waitcnt lgkmcnt(10)
buffer_load_dwordx4 a[192:195], v200, s[4:7], s58 offen sc1
v_mfma_f32_16x16x32_bf16 v[96:99], a[72:75], a[224:227], v[96:99]
s_waitcnt lgkmcnt(9)
ds_read_b64_tr_b16 a[64:65], v192 offset:24704
v_mfma_f32_16x16x32_bf16 v[96:99], a[76:79], a[240:243], v[96:99]
ds_read_b64_tr_b16 a[66:67], v192 offset:30848
v_mfma_f32_16x16x32_bf16 v[100:103], a[76:79], a[244:247], v[100:103]
ds_read_b64_tr_b16 a[70:71], v192 offset:43136
v_mfma_f32_16x16x32_bf16 v[100:103], a[72:75], a[228:231], v[100:103]
v_mfma_f32_16x16x32_bf16 v[104:107], a[72:75], a[232:235], v[104:107]
v_mfma_f32_16x16x32_bf16 v[104:107], a[76:79], a[248:251], v[104:107]
buffer_load_dwordx4 a[196:199], v201, s[4:7], s58 offen sc1
v_mfma_f32_16x16x32_bf16 v[108:111], a[76:79], a[252:255], v[108:111]
ds_read_b64_tr_b16 a[76:77], v192 offset:37000
v_mfma_f32_16x16x32_bf16 v[108:111], a[72:75], a[236:239], v[108:111]
s_waitcnt lgkmcnt(10)
ds_read_b64_tr_b16 a[72:73], v192 offset:24712
v_mfma_f32_16x16x32_bf16 v[28:31], a[80:83], a[236:239], v[28:31]
s_waitcnt lgkmcnt(10)
ds_read_b64_tr_b16 a[74:75], v192 offset:30856
v_mfma_f32_16x16x32_bf16 v[28:31], a[84:87], a[252:255], v[28:31]
ds_read_b64_tr_b16 a[78:79], v192 offset:43144
v_mfma_f32_16x16x32_bf16 v[24:27], a[84:87], a[248:251], v[24:27]
v_mfma_f32_16x16x32_bf16 v[24:27], a[80:83], a[232:235], v[24:27]
buffer_load_dwordx4 a[200:203], v202, s[4:7], s58 offen sc1
v_mfma_f32_16x16x32_bf16 v[20:23], a[80:83], a[228:231], v[20:23]
v_mfma_f32_16x16x32_bf16 v[20:23], a[84:87], a[244:247], v[20:23]
v_mfma_f32_16x16x32_bf16 v[16:19], a[84:87], a[240:243], v[16:19]
ds_read_b64_tr_b16 a[84:85], v193 offset:37056
v_mfma_f32_16x16x32_bf16 v[16:19], a[80:83], a[224:227], v[16:19]
s_waitcnt lgkmcnt(10)
ds_read_b64_tr_b16 a[80:81], v193 offset:24768
v_mfma_f32_16x16x32_bf16 v[112:115], a[88:91], a[224:227], v[112:115]
s_waitcnt lgkmcnt(10)
ds_read_b64_tr_b16 a[82:83], v193 offset:30912
v_mfma_f32_16x16x32_bf16 v[112:115], a[92:95], a[240:243], v[112:115]
buffer_load_dwordx4 a[204:207], v203, s[4:7], s58 offen sc1
v_mfma_f32_16x16x32_bf16 v[116:119], a[92:95], a[244:247], v[116:119]
ds_read_b64_tr_b16 a[86:87], v193 offset:43200
v_mfma_f32_16x16x32_bf16 v[116:119], a[88:91], a[228:231], v[116:119]
v_mfma_f32_16x16x32_bf16 v[120:123], a[88:91], a[232:235], v[120:123]
v_mfma_f32_16x16x32_bf16 v[120:123], a[92:95], a[248:251], v[120:123]
v_mfma_f32_16x16x32_bf16 v[124:127], a[92:95], a[252:255], v[124:127]
s_add_u32 s58, s58, 4096
ds_read_b64_tr_b16 a[92:93], v193 offset:37064
v_mfma_f32_16x16x32_bf16 v[124:127], a[88:91], a[236:239], v[124:127]
s_waitcnt lgkmcnt(10)
buffer_load_dwordx4 a[208:211], v200, s[4:7], s58 offen sc1
v_mfma_f32_16x16x32_bf16 v[44:47], a[64:67], a[236:239], v[44:47]
s_waitcnt lgkmcnt(9)
ds_read_b64_tr_b16 a[88:89], v193 offset:24776
v_mfma_f32_16x16x32_bf16 v[44:47], a[68:71], a[252:255], v[44:47]
ds_read_b64_tr_b16 a[90:91], v193 offset:30920
v_mfma_f32_16x16x32_bf16 v[40:43], a[68:71], a[248:251], v[40:43]
ds_read_b64_tr_b16 a[94:95], v193 offset:43208
v_mfma_f32_16x16x32_bf16 v[40:43], a[64:67], a[232:235], v[40:43]
v_mfma_f32_16x16x32_bf16 v[36:39], a[64:67], a[228:231], v[36:39]
v_mfma_f32_16x16x32_bf16 v[36:39], a[68:71], a[244:247], v[36:39]
buffer_load_dwordx4 a[212:215], v201, s[4:7], s58 offen sc1
v_mfma_f32_16x16x32_bf16 v[32:35], a[68:71], a[240:243], v[32:35]
ds_read_b64_tr_b16 a[68:69], v192 offset:37120
v_mfma_f32_16x16x32_bf16 v[32:35], a[64:67], a[224:227], v[32:35]
s_waitcnt lgkmcnt(10)
ds_read_b64_tr_b16 a[64:65], v192 offset:24832
v_mfma_f32_16x16x32_bf16 v[128:131], a[72:75], a[224:227], v[128:131]
s_waitcnt lgkmcnt(10)
ds_read_b64_tr_b16 a[66:67], v192 offset:30976
v_mfma_f32_16x16x32_bf16 v[128:131], a[76:79], a[240:243], v[128:131]
ds_read_b64_tr_b16 a[70:71], v192 offset:43264
v_mfma_f32_16x16x32_bf16 v[132:135], a[76:79], a[244:247], v[132:135]
v_mfma_f32_16x16x32_bf16 v[132:135], a[72:75], a[228:231], v[132:135]
buffer_load_dwordx4 a[216:219], v202, s[4:7], s58 offen sc1
v_mfma_f32_16x16x32_bf16 v[136:139], a[72:75], a[232:235], v[136:139]
v_mfma_f32_16x16x32_bf16 v[136:139], a[76:79], a[248:251], v[136:139]
v_mfma_f32_16x16x32_bf16 v[140:143], a[76:79], a[252:255], v[140:143]
ds_read_b64_tr_b16 a[76:77], v192 offset:37128
v_mfma_f32_16x16x32_bf16 v[140:143], a[72:75], a[236:239], v[140:143]
s_waitcnt lgkmcnt(10)
ds_read_b64_tr_b16 a[72:73], v192 offset:24840
v_mfma_f32_16x16x32_bf16 v[60:63], a[80:83], a[236:239], v[60:63]
s_waitcnt lgkmcnt(10)
ds_read_b64_tr_b16 a[74:75], v192 offset:30984
v_mfma_f32_16x16x32_bf16 v[60:63], a[84:87], a[252:255], v[60:63]
buffer_load_dwordx4 a[220:223], v203, s[4:7], s58 offen sc1
v_mfma_f32_16x16x32_bf16 v[56:59], a[84:87], a[248:251], v[56:59]
ds_read_b64_tr_b16 a[78:79], v192 offset:43272
v_mfma_f32_16x16x32_bf16 v[56:59], a[80:83], a[232:235], v[56:59]
v_mfma_f32_16x16x32_bf16 v[52:55], a[80:83], a[228:231], v[52:55]
v_mfma_f32_16x16x32_bf16 v[52:55], a[84:87], a[244:247], v[52:55]
v_mfma_f32_16x16x32_bf16 v[48:51], a[84:87], a[240:243], v[48:51]
s_add_u32 s3, s85, 1572864
ds_read_b64_tr_b16 a[84:85], v193 offset:37184
v_mfma_f32_16x16x32_bf16 v[48:51], a[80:83], a[224:227], v[48:51]
s_waitcnt lgkmcnt(10)
buffer_load_dword v206, v254, s[12:15], s3 offen
v_mfma_f32_16x16x32_bf16 v[144:147], a[88:91], a[224:227], v[144:147]
s_waitcnt lgkmcnt(9)
ds_read_b64_tr_b16 a[80:81], v193 offset:24896
v_mfma_f32_16x16x32_bf16 v[144:147], a[92:95], a[240:243], v[144:147]
ds_read_b64_tr_b16 a[82:83], v193 offset:31040
v_mfma_f32_16x16x32_bf16 v[148:151], a[92:95], a[244:247], v[148:151]
ds_read_b64_tr_b16 a[86:87], v193 offset:43328
v_mfma_f32_16x16x32_bf16 v[148:151], a[88:91], a[228:231], v[148:151]
v_mfma_f32_16x16x32_bf16 v[152:155], a[88:91], a[232:235], v[152:155]
s_add_u32 s3, s85, 1572864
v_mfma_f32_16x16x32_bf16 v[152:155], a[92:95], a[248:251], v[152:155]
buffer_load_dword v206, v254, s[16:19], s3 offen
v_mfma_f32_16x16x32_bf16 v[156:159], a[92:95], a[252:255], v[156:159]
ds_read_b64_tr_b16 a[92:93], v193 offset:37192
v_mfma_f32_16x16x32_bf16 v[156:159], a[88:91], a[236:239], v[156:159]
s_waitcnt lgkmcnt(10)
ds_read_b64_tr_b16 a[88:89], v193 offset:24904
v_mfma_f32_16x16x32_bf16 v[76:79], a[64:67], a[236:239], v[76:79]
s_waitcnt lgkmcnt(10)
ds_read_b64_tr_b16 a[90:91], v193 offset:31048
v_mfma_f32_16x16x32_bf16 v[76:79], a[68:71], a[252:255], v[76:79]
s_add_u32 m0, s53, 73728
ds_read_b64_tr_b16 a[94:95], v193 offset:43336
v_mfma_f32_16x16x32_bf16 v[72:75], a[68:71], a[248:251], v[72:75]
s_add_u32 s56, s56, 393216
v_mfma_f32_16x16x32_bf16 v[72:75], a[64:67], a[232:235], v[72:75]
buffer_load_dwordx4 v195, s[8:11], s56 offen lds
v_mfma_f32_16x16x32_bf16 v[68:71], a[64:67], a[228:231], v[68:71]
v_mfma_f32_16x16x32_bf16 v[68:71], a[68:71], a[244:247], v[68:71]
v_mfma_f32_16x16x32_bf16 v[64:67], a[68:71], a[240:243], v[64:67]
v_mfma_f32_16x16x32_bf16 v[64:67], a[64:67], a[224:227], v[64:67]
s_waitcnt lgkmcnt(9)
v_mfma_f32_16x16x32_bf16 v[160:163], a[72:75], a[224:227], v[160:163]
s_waitcnt lgkmcnt(8)
v_mfma_f32_16x16x32_bf16 v[160:163], a[76:79], a[240:243], v[160:163]
buffer_load_dwordx4 v196, s[8:11], s56 offen offset:1024 lds
v_mfma_f32_16x16x32_bf16 v[164:167], a[76:79], a[244:247], v[164:167]
v_mfma_f32_16x16x32_bf16 v[164:167], a[72:75], a[228:231], v[164:167]
v_mfma_f32_16x16x32_bf16 v[168:171], a[72:75], a[232:235], v[168:171]
v_mfma_f32_16x16x32_bf16 v[168:171], a[76:79], a[248:251], v[168:171]
v_mfma_f32_16x16x32_bf16 v[172:175], a[76:79], a[252:255], v[172:175]
v_mfma_f32_16x16x32_bf16 v[172:175], a[72:75], a[236:239], v[172:175]
s_waitcnt lgkmcnt(5)
buffer_load_dwordx4 v197, s[8:11], s56 offen offset:2048 lds
v_mfma_f32_16x16x32_bf16 v[92:95], a[80:83], a[236:239], v[92:95]
s_waitcnt lgkmcnt(4)
v_mfma_f32_16x16x32_bf16 v[92:95], a[84:87], a[252:255], v[92:95]
v_mfma_f32_16x16x32_bf16 v[88:91], a[84:87], a[248:251], v[88:91]
v_mfma_f32_16x16x32_bf16 v[88:91], a[80:83], a[232:235], v[88:91]
s_waitcnt vmcnt(13) lgkmcnt(0)
buffer_store_dwordx4 v[200:203], v252, s[4:7], s68 offen sc1
s_barrier
v_mfma_f32_16x16x32_bf16 v[84:87], a[80:83], a[228:231], v[84:87]
ds_read_b64_tr_b16 a[64:65], v194 offset:32768
v_mfma_f32_16x16x32_bf16 v[84:87], a[84:87], a[244:247], v[84:87]
s_add_u32 m0, s54, 118784
ds_read_b64_tr_b16 a[66:67], v194 offset:34816
v_mfma_f32_16x16x32_bf16 v[80:83], a[84:87], a[240:243], v[80:83]
s_add_u32 s57, s57, 98304
ds_read_b64_tr_b16 a[68:69], v194 offset:40960
v_mfma_f32_16x16x32_bf16 v[80:83], a[80:83], a[224:227], v[80:83]
buffer_load_dwordx4 v198, s[12:15], s57 offen lds
ds_read_b64_tr_b16 a[70:71], v194 offset:43008
v_mfma_f32_16x16x32_bf16 v[176:179], a[88:91], a[224:227], v[176:179]
ds_read_b64_tr_b16 a[72:73], v194 offset:36864
v_mfma_f32_16x16x32_bf16 v[176:179], a[92:95], a[240:243], v[176:179]
ds_read_b64_tr_b16 a[74:75], v194 offset:38912
v_mfma_f32_16x16x32_bf16 v[180:183], a[92:95], a[244:247], v[180:183]
s_add_u32 m0, s54, 122880
ds_read_b64_tr_b16 a[76:77], v194 offset:45056
v_mfma_f32_16x16x32_bf16 v[180:183], a[88:91], a[228:231], v[180:183]
buffer_load_dwordx4 v198, s[16:19], s57 offen lds
v_mfma_f32_16x16x32_bf16 v[184:187], a[88:91], a[232:235], v[184:187]
ds_read_b64_tr_b16 a[78:79], v194 offset:47104
v_mfma_f32_16x16x32_bf16 v[184:187], a[92:95], a[248:251], v[184:187]
s_add_u32 m0, s54, 126976
ds_read_b64_tr_b16 a[80:81], v194 offset:32800
v_mfma_f32_16x16x32_bf16 v[188:191], a[92:95], a[252:255], v[188:191]
s_add_u32 s57, s57, 98304
ds_read_b64_tr_b16 a[82:83], v194 offset:34848
v_mfma_f32_16x16x32_bf16 v[188:191], a[88:91], a[236:239], v[188:191]
s_waitcnt lgkmcnt(8)
ds_read_b64_tr_b16 a[84:85], v194 offset:40992
v_mfma_f32_16x16x32_bf16 a[96:99], a[64:67], a[32:35], a[96:99]
s_waitcnt lgkmcnt(7)
ds_read_b64_tr_b16 a[86:87], v194 offset:43040
v_mfma_f32_16x16x32_bf16 a[96:99], a[68:71], a[48:51], a[96:99]
buffer_load_dwordx4 v198, s[12:15], s57 offen lds
v_mfma_f32_16x16x32_bf16 a[100:103], a[68:71], a[52:55], a[100:103]
ds_read_b64_tr_b16 a[88:89], v194 offset:36896
v_mfma_f32_16x16x32_bf16 a[100:103], a[64:67], a[36:39], a[100:103]
ds_read_b64_tr_b16 a[90:91], v194 offset:38944
v_mfma_f32_16x16x32_bf16 a[104:107], a[64:67], a[40:43], a[104:107]
ds_read_b64_tr_b16 a[92:93], v194 offset:45088
v_mfma_f32_16x16x32_bf16 a[104:107], a[68:71], a[56:59], a[104:107]
ds_read_b64_tr_b16 a[94:95], v194 offset:47136
v_mfma_f32_16x16x32_bf16 a[108:111], a[68:71], a[60:63], a[108:111]
s_add_u32 m0, s54, 131072
ds_read_b64_tr_b16 a[68:69], v194 offset:41024
v_mfma_f32_16x16x32_bf16 a[108:111], a[64:67], a[44:47], a[108:111]
s_waitcnt lgkmcnt(11)
buffer_load_dwordx4 v198, s[16:19], s57 offen lds
v_mfma_f32_16x16x32_bf16 a[144:147], a[72:75], a[32:35], a[144:147]
s_waitcnt lgkmcnt(9)
ds_read_b64_tr_b16 a[64:65], v194 offset:32832
v_mfma_f32_16x16x32_bf16 a[144:147], a[76:79], a[48:51], a[144:147]
ds_read_b64_tr_b16 a[66:67], v194 offset:34880
v_mfma_f32_16x16x32_bf16 a[148:151], a[76:79], a[52:55], a[148:151]
ds_read_b64_tr_b16 a[70:71], v194 offset:43072
v_mfma_f32_16x16x32_bf16 a[148:151], a[72:75], a[36:39], a[148:151]
s_add_u32 m0, s53, 86016
v_mfma_f32_16x16x32_bf16 a[152:155], a[72:75], a[40:43], a[152:155]
s_add_u32 s56, s56, 393216
v_mfma_f32_16x16x32_bf16 a[152:155], a[76:79], a[56:59], a[152:155]
buffer_load_dwordx4 v195, s[8:11], s56 offen lds
v_mfma_f32_16x16x32_bf16 a[156:159], a[76:79], a[60:63], a[156:159]
ds_read_b64_tr_b16 a[76:77], v194 offset:45120
v_mfma_f32_16x16x32_bf16 a[156:159], a[72:75], a[44:47], a[156:159]
s_waitcnt lgkmcnt(11)
ds_read_b64_tr_b16 a[72:73], v194 offset:36928
v_mfma_f32_16x16x32_bf16 a[124:127], a[80:83], a[44:47], a[124:127]
s_waitcnt lgkmcnt(10)
ds_read_b64_tr_b16 a[74:75], v194 offset:38976
v_mfma_f32_16x16x32_bf16 a[124:127], a[84:87], a[60:63], a[124:127]
ds_read_b64_tr_b16 a[78:79], v194 offset:47168
v_mfma_f32_16x16x32_bf16 a[120:123], a[84:87], a[56:59], a[120:123]
v_mfma_f32_16x16x32_bf16 a[120:123], a[80:83], a[40:43], a[120:123]
buffer_load_dwordx4 v196, s[8:11], s56 offen offset:1024 lds
v_mfma_f32_16x16x32_bf16 a[116:119], a[80:83], a[36:39], a[116:119]
v_mfma_f32_16x16x32_bf16 a[116:119], a[84:87], a[52:55], a[116:119]
v_mfma_f32_16x16x32_bf16 a[112:115], a[84:87], a[48:51], a[112:115]
ds_read_b64_tr_b16 a[84:85], v194 offset:8192
v_mfma_f32_16x16x32_bf16 a[112:115], a[80:83], a[32:35], a[112:115]
s_waitcnt lgkmcnt(11)
ds_read_b64_tr_b16 a[80:81], v194 offset:0
v_mfma_f32_16x16x32_bf16 a[160:163], a[88:91], a[32:35], a[160:163]
s_waitcnt lgkmcnt(10)
ds_read_b64_tr_b16 a[82:83], v194 offset:2048
v_mfma_f32_16x16x32_bf16 a[160:163], a[92:95], a[48:51], a[160:163]
buffer_load_dwordx4 v197, s[8:11], s56 offen offset:2048 lds
v_mfma_f32_16x16x32_bf16 a[164:167], a[92:95], a[52:55], a[164:167]
ds_read_b64_tr_b16 a[86:87], v194 offset:10240
v_mfma_f32_16x16x32_bf16 a[164:167], a[88:91], a[36:39], a[164:167]
v_mfma_f32_16x16x32_bf16 a[168:171], a[88:91], a[40:43], a[168:171]
v_mfma_f32_16x16x32_bf16 a[168:171], a[92:95], a[56:59], a[168:171]
v_mfma_f32_16x16x32_bf16 a[172:175], a[92:95], a[60:63], a[172:175]
s_add_u32 s58, s58, 4096
ds_read_b64_tr_b16 a[92:93], v194 offset:12288
v_mfma_f32_16x16x32_bf16 a[172:175], a[88:91], a[44:47], a[172:175]
s_waitcnt lgkmcnt(10)
buffer_load_dwordx4 a[224:227], v200, s[4:7], s58 offen sc1
v_mfma_f32_16x16x32_bf16 a[140:143], a[64:67], a[44:47], a[140:143]
s_waitcnt lgkmcnt(9)
ds_read_b64_tr_b16 a[88:89], v194 offset:4096
v_mfma_f32_16x16x32_bf16 a[140:143], a[68:71], a[60:63], a[140:143]
ds_read_b64_tr_b16 a[90:91], v194 offset:6144
v_mfma_f32_16x16x32_bf16 a[136:139], a[68:71], a[56:59], a[136:139]
ds_read_b64_tr_b16 a[94:95], v194 offset:14336
v_mfma_f32_16x16x32_bf16 a[136:139], a[64:67], a[40:43], a[136:139]
v_mfma_f32_16x16x32_bf16 a[132:135], a[64:67], a[36:39], a[132:135]
v_mfma_f32_16x16x32_bf16 a[132:135], a[68:71], a[52:55], a[132:135]
buffer_load_dwordx4 a[228:231], v201, s[4:7], s58 offen sc1
v_mfma_f32_16x16x32_bf16 a[128:131], a[68:71], a[48:51], a[128:131]
ds_read_b64_tr_b16 a[68:69], v194 offset:8224
v_mfma_f32_16x16x32_bf16 a[128:131], a[64:67], a[32:35], a[128:131]
s_waitcnt lgkmcnt(10)
ds_read_b64_tr_b16 a[64:65], v194 offset:32
v_mfma_f32_16x16x32_bf16 a[176:179], a[72:75], a[32:35], a[176:179]
s_waitcnt lgkmcnt(10)
ds_read_b64_tr_b16 a[66:67], v194 offset:2080
v_mfma_f32_16x16x32_bf16 a[176:179], a[76:79], a[48:51], a[176:179]
ds_read_b64_tr_b16 a[70:71], v194 offset:10272
v_mfma_f32_16x16x32_bf16 a[180:183], a[76:79], a[52:55], a[180:183]
v_mfma_f32_16x16x32_bf16 a[180:183], a[72:75], a[36:39], a[180:183]
buffer_load_dwordx4 a[232:235], v202, s[4:7], s58 offen sc1
v_mfma_f32_16x16x32_bf16 a[184:187], a[72:75], a[40:43], a[184:187]
v_mfma_f32_16x16x32_bf16 a[184:187], a[76:79], a[56:59], a[184:187]
v_mfma_f32_16x16x32_bf16 a[188:191], a[76:79], a[60:63], a[188:191]
ds_read_b64_tr_b16 a[76:77], v194 offset:12320
v_mfma_f32_16x16x32_bf16 a[188:191], a[72:75], a[44:47], a[188:191]
s_waitcnt vmcnt(23) lgkmcnt(10)
ds_read_b64_tr_b16 a[72:73], v194 offset:4128
v_mfma_f32_16x16x32_bf16 a[96:99], a[80:83], a[192:195], a[96:99]
s_waitcnt vmcnt(19) lgkmcnt(10)
ds_read_b64_tr_b16 a[74:75], v194 offset:6176
v_mfma_f32_16x16x32_bf16 a[96:99], a[84:87], a[208:211], a[96:99]
s_waitcnt vmcnt(18)
buffer_load_dwordx4 a[236:239], v203, s[4:7], s58 offen sc1
v_mfma_f32_16x16x32_bf16 a[100:103], a[84:87], a[212:215], a[100:103]
ds_read_b64_tr_b16 a[78:79], v194 offset:14368
v_mfma_f32_16x16x32_bf16 a[100:103], a[80:83], a[196:199], a[100:103]
v_mfma_f32_16x16x32_bf16 a[104:107], a[80:83], a[200:203], a[104:107]
s_waitcnt vmcnt(18)
v_mfma_f32_16x16x32_bf16 a[104:107], a[84:87], a[216:219], a[104:107]
s_waitcnt vmcnt(17)
v_mfma_f32_16x16x32_bf16 a[108:111], a[84:87], a[220:223], a[108:111]
s_add_u32 s3, s84, 6291456
ds_read_b64_tr_b16 a[84:85], v194 offset:8256
v_mfma_f32_16x16x32_bf16 a[108:111], a[80:83], a[204:207], a[108:111]
s_waitcnt lgkmcnt(10)
buffer_load_dword v206, v253, s[8:11], s3 offen
v_mfma_f32_16x16x32_bf16 a[144:147], a[88:91], a[192:195], a[144:147]
s_waitcnt lgkmcnt(9)
ds_read_b64_tr_b16 a[80:81], v194 offset:64
v_mfma_f32_16x16x32_bf16 a[144:147], a[92:95], a[208:211], a[144:147]
ds_read_b64_tr_b16 a[82:83], v194 offset:2112
v_mfma_f32_16x16x32_bf16 a[148:151], a[92:95], a[212:215], a[148:151]
ds_read_b64_tr_b16 a[86:87], v194 offset:10304
v_mfma_f32_16x16x32_bf16 a[148:151], a[88:91], a[196:199], a[148:151]
v_mfma_f32_16x16x32_bf16 a[152:155], a[88:91], a[200:203], a[152:155]
s_add_u32 s58, s58, 4096
v_mfma_f32_16x16x32_bf16 a[152:155], a[92:95], a[216:219], a[152:155]
buffer_load_dwordx4 a[240:243], v200, s[4:7], s58 offen sc1
v_mfma_f32_16x16x32_bf16 a[156:159], a[92:95], a[220:223], a[156:159]
ds_read_b64_tr_b16 a[92:93], v194 offset:12352
v_mfma_f32_16x16x32_bf16 a[156:159], a[88:91], a[204:207], a[156:159]
s_waitcnt lgkmcnt(10)
ds_read_b64_tr_b16 a[88:89], v194 offset:4160
v_mfma_f32_16x16x32_bf16 a[124:127], a[64:67], a[204:207], a[124:127]
s_waitcnt lgkmcnt(10)
ds_read_b64_tr_b16 a[90:91], v194 offset:6208
v_mfma_f32_16x16x32_bf16 a[124:127], a[68:71], a[220:223], a[124:127]
ds_read_b64_tr_b16 a[94:95], v194 offset:14400
v_mfma_f32_16x16x32_bf16 a[120:123], a[68:71], a[216:219], a[120:123]
v_mfma_f32_16x16x32_bf16 a[120:123], a[64:67], a[200:203], a[120:123]
buffer_load_dwordx4 a[244:247], v201, s[4:7], s58 offen sc1
v_mfma_f32_16x16x32_bf16 a[116:119], a[64:67], a[196:199], a[116:119]
v_mfma_f32_16x16x32_bf16 a[116:119], a[68:71], a[212:215], a[116:119]
v_mfma_f32_16x16x32_bf16 a[112:115], a[68:71], a[208:211], a[112:115]
ds_read_b64_tr_b16 a[68:69], v192 offset:12288
v_mfma_f32_16x16x32_bf16 a[112:115], a[64:67], a[192:195], a[112:115]
s_waitcnt lgkmcnt(10)
ds_read_b64_tr_b16 a[64:65], v192 offset:0
v_mfma_f32_16x16x32_bf16 a[160:163], a[72:75], a[192:195], a[160:163]
s_waitcnt lgkmcnt(10)
ds_read_b64_tr_b16 a[66:67], v192 offset:6144
v_mfma_f32_16x16x32_bf16 a[160:163], a[76:79], a[208:211], a[160:163]
buffer_load_dwordx4 a[248:251], v202, s[4:7], s58 offen sc1
v_mfma_f32_16x16x32_bf16 a[164:167], a[76:79], a[212:215], a[164:167]
ds_read_b64_tr_b16 a[70:71], v192 offset:18432
v_mfma_f32_16x16x32_bf16 a[164:167], a[72:75], a[196:199], a[164:167]
v_mfma_f32_16x16x32_bf16 a[168:171], a[72:75], a[200:203], a[168:171]
v_mfma_f32_16x16x32_bf16 a[168:171], a[76:79], a[216:219], a[168:171]
v_mfma_f32_16x16x32_bf16 a[172:175], a[76:79], a[220:223], a[172:175]
ds_read_b64_tr_b16 a[76:77], v192 offset:12296
v_mfma_f32_16x16x32_bf16 a[172:175], a[72:75], a[204:207], a[172:175]
s_waitcnt lgkmcnt(10)
buffer_load_dwordx4 a[252:255], v203, s[4:7], s58 offen sc1
v_mfma_f32_16x16x32_bf16 a[140:143], a[80:83], a[204:207], a[140:143]
s_waitcnt lgkmcnt(9)
ds_read_b64_tr_b16 a[72:73], v192 offset:8
v_mfma_f32_16x16x32_bf16 a[140:143], a[84:87], a[220:223], a[140:143]
ds_read_b64_tr_b16 a[74:75], v192 offset:6152
v_mfma_f32_16x16x32_bf16 a[136:139], a[84:87], a[216:219], a[136:139]
ds_read_b64_tr_b16 a[78:79], v192 offset:18440
v_mfma_f32_16x16x32_bf16 a[136:139], a[80:83], a[200:203], a[136:139]
s_and_b32 s3, s0, 1073807359
v_mfma_f32_16x16x32_bf16 a[132:135], a[80:83], a[196:199], a[132:135]
s_add_u32 s3, s3, 0
v_mfma_f32_16x16x32_bf16 a[132:135], a[84:87], a[212:215], a[132:135]
buffer_load_dword v206, v205, s[20:23], s3 offen
v_mfma_f32_16x16x32_bf16 a[128:131], a[84:87], a[208:211], a[128:131]
ds_read_b64_tr_b16 a[84:85], v193 offset:12352
v_mfma_f32_16x16x32_bf16 a[128:131], a[80:83], a[192:195], a[128:131]
s_waitcnt lgkmcnt(10)
ds_read_b64_tr_b16 a[80:81], v193 offset:64
v_mfma_f32_16x16x32_bf16 a[176:179], a[88:91], a[192:195], a[176:179]
s_waitcnt lgkmcnt(10)
ds_read_b64_tr_b16 a[82:83], v193 offset:6208
v_mfma_f32_16x16x32_bf16 a[176:179], a[92:95], a[208:211], a[176:179]
s_add_u32 m0, s53, 24576
ds_read_b64_tr_b16 a[86:87], v193 offset:18496
v_mfma_f32_16x16x32_bf16 a[180:183], a[92:95], a[212:215], a[180:183]
s_add_u32 s56, s56, 393216
v_mfma_f32_16x16x32_bf16 a[180:183], a[88:91], a[196:199], a[180:183]
buffer_load_dwordx4 v195, s[8:11], s56 offen lds
v_mfma_f32_16x16x32_bf16 a[184:187], a[88:91], a[200:203], a[184:187]
v_mfma_f32_16x16x32_bf16 a[184:187], a[92:95], a[216:219], a[184:187]
v_mfma_f32_16x16x32_bf16 a[188:191], a[92:95], a[220:223], a[188:191]
ds_read_b64_tr_b16 a[92:93], v193 offset:12360
v_mfma_f32_16x16x32_bf16 a[188:191], a[88:91], a[204:207], a[188:191]
s_waitcnt lgkmcnt(10)
ds_read_b64_tr_b16 a[88:89], v193 offset:72
v_mfma_f32_16x16x32_bf16 v[0:3], a[64:67], a[0:3], v[0:3]
s_waitcnt lgkmcnt(10)
ds_read_b64_tr_b16 a[90:91], v193 offset:6216
v_mfma_f32_16x16x32_bf16 v[0:3], a[68:71], a[16:19], v[0:3]
buffer_load_dwordx4 v196, s[8:11], s56 offen offset:1024 lds
v_mfma_f32_16x16x32_bf16 v[4:7], a[68:71], a[20:23], v[4:7]
ds_read_b64_tr_b16 a[94:95], v193 offset:18504
v_mfma_f32_16x16x32_bf16 v[4:7], a[64:67], a[4:7], v[4:7]
v_mfma_f32_16x16x32_bf16 v[8:11], a[64:67], a[8:11], v[8:11]
v_mfma_f32_16x16x32_bf16 v[8:11], a[68:71], a[24:27], v[8:11]
v_mfma_f32_16x16x32_bf16 v[12:15], a[68:71], a[28:31], v[12:15]
ds_read_b64_tr_b16 a[68:69], v192 offset:12416
v_mfma_f32_16x16x32_bf16 v[12:15], a[64:67], a[12:15], v[12:15]
s_waitcnt lgkmcnt(10)
buffer_load_dwordx4 v197, s[8:11], s56 offen offset:2048 lds
v_mfma_f32_16x16x32_bf16 v[96:99], a[72:75], a[0:3], v[96:99]
s_waitcnt lgkmcnt(9)
ds_read_b64_tr_b16 a[64:65], v192 offset:128
v_mfma_f32_16x16x32_bf16 v[96:99], a[76:79], a[16:19], v[96:99]
ds_read_b64_tr_b16 a[66:67], v192 offset:6272
v_mfma_f32_16x16x32_bf16 v[100:103], a[76:79], a[20:23], v[100:103]
ds_read_b64_tr_b16 a[70:71], v192 offset:18560
v_mfma_f32_16x16x32_bf16 v[100:103], a[72:75], a[4:7], v[100:103]
s_add_u32 m0, s53, 36864
v_mfma_f32_16x16x32_bf16 v[104:107], a[72:75], a[8:11], v[104:107]
s_add_u32 s56, s56, 393216
v_mfma_f32_16x16x32_bf16 v[104:107], a[76:79], a[24:27], v[104:107]
buffer_load_dwordx4 v195, s[8:11], s56 offen lds
v_mfma_f32_16x16x32_bf16 v[108:111], a[76:79], a[28:31], v[108:111]
ds_read_b64_tr_b16 a[76:77], v192 offset:12424
v_mfma_f32_16x16x32_bf16 v[108:111], a[72:75], a[12:15], v[108:111]
s_waitcnt lgkmcnt(10)
ds_read_b64_tr_b16 a[72:73], v192 offset:136
v_mfma_f32_16x16x32_bf16 v[28:31], a[80:83], a[12:15], v[28:31]
s_waitcnt lgkmcnt(10)
ds_read_b64_tr_b16 a[74:75], v192 offset:6280
v_mfma_f32_16x16x32_bf16 v[28:31], a[84:87], a[28:31], v[28:31]
L_walk1_3:
s_cbranch_execz L_walk1_7
ds_read_b64_tr_b16 a[78:79], v192 offset:18568
v_mfma_f32_16x16x32_bf16 v[24:27], a[84:87], a[24:27], v[24:27]
v_mfma_f32_16x16x32_bf16 v[24:27], a[80:83], a[8:11], v[24:27]
buffer_load_dwordx4 v196, s[8:11], s56 offen offset:1024 lds
v_mfma_f32_16x16x32_bf16 v[20:23], a[80:83], a[4:7], v[20:23]
v_mfma_f32_16x16x32_bf16 v[20:23], a[84:87], a[20:23], v[20:23]
v_mfma_f32_16x16x32_bf16 v[16:19], a[84:87], a[16:19], v[16:19]
ds_read_b64_tr_b16 a[84:85], v193 offset:12480
v_mfma_f32_16x16x32_bf16 v[16:19], a[80:83], a[0:3], v[16:19]
s_waitcnt lgkmcnt(10)
ds_read_b64_tr_b16 a[80:81], v193 offset:192
v_mfma_f32_16x16x32_bf16 v[112:115], a[88:91], a[0:3], v[112:115]
s_waitcnt lgkmcnt(10)
ds_read_b64_tr_b16 a[82:83], v193 offset:6336
v_mfma_f32_16x16x32_bf16 v[112:115], a[92:95], a[16:19], v[112:115]
buffer_load_dwordx4 v197, s[8:11], s56 offen offset:2048 lds
v_mfma_f32_16x16x32_bf16 v[116:119], a[92:95], a[20:23], v[116:119]
ds_read_b64_tr_b16 a[86:87], v193 offset:18624
v_mfma_f32_16x16x32_bf16 v[116:119], a[88:91], a[4:7], v[116:119]
v_mfma_f32_16x16x32_bf16 v[120:123], a[88:91], a[8:11], v[120:123]
v_mfma_f32_16x16x32_bf16 v[120:123], a[92:95], a[24:27], v[120:123]
v_mfma_f32_16x16x32_bf16 v[124:127], a[92:95], a[28:31], v[124:127]
ds_read_b64_tr_b16 a[92:93], v193 offset:12488
v_mfma_f32_16x16x32_bf16 v[124:127], a[88:91], a[12:15], v[124:127]
s_waitcnt lgkmcnt(10)
ds_read_b64_tr_b16 a[88:89], v193 offset:200
v_mfma_f32_16x16x32_bf16 v[44:47], a[64:67], a[12:15], v[44:47]
s_waitcnt lgkmcnt(10)
ds_read_b64_tr_b16 a[90:91], v193 offset:6344
v_mfma_f32_16x16x32_bf16 v[44:47], a[68:71], a[28:31], v[44:47]
ds_read_b64_tr_b16 a[94:95], v193 offset:18632
v_mfma_f32_16x16x32_bf16 v[40:43], a[68:71], a[24:27], v[40:43]
v_mfma_f32_16x16x32_bf16 v[40:43], a[64:67], a[8:11], v[40:43]
v_mfma_f32_16x16x32_bf16 v[36:39], a[64:67], a[4:7], v[36:39]
v_mfma_f32_16x16x32_bf16 v[36:39], a[68:71], a[20:23], v[36:39]
v_mfma_f32_16x16x32_bf16 v[32:35], a[68:71], a[16:19], v[32:35]
ds_read_b64_tr_b16 a[68:69], v192 offset:12544
v_mfma_f32_16x16x32_bf16 v[32:35], a[64:67], a[0:3], v[32:35]
s_waitcnt lgkmcnt(10)
ds_read_b64_tr_b16 a[64:65], v192 offset:256
v_mfma_f32_16x16x32_bf16 v[128:131], a[72:75], a[0:3], v[128:131]
s_waitcnt lgkmcnt(10)
ds_read_b64_tr_b16 a[66:67], v192 offset:6400
v_mfma_f32_16x16x32_bf16 v[128:131], a[76:79], a[16:19], v[128:131]
s_buffer_load_dword s79, s[4:7], s78 offset:2056
s_buffer_load_dword s79, s[4:7], s94 offset:2056
ds_read_b64_tr_b16 a[70:71], v192 offset:18688
v_mfma_f32_16x16x32_bf16 v[132:135], a[76:79], a[20:23], v[132:135]
s_lshl_b32 s94, s48, 4
v_mfma_f32_16x16x32_bf16 v[132:135], a[72:75], a[4:7], v[132:135]
s_and_b32 s94, s94, 32
v_mfma_f32_16x16x32_bf16 v[136:139], a[72:75], a[8:11], v[136:139]
v_mfma_f32_16x16x32_bf16 v[136:139], a[76:79], a[24:27], v[136:139]
v_mfma_f32_16x16x32_bf16 v[140:143], a[76:79], a[28:31], v[140:143]
ds_read_b64_tr_b16 a[76:77], v192 offset:12552
v_mfma_f32_16x16x32_bf16 v[140:143], a[72:75], a[12:15], v[140:143]
s_waitcnt lgkmcnt(10)
ds_read_b64_tr_b16 a[72:73], v192 offset:264
v_mfma_f32_16x16x32_bf16 v[60:63], a[80:83], a[12:15], v[60:63]
s_waitcnt lgkmcnt(10)
ds_read_b64_tr_b16 a[74:75], v192 offset:6408
v_mfma_f32_16x16x32_bf16 v[60:63], a[84:87], a[28:31], v[60:63]
ds_read_b64_tr_b16 a[78:79], v192 offset:18696
v_xor_b32 v192, 32768, v192
v_mfma_f32_16x16x32_bf16 v[56:59], a[84:87], a[24:27], v[56:59]
v_mfma_f32_16x16x32_bf16 v[56:59], a[80:83], a[8:11], v[56:59]
v_mfma_f32_16x16x32_bf16 v[52:55], a[80:83], a[4:7], v[52:55]
v_mfma_f32_16x16x32_bf16 v[52:55], a[84:87], a[20:23], v[52:55]
v_mfma_f32_16x16x32_bf16 v[48:51], a[84:87], a[16:19], v[48:51]
ds_read_b64_tr_b16 a[84:85], v193 offset:12608
v_mfma_f32_16x16x32_bf16 v[48:51], a[80:83], a[0:3], v[48:51]
s_waitcnt lgkmcnt(10)
ds_read_b64_tr_b16 a[80:81], v193 offset:320
v_mfma_f32_16x16x32_bf16 v[144:147], a[88:91], a[0:3], v[144:147]
s_waitcnt lgkmcnt(10)
ds_read_b64_tr_b16 a[82:83], v193 offset:6464
v_mfma_f32_16x16x32_bf16 v[144:147], a[92:95], a[16:19], v[144:147]
ds_read_b64_tr_b16 a[86:87], v193 offset:18752
v_mfma_f32_16x16x32_bf16 v[148:151], a[92:95], a[20:23], v[148:151]
v_mfma_f32_16x16x32_bf16 v[148:151], a[88:91], a[4:7], v[148:151]
v_mfma_f32_16x16x32_bf16 v[152:155], a[88:91], a[8:11], v[152:155]
v_mfma_f32_16x16x32_bf16 v[152:155], a[92:95], a[24:27], v[152:155]
v_mfma_f32_16x16x32_bf16 v[156:159], a[92:95], a[28:31], v[156:159]
ds_read_b64_tr_b16 a[92:93], v193 offset:12616
v_mfma_f32_16x16x32_bf16 v[156:159], a[88:91], a[12:15], v[156:159]
s_waitcnt lgkmcnt(10)
ds_read_b64_tr_b16 a[88:89], v193 offset:328
v_mfma_f32_16x16x32_bf16 v[76:79], a[64:67], a[12:15], v[76:79]
s_waitcnt lgkmcnt(10)
ds_read_b64_tr_b16 a[90:91], v193 offset:6472
v_mfma_f32_16x16x32_bf16 v[76:79], a[68:71], a[28:31], v[76:79]
ds_read_b64_tr_b16 a[94:95], v193 offset:18760
v_xor_b32 v193, 32768, v193
v_mfma_f32_16x16x32_bf16 v[72:75], a[68:71], a[24:27], v[72:75]
v_mfma_f32_16x16x32_bf16 v[72:75], a[64:67], a[8:11], v[72:75]
v_mfma_f32_16x16x32_bf16 v[68:71], a[64:67], a[4:7], v[68:71]
v_mfma_f32_16x16x32_bf16 v[68:71], a[68:71], a[20:23], v[68:71]
v_mfma_f32_16x16x32_bf16 v[64:67], a[68:71], a[16:19], v[64:67]
v_mfma_f32_16x16x32_bf16 v[64:67], a[64:67], a[0:3], v[64:67]
s_waitcnt lgkmcnt(9)
v_mfma_f32_16x16x32_bf16 v[160:163], a[72:75], a[0:3], v[160:163]
s_waitcnt lgkmcnt(8)
v_mfma_f32_16x16x32_bf16 v[160:163], a[76:79], a[16:19], v[160:163]
v_mfma_f32_16x16x32_bf16 v[164:167], a[76:79], a[20:23], v[164:167]
v_mfma_f32_16x16x32_bf16 v[164:167], a[72:75], a[4:7], v[164:167]
v_mfma_f32_16x16x32_bf16 v[168:171], a[72:75], a[8:11], v[168:171]
v_mfma_f32_16x16x32_bf16 v[168:171], a[76:79], a[24:27], v[168:171]
v_mfma_f32_16x16x32_bf16 v[172:175], a[76:79], a[28:31], v[172:175]
v_mfma_f32_16x16x32_bf16 v[172:175], a[72:75], a[12:15], v[172:175]
s_waitcnt lgkmcnt(5)
v_mfma_f32_16x16x32_bf16 v[92:95], a[80:83], a[12:15], v[92:95]
s_waitcnt lgkmcnt(4)
v_mfma_f32_16x16x32_bf16 v[92:95], a[84:87], a[28:31], v[92:95]
s_add_u32 m0, s54, 135168
v_mfma_f32_16x16x32_bf16 v[88:91], a[84:87], a[24:27], v[88:91]
s_add_u32 s57, s57, 98304
v_mfma_f32_16x16x32_bf16 v[88:91], a[80:83], a[8:11], v[88:91]
s_waitcnt vmcnt(16) lgkmcnt(0)
s_barrier
v_mfma_f32_16x16x32_bf16 v[84:87], a[80:83], a[4:7], v[84:87]
buffer_load_dwordx4 v198, s[12:15], s57 offen lds
v_mfma_f32_16x16x32_bf16 v[84:87], a[84:87], a[20:23], v[84:87]
ds_read_b64_tr_b16 a[64:65], v194 offset:16384
v_mfma_f32_16x16x32_bf16 v[80:83], a[84:87], a[16:19], v[80:83]
ds_read_b64_tr_b16 a[66:67], v194 offset:18432
v_mfma_f32_16x16x32_bf16 v[80:83], a[80:83], a[0:3], v[80:83]
ds_read_b64_tr_b16 a[68:69], v194 offset:24576
ds_read_b64_tr_b16 a[70:71], v194 offset:26624
v_mfma_f32_16x16x32_bf16 v[176:179], a[88:91], a[0:3], v[176:179]
ds_read_b64_tr_b16 a[72:73], v194 offset:20480
v_mfma_f32_16x16x32_bf16 v[176:179], a[92:95], a[16:19], v[176:179]
s_add_u32 m0, s54, 139264
ds_read_b64_tr_b16 a[74:75], v194 offset:22528
v_mfma_f32_16x16x32_bf16 v[180:183], a[92:95], a[20:23], v[180:183]
buffer_load_dwordx4 v198, s[16:19], s57 offen lds
v_mfma_f32_16x16x32_bf16 v[180:183], a[88:91], a[4:7], v[180:183]
ds_read_b64_tr_b16 a[76:77], v194 offset:28672
v_mfma_f32_16x16x32_bf16 v[184:187], a[88:91], a[8:11], v[184:187]
ds_read_b64_tr_b16 a[78:79], v194 offset:30720
v_mfma_f32_16x16x32_bf16 v[184:187], a[92:95], a[24:27], v[184:187]
s_add_u32 m0, s54, 143360
ds_read_b64_tr_b16 a[80:81], v194 offset:16416
v_mfma_f32_16x16x32_bf16 v[188:191], a[92:95], a[28:31], v[188:191]
s_add_u32 s57, s57, 98304
ds_read_b64_tr_b16 a[82:83], v194 offset:18464
v_mfma_f32_16x16x32_bf16 v[188:191], a[88:91], a[12:15], v[188:191]
s_waitcnt vmcnt(17) lgkmcnt(8)
ds_read_b64_tr_b16 a[84:85], v194 offset:24608
v_mfma_f32_16x16x32_bf16 a[96:99], a[64:67], a[224:227], a[96:99]
s_waitcnt vmcnt(12) lgkmcnt(7)
buffer_load_dwordx4 v198, s[12:15], s57 offen lds
v_mfma_f32_16x16x32_bf16 a[96:99], a[68:71], a[240:243], a[96:99]
s_waitcnt vmcnt(12)
ds_read_b64_tr_b16 a[86:87], v194 offset:26656
v_mfma_f32_16x16x32_bf16 a[100:103], a[68:71], a[244:247], a[100:103]
ds_read_b64_tr_b16 a[88:89], v194 offset:20512
v_mfma_f32_16x16x32_bf16 a[100:103], a[64:67], a[228:231], a[100:103]
s_add_u32 m0, s54, 147456
ds_read_b64_tr_b16 a[90:91], v194 offset:22560
v_mfma_f32_16x16x32_bf16 a[104:107], a[64:67], a[232:235], a[104:107]
s_waitcnt vmcnt(11)
ds_read_b64_tr_b16 a[92:93], v194 offset:28704
v_mfma_f32_16x16x32_bf16 a[104:107], a[68:71], a[248:251], a[104:107]
s_waitcnt vmcnt(10)
ds_read_b64_tr_b16 a[94:95], v194 offset:30752
v_mfma_f32_16x16x32_bf16 a[108:111], a[68:71], a[252:255], a[108:111]
buffer_load_dwordx4 v198, s[16:19], s57 offen lds
v_mfma_f32_16x16x32_bf16 a[108:111], a[64:67], a[236:239], a[108:111]
s_waitcnt lgkmcnt(10)
ds_read_b64_tr_b16 a[64:65], v194 offset:16448
v_mfma_f32_16x16x32_bf16 a[144:147], a[72:75], a[224:227], a[144:147]
s_waitcnt lgkmcnt(9)
ds_read_b64_tr_b16 a[66:67], v194 offset:18496
v_mfma_f32_16x16x32_bf16 a[144:147], a[76:79], a[240:243], a[144:147]
ds_read_b64_tr_b16 a[68:69], v194 offset:24640
v_mfma_f32_16x16x32_bf16 a[148:151], a[76:79], a[244:247], a[148:151]
s_add_u32 m0, s54, 102400
ds_read_b64_tr_b16 a[70:71], v194 offset:26688
v_mfma_f32_16x16x32_bf16 a[148:151], a[72:75], a[228:231], a[148:151]
s_add_u32 s57, s57, 98304
v_mfma_f32_16x16x32_bf16 a[152:155], a[72:75], a[232:235], a[152:155]
buffer_load_dwordx4 v198, s[12:15], s57 offen lds
v_mfma_f32_16x16x32_bf16 a[152:155], a[76:79], a[248:251], a[152:155]
v_mfma_f32_16x16x32_bf16 a[156:159], a[76:79], a[252:255], a[156:159]
ds_read_b64_tr_b16 a[76:77], v194 offset:28736
v_mfma_f32_16x16x32_bf16 a[156:159], a[72:75], a[236:239], a[156:159]
s_waitcnt lgkmcnt(11)
ds_read_b64_tr_b16 a[72:73], v194 offset:20544
v_mfma_f32_16x16x32_bf16 a[124:127], a[80:83], a[236:239], a[124:127]
s_waitcnt lgkmcnt(10)
ds_read_b64_tr_b16 a[74:75], v194 offset:22592
v_mfma_f32_16x16x32_bf16 a[124:127], a[84:87], a[252:255], a[124:127]
s_add_u32 m0, s54, 106496
ds_read_b64_tr_b16 a[78:79], v194 offset:30784
v_mfma_f32_16x16x32_bf16 a[120:123], a[84:87], a[248:251], a[120:123]
buffer_load_dwordx4 v198, s[16:19], s57 offen lds
v_mfma_f32_16x16x32_bf16 a[120:123], a[80:83], a[232:235], a[120:123]
v_mfma_f32_16x16x32_bf16 a[116:119], a[80:83], a[228:231], a[116:119]
v_mfma_f32_16x16x32_bf16 a[116:119], a[84:87], a[244:247], a[116:119]
s_add_u32 m0, s54, 110592
v_mfma_f32_16x16x32_bf16 a[112:115], a[84:87], a[240:243], a[112:115]
s_add_u32 s57, s57, 98304
ds_read_b64_tr_b16 a[84:85], v192 offset:53248
v_mfma_f32_16x16x32_bf16 a[112:115], a[80:83], a[224:227], a[112:115]
s_waitcnt lgkmcnt(11)
ds_read_b64_tr_b16 a[80:81], v192 offset:40960
v_mfma_f32_16x16x32_bf16 a[160:163], a[88:91], a[224:227], a[160:163]
s_waitcnt lgkmcnt(10)
buffer_load_dwordx4 v198, s[12:15], s57 offen lds
v_mfma_f32_16x16x32_bf16 a[160:163], a[92:95], a[240:243], a[160:163]
ds_read_b64_tr_b16 a[82:83], v192 offset:47104
v_mfma_f32_16x16x32_bf16 a[164:167], a[92:95], a[244:247], a[164:167]
ds_read_b64_tr_b16 a[86:87], v192 offset:59392
v_mfma_f32_16x16x32_bf16 a[164:167], a[88:91], a[228:231], a[164:167]
v_mfma_f32_16x16x32_bf16 a[168:171], a[88:91], a[232:235], a[168:171]
v_mfma_f32_16x16x32_bf16 a[168:171], a[92:95], a[248:251], a[168:171]
s_add_u32 m0, s54, 114688
v_mfma_f32_16x16x32_bf16 a[172:175], a[92:95], a[252:255], a[172:175]
buffer_load_dwordx4 v198, s[16:19], s57 offen lds
v_mfma_f32_16x16x32_bf16 a[172:175], a[88:91], a[236:239], a[172:175]
s_waitcnt lgkmcnt(10)
ds_read_b64_tr_b16 a[88:89], v192 offset:40968
v_mfma_f32_16x16x32_bf16 a[140:143], a[64:67], a[236:239], a[140:143]
s_waitcnt lgkmcnt(9)
ds_read_b64_tr_b16 a[90:91], v192 offset:47112
v_mfma_f32_16x16x32_bf16 a[140:143], a[68:71], a[252:255], a[140:143]
ds_read_b64_tr_b16 a[92:93], v192 offset:53256
v_mfma_f32_16x16x32_bf16 a[136:139], a[68:71], a[248:251], a[136:139]
ds_read_b64_tr_b16 a[94:95], v192 offset:59400
v_mfma_f32_16x16x32_bf16 a[136:139], a[64:67], a[232:235], a[136:139]
s_add_u32 s58, s58, 4096
v_mfma_f32_16x16x32_bf16 a[132:135], a[64:67], a[228:231], a[132:135]
buffer_load_dwordx4 a[0:3], v200, s[4:7], s58 offen sc1
v_mfma_f32_16x16x32_bf16 a[132:135], a[68:71], a[244:247], a[132:135]
v_mfma_f32_16x16x32_bf16 a[128:131], a[68:71], a[240:243], a[128:131]
ds_read_b64_tr_b16 a[68:69], v193 offset:53312
v_mfma_f32_16x16x32_bf16 a[128:131], a[64:67], a[224:227], a[128:131]
s_waitcnt lgkmcnt(10)
ds_read_b64_tr_b16 a[64:65], v193 offset:41024
v_mfma_f32_16x16x32_bf16 a[176:179], a[72:75], a[224:227], a[176:179]
s_waitcnt lgkmcnt(10)
ds_read_b64_tr_b16 a[66:67], v193 offset:47168
v_mfma_f32_16x16x32_bf16 a[176:179], a[76:79], a[240:243], a[176:179]
ds_read_b64_tr_b16 a[70:71], v193 offset:59456
v_mfma_f32_16x16x32_bf16 a[180:183], a[76:79], a[244:247], a[180:183]
buffer_load_dwordx4 a[4:7], v201, s[4:7], s58 offen sc1
v_mfma_f32_16x16x32_bf16 a[180:183], a[72:75], a[228:231], a[180:183]
v_mfma_f32_16x16x32_bf16 a[184:187], a[72:75], a[232:235], a[184:187]
v_mfma_f32_16x16x32_bf16 a[184:187], a[76:79], a[248:251], a[184:187]
v_mfma_f32_16x16x32_bf16 a[188:191], a[76:79], a[252:255], a[188:191]
ds_read_b64_tr_b16 a[76:77], v193 offset:53320
v_mfma_f32_16x16x32_bf16 a[188:191], a[72:75], a[236:239], a[188:191]
s_waitcnt lgkmcnt(10)
ds_read_b64_tr_b16 a[72:73], v193 offset:41032
v_mfma_f32_16x16x32_bf16 v[0:3], a[80:83], a[32:35], v[0:3]
s_waitcnt lgkmcnt(10)
buffer_load_dwordx4 a[8:11], v202, s[4:7], s58 offen sc1
v_mfma_f32_16x16x32_bf16 v[0:3], a[84:87], a[48:51], v[0:3]
ds_read_b64_tr_b16 a[74:75], v193 offset:47176
v_mfma_f32_16x16x32_bf16 v[4:7], a[84:87], a[52:55], v[4:7]
ds_read_b64_tr_b16 a[78:79], v193 offset:59464
v_mfma_f32_16x16x32_bf16 v[4:7], a[80:83], a[36:39], v[4:7]
v_mfma_f32_16x16x32_bf16 v[8:11], a[80:83], a[40:43], v[8:11]
v_mfma_f32_16x16x32_bf16 v[8:11], a[84:87], a[56:59], v[8:11]
v_mfma_f32_16x16x32_bf16 v[12:15], a[84:87], a[60:63], v[12:15]
buffer_load_dwordx4 a[12:15], v203, s[4:7], s58 offen sc1
v_mfma_f32_16x16x32_bf16 v[12:15], a[80:83], a[44:47], v[12:15]
s_waitcnt lgkmcnt(10)
ds_read_b64_tr_b16 a[80:81], v192 offset:41088
v_mfma_f32_16x16x32_bf16 v[96:99], a[88:91], a[32:35], v[96:99]
s_waitcnt lgkmcnt(9)
ds_read_b64_tr_b16 a[82:83], v192 offset:47232
v_mfma_f32_16x16x32_bf16 v[96:99], a[92:95], a[48:51], v[96:99]
ds_read_b64_tr_b16 a[84:85], v192 offset:53376
v_mfma_f32_16x16x32_bf16 v[100:103], a[92:95], a[52:55], v[100:103]
ds_read_b64_tr_b16 a[86:87], v192 offset:59520
v_mfma_f32_16x16x32_bf16 v[100:103], a[88:91], a[36:39], v[100:103]
s_add_u32 s58, s58, 4096
v_mfma_f32_16x16x32_bf16 v[104:107], a[88:91], a[40:43], v[104:107]
buffer_load_dwordx4 a[16:19], v200, s[4:7], s58 offen sc1
v_mfma_f32_16x16x32_bf16 v[104:107], a[92:95], a[56:59], v[104:107]
v_mfma_f32_16x16x32_bf16 v[108:111], a[92:95], a[60:63], v[108:111]
ds_read_b64_tr_b16 a[92:93], v192 offset:53384
v_mfma_f32_16x16x32_bf16 v[108:111], a[88:91], a[44:47], v[108:111]
s_waitcnt lgkmcnt(10)
ds_read_b64_tr_b16 a[88:89], v192 offset:41096
v_mfma_f32_16x16x32_bf16 v[28:31], a[64:67], a[44:47], v[28:31]
s_waitcnt lgkmcnt(10)
ds_read_b64_tr_b16 a[90:91], v192 offset:47240
v_mfma_f32_16x16x32_bf16 v[28:31], a[68:71], a[60:63], v[28:31]
ds_read_b64_tr_b16 a[94:95], v192 offset:59528
v_mfma_f32_16x16x32_bf16 v[24:27], a[68:71], a[56:59], v[24:27]
buffer_load_dwordx4 a[20:23], v201, s[4:7], s58 offen sc1
v_mfma_f32_16x16x32_bf16 v[24:27], a[64:67], a[40:43], v[24:27]
v_mfma_f32_16x16x32_bf16 v[20:23], a[64:67], a[36:39], v[20:23]
v_mfma_f32_16x16x32_bf16 v[20:23], a[68:71], a[52:55], v[20:23]
v_mfma_f32_16x16x32_bf16 v[16:19], a[68:71], a[48:51], v[16:19]
ds_read_b64_tr_b16 a[68:69], v193 offset:53440
v_mfma_f32_16x16x32_bf16 v[16:19], a[64:67], a[32:35], v[16:19]
s_waitcnt lgkmcnt(10)
ds_read_b64_tr_b16 a[64:65], v193 offset:41152
v_mfma_f32_16x16x32_bf16 v[112:115], a[72:75], a[32:35], v[112:115]
s_waitcnt lgkmcnt(10)
buffer_load_dwordx4 a[24:27], v202, s[4:7], s58 offen sc1
v_mfma_f32_16x16x32_bf16 v[112:115], a[76:79], a[48:51], v[112:115]
ds_read_b64_tr_b16 a[66:67], v193 offset:47296
v_mfma_f32_16x16x32_bf16 v[116:119], a[76:79], a[52:55], v[116:119]
ds_read_b64_tr_b16 a[70:71], v193 offset:59584
v_mfma_f32_16x16x32_bf16 v[116:119], a[72:75], a[36:39], v[116:119]
v_mfma_f32_16x16x32_bf16 v[120:123], a[72:75], a[40:43], v[120:123]
v_mfma_f32_16x16x32_bf16 v[120:123], a[76:79], a[56:59], v[120:123]
v_mfma_f32_16x16x32_bf16 v[124:127], a[76:79], a[60:63], v[124:127]
buffer_load_dwordx4 a[28:31], v203, s[4:7], s58 offen sc1
v_mfma_f32_16x16x32_bf16 v[124:127], a[72:75], a[44:47], v[124:127]
s_waitcnt lgkmcnt(10)
ds_read_b64_tr_b16 a[72:73], v193 offset:41160
v_mfma_f32_16x16x32_bf16 v[44:47], a[80:83], a[44:47], v[44:47]
s_waitcnt lgkmcnt(9)
ds_read_b64_tr_b16 a[74:75], v193 offset:47304
v_mfma_f32_16x16x32_bf16 v[44:47], a[84:87], a[60:63], v[44:47]
ds_read_b64_tr_b16 a[76:77], v193 offset:53448
v_mfma_f32_16x16x32_bf16 v[40:43], a[84:87], a[56:59], v[40:43]
s_add_u32 m0, s53, 0
ds_read_b64_tr_b16 a[78:79], v193 offset:59592
v_mfma_f32_16x16x32_bf16 v[40:43], a[80:83], a[40:43], v[40:43]
s_add_u32 s56, s56, 393216
v_mfma_f32_16x16x32_bf16 v[36:39], a[80:83], a[36:39], v[36:39]
buffer_load_dwordx4 v195, s[8:11], s56 offen lds
v_mfma_f32_16x16x32_bf16 v[36:39], a[84:87], a[52:55], v[36:39]
v_mfma_f32_16x16x32_bf16 v[32:35], a[84:87], a[48:51], v[32:35]
ds_read_b64_tr_b16 a[84:85], v192 offset:53504
v_mfma_f32_16x16x32_bf16 v[32:35], a[80:83], a[32:35], v[32:35]
s_waitcnt lgkmcnt(10)
ds_read_b64_tr_b16 a[80:81], v192 offset:41216
v_mfma_f32_16x16x32_bf16 v[128:131], a[88:91], a[32:35], v[128:131]
s_waitcnt lgkmcnt(10)
ds_read_b64_tr_b16 a[82:83], v192 offset:47360
v_mfma_f32_16x16x32_bf16 v[128:131], a[92:95], a[48:51], v[128:131]
ds_read_b64_tr_b16 a[86:87], v192 offset:59648
v_mfma_f32_16x16x32_bf16 v[132:135], a[92:95], a[52:55], v[132:135]
buffer_load_dwordx4 v196, s[8:11], s56 offen offset:1024 lds
v_mfma_f32_16x16x32_bf16 v[132:135], a[88:91], a[36:39], v[132:135]
v_mfma_f32_16x16x32_bf16 v[136:139], a[88:91], a[40:43], v[136:139]
v_mfma_f32_16x16x32_bf16 v[136:139], a[92:95], a[56:59], v[136:139]
v_mfma_f32_16x16x32_bf16 v[140:143], a[92:95], a[60:63], v[140:143]
ds_read_b64_tr_b16 a[92:93], v192 offset:53512
v_mfma_f32_16x16x32_bf16 v[140:143], a[88:91], a[44:47], v[140:143]
s_waitcnt lgkmcnt(10)
ds_read_b64_tr_b16 a[88:89], v192 offset:41224
v_mfma_f32_16x16x32_bf16 v[60:63], a[64:67], a[44:47], v[60:63]
s_waitcnt lgkmcnt(10)
buffer_load_dwordx4 v197, s[8:11], s56 offen offset:2048 lds
v_mfma_f32_16x16x32_bf16 v[60:63], a[68:71], a[60:63], v[60:63]
ds_read_b64_tr_b16 a[90:91], v192 offset:47368
v_mfma_f32_16x16x32_bf16 v[56:59], a[68:71], a[56:59], v[56:59]
ds_read_b64_tr_b16 a[94:95], v192 offset:59656
v_xor_b32 v192, 32768, v192
v_mfma_f32_16x16x32_bf16 v[56:59], a[64:67], a[40:43], v[56:59]
v_mfma_f32_16x16x32_bf16 v[52:55], a[64:67], a[36:39], v[52:55]
s_add_u32 m0, s53, 12288
v_mfma_f32_16x16x32_bf16 v[52:55], a[68:71], a[52:55], v[52:55]
s_add_u32 s56, s56, 393216
v_mfma_f32_16x16x32_bf16 v[48:51], a[68:71], a[48:51], v[48:51]
buffer_load_dwordx4 v195, s[8:11], s56 offen lds
v_mfma_f32_16x16x32_bf16 v[48:51], a[64:67], a[32:35], v[48:51]
s_waitcnt lgkmcnt(10)
ds_read_b64_tr_b16 a[64:65], v193 offset:41280
v_mfma_f32_16x16x32_bf16 v[144:147], a[72:75], a[32:35], v[144:147]
s_waitcnt lgkmcnt(9)
ds_read_b64_tr_b16 a[66:67], v193 offset:47424
v_mfma_f32_16x16x32_bf16 v[144:147], a[76:79], a[48:51], v[144:147]
ds_read_b64_tr_b16 a[68:69], v193 offset:53568
v_mfma_f32_16x16x32_bf16 v[148:151], a[76:79], a[52:55], v[148:151]
ds_read_b64_tr_b16 a[70:71], v193 offset:59712
v_mfma_f32_16x16x32_bf16 v[148:151], a[72:75], a[36:39], v[148:151]
v_mfma_f32_16x16x32_bf16 v[152:155], a[72:75], a[40:43], v[152:155]
buffer_load_dwordx4 v196, s[8:11], s56 offen offset:1024 lds
v_mfma_f32_16x16x32_bf16 v[152:155], a[76:79], a[56:59], v[152:155]
v_mfma_f32_16x16x32_bf16 v[156:159], a[76:79], a[60:63], v[156:159]
ds_read_b64_tr_b16 a[76:77], v193 offset:53576
v_mfma_f32_16x16x32_bf16 v[156:159], a[72:75], a[44:47], v[156:159]
s_waitcnt lgkmcnt(10)
ds_read_b64_tr_b16 a[72:73], v193 offset:41288
v_mfma_f32_16x16x32_bf16 v[76:79], a[80:83], a[44:47], v[76:79]
s_waitcnt lgkmcnt(10)
ds_read_b64_tr_b16 a[74:75], v193 offset:47432
v_mfma_f32_16x16x32_bf16 v[76:79], a[84:87], a[60:63], v[76:79]
ds_read_b64_tr_b16 a[78:79], v193 offset:59720
v_xor_b32 v193, 32768, v193
v_mfma_f32_16x16x32_bf16 v[72:75], a[84:87], a[56:59], v[72:75]
buffer_load_dwordx4 v197, s[8:11], s56 offen offset:2048 lds
v_mfma_f32_16x16x32_bf16 v[72:75], a[80:83], a[40:43], v[72:75]
v_mfma_f32_16x16x32_bf16 v[68:71], a[80:83], a[36:39], v[68:71]
v_mfma_f32_16x16x32_bf16 v[68:71], a[84:87], a[52:55], v[68:71]
v_mfma_f32_16x16x32_bf16 v[64:67], a[84:87], a[48:51], v[64:67]
v_mfma_f32_16x16x32_bf16 v[64:67], a[80:83], a[32:35], v[64:67]
s_waitcnt lgkmcnt(9)
v_mfma_f32_16x16x32_bf16 v[160:163], a[88:91], a[32:35], v[160:163]
s_waitcnt lgkmcnt(8)
v_mfma_f32_16x16x32_bf16 v[160:163], a[92:95], a[48:51], v[160:163]
v_mfma_f32_16x16x32_bf16 v[164:167], a[92:95], a[52:55], v[164:167]
v_mfma_f32_16x16x32_bf16 v[164:167], a[88:91], a[36:39], v[164:167]
v_mfma_f32_16x16x32_bf16 v[168:171], a[88:91], a[40:43], v[168:171]
v_mfma_f32_16x16x32_bf16 v[168:171], a[92:95], a[56:59], v[168:171]
v_mfma_f32_16x16x32_bf16 v[172:175], a[92:95], a[60:63], v[172:175]
v_mfma_f32_16x16x32_bf16 v[172:175], a[88:91], a[44:47], v[172:175]
s_waitcnt lgkmcnt(6)
v_mfma_f32_16x16x32_bf16 v[92:95], a[64:67], a[44:47], v[92:95]
s_waitcnt lgkmcnt(4)
v_mfma_f32_16x16x32_bf16 v[92:95], a[68:71], a[60:63], v[92:95]
v_mfma_f32_16x16x32_bf16 v[88:91], a[68:71], a[56:59], v[88:91]
s_waitcnt lgkmcnt(0)
s_lshr_b32 s79, s79, 11
v_mfma_f32_16x16x32_bf16 v[88:91], a[64:67], a[40:43], v[88:91]
s_waitcnt vmcnt(14)
s_barrier
v_mfma_f32_16x16x32_bf16 v[84:87], a[64:67], a[36:39], v[84:87]
s_xor_b32 s79, s79, s2
ds_read_b64_tr_b16 a[80:81], v194 offset:32768
v_mfma_f32_16x16x32_bf16 v[84:87], a[68:71], a[52:55], v[84:87]
s_andn2_b32 s79, 4, s79
ds_read_b64_tr_b16 a[82:83], v194 offset:34816
v_mfma_f32_16x16x32_bf16 v[80:83], a[68:71], a[48:51], v[80:83]
s_lshr_b32 s79, s79, 2
ds_read_b64_tr_b16 a[84:85], v194 offset:40960
v_mfma_f32_16x16x32_bf16 v[80:83], a[64:67], a[32:35], v[80:83]
ds_read_b64_tr_b16 a[86:87], v194 offset:43008
v_mfma_f32_16x16x32_bf16 v[176:179], a[72:75], a[32:35], v[176:179]
ds_read_b64_tr_b16 a[88:89], v194 offset:36864
v_mfma_f32_16x16x32_bf16 v[176:179], a[76:79], a[48:51], v[176:179]
ds_read_b64_tr_b16 a[90:91], v194 offset:38912
v_mfma_f32_16x16x32_bf16 v[180:183], a[76:79], a[52:55], v[180:183]
ds_read_b64_tr_b16 a[92:93], v194 offset:45056
v_mfma_f32_16x16x32_bf16 v[180:183], a[72:75], a[36:39], v[180:183]
ds_read_b64_tr_b16 a[94:95], v194 offset:47104
v_mfma_f32_16x16x32_bf16 v[184:187], a[72:75], a[40:43], v[184:187]
ds_read_b64_tr_b16 a[64:65], v194 offset:32800
v_mfma_f32_16x16x32_bf16 v[184:187], a[76:79], a[56:59], v[184:187]
ds_read_b64_tr_b16 a[66:67], v194 offset:34848
v_mfma_f32_16x16x32_bf16 v[188:191], a[76:79], a[60:63], v[188:191]
s_add_u32 s58, s58, 4096
ds_read_b64_tr_b16 a[68:69], v194 offset:40992
v_mfma_f32_16x16x32_bf16 v[188:191], a[72:75], a[44:47], v[188:191]
s_waitcnt vmcnt(13) lgkmcnt(9)
ds_read_b64_tr_b16 a[70:71], v194 offset:43040
v_mfma_f32_16x16x32_bf16 a[96:99], a[80:83], a[0:3], a[96:99]
s_waitcnt vmcnt(9) lgkmcnt(8)
ds_read_b64_tr_b16 a[72:73], v194 offset:36896
v_mfma_f32_16x16x32_bf16 a[96:99], a[84:87], a[16:19], a[96:99]
s_waitcnt vmcnt(8)
buffer_load_dwordx4 a[32:35], v200, s[4:7], s58 offen sc1
v_mfma_f32_16x16x32_bf16 a[100:103], a[84:87], a[20:23], a[100:103]
ds_read_b64_tr_b16 a[74:75], v194 offset:38944
v_mfma_f32_16x16x32_bf16 a[100:103], a[80:83], a[4:7], a[100:103]
ds_read_b64_tr_b16 a[76:77], v194 offset:45088
v_mfma_f32_16x16x32_bf16 a[104:107], a[80:83], a[8:11], a[104:107]
s_waitcnt vmcnt(8)
ds_read_b64_tr_b16 a[78:79], v194 offset:47136
v_mfma_f32_16x16x32_bf16 a[104:107], a[84:87], a[24:27], a[104:107]
s_waitcnt vmcnt(7)
v_mfma_f32_16x16x32_bf16 a[108:111], a[84:87], a[28:31], a[108:111]
ds_read_b64_tr_b16 a[84:85], v194 offset:41024
v_mfma_f32_16x16x32_bf16 a[108:111], a[80:83], a[12:15], a[108:111]
s_waitcnt lgkmcnt(11)
buffer_load_dwordx4 a[36:39], v201, s[4:7], s58 offen sc1
v_mfma_f32_16x16x32_bf16 a[144:147], a[88:91], a[0:3], a[144:147]
s_waitcnt lgkmcnt(9)
ds_read_b64_tr_b16 a[80:81], v194 offset:32832
v_mfma_f32_16x16x32_bf16 a[144:147], a[92:95], a[16:19], a[144:147]
ds_read_b64_tr_b16 a[82:83], v194 offset:34880
v_mfma_f32_16x16x32_bf16 a[148:151], a[92:95], a[20:23], a[148:151]
ds_read_b64_tr_b16 a[86:87], v194 offset:43072
v_mfma_f32_16x16x32_bf16 a[148:151], a[88:91], a[4:7], a[148:151]
v_mfma_f32_16x16x32_bf16 a[152:155], a[88:91], a[8:11], a[152:155]
v_mfma_f32_16x16x32_bf16 a[152:155], a[92:95], a[24:27], a[152:155]
buffer_load_dwordx4 a[40:43], v202, s[4:7], s58 offen sc1
v_mfma_f32_16x16x32_bf16 a[156:159], a[92:95], a[28:31], a[156:159]
ds_read_b64_tr_b16 a[92:93], v194 offset:45120
v_mfma_f32_16x16x32_bf16 a[156:159], a[88:91], a[12:15], a[156:159]
s_waitcnt lgkmcnt(11)
ds_read_b64_tr_b16 a[88:89], v194 offset:36928
v_mfma_f32_16x16x32_bf16 a[124:127], a[64:67], a[12:15], a[124:127]
s_waitcnt lgkmcnt(10)
ds_read_b64_tr_b16 a[90:91], v194 offset:38976
v_mfma_f32_16x16x32_bf16 a[124:127], a[68:71], a[28:31], a[124:127]
ds_read_b64_tr_b16 a[94:95], v194 offset:47168
v_mfma_f32_16x16x32_bf16 a[120:123], a[68:71], a[24:27], a[120:123]
v_mfma_f32_16x16x32_bf16 a[120:123], a[64:67], a[8:11], a[120:123]
buffer_load_dwordx4 a[44:47], v203, s[4:7], s58 offen sc1
v_mfma_f32_16x16x32_bf16 a[116:119], a[64:67], a[4:7], a[116:119]
v_mfma_f32_16x16x32_bf16 a[116:119], a[68:71], a[20:23], a[116:119]
v_mfma_f32_16x16x32_bf16 a[112:115], a[68:71], a[16:19], a[112:115]
s_add_u32 s58, s58, 4096
ds_read_b64_tr_b16 a[68:69], v192 offset:36864
v_mfma_f32_16x16x32_bf16 a[112:115], a[64:67], a[0:3], a[112:115]
s_waitcnt lgkmcnt(11)
ds_read_b64_tr_b16 a[64:65], v192 offset:24576
v_mfma_f32_16x16x32_bf16 a[160:163], a[72:75], a[0:3], a[160:163]
s_waitcnt lgkmcnt(10)
ds_read_b64_tr_b16 a[66:67], v192 offset:30720
v_mfma_f32_16x16x32_bf16 a[160:163], a[76:79], a[16:19], a[160:163]
buffer_load_dwordx4 a[48:51], v200, s[4:7], s58 offen sc1
v_mfma_f32_16x16x32_bf16 a[164:167], a[76:79], a[20:23], a[164:167]
ds_read_b64_tr_b16 a[70:71], v192 offset:43008
v_mfma_f32_16x16x32_bf16 a[164:167], a[72:75], a[4:7], a[164:167]
v_mfma_f32_16x16x32_bf16 a[168:171], a[72:75], a[8:11], a[168:171]
v_mfma_f32_16x16x32_bf16 a[168:171], a[76:79], a[24:27], a[168:171]
v_mfma_f32_16x16x32_bf16 a[172:175], a[76:79], a[28:31], a[172:175]
ds_read_b64_tr_b16 a[76:77], v192 offset:36872
v_mfma_f32_16x16x32_bf16 a[172:175], a[72:75], a[12:15], a[172:175]
s_waitcnt lgkmcnt(10)
buffer_load_dwordx4 a[52:55], v201, s[4:7], s58 offen sc1
v_mfma_f32_16x16x32_bf16 a[140:143], a[80:83], a[12:15], a[140:143]
s_waitcnt lgkmcnt(9)
ds_read_b64_tr_b16 a[72:73], v192 offset:24584
v_mfma_f32_16x16x32_bf16 a[140:143], a[84:87], a[28:31], a[140:143]
ds_read_b64_tr_b16 a[74:75], v192 offset:30728
v_mfma_f32_16x16x32_bf16 a[136:139], a[84:87], a[24:27], a[136:139]
ds_read_b64_tr_b16 a[78:79], v192 offset:43016
v_mfma_f32_16x16x32_bf16 a[136:139], a[80:83], a[8:11], a[136:139]
v_mfma_f32_16x16x32_bf16 a[132:135], a[80:83], a[4:7], a[132:135]
v_mfma_f32_16x16x32_bf16 a[132:135], a[84:87], a[20:23], a[132:135]
buffer_load_dwordx4 a[56:59], v202, s[4:7], s58 offen sc1
v_mfma_f32_16x16x32_bf16 a[128:131], a[84:87], a[16:19], a[128:131]
ds_read_b64_tr_b16 a[84:85], v193 offset:36928
v_mfma_f32_16x16x32_bf16 a[128:131], a[80:83], a[0:3], a[128:131]
s_waitcnt lgkmcnt(10)
ds_read_b64_tr_b16 a[80:81], v193 offset:24640
v_mfma_f32_16x16x32_bf16 a[176:179], a[88:91], a[0:3], a[176:179]
s_waitcnt lgkmcnt(10)
ds_read_b64_tr_b16 a[82:83], v193 offset:30784
v_mfma_f32_16x16x32_bf16 a[176:179], a[92:95], a[16:19], a[176:179]
ds_read_b64_tr_b16 a[86:87], v193 offset:43072
v_mfma_f32_16x16x32_bf16 a[180:183], a[92:95], a[20:23], a[180:183]
v_mfma_f32_16x16x32_bf16 a[180:183], a[88:91], a[4:7], a[180:183]
buffer_load_dwordx4 a[60:63], v203, s[4:7], s58 offen sc1
v_mfma_f32_16x16x32_bf16 a[184:187], a[88:91], a[8:11], a[184:187]
v_mfma_f32_16x16x32_bf16 a[184:187], a[92:95], a[24:27], a[184:187]
s_add_u32 m0, s53, 73728
v_mfma_f32_16x16x32_bf16 a[188:191], a[92:95], a[28:31], a[188:191]
s_add_u32 s56, s56, 393216
ds_read_b64_tr_b16 a[92:93], v193 offset:36936
v_mfma_f32_16x16x32_bf16 a[188:191], a[88:91], a[12:15], a[188:191]
s_waitcnt lgkmcnt(10)
ds_read_b64_tr_b16 a[88:89], v193 offset:24648
v_mfma_f32_16x16x32_bf16 v[0:3], a[64:67], a[192:195], v[0:3]
s_waitcnt lgkmcnt(10)
ds_read_b64_tr_b16 a[90:91], v193 offset:30792
v_mfma_f32_16x16x32_bf16 v[0:3], a[68:71], a[208:211], v[0:3]
L_walk1_4:
s_cbranch_execz L_walk1_8
buffer_load_dwordx4 v195, s[8:11], s56 offen lds
v_mfma_f32_16x16x32_bf16 v[4:7], a[68:71], a[212:215], v[4:7]
ds_read_b64_tr_b16 a[94:95], v193 offset:43080
v_mfma_f32_16x16x32_bf16 v[4:7], a[64:67], a[196:199], v[4:7]
v_mfma_f32_16x16x32_bf16 v[8:11], a[64:67], a[200:203], v[8:11]
v_mfma_f32_16x16x32_bf16 v[8:11], a[68:71], a[216:219], v[8:11]
v_mfma_f32_16x16x32_bf16 v[12:15], a[68:71], a[220:223], v[12:15]
ds_read_b64_tr_b16 a[68:69], v192 offset:36992
v_mfma_f32_16x16x32_bf16 v[12:15], a[64:67], a[204:207], v[12:15]
s_waitcnt lgkmcnt(10)
buffer_load_dwordx4 v196, s[8:11], s56 offen offset:1024 lds
v_mfma_f32_16x16x32_bf16 v[96:99], a[72:75], a[192:195], v[96:99]
s_waitcnt lgkmcnt(9)
ds_read_b64_tr_b16 a[64:65], v192 offset:24704
v_mfma_f32_16x16x32_bf16 v[96:99], a[76:79], a[208:211], v[96:99]
ds_read_b64_tr_b16 a[66:67], v192 offset:30848
v_mfma_f32_16x16x32_bf16 v[100:103], a[76:79], a[212:215], v[100:103]
ds_read_b64_tr_b16 a[70:71], v192 offset:43136
v_mfma_f32_16x16x32_bf16 v[100:103], a[72:75], a[196:199], v[100:103]
v_mfma_f32_16x16x32_bf16 v[104:107], a[72:75], a[200:203], v[104:107]
v_mfma_f32_16x16x32_bf16 v[104:107], a[76:79], a[216:219], v[104:107]
buffer_load_dwordx4 v197, s[8:11], s56 offen offset:2048 lds
v_mfma_f32_16x16x32_bf16 v[108:111], a[76:79], a[220:223], v[108:111]
ds_read_b64_tr_b16 a[76:77], v192 offset:37000
v_mfma_f32_16x16x32_bf16 v[108:111], a[72:75], a[204:207], v[108:111]
s_waitcnt lgkmcnt(10)
ds_read_b64_tr_b16 a[72:73], v192 offset:24712
v_mfma_f32_16x16x32_bf16 v[28:31], a[80:83], a[204:207], v[28:31]
s_waitcnt lgkmcnt(10)
ds_read_b64_tr_b16 a[74:75], v192 offset:30856
v_mfma_f32_16x16x32_bf16 v[28:31], a[84:87], a[220:223], v[28:31]
s_and_b32 s3, s1, 1073807359
ds_read_b64_tr_b16 a[78:79], v192 offset:43144
v_mfma_f32_16x16x32_bf16 v[24:27], a[84:87], a[216:219], v[24:27]
s_add_u32 s3, s3, 0
v_mfma_f32_16x16x32_bf16 v[24:27], a[80:83], a[200:203], v[24:27]
buffer_load_dword v206, v205, s[24:27], s3 offen
v_mfma_f32_16x16x32_bf16 v[20:23], a[80:83], a[196:199], v[20:23]
v_mfma_f32_16x16x32_bf16 v[20:23], a[84:87], a[212:215], v[20:23]
s_add_u32 m0, s53, 86016
v_mfma_f32_16x16x32_bf16 v[16:19], a[84:87], a[208:211], v[16:19]
s_add_u32 s56, s56, 393216
ds_read_b64_tr_b16 a[84:85], v194 offset:8192
v_mfma_f32_16x16x32_bf16 v[16:19], a[80:83], a[192:195], v[16:19]
s_waitcnt lgkmcnt(10)
ds_read_b64_tr_b16 a[80:81], v194 offset:0
v_mfma_f32_16x16x32_bf16 v[112:115], a[88:91], a[192:195], v[112:115]
s_waitcnt lgkmcnt(10)
ds_read_b64_tr_b16 a[82:83], v194 offset:2048
v_mfma_f32_16x16x32_bf16 v[112:115], a[92:95], a[208:211], v[112:115]
buffer_load_dwordx4 v195, s[8:11], s56 offen lds
v_mfma_f32_16x16x32_bf16 v[116:119], a[92:95], a[212:215], v[116:119]
ds_read_b64_tr_b16 a[86:87], v194 offset:10240
v_mfma_f32_16x16x32_bf16 v[116:119], a[88:91], a[196:199], v[116:119]
v_mfma_f32_16x16x32_bf16 v[120:123], a[88:91], a[200:203], v[120:123]
v_mfma_f32_16x16x32_bf16 v[120:123], a[92:95], a[216:219], v[120:123]
v_mfma_f32_16x16x32_bf16 v[124:127], a[92:95], a[220:223], v[124:127]
ds_read_b64_tr_b16 a[92:93], v194 offset:12288
v_mfma_f32_16x16x32_bf16 v[124:127], a[88:91], a[204:207], v[124:127]
s_waitcnt lgkmcnt(10)
buffer_load_dwordx4 v196, s[8:11], s56 offen offset:1024 lds
v_mfma_f32_16x16x32_bf16 v[44:47], a[64:67], a[204:207], v[44:47]
s_waitcnt lgkmcnt(9)
ds_read_b64_tr_b16 a[88:89], v194 offset:4096
v_mfma_f32_16x16x32_bf16 v[44:47], a[68:71], a[220:223], v[44:47]
ds_read_b64_tr_b16 a[90:91], v194 offset:6144
v_mfma_f32_16x16x32_bf16 v[40:43], a[68:71], a[216:219], v[40:43]
ds_read_b64_tr_b16 a[94:95], v194 offset:14336
v_mfma_f32_16x16x32_bf16 v[40:43], a[64:67], a[200:203], v[40:43]
v_mfma_f32_16x16x32_bf16 v[36:39], a[64:67], a[196:199], v[36:39]
v_mfma_f32_16x16x32_bf16 v[36:39], a[68:71], a[212:215], v[36:39]
buffer_load_dwordx4 v197, s[8:11], s56 offen offset:2048 lds
v_mfma_f32_16x16x32_bf16 v[32:35], a[68:71], a[208:211], v[32:35]
ds_read_b64_tr_b16 a[68:69], v194 offset:8224
v_mfma_f32_16x16x32_bf16 v[32:35], a[64:67], a[192:195], v[32:35]
s_waitcnt lgkmcnt(10)
ds_read_b64_tr_b16 a[64:65], v194 offset:32
v_mfma_f32_16x16x32_bf16 v[128:131], a[72:75], a[192:195], v[128:131]
s_waitcnt lgkmcnt(10)
ds_read_b64_tr_b16 a[66:67], v194 offset:2080
v_mfma_f32_16x16x32_bf16 v[128:131], a[76:79], a[208:211], v[128:131]
ds_read_b64_tr_b16 a[70:71], v194 offset:10272
v_mfma_f32_16x16x32_bf16 v[132:135], a[76:79], a[212:215], v[132:135]
v_mfma_f32_16x16x32_bf16 v[132:135], a[72:75], a[196:199], v[132:135]
v_mfma_f32_16x16x32_bf16 v[136:139], a[72:75], a[200:203], v[136:139]
v_mfma_f32_16x16x32_bf16 v[136:139], a[76:79], a[216:219], v[136:139]
v_mfma_f32_16x16x32_bf16 v[140:143], a[76:79], a[220:223], v[140:143]
ds_read_b64_tr_b16 a[76:77], v194 offset:12320
v_mfma_f32_16x16x32_bf16 v[140:143], a[72:75], a[204:207], v[140:143]
s_waitcnt vmcnt(14) lgkmcnt(10)
ds_read_b64_tr_b16 a[72:73], v194 offset:4128
v_mfma_f32_16x16x32_bf16 a[96:99], a[80:83], a[32:35], a[96:99]
s_waitcnt vmcnt(10) lgkmcnt(10)
ds_read_b64_tr_b16 a[74:75], v194 offset:6176
v_mfma_f32_16x16x32_bf16 a[96:99], a[84:87], a[48:51], a[96:99]
s_waitcnt vmcnt(9)
ds_read_b64_tr_b16 a[78:79], v194 offset:14368
v_mfma_f32_16x16x32_bf16 a[100:103], a[84:87], a[52:55], a[100:103]
v_mfma_f32_16x16x32_bf16 a[100:103], a[80:83], a[36:39], a[100:103]
v_mfma_f32_16x16x32_bf16 a[104:107], a[80:83], a[40:43], a[104:107]
s_waitcnt vmcnt(8)
v_mfma_f32_16x16x32_bf16 a[104:107], a[84:87], a[56:59], a[104:107]
s_waitcnt vmcnt(7)
v_accvgpr_read_b32 v207, a96
v_accvgpr_read_b32 v208, a97
v_mfma_f32_16x16x32_bf16 a[108:111], a[84:87], a[60:63], a[108:111]
ds_read_b64_tr_b16 a[84:85], v194 offset:8256
v_accvgpr_read_b32 v209, a98
v_mfma_f32_16x16x32_bf16 a[108:111], a[80:83], a[44:47], a[108:111]
s_waitcnt lgkmcnt(10)
ds_read_b64_tr_b16 a[80:81], v194 offset:64
v_accvgpr_read_b32 v210, a99
v_mfma_f32_16x16x32_bf16 a[144:147], a[88:91], a[32:35], a[144:147]
s_waitcnt lgkmcnt(10)
ds_read_b64_tr_b16 a[82:83], v194 offset:2112
v_mul_f32 v215, 0xc15db3d7, v207
v_mfma_f32_16x16x32_bf16 a[144:147], a[92:95], a[48:51], a[144:147]
ds_read_b64_tr_b16 a[86:87], v194 offset:10304
v_mul_f32 v216, 0xc15db3d7, v208
v_mfma_f32_16x16x32_bf16 a[148:151], a[92:95], a[52:55], a[148:151]
v_mul_f32 v217, 0xc15db3d7, v209
v_mul_f32 v218, 0xc15db3d7, v210
v_mfma_f32_16x16x32_bf16 a[148:151], a[88:91], a[36:39], a[148:151]
v_exp_f32 v215, v215
v_mfma_f32_16x16x32_bf16 a[152:155], a[88:91], a[40:43], a[152:155]
v_exp_f32 v216, v216
v_mfma_f32_16x16x32_bf16 a[152:155], a[92:95], a[56:59], a[152:155]
v_exp_f32 v217, v217
v_mfma_f32_16x16x32_bf16 a[156:159], a[92:95], a[60:63], a[156:159]
ds_read_b64_tr_b16 a[92:93], v194 offset:12352
v_fma_f32 v215, v215, s92, s92
v_mfma_f32_16x16x32_bf16 a[156:159], a[88:91], a[44:47], a[156:159]
s_waitcnt lgkmcnt(10)
ds_read_b64_tr_b16 a[88:89], v194 offset:4160
v_fma_f32 v216, v216, s92, s92
v_mfma_f32_16x16x32_bf16 a[124:127], a[64:67], a[44:47], a[124:127]
s_waitcnt lgkmcnt(10)
ds_read_b64_tr_b16 a[90:91], v194 offset:6208
v_fma_f32 v217, v217, s92, s92
v_mfma_f32_16x16x32_bf16 a[124:127], a[68:71], a[60:63], a[124:127]
ds_read_b64_tr_b16 a[94:95], v194 offset:14400
v_accvgpr_read_b32 v211, a144
v_mfma_f32_16x16x32_bf16 a[120:123], a[68:71], a[56:59], a[120:123]
s_and_b32 s3, s0, 1073807359
v_exp_f32 v218, v218
v_mfma_f32_16x16x32_bf16 a[120:123], a[64:67], a[40:43], a[120:123]
s_add_u32 s3, s3, 65536
v_accvgpr_read_b32 v212, a145
v_fma_f32 v218, v218, s92, s92
v_mfma_f32_16x16x32_bf16 a[116:119], a[64:67], a[36:39], a[116:119]
buffer_load_dword v206, v205, s[20:23], s3 offen
v_mfma_f32_16x16x32_bf16 a[116:119], a[68:71], a[52:55], a[116:119]
v_rcp_f32 v215, v215
v_mfma_f32_16x16x32_bf16 a[112:115], a[68:71], a[48:51], a[112:115]
ds_read_b64_tr_b16 a[68:69], v193 offset:37056
v_accvgpr_read_b32 v213, a146
v_mfma_f32_16x16x32_bf16 a[112:115], a[64:67], a[32:35], a[112:115]
s_waitcnt lgkmcnt(10)
ds_read_b64_tr_b16 a[64:65], v193 offset:24768
v_accvgpr_read_b32 v214, a147
v_mfma_f32_16x16x32_bf16 a[160:163], a[72:75], a[32:35], a[160:163]
s_waitcnt lgkmcnt(10)
ds_read_b64_tr_b16 a[66:67], v193 offset:30912
v_mul_f32 v211, v207, v211
v_mfma_f32_16x16x32_bf16 a[160:163], a[76:79], a[48:51], a[160:163]
ds_read_b64_tr_b16 a[70:71], v193 offset:43200
v_mul_f32 v212, v208, v212
v_mfma_f32_16x16x32_bf16 a[164:167], a[76:79], a[52:55], a[164:167]
v_rcp_f32 v216, v216
v_mfma_f32_16x16x32_bf16 a[164:167], a[72:75], a[36:39], a[164:167]
v_rcp_f32 v217, v217
v_mfma_f32_16x16x32_bf16 a[168:171], a[72:75], a[40:43], a[168:171]
v_rcp_f32 v218, v218
v_mfma_f32_16x16x32_bf16 a[168:171], a[76:79], a[56:59], a[168:171]
v_mul_f32 v213, v209, v213
v_mul_f32 v214, v210, v214
v_mfma_f32_16x16x32_bf16 a[172:175], a[76:79], a[60:63], a[172:175]
ds_read_b64_tr_b16 a[76:77], v193 offset:37064
v_mul_f32 v211, v211, v215
v_mfma_f32_16x16x32_bf16 a[172:175], a[72:75], a[44:47], a[172:175]
s_waitcnt lgkmcnt(10)
ds_read_b64_tr_b16 a[72:73], v193 offset:24776
v_mul_f32 v212, v212, v216
v_mfma_f32_16x16x32_bf16 a[140:143], a[80:83], a[44:47], a[140:143]
s_waitcnt lgkmcnt(10)
ds_read_b64_tr_b16 a[74:75], v193 offset:30920
v_mul_f32 v213, v213, v217
v_mfma_f32_16x16x32_bf16 a[140:143], a[84:87], a[60:63], a[140:143]
ds_read_b64_tr_b16 a[78:79], v193 offset:43208
v_mul_f32 v214, v214, v218
v_mfma_f32_16x16x32_bf16 a[136:139], a[84:87], a[56:59], a[136:139]
v_accvgpr_read_b32 v207, a112
v_accvgpr_read_b32 v208, a113
v_mfma_f32_16x16x32_bf16 a[136:139], a[80:83], a[40:43], a[136:139]
v_accvgpr_read_b32 v209, a114
v_accvgpr_read_b32 v210, a115
v_mfma_f32_16x16x32_bf16 a[132:135], a[80:83], a[36:39], a[132:135]
v_mul_f32 v215, 0xc15db3d7, v207
v_mul_f32 v216, 0xc15db3d7, v208
v_mfma_f32_16x16x32_bf16 a[132:135], a[84:87], a[52:55], a[132:135]
v_mul_f32 v217, 0xc15db3d7, v209
v_mul_f32 v218, 0xc15db3d7, v210
v_mfma_f32_16x16x32_bf16 a[128:131], a[84:87], a[48:51], a[128:131]
ds_read_b64_tr_b16 a[84:85], v192 offset:37120
v_cvt_pk_bf16_f32 v220, v211, v212
v_mfma_f32_16x16x32_bf16 a[128:131], a[80:83], a[32:35], a[128:131]
s_waitcnt lgkmcnt(10)
ds_read_b64_tr_b16 a[80:81], v192 offset:24832
v_cvt_pk_bf16_f32 v221, v213, v214
v_mfma_f32_16x16x32_bf16 a[176:179], a[88:91], a[32:35], a[176:179]
s_waitcnt lgkmcnt(10)
ds_read_b64_tr_b16 a[82:83], v192 offset:30976
v_accvgpr_read_b32 v211, a160
v_mfma_f32_16x16x32_bf16 a[176:179], a[92:95], a[48:51], a[176:179]
ds_read_b64_tr_b16 a[86:87], v192 offset:43264
v_accvgpr_read_b32 v212, a161
v_mfma_f32_16x16x32_bf16 a[180:183], a[92:95], a[52:55], a[180:183]
v_exp_f32 v215, v215
v_mfma_f32_16x16x32_bf16 a[180:183], a[88:91], a[36:39], a[180:183]
v_exp_f32 v216, v216
v_mfma_f32_16x16x32_bf16 a[184:187], a[88:91], a[40:43], a[184:187]
s_add_u32 m0, s53, 49152
v_exp_f32 v217, v217
v_mfma_f32_16x16x32_bf16 a[184:187], a[92:95], a[56:59], a[184:187]
buffer_load_dwordx4 v236, s[20:23], s59 offen lds
v_mfma_f32_16x16x32_bf16 a[188:191], a[92:95], a[60:63], a[188:191]
ds_read_b64_tr_b16 a[92:93], v192 offset:37128
v_fma_f32 v215, v215, s92, s92
v_mfma_f32_16x16x32_bf16 a[188:191], a[88:91], a[44:47], a[188:191]
s_waitcnt lgkmcnt(10)
ds_read_b64_tr_b16 a[88:89], v192 offset:24840
v_fma_f32 v216, v216, s92, s92
v_mfma_f32_16x16x32_bf16 v[48:51], a[64:67], a[192:195], v[48:51]
s_waitcnt lgkmcnt(10)
ds_read_b64_tr_b16 a[90:91], v192 offset:30984
v_fma_f32 v217, v217, s92, s92
v_mfma_f32_16x16x32_bf16 v[48:51], a[68:71], a[208:211], v[48:51]
ds_read_b64_tr_b16 a[94:95], v192 offset:43272
v_accvgpr_read_b32 v213, a162
v_mfma_f32_16x16x32_bf16 v[52:55], a[68:71], a[212:215], v[52:55]
v_exp_f32 v218, v218
v_mfma_f32_16x16x32_bf16 v[52:55], a[64:67], a[196:199], v[52:55]
buffer_load_dwordx4 v237, s[20:23], s59 offen offset:1024 lds
v_mfma_f32_16x16x32_bf16 v[56:59], a[64:67], a[200:203], v[56:59]
v_accvgpr_read_b32 v214, a163
v_fma_f32 v218, v218, s92, s92
v_mfma_f32_16x16x32_bf16 v[56:59], a[68:71], a[216:219], v[56:59]
v_rcp_f32 v215, v215
v_mfma_f32_16x16x32_bf16 v[60:63], a[68:71], a[220:223], v[60:63]
ds_read_b64_tr_b16 a[68:69], v193 offset:37184
v_mul_f32 v211, v207, v211
v_mfma_f32_16x16x32_bf16 v[60:63], a[64:67], a[204:207], v[60:63]
s_waitcnt lgkmcnt(10)
ds_read_b64_tr_b16 a[64:65], v193 offset:24896
v_mul_f32 v212, v208, v212
v_mfma_f32_16x16x32_bf16 v[144:147], a[72:75], a[192:195], v[144:147]
s_waitcnt lgkmcnt(10)
ds_read_b64_tr_b16 a[66:67], v193 offset:31040
v_mul_f32 v213, v209, v213
v_mfma_f32_16x16x32_bf16 v[144:147], a[76:79], a[208:211], v[144:147]
buffer_load_dwordx4 v238, s[20:23], s59 offen offset:2048 lds
v_mfma_f32_16x16x32_bf16 v[148:151], a[76:79], a[212:215], v[148:151]
ds_read_b64_tr_b16 a[70:71], v193 offset:43328
v_mul_f32 v214, v210, v214
v_mfma_f32_16x16x32_bf16 v[148:151], a[72:75], a[196:199], v[148:151]
v_rcp_f32 v216, v216
v_mfma_f32_16x16x32_bf16 v[152:155], a[72:75], a[200:203], v[152:155]
v_rcp_f32 v217, v217
v_mfma_f32_16x16x32_bf16 v[152:155], a[76:79], a[216:219], v[152:155]
v_rcp_f32 v218, v218
v_mfma_f32_16x16x32_bf16 v[156:159], a[76:79], a[220:223], v[156:159]
ds_read_b64_tr_b16 a[76:77], v193 offset:37192
v_mul_f32 v211, v211, v215
v_mfma_f32_16x16x32_bf16 v[156:159], a[72:75], a[204:207], v[156:159]
s_waitcnt lgkmcnt(10)
ds_read_b64_tr_b16 a[72:73], v193 offset:24904
v_mul_f32 v212, v212, v216
v_mfma_f32_16x16x32_bf16 v[76:79], a[80:83], a[204:207], v[76:79]
s_waitcnt lgkmcnt(10)
ds_read_b64_tr_b16 a[74:75], v193 offset:31048
v_mul_f32 v213, v213, v217
v_mfma_f32_16x16x32_bf16 v[76:79], a[84:87], a[220:223], v[76:79]
ds_read_b64_tr_b16 a[78:79], v193 offset:43336
v_mul_f32 v214, v214, v218
v_mfma_f32_16x16x32_bf16 v[72:75], a[84:87], a[216:219], v[72:75]
v_cvt_pk_bf16_f32 v222, v211, v212
v_cvt_pk_bf16_f32 v223, v213, v214
v_mfma_f32_16x16x32_bf16 v[72:75], a[80:83], a[200:203], v[72:75]
v_permlane32_swap_b32 v220, v222
v_permlane32_swap_b32 v221, v223
v_mfma_f32_16x16x32_bf16 v[68:71], a[80:83], a[196:199], v[68:71]
buffer_store_dwordx4 v[220:223], v200, s[4:7], s62 offen sc1
v_mfma_f32_16x16x32_bf16 v[68:71], a[84:87], a[212:215], v[68:71]
v_accvgpr_read_b32 v207, a100
v_accvgpr_read_b32 v208, a101
v_mfma_f32_16x16x32_bf16 v[64:67], a[84:87], a[208:211], v[64:67]
v_accvgpr_read_b32 v209, a102
v_accvgpr_read_b32 v210, a103
v_mfma_f32_16x16x32_bf16 v[64:67], a[80:83], a[192:195], v[64:67]
s_waitcnt lgkmcnt(9)
v_mul_f32 v215, 0xc15db3d7, v207
v_mul_f32 v216, 0xc15db3d7, v208
v_mfma_f32_16x16x32_bf16 v[160:163], a[88:91], a[192:195], v[160:163]
s_waitcnt lgkmcnt(8)
v_mul_f32 v217, 0xc15db3d7, v209
v_mul_f32 v218, 0xc15db3d7, v210
v_mfma_f32_16x16x32_bf16 v[160:163], a[92:95], a[208:211], v[160:163]
v_exp_f32 v215, v215
v_mfma_f32_16x16x32_bf16 v[164:167], a[92:95], a[212:215], v[164:167]
v_exp_f32 v216, v216
v_mfma_f32_16x16x32_bf16 v[164:167], a[88:91], a[196:199], v[164:167]
v_exp_f32 v217, v217
v_mfma_f32_16x16x32_bf16 v[168:171], a[88:91], a[200:203], v[168:171]
v_exp_f32 v218, v218
v_mfma_f32_16x16x32_bf16 v[168:171], a[92:95], a[216:219], v[168:171]
v_fma_f32 v215, v215, s92, s92
v_fma_f32 v216, v216, s92, s92
v_mfma_f32_16x16x32_bf16 v[172:175], a[92:95], a[220:223], v[172:175]
v_fma_f32 v217, v217, s92, s92
v_fma_f32 v218, v218, s92, s92
v_mfma_f32_16x16x32_bf16 v[172:175], a[88:91], a[204:207], v[172:175]
s_waitcnt lgkmcnt(5)
v_rcp_f32 v215, v215
v_mfma_f32_16x16x32_bf16 v[92:95], a[64:67], a[204:207], v[92:95]
s_waitcnt lgkmcnt(4)
v_rcp_f32 v216, v216
v_mfma_f32_16x16x32_bf16 v[92:95], a[68:71], a[220:223], v[92:95]
s_add_u32 m0, s53, 24576
v_rcp_f32 v217, v217
v_mfma_f32_16x16x32_bf16 v[88:91], a[68:71], a[216:219], v[88:91]
s_add_u32 s56, s56, 393216
v_rcp_f32 v218, v218
v_mfma_f32_16x16x32_bf16 v[88:91], a[64:67], a[200:203], v[88:91]
s_waitcnt lgkmcnt(0)
s_barrier
v_mfma_f32_16x16x32_bf16 v[84:87], a[64:67], a[196:199], v[84:87]
buffer_load_dwordx4 v195, s[8:11], s56 offen lds
v_mfma_f32_16x16x32_bf16 v[84:87], a[68:71], a[212:215], v[84:87]
ds_read_b64_tr_b16 a[80:81], v192 offset:0
v_accvgpr_read_b32 v211, a148
v_mfma_f32_16x16x32_bf16 v[80:83], a[68:71], a[208:211], v[80:83]
ds_read_b64_tr_b16 a[82:83], v192 offset:6144
v_accvgpr_read_b32 v212, a149
v_mfma_f32_16x16x32_bf16 v[80:83], a[64:67], a[192:195], v[80:83]
ds_read_b64_tr_b16 a[84:85], v192 offset:12288
ds_read_b64_tr_b16 a[86:87], v192 offset:18432
v_mfma_f32_16x16x32_bf16 v[176:179], a[72:75], a[192:195], v[176:179]
ds_read_b64_tr_b16 a[88:89], v192 offset:8
v_accvgpr_read_b32 v213, a150
v_mfma_f32_16x16x32_bf16 v[176:179], a[76:79], a[208:211], v[176:179]
ds_read_b64_tr_b16 a[90:91], v192 offset:6152
v_accvgpr_read_b32 v214, a151
v_mfma_f32_16x16x32_bf16 v[180:183], a[76:79], a[212:215], v[180:183]
buffer_load_dwordx4 v196, s[8:11], s56 offen offset:1024 lds
v_mfma_f32_16x16x32_bf16 v[180:183], a[72:75], a[196:199], v[180:183]
ds_read_b64_tr_b16 a[92:93], v192 offset:12296
v_mul_f32 v211, v207, v211
v_mfma_f32_16x16x32_bf16 v[184:187], a[72:75], a[200:203], v[184:187]
ds_read_b64_tr_b16 a[94:95], v192 offset:18440
v_mul_f32 v212, v208, v212
v_mfma_f32_16x16x32_bf16 v[184:187], a[76:79], a[216:219], v[184:187]
ds_read_b64_tr_b16 a[64:65], v193 offset:64
v_mul_f32 v213, v209, v213
v_mfma_f32_16x16x32_bf16 v[188:191], a[76:79], a[220:223], v[188:191]
ds_read_b64_tr_b16 a[66:67], v193 offset:6208
v_mul_f32 v214, v210, v214
v_mfma_f32_16x16x32_bf16 v[188:191], a[72:75], a[204:207], v[188:191]
s_waitcnt lgkmcnt(8)
ds_read_b64_tr_b16 a[68:69], v193 offset:12352
v_mul_f32 v211, v211, v215
v_mfma_f32_16x16x32_bf16 v[0:3], a[80:83], a[224:227], v[0:3]
s_waitcnt lgkmcnt(7)
buffer_load_dwordx4 v197, s[8:11], s56 offen offset:2048 lds
v_mfma_f32_16x16x32_bf16 v[0:3], a[84:87], a[240:243], v[0:3]
ds_read_b64_tr_b16 a[70:71], v193 offset:18496
v_mul_f32 v212, v212, v216
v_mfma_f32_16x16x32_bf16 v[4:7], a[84:87], a[244:247], v[4:7]
ds_read_b64_tr_b16 a[72:73], v193 offset:72
v_mul_f32 v213, v213, v217
v_mfma_f32_16x16x32_bf16 v[4:7], a[80:83], a[228:231], v[4:7]
ds_read_b64_tr_b16 a[74:75], v193 offset:6216
v_mul_f32 v214, v214, v218
v_mfma_f32_16x16x32_bf16 v[8:11], a[80:83], a[232:235], v[8:11]
s_add_u32 m0, s53, 36864
ds_read_b64_tr_b16 a[76:77], v193 offset:12360
v_accvgpr_read_b32 v207, a116
v_mfma_f32_16x16x32_bf16 v[8:11], a[84:87], a[248:251], v[8:11]
s_add_u32 s56, s56, 393216
ds_read_b64_tr_b16 a[78:79], v193 offset:18504
v_accvgpr_read_b32 v208, a117
v_mfma_f32_16x16x32_bf16 v[12:15], a[84:87], a[252:255], v[12:15]
buffer_load_dwordx4 v195, s[8:11], s56 offen lds
v_mfma_f32_16x16x32_bf16 v[12:15], a[80:83], a[236:239], v[12:15]
s_waitcnt lgkmcnt(10)
ds_read_b64_tr_b16 a[80:81], v192 offset:128
v_accvgpr_read_b32 v209, a118
v_mfma_f32_16x16x32_bf16 v[96:99], a[88:91], a[224:227], v[96:99]
s_waitcnt lgkmcnt(9)
ds_read_b64_tr_b16 a[82:83], v192 offset:6272
v_accvgpr_read_b32 v210, a119
v_mfma_f32_16x16x32_bf16 v[96:99], a[92:95], a[240:243], v[96:99]
ds_read_b64_tr_b16 a[84:85], v192 offset:12416
v_mul_f32 v215, 0xc15db3d7, v207
v_mfma_f32_16x16x32_bf16 v[100:103], a[92:95], a[244:247], v[100:103]
ds_read_b64_tr_b16 a[86:87], v192 offset:18560
v_mul_f32 v216, 0xc15db3d7, v208
v_mfma_f32_16x16x32_bf16 v[100:103], a[88:91], a[228:231], v[100:103]
v_mul_f32 v217, 0xc15db3d7, v209
v_mul_f32 v218, 0xc15db3d7, v210
v_mfma_f32_16x16x32_bf16 v[104:107], a[88:91], a[232:235], v[104:107]
buffer_load_dwordx4 v196, s[8:11], s56 offen offset:1024 lds
v_mfma_f32_16x16x32_bf16 v[104:107], a[92:95], a[248:251], v[104:107]
v_exp_f32 v215, v215
v_mfma_f32_16x16x32_bf16 v[108:111], a[92:95], a[252:255], v[108:111]
ds_read_b64_tr_b16 a[92:93], v192 offset:12424
v_fma_f32 v215, v215, s92, s92
v_mfma_f32_16x16x32_bf16 v[108:111], a[88:91], a[236:239], v[108:111]
s_waitcnt lgkmcnt(11)
ds_read_b64_tr_b16 a[88:89], v192 offset:136
v_cvt_pk_bf16_f32 v220, v211, v212
v_mfma_f32_16x16x32_bf16 v[28:31], a[64:67], a[236:239], v[28:31]
s_waitcnt lgkmcnt(10)
ds_read_b64_tr_b16 a[90:91], v192 offset:6280
v_cvt_pk_bf16_f32 v221, v213, v214
v_mfma_f32_16x16x32_bf16 v[28:31], a[68:71], a[252:255], v[28:31]
ds_read_b64_tr_b16 a[94:95], v192 offset:18568
v_accvgpr_read_b32 v211, a164
v_mfma_f32_16x16x32_bf16 v[24:27], a[68:71], a[248:251], v[24:27]
buffer_load_dwordx4 v197, s[8:11], s56 offen offset:2048 lds
v_mfma_f32_16x16x32_bf16 v[24:27], a[64:67], a[232:235], v[24:27]
v_exp_f32 v216, v216
v_mfma_f32_16x16x32_bf16 v[20:23], a[64:67], a[228:231], v[20:23]
v_exp_f32 v217, v217
v_mfma_f32_16x16x32_bf16 v[20:23], a[68:71], a[244:247], v[20:23]
v_exp_f32 v218, v218
v_mfma_f32_16x16x32_bf16 v[16:19], a[68:71], a[240:243], v[16:19]
s_add_u32 s3, s1, 0
ds_read_b64_tr_b16 a[68:69], v193 offset:12480
v_fma_f32 v216, v216, s92, s92
v_mfma_f32_16x16x32_bf16 v[16:19], a[64:67], a[224:227], v[16:19]
s_waitcnt lgkmcnt(11)
ds_read_b64_tr_b16 a[64:65], v193 offset:192
v_fma_f32 v217, v217, s92, s92
v_mfma_f32_16x16x32_bf16 v[112:115], a[72:75], a[224:227], v[112:115]
s_waitcnt lgkmcnt(10)
buffer_load_dword v206, v205, s[32:35], s3 offen
v_mfma_f32_16x16x32_bf16 v[112:115], a[76:79], a[240:243], v[112:115]
ds_read_b64_tr_b16 a[66:67], v193 offset:6336
v_fma_f32 v218, v218, s92, s92
v_mfma_f32_16x16x32_bf16 v[116:119], a[76:79], a[244:247], v[116:119]
ds_read_b64_tr_b16 a[70:71], v193 offset:18624
v_accvgpr_read_b32 v212, a165
v_mfma_f32_16x16x32_bf16 v[116:119], a[72:75], a[228:231], v[116:119]
v_rcp_f32 v215, v215
v_mfma_f32_16x16x32_bf16 v[120:123], a[72:75], a[232:235], v[120:123]
s_add_u32 m0, s53, 61440
v_rcp_f32 v216, v216
v_mfma_f32_16x16x32_bf16 v[120:123], a[76:79], a[248:251], v[120:123]
s_add_u32 s59, s59, 12288
v_rcp_f32 v217, v217
v_mfma_f32_16x16x32_bf16 v[124:127], a[76:79], a[252:255], v[124:127]
buffer_load_dwordx4 v236, s[20:23], s59 offen lds
v_mfma_f32_16x16x32_bf16 v[124:127], a[72:75], a[236:239], v[124:127]
s_waitcnt lgkmcnt(10)
ds_read_b64_tr_b16 a[72:73], v193 offset:200
v_accvgpr_read_b32 v213, a166
v_mfma_f32_16x16x32_bf16 v[44:47], a[80:83], a[236:239], v[44:47]
s_waitcnt lgkmcnt(9)
ds_read_b64_tr_b16 a[74:75], v193 offset:6344
v_accvgpr_read_b32 v214, a167
v_mfma_f32_16x16x32_bf16 v[44:47], a[84:87], a[252:255], v[44:47]
ds_read_b64_tr_b16 a[76:77], v193 offset:12488
v_mul_f32 v211, v207, v211
v_mfma_f32_16x16x32_bf16 v[40:43], a[84:87], a[248:251], v[40:43]
ds_read_b64_tr_b16 a[78:79], v193 offset:18632
v_mul_f32 v212, v208, v212
v_mfma_f32_16x16x32_bf16 v[40:43], a[80:83], a[232:235], v[40:43]
v_rcp_f32 v218, v218
v_mfma_f32_16x16x32_bf16 v[36:39], a[80:83], a[228:231], v[36:39]
buffer_load_dwordx4 v237, s[20:23], s59 offen offset:1024 lds
v_mfma_f32_16x16x32_bf16 v[36:39], a[84:87], a[244:247], v[36:39]
v_mul_f32 v213, v209, v213
v_mul_f32 v214, v210, v214
v_mfma_f32_16x16x32_bf16 v[32:35], a[84:87], a[240:243], v[32:35]
ds_read_b64_tr_b16 a[84:85], v192 offset:12544
v_mul_f32 v211, v211, v215
v_mfma_f32_16x16x32_bf16 v[32:35], a[80:83], a[224:227], v[32:35]
s_waitcnt lgkmcnt(10)
ds_read_b64_tr_b16 a[80:81], v192 offset:256
v_mul_f32 v212, v212, v216
v_mfma_f32_16x16x32_bf16 v[128:131], a[88:91], a[224:227], v[128:131]
s_waitcnt lgkmcnt(10)
ds_read_b64_tr_b16 a[82:83], v192 offset:6400
v_mul_f32 v213, v213, v217
v_mfma_f32_16x16x32_bf16 v[128:131], a[92:95], a[240:243], v[128:131]
ds_read_b64_tr_b16 a[86:87], v192 offset:18688
v_mul_f32 v214, v214, v218
v_mfma_f32_16x16x32_bf16 v[132:135], a[92:95], a[244:247], v[132:135]
buffer_load_dwordx4 v238, s[20:23], s59 offen offset:2048 lds
v_mfma_f32_16x16x32_bf16 v[132:135], a[88:91], a[228:231], v[132:135]
v_cvt_pk_bf16_f32 v222, v211, v212
v_cvt_pk_bf16_f32 v223, v213, v214
v_mfma_f32_16x16x32_bf16 v[136:139], a[88:91], a[232:235], v[136:139]
v_permlane32_swap_b32 v220, v222
v_permlane32_swap_b32 v221, v223
v_mfma_f32_16x16x32_bf16 v[136:139], a[92:95], a[248:251], v[136:139]
v_accvgpr_read_b32 v207, a104
v_accvgpr_read_b32 v208, a105
v_mfma_f32_16x16x32_bf16 v[140:143], a[92:95], a[252:255], v[140:143]
ds_read_b64_tr_b16 a[92:93], v192 offset:12552
v_accvgpr_read_b32 v209, a106
v_mfma_f32_16x16x32_bf16 v[140:143], a[88:91], a[236:239], v[140:143]
s_waitcnt lgkmcnt(10)
ds_read_b64_tr_b16 a[88:89], v192 offset:264
v_accvgpr_read_b32 v210, a107
v_mfma_f32_16x16x32_bf16 v[60:63], a[64:67], a[236:239], v[60:63]
s_waitcnt lgkmcnt(10)
ds_read_b64_tr_b16 a[90:91], v192 offset:6408
v_mul_f32 v215, 0xc15db3d7, v207
v_mfma_f32_16x16x32_bf16 v[60:63], a[68:71], a[252:255], v[60:63]
ds_read_b64_tr_b16 a[94:95], v192 offset:18696
v_xor_b32 v192, 32768, v192
v_mfma_f32_16x16x32_bf16 v[56:59], a[68:71], a[248:251], v[56:59]
buffer_store_dwordx4 v[220:223], v201, s[4:7], s62 offen sc1
v_mfma_f32_16x16x32_bf16 v[56:59], a[64:67], a[232:235], v[56:59]
v_mul_f32 v216, 0xc15db3d7, v208
v_mul_f32 v217, 0xc15db3d7, v209
v_mfma_f32_16x16x32_bf16 v[52:55], a[64:67], a[228:231], v[52:55]
v_mul_f32 v218, 0xc15db3d7, v210
v_accvgpr_read_b32 v211, a152
v_mfma_f32_16x16x32_bf16 v[52:55], a[68:71], a[244:247], v[52:55]
v_exp_f32 v215, v215
v_mfma_f32_16x16x32_bf16 v[48:51], a[68:71], a[240:243], v[48:51]
ds_read_b64_tr_b16 a[68:69], v193 offset:12608
v_fma_f32 v215, v215, s92, s92
v_mfma_f32_16x16x32_bf16 v[48:51], a[64:67], a[224:227], v[48:51]
s_waitcnt lgkmcnt(11)
ds_read_b64_tr_b16 a[64:65], v193 offset:320
v_accvgpr_read_b32 v212, a153
v_mfma_f32_16x16x32_bf16 v[144:147], a[72:75], a[224:227], v[144:147]
s_waitcnt lgkmcnt(10)
ds_read_b64_tr_b16 a[66:67], v193 offset:6464
v_accvgpr_read_b32 v213, a154
v_mfma_f32_16x16x32_bf16 v[144:147], a[76:79], a[240:243], v[144:147]
ds_read_b64_tr_b16 a[70:71], v193 offset:18752
v_accvgpr_read_b32 v214, a155
v_mfma_f32_16x16x32_bf16 v[148:151], a[76:79], a[244:247], v[148:151]
v_exp_f32 v216, v216
v_mfma_f32_16x16x32_bf16 v[148:151], a[72:75], a[228:231], v[148:151]
v_exp_f32 v217, v217
v_mfma_f32_16x16x32_bf16 v[152:155], a[72:75], a[232:235], v[152:155]
v_exp_f32 v218, v218
v_mfma_f32_16x16x32_bf16 v[152:155], a[76:79], a[248:251], v[152:155]
v_fma_f32 v216, v216, s92, s92
v_fma_f32 v217, v217, s92, s92
v_mfma_f32_16x16x32_bf16 v[156:159], a[76:79], a[252:255], v[156:159]
ds_read_b64_tr_b16 a[76:77], v193 offset:12616
v_fma_f32 v218, v218, s92, s92
v_mfma_f32_16x16x32_bf16 v[156:159], a[72:75], a[236:239], v[156:159]
s_waitcnt lgkmcnt(10)
ds_read_b64_tr_b16 a[72:73], v193 offset:328
v_mul_f32 v211, v207, v211
v_mfma_f32_16x16x32_bf16 v[76:79], a[80:83], a[236:239], v[76:79]
s_waitcnt lgkmcnt(10)
ds_read_b64_tr_b16 a[74:75], v193 offset:6472
v_mul_f32 v212, v208, v212
v_mfma_f32_16x16x32_bf16 v[76:79], a[84:87], a[252:255], v[76:79]
ds_read_b64_tr_b16 a[78:79], v193 offset:18760
v_xor_b32 v193, 32768, v193
v_mfma_f32_16x16x32_bf16 v[72:75], a[84:87], a[248:251], v[72:75]
v_rcp_f32 v215, v215
v_mfma_f32_16x16x32_bf16 v[72:75], a[80:83], a[232:235], v[72:75]
v_rcp_f32 v216, v216
v_mfma_f32_16x16x32_bf16 v[68:71], a[80:83], a[228:231], v[68:71]
v_rcp_f32 v217, v217
v_mfma_f32_16x16x32_bf16 v[68:71], a[84:87], a[244:247], v[68:71]
v_rcp_f32 v218, v218
v_mfma_f32_16x16x32_bf16 v[64:67], a[84:87], a[240:243], v[64:67]
v_mul_f32 v213, v209, v213
v_mul_f32 v214, v210, v214
v_mfma_f32_16x16x32_bf16 v[64:67], a[80:83], a[224:227], v[64:67]
s_waitcnt lgkmcnt(9)
v_mul_f32 v211, v211, v215
v_mul_f32 v212, v212, v216
v_mfma_f32_16x16x32_bf16 v[160:163], a[88:91], a[224:227], v[160:163]
s_waitcnt lgkmcnt(8)
v_mul_f32 v213, v213, v217
v_mul_f32 v214, v214, v218
v_mfma_f32_16x16x32_bf16 v[160:163], a[92:95], a[240:243], v[160:163]
L_walk1_5:
s_cbranch_execz L_walk1_9
v_accvgpr_read_b32 v207, a120
v_accvgpr_read_b32 v208, a121
v_mfma_f32_16x16x32_bf16 v[164:167], a[92:95], a[244:247], v[164:167]
v_accvgpr_read_b32 v209, a122
v_accvgpr_read_b32 v210, a123
v_mfma_f32_16x16x32_bf16 v[164:167], a[88:91], a[228:231], v[164:167]
v_mul_f32 v215, 0xc15db3d7, v207
v_mul_f32 v216, 0xc15db3d7, v208
v_mfma_f32_16x16x32_bf16 v[168:171], a[88:91], a[232:235], v[168:171]
v_mul_f32 v217, 0xc15db3d7, v209
v_mul_f32 v218, 0xc15db3d7, v210
v_mfma_f32_16x16x32_bf16 v[168:171], a[92:95], a[248:251], v[168:171]
v_exp_f32 v215, v215
v_mfma_f32_16x16x32_bf16 v[172:175], a[92:95], a[252:255], v[172:175]
v_exp_f32 v216, v216
v_mfma_f32_16x16x32_bf16 v[172:175], a[88:91], a[236:239], v[172:175]
s_waitcnt lgkmcnt(5)
v_exp_f32 v217, v217
v_mfma_f32_16x16x32_bf16 v[92:95], a[64:67], a[236:239], v[92:95]
s_waitcnt lgkmcnt(4)
v_exp_f32 v218, v218
v_mfma_f32_16x16x32_bf16 v[92:95], a[68:71], a[252:255], v[92:95]
v_fma_f32 v215, v215, s92, s92
v_fma_f32 v216, v216, s92, s92
v_mfma_f32_16x16x32_bf16 v[88:91], a[68:71], a[248:251], v[88:91]
s_add_u32 m0, s53, 0
v_fma_f32 v217, v217, s92, s92
v_fma_f32 v218, v218, s92, s92
v_mfma_f32_16x16x32_bf16 v[88:91], a[64:67], a[232:235], v[88:91]
s_waitcnt vmcnt(16) lgkmcnt(0)
s_barrier
v_mfma_f32_16x16x32_bf16 v[84:87], a[64:67], a[228:231], v[84:87]
buffer_load_dwordx4 v239, s[24:27], s60 offen lds
v_mfma_f32_16x16x32_bf16 v[84:87], a[68:71], a[244:247], v[84:87]
ds_read_b64_tr_b16 a[80:81], v192 offset:40960
v_cvt_pk_bf16_f32 v220, v211, v212
v_mfma_f32_16x16x32_bf16 v[80:83], a[68:71], a[240:243], v[80:83]
ds_read_b64_tr_b16 a[82:83], v192 offset:47104
v_cvt_pk_bf16_f32 v221, v213, v214
v_mfma_f32_16x16x32_bf16 v[80:83], a[64:67], a[224:227], v[80:83]
ds_read_b64_tr_b16 a[84:85], v192 offset:53248
ds_read_b64_tr_b16 a[86:87], v192 offset:59392
v_mfma_f32_16x16x32_bf16 v[176:179], a[72:75], a[224:227], v[176:179]
ds_read_b64_tr_b16 a[88:89], v192 offset:40968
v_accvgpr_read_b32 v211, a168
v_mfma_f32_16x16x32_bf16 v[176:179], a[76:79], a[240:243], v[176:179]
ds_read_b64_tr_b16 a[90:91], v192 offset:47112
v_accvgpr_read_b32 v212, a169
v_mfma_f32_16x16x32_bf16 v[180:183], a[76:79], a[244:247], v[180:183]
buffer_load_dwordx4 v240, s[24:27], s60 offen offset:1024 lds
v_mfma_f32_16x16x32_bf16 v[180:183], a[72:75], a[228:231], v[180:183]
ds_read_b64_tr_b16 a[92:93], v192 offset:53256
v_accvgpr_read_b32 v213, a170
v_mfma_f32_16x16x32_bf16 v[184:187], a[72:75], a[232:235], v[184:187]
ds_read_b64_tr_b16 a[94:95], v192 offset:59400
v_accvgpr_read_b32 v214, a171
v_mfma_f32_16x16x32_bf16 v[184:187], a[76:79], a[248:251], v[184:187]
ds_read_b64_tr_b16 a[64:65], v193 offset:41024
v_mul_f32 v211, v207, v211
v_mfma_f32_16x16x32_bf16 v[188:191], a[76:79], a[252:255], v[188:191]
ds_read_b64_tr_b16 a[66:67], v193 offset:47168
v_mul_f32 v212, v208, v212
v_mfma_f32_16x16x32_bf16 v[188:191], a[72:75], a[236:239], v[188:191]
s_waitcnt lgkmcnt(8)
ds_read_b64_tr_b16 a[68:69], v193 offset:53312
v_mul_f32 v213, v209, v213
v_mfma_f32_16x16x32_bf16 v[0:3], a[80:83], a[0:3], v[0:3]
s_waitcnt lgkmcnt(7)
buffer_load_dwordx4 v241, s[24:27], s60 offen offset:2048 lds
v_mfma_f32_16x16x32_bf16 v[0:3], a[84:87], a[16:19], v[0:3]
ds_read_b64_tr_b16 a[70:71], v193 offset:59456
v_mul_f32 v214, v210, v214
v_mfma_f32_16x16x32_bf16 v[4:7], a[84:87], a[20:23], v[4:7]
ds_read_b64_tr_b16 a[72:73], v193 offset:41032
v_accvgpr_read_b32 v207, a108
v_mfma_f32_16x16x32_bf16 v[4:7], a[80:83], a[4:7], v[4:7]
ds_read_b64_tr_b16 a[74:75], v193 offset:47176
v_accvgpr_read_b32 v208, a109
v_mfma_f32_16x16x32_bf16 v[8:11], a[80:83], a[8:11], v[8:11]
s_add_u32 m0, s53, 12288
ds_read_b64_tr_b16 a[76:77], v193 offset:53320
v_accvgpr_read_b32 v209, a110
v_mfma_f32_16x16x32_bf16 v[8:11], a[84:87], a[24:27], v[8:11]
s_add_u32 s60, s60, 12288
ds_read_b64_tr_b16 a[78:79], v193 offset:59464
v_accvgpr_read_b32 v210, a111
v_mfma_f32_16x16x32_bf16 v[12:15], a[84:87], a[28:31], v[12:15]
buffer_load_dwordx4 v239, s[24:27], s60 offen lds
v_mfma_f32_16x16x32_bf16 v[12:15], a[80:83], a[12:15], v[12:15]
s_waitcnt lgkmcnt(10)
v_rcp_f32 v215, v215
v_mfma_f32_16x16x32_bf16 v[96:99], a[88:91], a[0:3], v[96:99]
s_waitcnt lgkmcnt(8)
ds_read_b64_tr_b16 a[80:81], v192 offset:41088
v_mul_f32 v211, v211, v215
v_mfma_f32_16x16x32_bf16 v[96:99], a[92:95], a[16:19], v[96:99]
ds_read_b64_tr_b16 a[82:83], v192 offset:47232
v_mul_f32 v215, 0xc15db3d7, v207
v_mfma_f32_16x16x32_bf16 v[100:103], a[92:95], a[20:23], v[100:103]
v_rcp_f32 v216, v216
v_mfma_f32_16x16x32_bf16 v[100:103], a[88:91], a[4:7], v[100:103]
ds_read_b64_tr_b16 a[84:85], v192 offset:53376
v_mul_f32 v212, v212, v216
v_mfma_f32_16x16x32_bf16 v[104:107], a[88:91], a[8:11], v[104:107]
buffer_load_dwordx4 v240, s[24:27], s60 offen offset:1024 lds
v_mfma_f32_16x16x32_bf16 v[104:107], a[92:95], a[24:27], v[104:107]
ds_read_b64_tr_b16 a[86:87], v192 offset:59520
v_cvt_pk_bf16_f32 v222, v211, v212
v_mfma_f32_16x16x32_bf16 v[108:111], a[92:95], a[28:31], v[108:111]
ds_read_b64_tr_b16 a[92:93], v192 offset:53384
v_permlane32_swap_b32 v220, v222
v_mfma_f32_16x16x32_bf16 v[108:111], a[88:91], a[12:15], v[108:111]
s_waitcnt lgkmcnt(11)
ds_read_b64_tr_b16 a[88:89], v192 offset:41096
v_mul_f32 v216, 0xc15db3d7, v208
v_mfma_f32_16x16x32_bf16 v[28:31], a[64:67], a[12:15], v[28:31]
s_waitcnt lgkmcnt(10)
ds_read_b64_tr_b16 a[90:91], v192 offset:47240
v_accvgpr_read_b32 v211, a156
v_mfma_f32_16x16x32_bf16 v[28:31], a[68:71], a[28:31], v[28:31]
ds_read_b64_tr_b16 a[94:95], v192 offset:59528
v_accvgpr_read_b32 v212, a157
v_mfma_f32_16x16x32_bf16 v[24:27], a[68:71], a[24:27], v[24:27]
buffer_load_dwordx4 v241, s[24:27], s60 offen offset:2048 lds
v_mfma_f32_16x16x32_bf16 v[24:27], a[64:67], a[8:11], v[24:27]
v_rcp_f32 v217, v217
v_mfma_f32_16x16x32_bf16 v[20:23], a[64:67], a[4:7], v[20:23]
v_rcp_f32 v218, v218
v_mfma_f32_16x16x32_bf16 v[20:23], a[68:71], a[20:23], v[20:23]
v_mul_f32 v213, v213, v217
v_mul_f32 v214, v214, v218
v_mfma_f32_16x16x32_bf16 v[16:19], a[68:71], a[16:19], v[16:19]
ds_read_b64_tr_b16 a[68:69], v193 offset:53440
v_cvt_pk_bf16_f32 v223, v213, v214
v_mfma_f32_16x16x32_bf16 v[16:19], a[64:67], a[0:3], v[16:19]
s_waitcnt lgkmcnt(11)
ds_read_b64_tr_b16 a[64:65], v193 offset:41152
v_permlane32_swap_b32 v221, v223
v_mfma_f32_16x16x32_bf16 v[112:115], a[72:75], a[0:3], v[112:115]
s_waitcnt lgkmcnt(10)
ds_read_b64_tr_b16 a[66:67], v193 offset:47296
v_mul_f32 v217, 0xc15db3d7, v209
v_mfma_f32_16x16x32_bf16 v[112:115], a[76:79], a[16:19], v[112:115]
ds_read_b64_tr_b16 a[70:71], v193 offset:59584
v_mul_f32 v218, 0xc15db3d7, v210
v_mfma_f32_16x16x32_bf16 v[116:119], a[76:79], a[20:23], v[116:119]
buffer_store_dwordx4 v[220:223], v202, s[4:7], s62 offen sc1
v_mfma_f32_16x16x32_bf16 v[116:119], a[72:75], a[4:7], v[116:119]
v_exp_f32 v215, v215
v_mfma_f32_16x16x32_bf16 v[120:123], a[72:75], a[8:11], v[120:123]
s_and_b32 s3, s0, 1073807359
v_exp_f32 v216, v216
v_mfma_f32_16x16x32_bf16 v[120:123], a[76:79], a[24:27], v[120:123]
s_add_u32 s3, s3, 65536
v_exp_f32 v217, v217
v_mfma_f32_16x16x32_bf16 v[124:127], a[76:79], a[28:31], v[124:127]
buffer_load_dword v206, v205, s[24:27], s3 offen
v_mfma_f32_16x16x32_bf16 v[124:127], a[72:75], a[12:15], v[124:127]
s_waitcnt lgkmcnt(10)
ds_read_b64_tr_b16 a[72:73], v193 offset:41160
v_fma_f32 v215, v215, s92, s92
v_mfma_f32_16x16x32_bf16 v[44:47], a[80:83], a[12:15], v[44:47]
s_waitcnt lgkmcnt(9)
ds_read_b64_tr_b16 a[74:75], v193 offset:47304
v_fma_f32 v216, v216, s92, s92
v_mfma_f32_16x16x32_bf16 v[44:47], a[84:87], a[28:31], v[44:47]
ds_read_b64_tr_b16 a[76:77], v193 offset:53448
v_fma_f32 v217, v217, s92, s92
v_mfma_f32_16x16x32_bf16 v[40:43], a[84:87], a[24:27], v[40:43]
ds_read_b64_tr_b16 a[78:79], v193 offset:59592
v_accvgpr_read_b32 v213, a158
v_mfma_f32_16x16x32_bf16 v[40:43], a[80:83], a[8:11], v[40:43]
v_exp_f32 v218, v218
v_mfma_f32_16x16x32_bf16 v[36:39], a[80:83], a[4:7], v[36:39]
v_accvgpr_read_b32 v214, a159
v_fma_f32 v218, v218, s92, s92
v_mfma_f32_16x16x32_bf16 v[36:39], a[84:87], a[20:23], v[36:39]
v_rcp_f32 v215, v215
v_mfma_f32_16x16x32_bf16 v[32:35], a[84:87], a[16:19], v[32:35]
ds_read_b64_tr_b16 a[84:85], v192 offset:53504
v_mul_f32 v211, v207, v211
v_mfma_f32_16x16x32_bf16 v[32:35], a[80:83], a[0:3], v[32:35]
s_waitcnt lgkmcnt(10)
ds_read_b64_tr_b16 a[80:81], v192 offset:41216
v_mul_f32 v212, v208, v212
v_mfma_f32_16x16x32_bf16 v[128:131], a[88:91], a[0:3], v[128:131]
s_waitcnt lgkmcnt(10)
ds_read_b64_tr_b16 a[82:83], v192 offset:47360
v_mul_f32 v213, v209, v213
v_mfma_f32_16x16x32_bf16 v[128:131], a[92:95], a[16:19], v[128:131]
ds_read_b64_tr_b16 a[86:87], v192 offset:59648
v_mul_f32 v214, v210, v214
v_mfma_f32_16x16x32_bf16 v[132:135], a[92:95], a[20:23], v[132:135]
v_rcp_f32 v216, v216
v_mfma_f32_16x16x32_bf16 v[132:135], a[88:91], a[4:7], v[132:135]
v_rcp_f32 v217, v217
v_mfma_f32_16x16x32_bf16 v[136:139], a[88:91], a[8:11], v[136:139]
v_rcp_f32 v218, v218
v_mfma_f32_16x16x32_bf16 v[136:139], a[92:95], a[24:27], v[136:139]
v_mul_f32 v211, v211, v215
v_mul_f32 v212, v212, v216
v_mfma_f32_16x16x32_bf16 v[140:143], a[92:95], a[28:31], v[140:143]
ds_read_b64_tr_b16 a[92:93], v192 offset:53512
v_mul_f32 v213, v213, v217
v_mfma_f32_16x16x32_bf16 v[140:143], a[88:91], a[12:15], v[140:143]
s_waitcnt lgkmcnt(10)
ds_read_b64_tr_b16 a[88:89], v192 offset:41224
v_mul_f32 v214, v214, v218
v_mfma_f32_16x16x32_bf16 v[60:63], a[64:67], a[12:15], v[60:63]
s_waitcnt lgkmcnt(10)
ds_read_b64_tr_b16 a[90:91], v192 offset:47368
v_accvgpr_read_b32 v207, a124
v_mfma_f32_16x16x32_bf16 v[60:63], a[68:71], a[28:31], v[60:63]
ds_read_b64_tr_b16 a[94:95], v192 offset:59656
v_xor_b32 v192, 32768, v192
v_mfma_f32_16x16x32_bf16 v[56:59], a[68:71], a[24:27], v[56:59]
v_accvgpr_read_b32 v208, a125
v_accvgpr_read_b32 v209, a126
v_mfma_f32_16x16x32_bf16 v[56:59], a[64:67], a[8:11], v[56:59]
v_accvgpr_read_b32 v210, a127
v_mul_f32 v215, 0xc15db3d7, v207
v_mfma_f32_16x16x32_bf16 v[52:55], a[64:67], a[4:7], v[52:55]
v_mul_f32 v216, 0xc15db3d7, v208
v_mul_f32 v217, 0xc15db3d7, v209
v_mfma_f32_16x16x32_bf16 v[52:55], a[68:71], a[20:23], v[52:55]
v_cvt_pk_bf16_f32 v220, v211, v212
v_mul_f32 v218, 0xc15db3d7, v210
v_mfma_f32_16x16x32_bf16 v[48:51], a[68:71], a[16:19], v[48:51]
ds_read_b64_tr_b16 a[68:69], v193 offset:53568
v_cvt_pk_bf16_f32 v221, v213, v214
v_mfma_f32_16x16x32_bf16 v[48:51], a[64:67], a[0:3], v[48:51]
s_waitcnt lgkmcnt(11)
ds_read_b64_tr_b16 a[64:65], v193 offset:41280
v_accvgpr_read_b32 v211, a172
v_mfma_f32_16x16x32_bf16 v[144:147], a[72:75], a[0:3], v[144:147]
s_waitcnt lgkmcnt(10)
ds_read_b64_tr_b16 a[66:67], v193 offset:47424
v_accvgpr_read_b32 v212, a173
v_mfma_f32_16x16x32_bf16 v[144:147], a[76:79], a[16:19], v[144:147]
ds_read_b64_tr_b16 a[70:71], v193 offset:59712
v_accvgpr_read_b32 v213, a174
v_mfma_f32_16x16x32_bf16 v[148:151], a[76:79], a[20:23], v[148:151]
v_exp_f32 v215, v215
v_mfma_f32_16x16x32_bf16 v[148:151], a[72:75], a[4:7], v[148:151]
v_exp_f32 v216, v216
v_mfma_f32_16x16x32_bf16 v[152:155], a[72:75], a[8:11], v[152:155]
v_exp_f32 v217, v217
v_mfma_f32_16x16x32_bf16 v[152:155], a[76:79], a[24:27], v[152:155]
v_exp_f32 v218, v218
v_mfma_f32_16x16x32_bf16 v[156:159], a[76:79], a[28:31], v[156:159]
ds_read_b64_tr_b16 a[76:77], v193 offset:53576
v_fma_f32 v215, v215, s92, s92
v_mfma_f32_16x16x32_bf16 v[156:159], a[72:75], a[12:15], v[156:159]
s_waitcnt lgkmcnt(10)
ds_read_b64_tr_b16 a[72:73], v193 offset:41288
v_fma_f32 v216, v216, s92, s92
v_mfma_f32_16x16x32_bf16 v[76:79], a[80:83], a[12:15], v[76:79]
s_waitcnt lgkmcnt(10)
ds_read_b64_tr_b16 a[74:75], v193 offset:47432
v_fma_f32 v217, v217, s92, s92
v_mfma_f32_16x16x32_bf16 v[76:79], a[84:87], a[28:31], v[76:79]
ds_read_b64_tr_b16 a[78:79], v193 offset:59720
v_xor_b32 v193, 32768, v193
v_mfma_f32_16x16x32_bf16 v[72:75], a[84:87], a[24:27], v[72:75]
v_accvgpr_read_b32 v214, a175
v_fma_f32 v218, v218, s92, s92
v_mfma_f32_16x16x32_bf16 v[72:75], a[80:83], a[8:11], v[72:75]
v_rcp_f32 v215, v215
v_mfma_f32_16x16x32_bf16 v[68:71], a[80:83], a[4:7], v[68:71]
v_rcp_f32 v216, v216
v_mfma_f32_16x16x32_bf16 v[68:71], a[84:87], a[20:23], v[68:71]
v_rcp_f32 v217, v217
v_mfma_f32_16x16x32_bf16 v[64:67], a[84:87], a[16:19], v[64:67]
v_rcp_f32 v218, v218
v_mfma_f32_16x16x32_bf16 v[64:67], a[80:83], a[0:3], v[64:67]
s_waitcnt lgkmcnt(9)
v_mul_f32 v211, v207, v211
v_mul_f32 v212, v208, v212
v_mfma_f32_16x16x32_bf16 v[160:163], a[88:91], a[0:3], v[160:163]
s_waitcnt lgkmcnt(8)
v_mul_f32 v213, v209, v213
v_mul_f32 v214, v210, v214
v_mfma_f32_16x16x32_bf16 v[160:163], a[92:95], a[16:19], v[160:163]
v_mul_f32 v211, v211, v215
v_mul_f32 v212, v212, v216
v_mfma_f32_16x16x32_bf16 v[164:167], a[92:95], a[20:23], v[164:167]
v_mul_f32 v213, v213, v217
v_mul_f32 v214, v214, v218
v_mfma_f32_16x16x32_bf16 v[164:167], a[88:91], a[4:7], v[164:167]
v_cvt_pk_bf16_f32 v222, v211, v212
v_cvt_pk_bf16_f32 v223, v213, v214
v_mfma_f32_16x16x32_bf16 v[168:171], a[88:91], a[8:11], v[168:171]
v_permlane32_swap_b32 v220, v222
v_permlane32_swap_b32 v221, v223
v_mfma_f32_16x16x32_bf16 v[168:171], a[92:95], a[24:27], v[168:171]
buffer_store_dwordx4 v[220:223], v203, s[4:7], s62 offen sc1
v_mfma_f32_16x16x32_bf16 v[172:175], a[92:95], a[28:31], v[172:175]
v_accvgpr_read_b32 v207, a128
v_accvgpr_read_b32 v208, a129
v_mfma_f32_16x16x32_bf16 v[172:175], a[88:91], a[12:15], v[172:175]
s_waitcnt lgkmcnt(5)
v_accvgpr_read_b32 v209, a130
v_accvgpr_read_b32 v210, a131
v_mfma_f32_16x16x32_bf16 v[92:95], a[64:67], a[12:15], v[92:95]
s_waitcnt lgkmcnt(4)
v_mul_f32 v215, 0xc15db3d7, v207
v_mul_f32 v216, 0xc15db3d7, v208
v_mfma_f32_16x16x32_bf16 v[92:95], a[68:71], a[28:31], v[92:95]
s_add_u32 m0, s53, 73728
v_mul_f32 v217, 0xc15db3d7, v209
v_mul_f32 v218, 0xc15db3d7, v210
v_mfma_f32_16x16x32_bf16 v[88:91], a[68:71], a[24:27], v[88:91]
s_add_u32 s59, s59, 12288
v_exp_f32 v215, v215
v_mfma_f32_16x16x32_bf16 v[88:91], a[64:67], a[8:11], v[88:91]
s_waitcnt vmcnt(10) lgkmcnt(0)
s_barrier
v_mfma_f32_16x16x32_bf16 v[84:87], a[64:67], a[4:7], v[84:87]
buffer_load_dwordx4 v236, s[20:23], s59 offen lds
v_mfma_f32_16x16x32_bf16 v[84:87], a[68:71], a[20:23], v[84:87]
ds_read_b64_tr_b16 a[80:81], v192 offset:24576
v_fma_f32 v215, v215, s92, s92
v_mfma_f32_16x16x32_bf16 v[80:83], a[68:71], a[16:19], v[80:83]
ds_read_b64_tr_b16 a[82:83], v192 offset:30720
v_accvgpr_read_b32 v211, a176
v_mfma_f32_16x16x32_bf16 v[80:83], a[64:67], a[0:3], v[80:83]
ds_read_b64_tr_b16 a[84:85], v192 offset:36864
ds_read_b64_tr_b16 a[86:87], v192 offset:43008
v_mfma_f32_16x16x32_bf16 v[176:179], a[72:75], a[0:3], v[176:179]
ds_read_b64_tr_b16 a[88:89], v192 offset:24584
v_accvgpr_read_b32 v212, a177
v_mfma_f32_16x16x32_bf16 v[176:179], a[76:79], a[16:19], v[176:179]
ds_read_b64_tr_b16 a[90:91], v192 offset:30728
v_accvgpr_read_b32 v213, a178
v_mfma_f32_16x16x32_bf16 v[180:183], a[76:79], a[20:23], v[180:183]
buffer_load_dwordx4 v237, s[20:23], s59 offen offset:1024 lds
v_mfma_f32_16x16x32_bf16 v[180:183], a[72:75], a[4:7], v[180:183]
ds_read_b64_tr_b16 a[92:93], v192 offset:36872
v_accvgpr_read_b32 v214, a179
v_mfma_f32_16x16x32_bf16 v[184:187], a[72:75], a[8:11], v[184:187]
ds_read_b64_tr_b16 a[94:95], v192 offset:43016
v_mul_f32 v211, v207, v211
v_mfma_f32_16x16x32_bf16 v[184:187], a[76:79], a[24:27], v[184:187]
ds_read_b64_tr_b16 a[64:65], v193 offset:24640
v_mul_f32 v212, v208, v212
v_mfma_f32_16x16x32_bf16 v[188:191], a[76:79], a[28:31], v[188:191]
ds_read_b64_tr_b16 a[66:67], v193 offset:30784
v_mul_f32 v213, v209, v213
v_mfma_f32_16x16x32_bf16 v[188:191], a[72:75], a[12:15], v[188:191]
s_waitcnt lgkmcnt(8)
ds_read_b64_tr_b16 a[68:69], v193 offset:36928
v_mul_f32 v214, v210, v214
v_mfma_f32_16x16x32_bf16 v[0:3], a[80:83], a[32:35], v[0:3]
s_waitcnt lgkmcnt(7)
buffer_load_dwordx4 v238, s[20:23], s59 offen offset:2048 lds
v_mfma_f32_16x16x32_bf16 v[0:3], a[84:87], a[48:51], v[0:3]
ds_read_b64_tr_b16 a[70:71], v193 offset:43072
v_accvgpr_read_b32 v207, a132
v_mfma_f32_16x16x32_bf16 v[4:7], a[84:87], a[52:55], v[4:7]
ds_read_b64_tr_b16 a[72:73], v193 offset:24648
v_accvgpr_read_b32 v208, a133
v_mfma_f32_16x16x32_bf16 v[4:7], a[80:83], a[36:39], v[4:7]
ds_read_b64_tr_b16 a[74:75], v193 offset:30792
v_accvgpr_read_b32 v209, a134
v_mfma_f32_16x16x32_bf16 v[8:11], a[80:83], a[40:43], v[8:11]
s_add_u32 m0, s53, 86016
ds_read_b64_tr_b16 a[76:77], v193 offset:36936
v_accvgpr_read_b32 v210, a135
v_mfma_f32_16x16x32_bf16 v[8:11], a[84:87], a[56:59], v[8:11]
s_add_u32 s59, s59, 12288
ds_read_b64_tr_b16 a[78:79], v193 offset:43080
v_cvt_pk_bf16_f32 v0, v0, v1
v_mfma_f32_16x16x32_bf16 v[12:15], a[84:87], a[60:63], v[12:15]
buffer_load_dwordx4 v236, s[20:23], s59 offen lds
v_mfma_f32_16x16x32_bf16 v[12:15], a[80:83], a[44:47], v[12:15]
s_waitcnt lgkmcnt(10)
ds_read_b64_tr_b16 a[80:81], v192 offset:24704
v_cvt_pk_bf16_f32 v1, v2, v3
v_mfma_f32_16x16x32_bf16 v[96:99], a[88:91], a[32:35], v[96:99]
s_waitcnt lgkmcnt(9)
ds_read_b64_tr_b16 a[82:83], v192 offset:30848
v_cvt_pk_bf16_f32 v4, v4, v5
v_mfma_f32_16x16x32_bf16 v[96:99], a[92:95], a[48:51], v[96:99]
ds_read_b64_tr_b16 a[84:85], v192 offset:36992
v_cvt_pk_bf16_f32 v5, v6, v7
v_mfma_f32_16x16x32_bf16 v[100:103], a[92:95], a[52:55], v[100:103]
ds_read_b64_tr_b16 a[86:87], v192 offset:43136
v_cvt_pk_bf16_f32 v8, v8, v9
v_mfma_f32_16x16x32_bf16 v[100:103], a[88:91], a[36:39], v[100:103]
v_exp_f32 v216, v216
v_mfma_f32_16x16x32_bf16 v[104:107], a[88:91], a[40:43], v[104:107]
buffer_load_dwordx4 v237, s[20:23], s59 offen offset:1024 lds
v_mfma_f32_16x16x32_bf16 v[104:107], a[92:95], a[56:59], v[104:107]
v_exp_f32 v217, v217
v_mfma_f32_16x16x32_bf16 v[108:111], a[92:95], a[60:63], v[108:111]
ds_read_b64_tr_b16 a[92:93], v192 offset:37000
v_fma_f32 v216, v216, s92, s92
v_mfma_f32_16x16x32_bf16 v[108:111], a[88:91], a[44:47], v[108:111]
s_waitcnt lgkmcnt(11)
ds_read_b64_tr_b16 a[88:89], v192 offset:24712
v_fma_f32 v217, v217, s92, s92
v_mfma_f32_16x16x32_bf16 v[28:31], a[64:67], a[44:47], v[28:31]
s_waitcnt lgkmcnt(10)
ds_read_b64_tr_b16 a[90:91], v192 offset:30856
v_cvt_pk_bf16_f32 v2, v96, v97
v_mfma_f32_16x16x32_bf16 v[28:31], a[68:71], a[60:63], v[28:31]
ds_read_b64_tr_b16 a[94:95], v192 offset:43144
v_cvt_pk_bf16_f32 v3, v98, v99
v_mfma_f32_16x16x32_bf16 v[24:27], a[68:71], a[56:59], v[24:27]
buffer_load_dwordx4 v238, s[20:23], s59 offen offset:2048 lds
v_mfma_f32_16x16x32_bf16 v[24:27], a[64:67], a[40:43], v[24:27]
v_exp_f32 v218, v218
v_mfma_f32_16x16x32_bf16 v[20:23], a[64:67], a[36:39], v[20:23]
ds_read_b128 a[192:195], v248 offset:0
v_fma_f32 v218, v218, s92, s92
v_mfma_f32_16x16x32_bf16 v[20:23], a[68:71], a[52:55], v[20:23]
v_rcp_f32 v215, v215
v_mfma_f32_16x16x32_bf16 v[16:19], a[68:71], a[48:51], v[16:19]
ds_read_b64_tr_b16 a[68:69], v193 offset:37056
v_mul_f32 v211, v211, v215
v_mfma_f32_16x16x32_bf16 v[16:19], a[64:67], a[32:35], v[16:19]
s_waitcnt lgkmcnt(12)
ds_read_b64_tr_b16 a[64:65], v193 offset:24768
v_mul_f32 v215, 0xc15db3d7, v207
v_mfma_f32_16x16x32_bf16 v[112:115], a[72:75], a[32:35], v[112:115]
s_waitcnt lgkmcnt(11)
ds_read_b64_tr_b16 a[66:67], v193 offset:30912
v_cvt_pk_bf16_f32 v6, v100, v101
v_mfma_f32_16x16x32_bf16 v[112:115], a[76:79], a[48:51], v[112:115]
ds_read_b64_tr_b16 a[70:71], v193 offset:43200
v_cvt_pk_bf16_f32 v7, v102, v103
v_mfma_f32_16x16x32_bf16 v[116:119], a[76:79], a[52:55], v[116:119]
v_rcp_f32 v216, v216
v_mfma_f32_16x16x32_bf16 v[116:119], a[72:75], a[36:39], v[116:119]
v_rcp_f32 v217, v217
v_mfma_f32_16x16x32_bf16 v[120:123], a[72:75], a[40:43], v[120:123]
v_rcp_f32 v218, v218
v_mfma_f32_16x16x32_bf16 v[120:123], a[76:79], a[56:59], v[120:123]
ds_read_b128 a[196:199], v249 offset:0
v_mul_f32 v212, v212, v216
v_mfma_f32_16x16x32_bf16 v[124:127], a[76:79], a[60:63], v[124:127]
ds_read_b64_tr_b16 a[76:77], v193 offset:37064
v_mul_f32 v213, v213, v217
v_mfma_f32_16x16x32_bf16 v[124:127], a[72:75], a[44:47], v[124:127]
s_waitcnt lgkmcnt(13)
ds_read_b64_tr_b16 a[72:73], v193 offset:24776
v_mul_f32 v214, v214, v218
v_mfma_f32_16x16x32_bf16 v[44:47], a[80:83], a[44:47], v[44:47]
s_waitcnt lgkmcnt(12)
ds_read_b64_tr_b16 a[74:75], v193 offset:30920
v_mul_f32 v216, 0xc15db3d7, v208
v_mfma_f32_16x16x32_bf16 v[44:47], a[84:87], a[60:63], v[44:47]
ds_read_b64_tr_b16 a[78:79], v193 offset:43208
v_mul_f32 v217, 0xc15db3d7, v209
v_mfma_f32_16x16x32_bf16 v[40:43], a[84:87], a[56:59], v[40:43]
ds_read_b128 a[200:203], v248 offset:128
v_mul_f32 v218, 0xc15db3d7, v210
v_mfma_f32_16x16x32_bf16 v[40:43], a[80:83], a[40:43], v[40:43]
v_exp_f32 v215, v215
v_mfma_f32_16x16x32_bf16 v[36:39], a[80:83], a[36:39], v[36:39]
v_exp_f32 v216, v216
v_mfma_f32_16x16x32_bf16 v[36:39], a[84:87], a[52:55], v[36:39]
v_exp_f32 v217, v217
v_mfma_f32_16x16x32_bf16 v[32:35], a[84:87], a[48:51], v[32:35]
ds_read_b64_tr_b16 a[84:85], v192 offset:37120
v_fma_f32 v215, v215, s92, s92
v_mfma_f32_16x16x32_bf16 v[32:35], a[80:83], a[32:35], v[32:35]
s_waitcnt lgkmcnt(13)
ds_read_b64_tr_b16 a[80:81], v192 offset:24832
v_fma_f32 v216, v216, s92, s92
v_mfma_f32_16x16x32_bf16 v[128:131], a[88:91], a[32:35], v[128:131]
s_waitcnt lgkmcnt(13)
ds_read_b64_tr_b16 a[82:83], v192 offset:30976
v_fma_f32 v217, v217, s92, s92
v_mfma_f32_16x16x32_bf16 v[128:131], a[92:95], a[48:51], v[128:131]
ds_read_b64_tr_b16 a[86:87], v192 offset:43264
v_cvt_pk_bf16_f32 v220, v211, v212
v_mfma_f32_16x16x32_bf16 v[132:135], a[92:95], a[52:55], v[132:135]
v_exp_f32 v218, v218
v_mfma_f32_16x16x32_bf16 v[132:135], a[88:91], a[36:39], v[132:135]
ds_read_b128 a[204:207], v249 offset:128
v_fma_f32 v218, v218, s92, s92
v_mfma_f32_16x16x32_bf16 v[136:139], a[88:91], a[40:43], v[136:139]
v_rcp_f32 v215, v215
v_mfma_f32_16x16x32_bf16 v[136:139], a[92:95], a[56:59], v[136:139]
v_rcp_f32 v216, v216
v_mfma_f32_16x16x32_bf16 v[140:143], a[92:95], a[60:63], v[140:143]
ds_read_b64_tr_b16 a[92:93], v192 offset:37128
v_cvt_pk_bf16_f32 v221, v213, v214
v_mfma_f32_16x16x32_bf16 v[140:143], a[88:91], a[44:47], v[140:143]
s_waitcnt lgkmcnt(13)
ds_read_b64_tr_b16 a[88:89], v192 offset:24840
v_accvgpr_read_b32 v211, a180
v_mfma_f32_16x16x32_bf16 v[60:63], a[64:67], a[44:47], v[60:63]
s_waitcnt lgkmcnt(13)
ds_read_b64_tr_b16 a[90:91], v192 offset:30984
v_accvgpr_read_b32 v212, a181
v_mfma_f32_16x16x32_bf16 v[60:63], a[68:71], a[60:63], v[60:63]
ds_read_b64_tr_b16 a[94:95], v192 offset:43272
v_accvgpr_read_b32 v213, a182
v_mfma_f32_16x16x32_bf16 v[56:59], a[68:71], a[56:59], v[56:59]
v_rcp_f32 v217, v217
v_mfma_f32_16x16x32_bf16 v[56:59], a[64:67], a[40:43], v[56:59]
v_rcp_f32 v218, v218
v_mfma_f32_16x16x32_bf16 v[52:55], a[64:67], a[36:39], v[52:55]
ds_read_b128 a[208:211], v248 offset:256
v_accvgpr_read_b32 v214, a183
v_mfma_f32_16x16x32_bf16 v[52:55], a[68:71], a[52:55], v[52:55]
ds_read_b128 a[212:215], v249 offset:256
v_mul_f32 v211, v207, v211
v_mfma_f32_16x16x32_bf16 v[48:51], a[68:71], a[48:51], v[48:51]
ds_read_b64_tr_b16 a[68:69], v193 offset:37184
v_mul_f32 v212, v208, v212
v_mfma_f32_16x16x32_bf16 v[48:51], a[64:67], a[32:35], v[48:51]
s_waitcnt lgkmcnt(14)
ds_read_b64_tr_b16 a[64:65], v193 offset:24896
v_mul_f32 v213, v209, v213
v_mfma_f32_16x16x32_bf16 v[144:147], a[72:75], a[32:35], v[144:147]
s_waitcnt lgkmcnt(14)
ds_read_b64_tr_b16 a[66:67], v193 offset:31040
v_mul_f32 v214, v210, v214
v_mfma_f32_16x16x32_bf16 v[144:147], a[76:79], a[48:51], v[144:147]
ds_read_b64_tr_b16 a[70:71], v193 offset:43328
v_mul_f32 v211, v211, v215
v_mfma_f32_16x16x32_bf16 v[148:151], a[76:79], a[52:55], v[148:151]
ds_read_b128 a[216:219], v248 offset:6144
v_mul_f32 v212, v212, v216
v_mfma_f32_16x16x32_bf16 v[148:151], a[72:75], a[36:39], v[148:151]
ds_read_b128 a[220:223], v249 offset:6144
v_mul_f32 v213, v213, v217
v_mfma_f32_16x16x32_bf16 v[152:155], a[72:75], a[40:43], v[152:155]
ds_read_b128 a[224:227], v248 offset:6272
v_mul_f32 v214, v214, v218
v_mfma_f32_16x16x32_bf16 v[152:155], a[76:79], a[56:59], v[152:155]
ds_read_b128 a[228:231], v249 offset:6272
v_cvt_pk_bf16_f32 v222, v211, v212
v_mfma_f32_16x16x32_bf16 v[156:159], a[76:79], a[60:63], v[156:159]
ds_read_b64_tr_b16 a[76:77], v193 offset:37192
v_cvt_pk_bf16_f32 v223, v213, v214
v_mfma_f32_16x16x32_bf16 v[156:159], a[72:75], a[44:47], v[156:159]
s_waitcnt lgkmcnt(14)
ds_read_b64_tr_b16 a[72:73], v193 offset:24904
v_permlane32_swap_b32 v220, v222
v_mfma_f32_16x16x32_bf16 v[76:79], a[80:83], a[44:47], v[76:79]
s_waitcnt lgkmcnt(14)
ds_read_b64_tr_b16 a[74:75], v193 offset:31048
v_permlane32_swap_b32 v221, v223
v_mfma_f32_16x16x32_bf16 v[76:79], a[84:87], a[60:63], v[76:79]
ds_read_b64_tr_b16 a[78:79], v193 offset:43336
v_cvt_pk_bf16_f32 v16, v16, v17
v_mfma_f32_16x16x32_bf16 v[72:75], a[84:87], a[56:59], v[72:75]
buffer_store_dwordx4 v[220:223], v219, s[4:7], s63 offen sc1
v_mfma_f32_16x16x32_bf16 v[72:75], a[80:83], a[40:43], v[72:75]
ds_read_b128 a[232:235], v248 offset:6400
v_cvt_pk_bf16_f32 v17, v18, v19
v_mfma_f32_16x16x32_bf16 v[68:71], a[80:83], a[36:39], v[68:71]
ds_read_b128 v[224:227], v249 offset:6400
v_cvt_pk_bf16_f32 v18, v112, v113
v_mfma_f32_16x16x32_bf16 v[68:71], a[84:87], a[52:55], v[68:71]
v_cvt_pk_bf16_f32 v19, v114, v115
v_cvt_pk_bf16_f32 v32, v32, v33
v_mfma_f32_16x16x32_bf16 v[64:67], a[84:87], a[48:51], v[64:67]
v_cvt_pk_bf16_f32 v33, v34, v35
v_cvt_pk_bf16_f32 v34, v128, v129
v_mfma_f32_16x16x32_bf16 v[64:67], a[80:83], a[32:35], v[64:67]
s_waitcnt lgkmcnt(14)
v_cvt_pk_bf16_f32 v35, v130, v131
v_cvt_pk_bf16_f32 v48, v48, v49
v_mfma_f32_16x16x32_bf16 v[160:163], a[88:91], a[32:35], v[160:163]
s_waitcnt lgkmcnt(14)
v_cvt_pk_bf16_f32 v49, v50, v51
v_cvt_pk_bf16_f32 v50, v144, v145
v_mfma_f32_16x16x32_bf16 v[160:163], a[92:95], a[48:51], v[160:163]
L_walk1_6:
s_cbranch_execz L_walk1_10
v_cvt_pk_bf16_f32 v20, v20, v21
v_cvt_pk_bf16_f32 v51, v146, v147
v_mfma_f32_16x16x32_bf16 v[164:167], a[92:95], a[52:55], v[164:167]
v_cvt_pk_bf16_f32 v21, v22, v23
v_cvt_pk_bf16_f32 v22, v116, v117
v_mfma_f32_16x16x32_bf16 v[164:167], a[88:91], a[36:39], v[164:167]
v_cvt_pk_bf16_f32 v64, v64, v65
v_cvt_pk_bf16_f32 v65, v66, v67
v_mfma_f32_16x16x32_bf16 v[168:171], a[88:91], a[40:43], v[168:171]
v_cvt_pk_bf16_f32 v23, v118, v119
v_cvt_pk_bf16_f32 v36, v36, v37
v_mfma_f32_16x16x32_bf16 v[168:171], a[92:95], a[56:59], v[168:171]
v_cvt_pk_bf16_f32 v66, v160, v161
v_cvt_pk_bf16_f32 v67, v162, v163
v_mfma_f32_16x16x32_bf16 v[172:175], a[92:95], a[60:63], v[172:175]
v_cvt_pk_bf16_f32 v37, v38, v39
v_cvt_pk_bf16_f32 v38, v132, v133
v_mfma_f32_16x16x32_bf16 v[172:175], a[88:91], a[44:47], v[172:175]
s_waitcnt lgkmcnt(11)
v_cvt_pk_bf16_f32 v39, v134, v135
v_cvt_pk_bf16_f32 v52, v52, v53
v_mfma_f32_16x16x32_bf16 v[92:95], a[64:67], a[44:47], v[92:95]
s_waitcnt lgkmcnt(10)
v_cvt_pk_bf16_f32 v53, v54, v55
v_cvt_pk_bf16_f32 v54, v148, v149
v_mfma_f32_16x16x32_bf16 v[92:95], a[68:71], a[60:63], v[92:95]
s_add_u32 m0, s53, 24576
v_cvt_pk_bf16_f32 v55, v150, v151
v_cvt_pk_bf16_f32 v68, v68, v69
v_mfma_f32_16x16x32_bf16 v[88:91], a[68:71], a[56:59], v[88:91]
s_add_u32 s60, s60, 12288
v_cvt_pk_bf16_f32 v69, v70, v71
v_cvt_pk_bf16_f32 v70, v164, v165
v_mfma_f32_16x16x32_bf16 v[88:91], a[64:67], a[40:43], v[88:91]
s_waitcnt lgkmcnt(2)
s_barrier
v_mfma_f32_16x16x32_bf16 v[84:87], a[64:67], a[36:39], v[84:87]
buffer_load_dwordx4 v239, s[24:27], s60 offen lds
v_mfma_f32_16x16x32_bf16 v[84:87], a[68:71], a[52:55], v[84:87]
ds_read_b128 a[0:3], v248 offset:12288
v_cvt_pk_bf16_f32 v71, v166, v167
v_mfma_f32_16x16x32_bf16 v[80:83], a[68:71], a[48:51], v[80:83]
ds_read_b128 a[4:7], v249 offset:12288
v_cvt_pk_bf16_f32 v9, v10, v11
v_mfma_f32_16x16x32_bf16 v[80:83], a[64:67], a[32:35], v[80:83]
ds_read_b128 a[8:11], v248 offset:12416
v_cvt_pk_bf16_f32 v10, v104, v105
v_mfma_f32_16x16x32_bf16 v[176:179], a[72:75], a[32:35], v[176:179]
ds_read_b128 a[12:15], v249 offset:12416
v_cvt_pk_bf16_f32 v11, v106, v107
v_mfma_f32_16x16x32_bf16 v[176:179], a[76:79], a[48:51], v[176:179]
ds_read_b128 a[16:19], v248 offset:12544
v_cvt_pk_bf16_f32 v84, v84, v85
v_mfma_f32_16x16x32_bf16 v[180:183], a[76:79], a[52:55], v[180:183]
buffer_load_dwordx4 v240, s[24:27], s60 offen offset:1024 lds
v_mfma_f32_16x16x32_bf16 v[180:183], a[72:75], a[36:39], v[180:183]
ds_read_b128 a[20:23], v249 offset:12544
v_cvt_pk_bf16_f32 v80, v80, v81
v_mfma_f32_16x16x32_bf16 v[184:187], a[72:75], a[40:43], v[184:187]
ds_read_b128 a[24:27], v248 offset:18432
v_cvt_pk_bf16_f32 v81, v82, v83
v_mfma_f32_16x16x32_bf16 v[184:187], a[76:79], a[56:59], v[184:187]
ds_read_b128 a[28:31], v249 offset:18432
v_cvt_pk_bf16_f32 v82, v176, v177
v_mfma_f32_16x16x32_bf16 v[188:191], a[76:79], a[60:63], v[188:191]
ds_read_b128 a[32:35], v248 offset:18560
v_cvt_pk_bf16_f32 v83, v178, v179
v_mfma_f32_16x16x32_bf16 v[188:191], a[72:75], a[44:47], v[188:191]
ds_read_b128 a[36:39], v249 offset:18560
v_cvt_pk_bf16_f32 v85, v86, v87
v_mfma_f32_16x16x32_bf16 v[112:115], a[192:195], v[0:3], 0
buffer_load_dwordx4 v241, s[24:27], s60 offen offset:2048 lds
v_mfma_f32_16x16x32_bf16 v[112:115], a[196:199], v[16:19], v[112:115]
ds_read_b128 a[40:43], v248 offset:18688
v_cvt_pk_bf16_f32 v86, v180, v181
v_mfma_f32_16x16x32_bf16 v[112:115], a[200:203], v[32:35], v[112:115]
ds_read_b128 a[44:47], v249 offset:18688
v_cvt_pk_bf16_f32 v87, v182, v183
v_mfma_f32_16x16x32_bf16 v[112:115], a[204:207], v[48:51], v[112:115]
v_cvt_pk_bf16_f32 v24, v24, v25
v_cvt_pk_bf16_f32 v25, v26, v27
v_mfma_f32_16x16x32_bf16 v[112:115], a[208:211], v[64:67], v[112:115]
v_cvt_pk_bf16_f32 v26, v120, v121
v_cvt_pk_bf16_f32 v27, v122, v123
v_mfma_f32_16x16x32_bf16 v[112:115], a[212:215], v[80:83], v[112:115]
v_cvt_pk_bf16_f32 v40, v40, v41
v_cvt_pk_bf16_f32 v41, v42, v43
v_mfma_f32_16x16x32_bf16 v[96:99], a[216:219], v[0:3], 0
v_cvt_pk_bf16_f32 v42, v136, v137
v_cvt_pk_bf16_f32 v43, v138, v139
v_mfma_f32_16x16x32_bf16 v[96:99], a[220:223], v[16:19], v[96:99]
v_cvt_pk_bf16_f32 v56, v56, v57
v_cvt_pk_bf16_f32 v57, v58, v59
v_mfma_f32_16x16x32_bf16 v[96:99], a[224:227], v[32:35], v[96:99]
v_cvt_pk_bf16_f32 v58, v152, v153
v_cvt_pk_bf16_f32 v59, v154, v155
v_mfma_f32_16x16x32_bf16 v[96:99], a[228:231], v[48:51], v[96:99]
s_waitcnt lgkmcnt(13)
v_cvt_pk_bf16_f32 v72, v72, v73
v_cvt_pk_bf16_f32 v73, v74, v75
v_mfma_f32_16x16x32_bf16 v[96:99], a[232:235], v[64:67], v[96:99]
s_waitcnt lgkmcnt(12)
v_cvt_pk_bf16_f32 v74, v168, v169
v_cvt_pk_bf16_f32 v75, v170, v171
v_mfma_f32_16x16x32_bf16 v[96:99], v[224:227], v[80:83], v[96:99]
v_cvt_pk_bf16_f32 v88, v88, v89
v_cvt_pk_bf16_f32 v89, v90, v91
v_mfma_f32_16x16x32_bf16 v[116:119], a[192:195], v[4:7], 0
v_cvt_pk_bf16_f32 v90, v184, v185
v_cvt_pk_bf16_f32 v91, v186, v187
v_mfma_f32_16x16x32_bf16 v[116:119], a[196:199], v[20:23], v[116:119]
v_cvt_pk_bf16_f32 v12, v12, v13
v_cvt_pk_bf16_f32 v13, v14, v15
v_mfma_f32_16x16x32_bf16 v[116:119], a[200:203], v[36:39], v[116:119]
v_cvt_pk_bf16_f32 v14, v108, v109
v_cvt_pk_bf16_f32 v15, v110, v111
v_mfma_f32_16x16x32_bf16 v[116:119], a[204:207], v[52:55], v[116:119]
v_cvt_pk_bf16_f32 v28, v28, v29
v_cvt_pk_bf16_f32 v29, v30, v31
v_mfma_f32_16x16x32_bf16 v[116:119], a[208:211], v[68:71], v[116:119]
v_cvt_pk_bf16_f32 v30, v124, v125
v_cvt_pk_bf16_f32 v31, v126, v127
v_mfma_f32_16x16x32_bf16 v[116:119], a[212:215], v[84:87], v[116:119]
v_cvt_pk_bf16_f32 v44, v44, v45
v_cvt_pk_bf16_f32 v45, v46, v47
v_mfma_f32_16x16x32_bf16 v[100:103], a[216:219], v[4:7], 0
v_cvt_pk_bf16_f32 v46, v140, v141
v_cvt_pk_bf16_f32 v47, v142, v143
v_mfma_f32_16x16x32_bf16 v[100:103], a[220:223], v[20:23], v[100:103]
v_cvt_pk_bf16_f32 v60, v60, v61
v_cvt_pk_bf16_f32 v61, v62, v63
v_mfma_f32_16x16x32_bf16 v[100:103], a[224:227], v[36:39], v[100:103]
v_cvt_pk_bf16_f32 v62, v156, v157
v_cvt_pk_bf16_f32 v63, v158, v159
v_mfma_f32_16x16x32_bf16 v[100:103], a[228:231], v[52:55], v[100:103]
v_cvt_pk_bf16_f32 v76, v76, v77
v_cvt_pk_bf16_f32 v77, v78, v79
v_mfma_f32_16x16x32_bf16 v[100:103], a[232:235], v[68:71], v[100:103]
v_cvt_pk_bf16_f32 v78, v172, v173
v_cvt_pk_bf16_f32 v79, v174, v175
v_mfma_f32_16x16x32_bf16 v[100:103], v[224:227], v[84:87], v[100:103]
v_cvt_pk_bf16_f32 v92, v92, v93
v_cvt_pk_bf16_f32 v93, v94, v95
v_mfma_f32_16x16x32_bf16 v[120:123], a[192:195], v[8:11], 0
v_cvt_pk_bf16_f32 v94, v188, v189
v_cvt_pk_bf16_f32 v95, v190, v191
v_mfma_f32_16x16x32_bf16 v[120:123], a[196:199], v[24:27], v[120:123]
v_accvgpr_read_b32 v207, a136
v_accvgpr_read_b32 v208, a137
v_mfma_f32_16x16x32_bf16 v[120:123], a[200:203], v[40:43], v[120:123]
v_accvgpr_read_b32 v209, a138
v_accvgpr_read_b32 v210, a139
v_mfma_f32_16x16x32_bf16 v[120:123], a[204:207], v[56:59], v[120:123]
v_mul_f32 v215, 0xc15db3d7, v207
v_mul_f32 v216, 0xc15db3d7, v208
v_mfma_f32_16x16x32_bf16 v[120:123], a[208:211], v[72:75], v[120:123]
v_mul_f32 v217, 0xc15db3d7, v209
v_mul_f32 v218, 0xc15db3d7, v210
v_mfma_f32_16x16x32_bf16 v[120:123], a[212:215], v[88:91], v[120:123]
v_exp_f32 v215, v215
v_mfma_f32_16x16x32_bf16 v[104:107], a[216:219], v[8:11], 0
v_exp_f32 v216, v216
v_mfma_f32_16x16x32_bf16 v[104:107], a[220:223], v[24:27], v[104:107]
v_exp_f32 v217, v217
v_mfma_f32_16x16x32_bf16 v[104:107], a[224:227], v[40:43], v[104:107]
v_exp_f32 v218, v218
v_mfma_f32_16x16x32_bf16 v[104:107], a[228:231], v[56:59], v[104:107]
v_fma_f32 v215, v215, s92, s92
v_fma_f32 v216, v216, s92, s92
v_mfma_f32_16x16x32_bf16 v[104:107], a[232:235], v[72:75], v[104:107]
v_fma_f32 v217, v217, s92, s92
v_fma_f32 v218, v218, s92, s92
v_mfma_f32_16x16x32_bf16 v[104:107], v[224:227], v[88:91], v[104:107]
v_rcp_f32 v215, v215
v_mfma_f32_16x16x32_bf16 v[124:127], a[192:195], v[12:15], 0
v_rcp_f32 v216, v216
v_mfma_f32_16x16x32_bf16 v[124:127], a[196:199], v[28:31], v[124:127]
v_rcp_f32 v217, v217
v_mfma_f32_16x16x32_bf16 v[124:127], a[200:203], v[44:47], v[124:127]
v_rcp_f32 v218, v218
v_mfma_f32_16x16x32_bf16 v[124:127], a[204:207], v[60:63], v[124:127]
v_accvgpr_read_b32 v211, a184
v_accvgpr_read_b32 v212, a185
v_mfma_f32_16x16x32_bf16 v[124:127], a[208:211], v[76:79], v[124:127]
v_accvgpr_read_b32 v213, a186
v_accvgpr_read_b32 v214, a187
v_mfma_f32_16x16x32_bf16 v[124:127], a[212:215], v[92:95], v[124:127]
v_mul_f32 v211, v207, v211
v_mul_f32 v212, v208, v212
v_mfma_f32_16x16x32_bf16 v[108:111], a[216:219], v[12:15], 0
v_mul_f32 v213, v209, v213
v_mul_f32 v214, v210, v214
v_mfma_f32_16x16x32_bf16 v[108:111], a[220:223], v[28:31], v[108:111]
v_mul_f32 v211, v211, v215
v_mul_f32 v212, v212, v216
v_mfma_f32_16x16x32_bf16 v[108:111], a[224:227], v[44:47], v[108:111]
v_mul_f32 v213, v213, v217
v_mul_f32 v214, v214, v218
v_mfma_f32_16x16x32_bf16 v[108:111], a[228:231], v[60:63], v[108:111]
v_accvgpr_read_b32 v207, a140
v_accvgpr_read_b32 v208, a141
v_mfma_f32_16x16x32_bf16 v[108:111], a[232:235], v[76:79], v[108:111]
v_accvgpr_read_b32 v209, a142
v_accvgpr_read_b32 v210, a143
v_mfma_f32_16x16x32_bf16 v[108:111], v[224:227], v[92:95], v[108:111]
s_waitcnt lgkmcnt(11)
v_mul_f32 v215, 0xc15db3d7, v207
v_mul_f32 v216, 0xc15db3d7, v208
v_mfma_f32_16x16x32_bf16 v[128:131], a[0:3], v[0:3], 0
s_waitcnt vmcnt(7) lgkmcnt(0)
s_barrier
v_mfma_f32_16x16x32_bf16 v[128:131], a[4:7], v[16:19], v[128:131]
v_mul_f32 v217, 0xc15db3d7, v209
v_mul_f32 v218, 0xc15db3d7, v210
v_mfma_f32_16x16x32_bf16 v[128:131], a[8:11], v[32:35], v[128:131]
v_exp_f32 v215, v215
v_exp_f32 v216, v216
v_exp_f32 v217, v217
v_exp_f32 v218, v218
v_mfma_f32_16x16x32_bf16 v[128:131], a[12:15], v[48:51], v[128:131]
v_fma_f32 v215, v215, s92, s92
v_fma_f32 v216, v216, s92, s92
v_fma_f32 v217, v217, s92, s92
v_fma_f32 v218, v218, s92, s92
v_rcp_f32 v215, v215
v_rcp_f32 v216, v216
v_rcp_f32 v217, v217
v_rcp_f32 v218, v218
v_mfma_f32_16x16x32_bf16 v[128:131], a[16:19], v[64:67], v[128:131]
v_cvt_pk_bf16_f32 v220, v211, v212
v_cvt_pk_bf16_f32 v221, v213, v214
v_accvgpr_read_b32 v211, a188
v_accvgpr_read_b32 v212, a189
v_accvgpr_read_b32 v213, a190
v_accvgpr_read_b32 v214, a191
v_mul_f32 v211, v207, v211
v_mul_f32 v212, v208, v212
v_mul_f32 v213, v209, v213
v_mul_f32 v214, v210, v214
v_mul_f32 v211, v211, v215
v_mul_f32 v212, v212, v216
v_mul_f32 v213, v213, v217
v_mul_f32 v214, v214, v218
v_cvt_pk_bf16_f32 v222, v211, v212
v_cvt_pk_bf16_f32 v223, v213, v214
v_exp_f32 v112, v112
v_exp_f32 v113, v113
v_exp_f32 v114, v114
v_exp_f32 v115, v115
v_exp_f32 v96, v96
v_exp_f32 v97, v97
v_exp_f32 v98, v98
v_exp_f32 v99, v99
v_mfma_f32_16x16x32_bf16 v[128:131], a[20:23], v[80:83], v[128:131]
v_and_b32 v219, 512, v250
v_mul_u32_u24 v219, 3, v219
v_xor_b32 v219, v219, v202
v_permlane32_swap_b32 v220, v222
v_permlane32_swap_b32 v221, v223
v_add_f32 v228, v228, v112
v_add_f32 v228, v228, v113
v_cvt_pk_bf16_f32 v112, v112, v113
v_add_f32 v228, v228, v114
v_add_f32 v228, v228, v115
v_cvt_pk_bf16_f32 v113, v114, v115
v_add_f32 v228, v228, v98
v_add_f32 v228, v228, v99
v_cvt_pk_bf16_f32 v115, v98, v99
v_add_f32 v228, v228, v96
v_add_f32 v228, v228, v97
v_cvt_pk_bf16_f32 v114, v96, v97
v_mfma_f32_16x16x32_bf16 v[96:99], a[44:47], v[80:83], 0
buffer_store_dwordx4 v[220:223], v219, s[4:7], s63 offen sc1
v_mfma_f32_16x16x32_bf16 v[96:99], a[40:43], v[64:67], v[96:99]
v_exp_f32 v116, v116
v_mfma_f32_16x16x32_bf16 v[96:99], a[36:39], v[48:51], v[96:99]
s_add_u32 m0, s53, 49152
v_exp_f32 v117, v117
v_mfma_f32_16x16x32_bf16 v[96:99], a[32:35], v[32:35], v[96:99]
s_add_u32 s59, s59, 12288
v_exp_f32 v118, v118
v_mfma_f32_16x16x32_bf16 v[96:99], a[28:31], v[16:19], v[96:99]
buffer_load_dwordx4 v236, s[20:23], s59 offen lds
v_mfma_f32_16x16x32_bf16 v[96:99], a[24:27], v[0:3], v[96:99]
v_exp_f32 v119, v119
v_mfma_f32_16x16x32_bf16 v[132:135], a[24:27], v[4:7], 0
v_exp_f32 v100, v100
v_mfma_f32_16x16x32_bf16 v[132:135], a[28:31], v[20:23], v[132:135]
v_exp_f32 v101, v101
v_mfma_f32_16x16x32_bf16 v[132:135], a[32:35], v[36:39], v[132:135]
v_exp_f32 v102, v102
v_mfma_f32_16x16x32_bf16 v[132:135], a[36:39], v[52:55], v[132:135]
v_exp_f32 v103, v103
v_mfma_f32_16x16x32_bf16 v[132:135], a[40:43], v[68:71], v[132:135]
v_add_f32 v229, v229, v116
v_add_f32 v229, v229, v117
v_mfma_f32_16x16x32_bf16 v[132:135], a[44:47], v[84:87], v[132:135]
v_cvt_pk_bf16_f32 v116, v116, v117
v_add_f32 v229, v229, v118
v_add_f32 v229, v229, v119
v_cvt_pk_bf16_f32 v117, v118, v119
v_add_f32 v229, v229, v102
v_add_f32 v229, v229, v103
v_cvt_pk_bf16_f32 v119, v102, v103
v_add_f32 v229, v229, v100
v_add_f32 v229, v229, v101
v_cvt_pk_bf16_f32 v118, v100, v101
v_mfma_f32_16x16x32_bf16 v[100:103], a[20:23], v[84:87], 0
buffer_load_dwordx4 v237, s[20:23], s59 offen offset:1024 lds
v_mfma_f32_16x16x32_bf16 v[100:103], a[16:19], v[68:71], v[100:103]
v_exp_f32 v120, v120
v_mfma_f32_16x16x32_bf16 v[100:103], a[12:15], v[52:55], v[100:103]
v_exp_f32 v121, v121
v_mfma_f32_16x16x32_bf16 v[100:103], a[8:11], v[36:39], v[100:103]
v_exp_f32 v122, v122
v_mfma_f32_16x16x32_bf16 v[100:103], a[4:7], v[20:23], v[100:103]
buffer_load_dwordx4 v238, s[20:23], s59 offen offset:2048 lds
v_mfma_f32_16x16x32_bf16 v[100:103], a[0:3], v[4:7], v[100:103]
v_exp_f32 v123, v123
v_mfma_f32_16x16x32_bf16 v[136:139], a[0:3], v[8:11], 0
v_exp_f32 v104, v104
v_mfma_f32_16x16x32_bf16 v[136:139], a[4:7], v[24:27], v[136:139]
v_exp_f32 v105, v105
v_mfma_f32_16x16x32_bf16 v[136:139], a[8:11], v[40:43], v[136:139]
v_exp_f32 v106, v106
v_mfma_f32_16x16x32_bf16 v[136:139], a[12:15], v[56:59], v[136:139]
v_exp_f32 v107, v107
v_mfma_f32_16x16x32_bf16 v[136:139], a[16:19], v[72:75], v[136:139]
s_add_u32 m0, s53, 36864
v_add_f32 v230, v230, v120
v_add_f32 v230, v230, v121
v_mfma_f32_16x16x32_bf16 v[136:139], a[20:23], v[88:91], v[136:139]
s_add_u32 s60, s60, 12288
v_cvt_pk_bf16_f32 v120, v120, v121
v_add_f32 v230, v230, v122
v_add_f32 v230, v230, v123
v_cvt_pk_bf16_f32 v121, v122, v123
v_add_f32 v230, v230, v106
v_add_f32 v230, v230, v107
v_cvt_pk_bf16_f32 v123, v106, v107
v_add_f32 v230, v230, v104
v_add_f32 v230, v230, v105
v_cvt_pk_bf16_f32 v122, v104, v105
v_mfma_f32_16x16x32_bf16 v[104:107], a[44:47], v[88:91], 0
buffer_load_dwordx4 v239, s[24:27], s60 offen lds
v_mfma_f32_16x16x32_bf16 v[104:107], a[40:43], v[72:75], v[104:107]
v_exp_f32 v124, v124
v_mfma_f32_16x16x32_bf16 v[104:107], a[36:39], v[56:59], v[104:107]
v_exp_f32 v125, v125
v_mfma_f32_16x16x32_bf16 v[104:107], a[32:35], v[40:43], v[104:107]
v_exp_f32 v126, v126
v_mfma_f32_16x16x32_bf16 v[104:107], a[28:31], v[24:27], v[104:107]
buffer_load_dwordx4 v240, s[24:27], s60 offen offset:1024 lds
v_mfma_f32_16x16x32_bf16 v[104:107], a[24:27], v[8:11], v[104:107]
v_exp_f32 v127, v127
v_mfma_f32_16x16x32_bf16 v[140:143], a[24:27], v[12:15], 0
v_exp_f32 v108, v108
v_mfma_f32_16x16x32_bf16 v[140:143], a[28:31], v[28:31], v[140:143]
v_exp_f32 v109, v109
v_mfma_f32_16x16x32_bf16 v[140:143], a[32:35], v[44:47], v[140:143]
v_exp_f32 v110, v110
v_mfma_f32_16x16x32_bf16 v[140:143], a[36:39], v[60:63], v[140:143]
v_exp_f32 v111, v111
v_mfma_f32_16x16x32_bf16 v[140:143], a[40:43], v[76:79], v[140:143]
v_add_f32 v231, v231, v124
v_add_f32 v231, v231, v125
v_mfma_f32_16x16x32_bf16 v[140:143], a[44:47], v[92:95], v[140:143]
v_cvt_pk_bf16_f32 v124, v124, v125
v_add_f32 v231, v231, v126
v_add_f32 v231, v231, v127
v_cvt_pk_bf16_f32 v125, v126, v127
v_add_f32 v231, v231, v110
v_add_f32 v231, v231, v111
v_cvt_pk_bf16_f32 v127, v110, v111
v_add_f32 v231, v231, v108
v_add_f32 v231, v231, v109
v_cvt_pk_bf16_f32 v126, v108, v109
ds_read_b64_tr_b16 v[160:161], v232 offset:0
ds_read_b64_tr_b16 v[162:163], v232 offset:6144
v_mfma_f32_16x16x32_bf16 v[108:111], a[20:23], v[92:95], 0
buffer_load_dwordx4 v241, s[24:27], s60 offen offset:2048 lds
v_mfma_f32_16x16x32_bf16 v[108:111], a[16:19], v[76:79], v[108:111]
ds_read_b64_tr_b16 v[164:165], v233 offset:0
v_lshrrev_b32 v253, 6, v250
v_mfma_f32_16x16x32_bf16 v[108:111], a[12:15], v[60:63], v[108:111]
s_add_u32 m0, s53, 61440
ds_read_b64_tr_b16 v[166:167], v233 offset:6144
v_lshlrev_b32 v253, 7, v253
v_mfma_f32_16x16x32_bf16 v[108:111], a[8:11], v[44:47], v[108:111]
s_add_u32 s59, s59, 12288
v_exp_f32 v128, v128
v_mfma_f32_16x16x32_bf16 v[108:111], a[4:7], v[28:31], v[108:111]
buffer_load_dwordx4 v236, s[20:23], s59 offen lds
v_mfma_f32_16x16x32_bf16 v[108:111], a[0:3], v[12:15], v[108:111]
s_waitcnt lgkmcnt(2)
ds_read_b64_tr_b16 v[168:169], v234 offset:0
v_add_f32 v228, v228, v128
v_mfma_f32_16x16x32_bf16 a[0:3], v[160:163], v[112:115], 0
ds_read_b64_tr_b16 v[170:171], v234 offset:6144
v_mfma_f32_16x16x32_bf16 a[4:7], v[160:163], v[116:119], 0
v_exp_f32 v129, v129
v_mfma_f32_16x16x32_bf16 a[8:11], v[160:163], v[120:123], 0
ds_read_b64_tr_b16 v[172:173], v235 offset:0
v_add_f32 v228, v228, v129
v_mfma_f32_16x16x32_bf16 a[12:15], v[160:163], v[124:127], 0
s_waitcnt lgkmcnt(3)
ds_read_b64_tr_b16 v[174:175], v235 offset:6144
v_cvt_pk_bf16_f32 v128, v128, v129
v_mfma_f32_16x16x32_bf16 a[28:31], v[164:167], v[124:127], 0
buffer_load_dwordx4 v237, s[20:23], s59 offen offset:1024 lds
v_mfma_f32_16x16x32_bf16 a[24:27], v[164:167], v[120:123], 0
v_exp_f32 v130, v130
v_mfma_f32_16x16x32_bf16 a[20:23], v[164:167], v[116:119], 0
ds_read_b64_tr_b16 v[160:161], v232 offset:128
v_add_f32 v228, v228, v130
v_mfma_f32_16x16x32_bf16 a[16:19], v[164:167], v[112:115], 0
s_waitcnt lgkmcnt(3)
v_exp_f32 v131, v131
v_mfma_f32_16x16x32_bf16 a[32:35], v[168:171], v[112:115], 0
ds_read_b64_tr_b16 v[162:163], v232 offset:6272
v_add_f32 v228, v228, v131
v_mfma_f32_16x16x32_bf16 a[36:39], v[168:171], v[116:119], 0
buffer_load_dwordx4 v238, s[20:23], s59 offen offset:2048 lds
v_mfma_f32_16x16x32_bf16 a[40:43], v[168:171], v[120:123], 0
s_and_b32 s3, s0, 1073807359
ds_read_b64_tr_b16 v[164:165], v233 offset:128
v_cvt_pk_bf16_f32 v129, v130, v131
v_mfma_f32_16x16x32_bf16 a[44:47], v[168:171], v[124:127], 0
s_waitcnt lgkmcnt(3)
v_exp_f32 v96, v96
v_mfma_f32_16x16x32_bf16 a[60:63], v[172:175], v[124:127], 0
s_add_u32 s3, s3, 131072
ds_read_b64_tr_b16 v[166:167], v233 offset:6272
v_mfma_f32_16x16x32_bf16 a[56:59], v[172:175], v[120:123], 0
buffer_load_dword v254, v253, s[20:23], s3 offen
v_mfma_f32_16x16x32_bf16 a[52:55], v[172:175], v[116:119], 0
ds_read_b128 a[192:195], v248 offset:24576
v_subrev_u32 v253, s79, v251
v_mfma_f32_16x16x32_bf16 a[48:51], v[172:175], v[112:115], 0
s_waitcnt lgkmcnt(3)
v_exp_f32 v97, v97
v_mfma_f32_16x16x32_bf16 a[64:67], v[160:163], v[112:115], 0
ds_read_b128 a[196:199], v249 offset:24576
v_cvt_pk_bf16_f32 v130, v96, v97
v_mfma_f32_16x16x32_bf16 a[68:71], v[160:163], v[116:119], 0
ds_read_b128 a[200:203], v248 offset:24704
ds_read_b128 a[204:207], v249 offset:24704
ds_read_b128 a[208:211], v248 offset:24832
ds_read_b128 a[212:215], v249 offset:24832
ds_read_b128 a[216:219], v248 offset:30720
ds_read_b128 a[220:223], v249 offset:30720
ds_read_b128 a[224:227], v248 offset:30848
ds_read_b128 a[228:231], v249 offset:30848
ds_read_b128 a[232:235], v248 offset:30976
ds_read_b128 v[224:227], v249 offset:30976
v_mfma_f32_16x16x32_bf16 a[72:75], v[160:163], v[120:123], 0
v_exp_f32 v98, v98
v_mfma_f32_16x16x32_bf16 a[76:79], v[160:163], v[124:127], 0
s_waitcnt lgkmcnt(12)
v_exp_f32 v99, v99
v_mfma_f32_16x16x32_bf16 a[92:95], v[164:167], v[124:127], 0
v_add_f32 v228, v228, v98
v_add_f32 v228, v228, v99
v_mfma_f32_16x16x32_bf16 a[88:91], v[164:167], v[120:123], 0
v_cvt_pk_bf16_f32 v131, v98, v99
v_add_f32 v228, v228, v96
v_mfma_f32_16x16x32_bf16 a[84:87], v[164:167], v[116:119], 0
v_exp_f32 v132, v132
v_mfma_f32_16x16x32_bf16 a[80:83], v[164:167], v[112:115], 0
s_waitcnt lgkmcnt(11)
v_exp_f32 v133, v133
v_mfma_f32_16x16x32_bf16 v[144:147], a[192:195], v[0:3], 0
s_waitcnt vmcnt(15) lgkmcnt(0)
s_barrier
v_mfma_f32_16x16x32_bf16 v[144:147], a[196:199], v[16:19], v[144:147]
v_exp_f32 v134, v134
v_mfma_f32_16x16x32_bf16 v[144:147], a[200:203], v[32:35], v[144:147]
s_waitcnt vmcnt(10)
buffer_store_dwordx4 v[250:253], v252, s[4:7], s68 offen sc1
v_mfma_f32_16x16x32_bf16 v[144:147], a[204:207], v[48:51], v[144:147]
v_add_f32 v228, v228, v97
v_add_f32 v229, v229, v134
v_mfma_f32_16x16x32_bf16 v[144:147], a[208:211], v[64:67], v[144:147]
v_exp_f32 v135, v135
v_mfma_f32_16x16x32_bf16 v[144:147], a[212:215], v[80:83], v[144:147]
v_exp_f32 v100, v100
v_mfma_f32_16x16x32_bf16 v[96:99], v[224:227], v[80:83], 0
v_exp_f32 v101, v101
v_mfma_f32_16x16x32_bf16 v[96:99], a[232:235], v[64:67], v[96:99]
v_exp_f32 v102, v102
v_mfma_f32_16x16x32_bf16 v[96:99], a[228:231], v[48:51], v[96:99]
v_exp_f32 v103, v103
v_mfma_f32_16x16x32_bf16 v[96:99], a[224:227], v[32:35], v[96:99]
v_add_f32 v229, v229, v135
v_cvt_pk_bf16_f32 v135, v134, v135
v_mfma_f32_16x16x32_bf16 v[96:99], a[220:223], v[16:19], v[96:99]
v_add_f32 v229, v229, v132
v_add_f32 v229, v229, v133
v_mfma_f32_16x16x32_bf16 v[96:99], a[216:219], v[0:3], v[96:99]
v_cvt_pk_bf16_f32 v134, v132, v133
v_add_f32 v229, v229, v100
v_mfma_f32_16x16x32_bf16 v[148:151], a[216:219], v[4:7], 0
v_add_f32 v229, v229, v101
v_cvt_pk_bf16_f32 v132, v100, v101
v_mfma_f32_16x16x32_bf16 v[148:151], a[220:223], v[20:23], v[148:151]
v_add_f32 v229, v229, v102
v_add_f32 v229, v229, v103
v_mfma_f32_16x16x32_bf16 v[148:151], a[224:227], v[36:39], v[148:151]
s_add_u32 m0, s55, 102400
v_cvt_pk_bf16_f32 v133, v102, v103
v_lshrrev_b32 v253, 6, v250
v_mfma_f32_16x16x32_bf16 v[148:151], a[228:231], v[52:55], v[148:151]
buffer_load_dwordx4 v242, s[32:35], s61 offen lds
v_mfma_f32_16x16x32_bf16 v[148:151], a[232:235], v[68:71], v[148:151]
v_exp_f32 v136, v136
v_mfma_f32_16x16x32_bf16 v[148:151], v[224:227], v[84:87], v[148:151]
v_exp_f32 v137, v137
v_mfma_f32_16x16x32_bf16 v[100:103], a[212:215], v[84:87], 0
v_exp_f32 v138, v138
v_mfma_f32_16x16x32_bf16 v[100:103], a[208:211], v[68:71], v[100:103]
buffer_load_dwordx4 v243, s[32:35], s61 offen offset:1024 lds
v_mfma_f32_16x16x32_bf16 v[100:103], a[204:207], v[52:55], v[100:103]
v_exp_f32 v139, v139
v_mfma_f32_16x16x32_bf16 v[100:103], a[200:203], v[36:39], v[100:103]
v_exp_f32 v104, v104
v_mfma_f32_16x16x32_bf16 v[100:103], a[196:199], v[20:23], v[100:103]
v_exp_f32 v105, v105
v_mfma_f32_16x16x32_bf16 v[100:103], a[192:195], v[4:7], v[100:103]
v_exp_f32 v106, v106
v_mfma_f32_16x16x32_bf16 v[152:155], a[192:195], v[8:11], 0
v_exp_f32 v107, v107
v_mfma_f32_16x16x32_bf16 v[152:155], a[196:199], v[24:27], v[152:155]
ds_read_b64_tr_b16 v[168:169], v234 offset:128
v_add_f32 v230, v230, v136
v_mfma_f32_16x16x32_bf16 v[152:155], a[200:203], v[40:43], v[152:155]
ds_read_b64_tr_b16 v[170:171], v234 offset:6272
v_add_f32 v230, v230, v137
v_mfma_f32_16x16x32_bf16 v[152:155], a[204:207], v[56:59], v[152:155]
ds_read_b64_tr_b16 v[172:173], v234 offset:12416
v_cvt_pk_bf16_f32 v136, v136, v137
v_mfma_f32_16x16x32_bf16 v[152:155], a[208:211], v[72:75], v[152:155]
v_add_f32 v230, v230, v138
v_add_f32 v230, v230, v139
v_mfma_f32_16x16x32_bf16 v[152:155], a[212:215], v[88:91], v[152:155]
v_cvt_pk_bf16_f32 v137, v138, v139
v_add_f32 v230, v230, v106
v_add_f32 v230, v230, v107
v_cvt_pk_bf16_f32 v139, v106, v107
v_add_f32 v230, v230, v104
v_add_f32 v230, v230, v105
v_cvt_pk_bf16_f32 v138, v104, v105
v_mfma_f32_16x16x32_bf16 v[104:107], v[224:227], v[88:91], 0
buffer_load_dwordx4 v244, s[32:35], s61 offen offset:2048 lds
v_mfma_f32_16x16x32_bf16 v[104:107], a[232:235], v[72:75], v[104:107]
v_exp_f32 v140, v140
v_mfma_f32_16x16x32_bf16 v[104:107], a[228:231], v[56:59], v[104:107]
v_exp_f32 v141, v141
v_mfma_f32_16x16x32_bf16 v[104:107], a[224:227], v[40:43], v[104:107]
v_exp_f32 v142, v142
v_mfma_f32_16x16x32_bf16 v[104:107], a[220:223], v[24:27], v[104:107]
buffer_load_dwordx4 v245, s[32:35], s61 offen offset:3072 lds
v_mfma_f32_16x16x32_bf16 v[104:107], a[216:219], v[8:11], v[104:107]
v_exp_f32 v143, v143
v_mfma_f32_16x16x32_bf16 v[156:159], a[216:219], v[12:15], 0
v_exp_f32 v108, v108
v_mfma_f32_16x16x32_bf16 v[156:159], a[220:223], v[28:31], v[156:159]
v_exp_f32 v109, v109
v_mfma_f32_16x16x32_bf16 v[156:159], a[224:227], v[44:47], v[156:159]
v_exp_f32 v110, v110
v_mfma_f32_16x16x32_bf16 v[156:159], a[228:231], v[60:63], v[156:159]
v_exp_f32 v111, v111
v_mfma_f32_16x16x32_bf16 v[156:159], a[232:235], v[76:79], v[156:159]
v_add_f32 v231, v231, v142
v_add_f32 v231, v231, v143
v_mfma_f32_16x16x32_bf16 v[156:159], v[224:227], v[92:95], v[156:159]
s_add_u32 m0, s55, 106496
v_cvt_pk_bf16_f32 v143, v142, v143
v_add_f32 v231, v231, v140
v_add_f32 v231, v231, v141
v_cvt_pk_bf16_f32 v142, v140, v141
v_add_f32 v231, v231, v108
v_add_f32 v231, v231, v109
v_cvt_pk_bf16_f32 v140, v108, v109
v_add_f32 v231, v231, v110
v_add_f32 v231, v231, v111
v_cvt_pk_bf16_f32 v141, v110, v111
v_mfma_f32_16x16x32_bf16 v[108:111], a[212:215], v[92:95], 0
buffer_load_dwordx4 v246, s[32:35], s61 offen lds
ds_read_b64_tr_b16 v[174:175], v234 offset:18560
v_mfma_f32_16x16x32_bf16 v[108:111], a[208:211], v[76:79], v[108:111]
ds_read_b64_tr_b16 v[160:161], v235 offset:128
v_lshlrev_b32 v253, 7, v253
v_mfma_f32_16x16x32_bf16 v[108:111], a[204:207], v[60:63], v[108:111]
s_add_u32 m0, s53, 73728
v_exp_f32 v144, v144
v_mfma_f32_16x16x32_bf16 v[108:111], a[200:203], v[44:47], v[108:111]
s_add_u32 s59, s59, 12288
ds_read_b64_tr_b16 v[162:163], v235 offset:6272
v_add_f32 v228, v228, v144
v_mfma_f32_16x16x32_bf16 v[108:111], a[196:199], v[28:31], v[108:111]
buffer_load_dwordx4 v236, s[20:23], s59 offen lds
v_mfma_f32_16x16x32_bf16 v[108:111], a[192:195], v[12:15], v[108:111]
s_waitcnt lgkmcnt(4)
v_exp_f32 v145, v145
v_mfma_f32_16x16x32_bf16 a[96:99], v[168:171], v[112:115], 0
s_waitcnt lgkmcnt(2)
ds_read_b64_tr_b16 v[164:165], v235 offset:12416
v_add_f32 v228, v228, v145
v_mfma_f32_16x16x32_bf16 a[96:99], v[172:175], v[128:131], a[96:99]
L_walk1_7:
s_cbranch_execz L_walk1_11
ds_read_b64_tr_b16 v[166:167], v235 offset:18560
v_cvt_pk_bf16_f32 v144, v144, v145
v_mfma_f32_16x16x32_bf16 a[100:103], v[172:175], v[132:135], 0
buffer_load_dwordx4 v237, s[20:23], s59 offen offset:1024 lds
v_mfma_f32_16x16x32_bf16 a[100:103], v[168:171], v[116:119], a[100:103]
v_exp_f32 v146, v146
v_mfma_f32_16x16x32_bf16 a[104:107], v[168:171], v[120:123], 0
ds_read_b128 a[192:195], v248 offset:36864
v_add_f32 v228, v228, v146
v_mfma_f32_16x16x32_bf16 a[104:107], v[172:175], v[136:139], a[104:107]
v_exp_f32 v147, v147
v_mfma_f32_16x16x32_bf16 a[108:111], v[172:175], v[140:143], 0
ds_read_b64_tr_b16 v[172:173], v232 offset:12544
v_add_f32 v228, v228, v147
v_mfma_f32_16x16x32_bf16 a[108:111], v[168:171], v[124:127], a[108:111]
s_waitcnt lgkmcnt(4)
ds_read_b64_tr_b16 v[168:169], v232 offset:256
v_cvt_pk_bf16_f32 v145, v146, v147
v_mfma_f32_16x16x32_bf16 a[124:127], v[160:163], v[124:127], 0
s_waitcnt lgkmcnt(3)
ds_read_b64_tr_b16 v[170:171], v232 offset:6400
v_mfma_f32_16x16x32_bf16 a[124:127], v[164:167], v[140:143], a[124:127]
ds_read_b64_tr_b16 v[174:175], v232 offset:18688
v_mfma_f32_16x16x32_bf16 a[120:123], v[164:167], v[136:139], 0
buffer_load_dwordx4 v238, s[20:23], s59 offen offset:2048 lds
v_mfma_f32_16x16x32_bf16 a[120:123], v[160:163], v[120:123], a[120:123]
v_exp_f32 v96, v96
v_mfma_f32_16x16x32_bf16 a[116:119], v[160:163], v[116:119], 0
v_exp_f32 v97, v97
v_mfma_f32_16x16x32_bf16 a[116:119], v[164:167], v[132:135], a[116:119]
ds_read_b128 a[196:199], v249 offset:36864
v_cvt_pk_bf16_f32 v146, v96, v97
v_mfma_f32_16x16x32_bf16 a[112:115], v[164:167], v[128:131], 0
v_exp_f32 v98, v98
v_mfma_f32_16x16x32_bf16 a[112:115], v[160:163], v[112:115], a[112:115]
s_waitcnt lgkmcnt(2)
ds_read_b64_tr_b16 v[160:161], v233 offset:256
v_add_f32 v228, v228, v98
v_mfma_f32_16x16x32_bf16 a[128:131], v[168:171], v[112:115], 0
s_waitcnt lgkmcnt(2)
ds_read_b64_tr_b16 v[162:163], v233 offset:6400
v_mfma_f32_16x16x32_bf16 a[128:131], v[172:175], v[128:131], a[128:131]
ds_read_b64_tr_b16 v[164:165], v233 offset:12544
v_mfma_f32_16x16x32_bf16 a[132:135], v[172:175], v[132:135], 0
ds_read_b64_tr_b16 v[166:167], v233 offset:18688
v_mfma_f32_16x16x32_bf16 a[132:135], v[168:171], v[116:119], a[132:135]
v_exp_f32 v99, v99
v_mfma_f32_16x16x32_bf16 a[136:139], v[168:171], v[120:123], 0
ds_read_b128 a[200:203], v248 offset:36992
v_add_f32 v228, v228, v99
v_mfma_f32_16x16x32_bf16 a[136:139], v[172:175], v[136:139], a[136:139]
ds_read_b128 a[204:207], v249 offset:36992
v_cvt_pk_bf16_f32 v147, v98, v99
v_mfma_f32_16x16x32_bf16 a[140:143], v[172:175], v[140:143], 0
ds_read_b64_tr_b16 v[172:173], v234 offset:12544
v_add_f32 v228, v228, v96
v_mfma_f32_16x16x32_bf16 a[140:143], v[168:171], v[124:127], a[140:143]
s_waitcnt lgkmcnt(5)
ds_read_b64_tr_b16 v[168:169], v234 offset:256
v_add_f32 v228, v228, v97
v_mfma_f32_16x16x32_bf16 a[156:159], v[160:163], v[124:127], 0
s_waitcnt lgkmcnt(4)
ds_read_b64_tr_b16 v[170:171], v234 offset:6400
v_mfma_f32_16x16x32_bf16 a[156:159], v[164:167], v[140:143], a[156:159]
ds_read_b64_tr_b16 v[174:175], v234 offset:18688
v_mfma_f32_16x16x32_bf16 a[152:155], v[164:167], v[136:139], 0
v_exp_f32 v148, v148
v_mfma_f32_16x16x32_bf16 a[152:155], v[160:163], v[120:123], a[152:155]
v_exp_f32 v149, v149
v_mfma_f32_16x16x32_bf16 a[148:151], v[160:163], v[116:119], 0
ds_read_b128 a[208:211], v248 offset:37120
v_and_b32 v253, 512, v250
v_mfma_f32_16x16x32_bf16 a[148:151], v[164:167], v[132:135], a[148:151]
ds_read_b128 a[212:215], v249 offset:37120
v_mul_u32_u24 v253, 7680, v253
v_mfma_f32_16x16x32_bf16 a[144:147], v[164:167], v[128:131], 0
ds_read_b64_tr_b16 v[164:165], v235 offset:12544
v_lshl_add_u32 v253, v250, 9, v253
v_mfma_f32_16x16x32_bf16 a[144:147], v[160:163], v[112:115], a[144:147]
s_waitcnt lgkmcnt(4)
ds_read_b64_tr_b16 v[160:161], v235 offset:256
v_and_b32 v253, 4251648, v253
v_mfma_f32_16x16x32_bf16 a[160:163], v[168:171], v[112:115], 0
s_waitcnt lgkmcnt(4)
ds_read_b64_tr_b16 v[162:163], v235 offset:6400
v_mfma_f32_16x16x32_bf16 a[160:163], v[172:175], v[128:131], a[160:163]
ds_read_b64_tr_b16 v[166:167], v235 offset:18688
v_mfma_f32_16x16x32_bf16 a[164:167], v[172:175], v[132:135], 0
v_exp_f32 v150, v150
v_mfma_f32_16x16x32_bf16 a[164:167], v[168:171], v[116:119], a[164:167]
ds_read_b128 a[216:219], v248 offset:43008
v_add_f32 v229, v229, v150
v_mfma_f32_16x16x32_bf16 a[168:171], v[168:171], v[120:123], 0
v_exp_f32 v151, v151
v_mfma_f32_16x16x32_bf16 a[168:171], v[172:175], v[136:139], a[168:171]
ds_read_b128 a[220:223], v249 offset:43008
v_add_f32 v229, v229, v151
v_mfma_f32_16x16x32_bf16 a[172:175], v[172:175], v[140:143], 0
ds_read_b128 a[224:227], v248 offset:43136
v_cvt_pk_bf16_f32 v151, v150, v151
v_mfma_f32_16x16x32_bf16 a[172:175], v[168:171], v[124:127], a[172:175]
s_waitcnt lgkmcnt(4)
ds_read_b128 a[228:231], v249 offset:43136
v_add_f32 v229, v229, v148
v_mfma_f32_16x16x32_bf16 a[188:191], v[160:163], v[124:127], 0
s_waitcnt lgkmcnt(4)
ds_read_b128 a[232:235], v248 offset:43264
v_add_f32 v229, v229, v149
v_mfma_f32_16x16x32_bf16 a[188:191], v[164:167], v[140:143], a[188:191]
ds_read_b128 v[224:227], v249 offset:43264
v_cvt_pk_bf16_f32 v150, v148, v149
v_mfma_f32_16x16x32_bf16 a[184:187], v[164:167], v[136:139], 0
v_exp_f32 v100, v100
v_mfma_f32_16x16x32_bf16 a[184:187], v[160:163], v[120:123], a[184:187]
v_exp_f32 v101, v101
v_mfma_f32_16x16x32_bf16 a[180:183], v[160:163], v[116:119], 0
v_exp_f32 v102, v102
v_mfma_f32_16x16x32_bf16 a[180:183], v[164:167], v[132:135], a[180:183]
v_exp_f32 v103, v103
v_mfma_f32_16x16x32_bf16 a[176:179], v[164:167], v[128:131], 0
v_add_f32 v229, v229, v100
v_add_f32 v229, v229, v101
v_mfma_f32_16x16x32_bf16 a[176:179], v[160:163], v[112:115], a[176:179]
v_cvt_pk_bf16_f32 v148, v100, v101
v_add_f32 v229, v229, v102
v_mfma_f32_16x16x32_bf16 v[112:115], a[192:195], v[0:3], 0
s_waitcnt vmcnt(16) lgkmcnt(0)
s_barrier
v_mfma_f32_16x16x32_bf16 v[112:115], a[196:199], v[16:19], v[112:115]
v_add_f32 v229, v229, v103
v_cvt_pk_bf16_f32 v149, v102, v103
v_mfma_f32_16x16x32_bf16 v[112:115], a[200:203], v[32:35], v[112:115]
buffer_load_dword v254, v253, s[4:7], s82 offen offset:12 sc1
v_mfma_f32_16x16x32_bf16 v[112:115], a[204:207], v[48:51], v[112:115]
v_exp_f32 v152, v152
v_mfma_f32_16x16x32_bf16 v[112:115], a[208:211], v[64:67], v[112:115]
v_exp_f32 v153, v153
v_mfma_f32_16x16x32_bf16 v[112:115], a[212:215], v[80:83], v[112:115]
v_exp_f32 v154, v154
v_mfma_f32_16x16x32_bf16 v[96:99], v[224:227], v[80:83], 0
s_add_u32 m0, s55, 122880
v_exp_f32 v155, v155
v_mfma_f32_16x16x32_bf16 v[96:99], a[232:235], v[64:67], v[96:99]
s_add_u32 s61, s61, 163840
v_exp_f32 v104, v104
v_mfma_f32_16x16x32_bf16 v[96:99], a[228:231], v[48:51], v[96:99]
buffer_load_dwordx4 v242, s[32:35], s61 offen lds
v_mfma_f32_16x16x32_bf16 v[96:99], a[224:227], v[32:35], v[96:99]
v_exp_f32 v105, v105
v_mfma_f32_16x16x32_bf16 v[96:99], a[220:223], v[16:19], v[96:99]
v_exp_f32 v106, v106
v_mfma_f32_16x16x32_bf16 v[96:99], a[216:219], v[0:3], v[96:99]
v_exp_f32 v107, v107
v_mfma_f32_16x16x32_bf16 v[116:119], a[216:219], v[4:7], 0
buffer_load_dwordx4 v243, s[32:35], s61 offen offset:1024 lds
v_mfma_f32_16x16x32_bf16 v[116:119], a[220:223], v[20:23], v[116:119]
v_add_f32 v230, v230, v152
v_add_f32 v230, v230, v153
v_mfma_f32_16x16x32_bf16 v[116:119], a[224:227], v[36:39], v[116:119]
v_cvt_pk_bf16_f32 v152, v152, v153
v_add_f32 v230, v230, v154
v_mfma_f32_16x16x32_bf16 v[116:119], a[228:231], v[52:55], v[116:119]
v_add_f32 v230, v230, v155
v_cvt_pk_bf16_f32 v153, v154, v155
v_mfma_f32_16x16x32_bf16 v[116:119], a[232:235], v[68:71], v[116:119]
v_add_f32 v230, v230, v106
v_add_f32 v230, v230, v107
v_mfma_f32_16x16x32_bf16 v[116:119], v[224:227], v[84:87], v[116:119]
v_cvt_pk_bf16_f32 v155, v106, v107
v_add_f32 v230, v230, v104
v_mfma_f32_16x16x32_bf16 v[100:103], a[212:215], v[84:87], 0
v_add_f32 v230, v230, v105
v_cvt_pk_bf16_f32 v154, v104, v105
v_mfma_f32_16x16x32_bf16 v[100:103], a[208:211], v[68:71], v[100:103]
buffer_load_dwordx4 v244, s[32:35], s61 offen offset:2048 lds
v_mfma_f32_16x16x32_bf16 v[100:103], a[204:207], v[52:55], v[100:103]
v_exp_f32 v156, v156
v_mfma_f32_16x16x32_bf16 v[100:103], a[200:203], v[36:39], v[100:103]
v_exp_f32 v157, v157
v_mfma_f32_16x16x32_bf16 v[100:103], a[196:199], v[20:23], v[100:103]
v_exp_f32 v158, v158
v_mfma_f32_16x16x32_bf16 v[100:103], a[192:195], v[4:7], v[100:103]
buffer_load_dwordx4 v245, s[32:35], s61 offen offset:3072 lds
v_mfma_f32_16x16x32_bf16 v[120:123], a[192:195], v[8:11], 0
v_exp_f32 v159, v159
v_mfma_f32_16x16x32_bf16 v[120:123], a[196:199], v[24:27], v[120:123]
v_exp_f32 v108, v108
v_mfma_f32_16x16x32_bf16 v[120:123], a[200:203], v[40:43], v[120:123]
v_exp_f32 v109, v109
v_mfma_f32_16x16x32_bf16 v[120:123], a[204:207], v[56:59], v[120:123]
v_exp_f32 v110, v110
v_mfma_f32_16x16x32_bf16 v[120:123], a[208:211], v[72:75], v[120:123]
v_exp_f32 v111, v111
v_mfma_f32_16x16x32_bf16 v[120:123], a[212:215], v[88:91], v[120:123]
ds_read_b64_tr_b16 v[168:169], v232 offset:12288
v_add_f32 v231, v231, v158
v_mfma_f32_16x16x32_bf16 v[104:107], v[224:227], v[88:91], 0
ds_read_b64_tr_b16 v[170:171], v232 offset:18432
v_add_f32 v231, v231, v159
v_mfma_f32_16x16x32_bf16 v[104:107], a[232:235], v[72:75], v[104:107]
ds_read_b64_tr_b16 v[172:173], v232 offset:24576
v_cvt_pk_bf16_f32 v159, v158, v159
v_mfma_f32_16x16x32_bf16 v[104:107], a[228:231], v[56:59], v[104:107]
ds_read_b64_tr_b16 v[174:175], v232 offset:30720
v_add_f32 v231, v231, v156
v_mfma_f32_16x16x32_bf16 v[104:107], a[224:227], v[40:43], v[104:107]
ds_read_b64_tr_b16 v[160:161], v233 offset:12288
v_add_f32 v231, v231, v157
v_mfma_f32_16x16x32_bf16 v[104:107], a[220:223], v[24:27], v[104:107]
ds_read_b64_tr_b16 v[162:163], v233 offset:18432
v_cvt_pk_bf16_f32 v158, v156, v157
v_mfma_f32_16x16x32_bf16 v[104:107], a[216:219], v[8:11], v[104:107]
ds_read_b64_tr_b16 v[164:165], v233 offset:24576
v_add_f32 v231, v231, v108
v_mfma_f32_16x16x32_bf16 v[124:127], a[216:219], v[12:15], 0
ds_read_b64_tr_b16 v[166:167], v233 offset:30720
v_add_f32 v231, v231, v109
v_mfma_f32_16x16x32_bf16 v[124:127], a[220:223], v[28:31], v[124:127]
ds_read_b128 a[216:219], v248 offset:6144
v_cvt_pk_bf16_f32 v156, v108, v109
v_mfma_f32_16x16x32_bf16 v[124:127], a[224:227], v[44:47], v[124:127]
ds_read_b128 a[220:223], v249 offset:6144
v_add_f32 v231, v231, v110
v_mfma_f32_16x16x32_bf16 v[124:127], a[228:231], v[60:63], v[124:127]
ds_read_b128 a[224:227], v248 offset:6272
v_add_f32 v231, v231, v111
v_mfma_f32_16x16x32_bf16 v[124:127], a[232:235], v[76:79], v[124:127]
s_add_u32 m0, s55, 126976
ds_read_b128 a[228:231], v249 offset:6272
v_cvt_pk_bf16_f32 v157, v110, v111
v_mfma_f32_16x16x32_bf16 v[124:127], v[224:227], v[92:95], v[124:127]
buffer_load_dwordx4 v246, s[32:35], s61 offen lds
v_mfma_f32_16x16x32_bf16 v[108:111], a[212:215], v[92:95], 0
s_waitcnt vmcnt(5)
ds_read_b128 a[212:215], v249 offset:256
v_sub_u32 v254, v251, v254
v_mfma_f32_16x16x32_bf16 v[108:111], a[208:211], v[76:79], v[108:111]
ds_read_b128 a[208:211], v248 offset:256
v_cmp_lt_u32 vcc, 1, v254
v_mfma_f32_16x16x32_bf16 v[108:111], a[204:207], v[60:63], v[108:111]
s_add_u32 s90, s65, 0
s_cbranch_vccnz L_spin_y
L_back_y:
ds_read_b128 a[204:207], v249 offset:128
v_mfma_f32_16x16x32_bf16 v[108:111], a[200:203], v[44:47], v[108:111]
buffer_load_dwordx4 v[176:179], v250, s[4:7], s90 offen sc1
v_mfma_f32_16x16x32_bf16 v[108:111], a[196:199], v[28:31], v[108:111]
s_add_u32 s90, s65, 4096
v_exp_f32 v112, v112
v_mfma_f32_16x16x32_bf16 v[108:111], a[192:195], v[12:15], v[108:111]
s_waitcnt lgkmcnt(13)
ds_read_b128 a[192:195], v248 offset:0
v_add_f32 v228, v228, v112
v_mfma_f32_16x16x32_bf16 a[0:3], v[168:171], v[128:131], a[0:3]
s_waitcnt lgkmcnt(12)
v_exp_f32 v113, v113
v_mfma_f32_16x16x32_bf16 a[0:3], v[172:175], v[144:147], a[0:3]
buffer_load_dwordx4 v[180:183], v250, s[4:7], s90 offen sc1
v_mfma_f32_16x16x32_bf16 a[4:7], v[172:175], v[148:151], a[4:7]
ds_read_b128 a[196:199], v249 offset:0
v_add_f32 v228, v228, v113
v_mfma_f32_16x16x32_bf16 a[4:7], v[168:171], v[132:135], a[4:7]
ds_read_b128 a[200:203], v248 offset:128
v_cvt_pk_bf16_f32 v112, v112, v113
v_mfma_f32_16x16x32_bf16 a[8:11], v[168:171], v[136:139], a[8:11]
s_add_u32 s90, s66, 0
v_exp_f32 v114, v114
v_mfma_f32_16x16x32_bf16 a[8:11], v[172:175], v[152:155], a[8:11]
buffer_load_dwordx4 v[184:187], v250, s[4:7], s90 offen sc1
v_mfma_f32_16x16x32_bf16 a[12:15], v[172:175], v[156:159], a[12:15]
ds_read_b64_tr_b16 v[172:173], v234 offset:24576
v_add_f32 v228, v228, v114
v_mfma_f32_16x16x32_bf16 a[12:15], v[168:171], v[140:143], a[12:15]
s_waitcnt lgkmcnt(13)
v_exp_f32 v115, v115
v_mfma_f32_16x16x32_bf16 a[28:31], v[160:163], v[140:143], a[28:31]
s_waitcnt lgkmcnt(11)
ds_read_b64_tr_b16 v[168:169], v234 offset:12288
v_add_f32 v228, v228, v115
v_mfma_f32_16x16x32_bf16 a[28:31], v[164:167], v[156:159], a[28:31]
ds_read_b64_tr_b16 v[170:171], v234 offset:18432
v_cvt_pk_bf16_f32 v113, v114, v115
v_mfma_f32_16x16x32_bf16 a[24:27], v[164:167], v[152:155], a[24:27]
s_add_u32 s90, s66, 4096
ds_read_b64_tr_b16 v[174:175], v234 offset:30720
v_mfma_f32_16x16x32_bf16 a[24:27], v[160:163], v[136:139], a[24:27]
buffer_load_dwordx4 v[188:191], v250, s[4:7], s90 offen sc1
v_mfma_f32_16x16x32_bf16 a[20:23], v[160:163], v[132:135], a[20:23]
v_exp_f32 v96, v96
v_mfma_f32_16x16x32_bf16 a[20:23], v[164:167], v[148:151], a[20:23]
v_exp_f32 v97, v97
v_mfma_f32_16x16x32_bf16 a[16:19], v[164:167], v[144:147], a[16:19]
ds_read_b64_tr_b16 v[164:165], v235 offset:24576
v_cvt_pk_bf16_f32 v114, v96, v97
v_mfma_f32_16x16x32_bf16 a[16:19], v[160:163], v[128:131], a[16:19]
s_waitcnt lgkmcnt(2)
v_exp_f32 v98, v98
v_mfma_f32_16x16x32_bf16 a[32:35], v[168:171], v[128:131], a[32:35]
s_waitcnt lgkmcnt(1)
ds_read_b64_tr_b16 v[160:161], v235 offset:12288
v_add_f32 v228, v228, v98
v_mfma_f32_16x16x32_bf16 a[32:35], v[172:175], v[144:147], a[32:35]
s_add_u32 m0, s53, 0
ds_read_b64_tr_b16 v[162:163], v235 offset:18432
v_mfma_f32_16x16x32_bf16 a[36:39], v[172:175], v[148:151], a[36:39]
s_add_u32 s60, s60, 12288
ds_read_b64_tr_b16 v[166:167], v235 offset:30720
v_mfma_f32_16x16x32_bf16 a[36:39], v[168:171], v[132:135], a[36:39]
buffer_load_dwordx4 v239, s[24:27], s60 offen lds
v_mfma_f32_16x16x32_bf16 a[40:43], v[168:171], v[136:139], a[40:43]
v_exp_f32 v99, v99
v_mfma_f32_16x16x32_bf16 a[40:43], v[172:175], v[152:155], a[40:43]
ds_read_b128 a[232:235], v248 offset:6400
v_add_f32 v228, v228, v99
v_mfma_f32_16x16x32_bf16 a[44:47], v[172:175], v[156:159], a[44:47]
ds_read_b64_tr_b16 v[172:173], v232 offset:24704
v_cvt_pk_bf16_f32 v115, v98, v99
v_mfma_f32_16x16x32_bf16 a[44:47], v[168:171], v[140:143], a[44:47]
s_waitcnt lgkmcnt(3)
ds_read_b64_tr_b16 v[168:169], v232 offset:12416
v_add_f32 v228, v228, v96
v_mfma_f32_16x16x32_bf16 a[60:63], v[160:163], v[140:143], a[60:63]
s_waitcnt lgkmcnt(3)
ds_read_b64_tr_b16 v[170:171], v232 offset:18560
v_add_f32 v228, v228, v97
v_mfma_f32_16x16x32_bf16 a[60:63], v[164:167], v[156:159], a[60:63]
ds_read_b64_tr_b16 v[174:175], v232 offset:30848
v_mfma_f32_16x16x32_bf16 a[56:59], v[164:167], v[152:155], a[56:59]
buffer_load_dwordx4 v240, s[24:27], s60 offen offset:1024 lds
v_mfma_f32_16x16x32_bf16 a[56:59], v[160:163], v[136:139], a[56:59]
v_exp_f32 v116, v116
v_mfma_f32_16x16x32_bf16 a[52:55], v[160:163], v[132:135], a[52:55]
v_exp_f32 v117, v117
v_mfma_f32_16x16x32_bf16 a[52:55], v[164:167], v[148:151], a[52:55]
v_exp_f32 v118, v118
v_mfma_f32_16x16x32_bf16 a[48:51], v[164:167], v[144:147], a[48:51]
ds_read_b64_tr_b16 v[164:165], v233 offset:24704
v_add_f32 v229, v229, v118
v_mfma_f32_16x16x32_bf16 a[48:51], v[160:163], v[128:131], a[48:51]
s_waitcnt lgkmcnt(2)
buffer_load_dwordx4 v241, s[24:27], s60 offen offset:2048 lds
v_mfma_f32_16x16x32_bf16 a[64:67], v[168:171], v[128:131], a[64:67]
s_waitcnt lgkmcnt(1)
ds_read_b64_tr_b16 v[160:161], v233 offset:12416
v_mfma_f32_16x16x32_bf16 a[64:67], v[172:175], v[144:147], a[64:67]
s_add_u32 m0, s53, 86016
ds_read_b64_tr_b16 v[162:163], v233 offset:18560
v_mfma_f32_16x16x32_bf16 a[68:71], v[172:175], v[148:151], a[68:71]
s_add_u32 s59, s59, 12288
ds_read_b64_tr_b16 v[166:167], v233 offset:30848
v_mfma_f32_16x16x32_bf16 a[68:71], v[168:171], v[132:135], a[68:71]
buffer_load_dwordx4 v236, s[20:23], s59 offen lds
v_mfma_f32_16x16x32_bf16 a[72:75], v[168:171], v[136:139], a[72:75]
v_exp_f32 v119, v119
v_mfma_f32_16x16x32_bf16 a[72:75], v[172:175], v[152:155], a[72:75]
v_exp_f32 v100, v100
v_mfma_f32_16x16x32_bf16 a[76:79], v[172:175], v[156:159], a[76:79]
v_exp_f32 v101, v101
v_mfma_f32_16x16x32_bf16 a[76:79], v[168:171], v[140:143], a[76:79]
s_waitcnt lgkmcnt(1)
buffer_load_dwordx4 v237, s[20:23], s59 offen offset:1024 lds
v_mfma_f32_16x16x32_bf16 a[92:95], v[160:163], v[140:143], a[92:95]
s_waitcnt lgkmcnt(0)
v_exp_f32 v102, v102
v_mfma_f32_16x16x32_bf16 a[92:95], v[164:167], v[156:159], a[92:95]
v_exp_f32 v103, v103
v_mfma_f32_16x16x32_bf16 a[88:91], v[164:167], v[152:155], a[88:91]
v_add_f32 v229, v229, v119
v_cvt_pk_bf16_f32 v119, v118, v119
v_mfma_f32_16x16x32_bf16 a[88:91], v[160:163], v[136:139], a[88:91]
buffer_load_dwordx4 v238, s[20:23], s59 offen offset:2048 lds
v_mfma_f32_16x16x32_bf16 a[84:87], v[160:163], v[132:135], a[84:87]
v_add_f32 v229, v229, v116
v_add_f32 v229, v229, v117
v_mfma_f32_16x16x32_bf16 a[84:87], v[164:167], v[148:151], a[84:87]
v_cvt_pk_bf16_f32 v118, v116, v117
v_add_f32 v229, v229, v100
v_mfma_f32_16x16x32_bf16 a[80:83], v[164:167], v[144:147], a[80:83]
v_add_f32 v229, v229, v101
v_cvt_pk_bf16_f32 v116, v100, v101
v_mfma_f32_16x16x32_bf16 a[80:83], v[160:163], v[128:131], a[80:83]
v_add_f32 v229, v229, v102
v_add_f32 v229, v229, v103
v_mfma_f32_16x16x32_bf16 v[128:131], a[192:195], v[0:3], 0
s_barrier
v_mfma_f32_16x16x32_bf16 v[128:131], a[196:199], v[16:19], v[128:131]
ds_read_b64_tr_b16 v[168:169], v247 offset:0
v_cvt_pk_bf16_f32 v117, v102, v103
v_mfma_f32_16x16x32_bf16 v[128:131], a[200:203], v[32:35], v[128:131]
ds_read_b64_tr_b16 v[170:171], v247 offset:1280
v_lshrrev_b32 v253, 6, v250
v_mfma_f32_16x16x32_bf16 v[128:131], a[204:207], v[48:51], v[128:131]
s_add_u32 s90, s65, 16384
ds_read_b64_tr_b16 v[172:173], v247 offset:5120
v_lshlrev_b32 v253, 7, v253
v_mfma_f32_16x16x32_bf16 v[128:131], a[208:211], v[64:67], v[128:131]
buffer_load_dwordx4 v[192:195], v250, s[4:7], s90 offen sc1
v_mfma_f32_16x16x32_bf16 v[128:131], a[212:215], v[80:83], v[128:131]
ds_read_b64_tr_b16 v[174:175], v247 offset:6400
v_mfma_f32_16x16x32_bf16 v[132:135], a[212:215], v[84:87], 0
v_exp_f32 v120, v120
v_mfma_f32_16x16x32_bf16 v[132:135], a[208:211], v[68:71], v[132:135]
s_add_u32 s90, s65, 20480
ds_read_b64_tr_b16 v[160:161], v247 offset:32
v_add_f32 v230, v230, v120
v_mfma_f32_16x16x32_bf16 v[132:135], a[204:207], v[52:55], v[132:135]
buffer_load_dwordx4 v[196:199], v250, s[4:7], s90 offen sc1
v_mfma_f32_16x16x32_bf16 v[132:135], a[200:203], v[36:39], v[132:135]
v_exp_f32 v121, v121
v_mfma_f32_16x16x32_bf16 v[132:135], a[196:199], v[20:23], v[132:135]
s_add_u32 s90, s66, 16384
ds_read_b64_tr_b16 v[162:163], v247 offset:1312
v_add_f32 v230, v230, v121
v_mfma_f32_16x16x32_bf16 v[132:135], a[192:195], v[4:7], v[132:135]
s_waitcnt vmcnt(11) lgkmcnt(4)
ds_read_b64_tr_b16 v[164:165], v247 offset:5152
v_cvt_pk_bf16_f32 v120, v120, v121
v_mfma_f32_16x16x32_bf16 a[236:239], v[168:171], v[176:179], 0
s_waitcnt vmcnt(10) lgkmcnt(3)
buffer_load_dwordx4 v[200:203], v250, s[4:7], s90 offen sc1
v_mfma_f32_16x16x32_bf16 a[236:239], v[172:175], v[180:183], a[236:239]
s_waitcnt vmcnt(9)
v_exp_f32 v122, v122
v_mfma_f32_16x16x32_bf16 v[216:219], v[172:175], v[188:191], 0
ds_read_b64_tr_b16 v[166:167], v247 offset:6432
v_add_f32 v230, v230, v122
v_mfma_f32_16x16x32_bf16 v[216:219], v[168:171], v[184:187], v[216:219]
s_add_u32 s90, s66, 20480
v_exp_f32 v123, v123
v_mfma_f32_16x16x32_bf16 v[136:139], a[192:195], v[8:11], 0
buffer_load_dwordx4 v[204:207], v250, s[4:7], s90 offen sc1
v_mfma_f32_16x16x32_bf16 v[136:139], a[196:199], v[24:27], v[136:139]
v_exp_f32 v104, v104
v_mfma_f32_16x16x32_bf16 v[136:139], a[200:203], v[40:43], v[136:139]
v_exp_f32 v105, v105
v_mfma_f32_16x16x32_bf16 v[136:139], a[204:207], v[56:59], v[136:139]
v_exp_f32 v106, v106
v_mfma_f32_16x16x32_bf16 v[136:139], a[208:211], v[72:75], v[136:139]
ds_read_b64_tr_b16 v[168:169], v247 offset:64
v_add_f32 v230, v230, v123
v_mfma_f32_16x16x32_bf16 v[136:139], a[212:215], v[88:91], v[136:139]
ds_read_b64_tr_b16 v[170:171], v247 offset:1344
v_cvt_pk_bf16_f32 v121, v122, v123
v_mfma_f32_16x16x32_bf16 v[140:143], a[212:215], v[92:95], 0
ds_read_b128 a[212:215], v249 offset:6400
v_add_f32 v230, v230, v106
v_mfma_f32_16x16x32_bf16 v[140:143], a[208:211], v[76:79], v[140:143]
ds_read_b64_tr_b16 v[172:173], v247 offset:5184
v_cvt_pk_bf16_f32 v122, v104, v105
v_mfma_f32_16x16x32_bf16 v[140:143], a[204:207], v[60:63], v[140:143]
s_add_u32 m0, s55, 143360
v_exp_f32 v107, v107
v_mfma_f32_16x16x32_bf16 v[140:143], a[200:203], v[44:47], v[140:143]
s_add_u32 s61, s61, 163840
ds_read_b64_tr_b16 v[174:175], v247 offset:6464
v_add_f32 v230, v230, v107
v_mfma_f32_16x16x32_bf16 v[140:143], a[196:199], v[28:31], v[140:143]
buffer_load_dwordx4 v242, s[32:35], s61 offen lds
v_mfma_f32_16x16x32_bf16 v[140:143], a[192:195], v[12:15], v[140:143]
s_waitcnt lgkmcnt(7)
ds_read_b128 a[192:195], v248 offset:12288
v_cvt_pk_bf16_f32 v123, v106, v107
v_mfma_f32_16x16x32_bf16 a[240:243], v[160:163], v[176:179], 0
s_waitcnt lgkmcnt(6)
ds_read_b128 a[196:199], v249 offset:12288
v_add_f32 v230, v230, v104
v_mfma_f32_16x16x32_bf16 a[240:243], v[164:167], v[180:183], a[240:243]
ds_read_b128 a[200:203], v248 offset:12416
v_add_f32 v230, v230, v105
v_mfma_f32_16x16x32_bf16 v[220:223], v[164:167], v[188:191], 0
buffer_load_dwordx4 v243, s[32:35], s61 offen offset:1024 lds
v_mfma_f32_16x16x32_bf16 v[220:223], v[160:163], v[184:187], v[220:223]
v_exp_f32 v124, v124
v_mfma_f32_16x16x32_bf16 v[96:99], a[216:219], v[0:3], 0
v_exp_f32 v125, v125
v_mfma_f32_16x16x32_bf16 v[96:99], a[220:223], v[16:19], v[96:99]
v_exp_f32 v126, v126
v_mfma_f32_16x16x32_bf16 v[96:99], a[224:227], v[32:35], v[96:99]
buffer_load_dwordx4 v244, s[32:35], s61 offen offset:2048 lds
v_mfma_f32_16x16x32_bf16 v[96:99], a[228:231], v[48:51], v[96:99]
v_exp_f32 v127, v127
v_mfma_f32_16x16x32_bf16 v[96:99], a[232:235], v[64:67], v[96:99]
s_waitcnt lgkmcnt(5)
v_exp_f32 v108, v108
v_mfma_f32_16x16x32_bf16 v[96:99], a[212:215], v[80:83], v[96:99]
v_exp_f32 v109, v109
v_mfma_f32_16x16x32_bf16 v[100:103], a[212:215], v[84:87], 0
v_exp_f32 v110, v110
v_mfma_f32_16x16x32_bf16 v[100:103], a[232:235], v[68:71], v[100:103]
v_exp_f32 v111, v111
v_mfma_f32_16x16x32_bf16 v[100:103], a[228:231], v[52:55], v[100:103]
ds_read_b64_tr_b16 v[160:161], v247 offset:96
v_add_f32 v231, v231, v126
v_mfma_f32_16x16x32_bf16 v[100:103], a[224:227], v[36:39], v[100:103]
ds_read_b64_tr_b16 v[162:163], v247 offset:1376
v_add_f32 v231, v231, v127
v_mfma_f32_16x16x32_bf16 v[100:103], a[220:223], v[20:23], v[100:103]
ds_read_b64_tr_b16 v[164:165], v247 offset:5216
v_cvt_pk_bf16_f32 v127, v126, v127
v_mfma_f32_16x16x32_bf16 v[100:103], a[216:219], v[4:7], v[100:103]
ds_read_b64_tr_b16 v[166:167], v247 offset:6496
v_add_f32 v231, v231, v124
v_mfma_f32_16x16x32_bf16 a[244:247], v[168:171], v[176:179], 0
s_waitcnt lgkmcnt(7)
ds_read_b128 a[204:207], v249 offset:12416
v_add_f32 v231, v231, v125
v_mfma_f32_16x16x32_bf16 a[244:247], v[172:175], v[180:183], a[244:247]
ds_read_b128 a[208:211], v248 offset:12544
v_cvt_pk_bf16_f32 v126, v124, v125
v_mfma_f32_16x16x32_bf16 v[208:211], v[172:175], v[188:191], 0
ds_read_b64_tr_b16 v[172:173], v234 offset:36992
v_add_f32 v231, v231, v108
v_mfma_f32_16x16x32_bf16 v[208:211], v[168:171], v[184:187], v[208:211]
ds_read_b64_tr_b16 v[168:169], v234 offset:24704
v_add_f32 v231, v231, v109
v_mfma_f32_16x16x32_bf16 v[104:107], a[216:219], v[8:11], 0
ds_read_b64_tr_b16 v[170:171], v234 offset:30848
v_cvt_pk_bf16_f32 v124, v108, v109
v_mfma_f32_16x16x32_bf16 v[104:107], a[220:223], v[24:27], v[104:107]
ds_read_b64_tr_b16 v[174:175], v234 offset:43136
v_add_f32 v231, v231, v110
v_mfma_f32_16x16x32_bf16 v[104:107], a[224:227], v[40:43], v[104:107]
v_add_f32 v231, v231, v111
v_cvt_pk_bf16_f32 v125, v110, v111
v_mfma_f32_16x16x32_bf16 v[104:107], a[228:231], v[56:59], v[104:107]
buffer_load_dwordx4 v245, s[32:35], s61 offen offset:3072 lds
v_mfma_f32_16x16x32_bf16 v[104:107], a[232:235], v[72:75], v[104:107]
v_exp_f32 v128, v128
v_mfma_f32_16x16x32_bf16 v[104:107], a[212:215], v[88:91], v[104:107]
v_exp_f32 v129, v129
v_mfma_f32_16x16x32_bf16 v[108:111], a[212:215], v[92:95], 0
s_add_u32 m0, s55, 147456
ds_read_b128 a[212:215], v249 offset:12544
v_add_f32 v228, v228, v128
v_mfma_f32_16x16x32_bf16 v[108:111], a[232:235], v[76:79], v[108:111]
buffer_load_dwordx4 v246, s[32:35], s61 offen lds
v_mfma_f32_16x16x32_bf16 v[108:111], a[228:231], v[60:63], v[108:111]
ds_read_b128 a[228:231], v249 offset:18560
v_add_f32 v228, v228, v129
v_mfma_f32_16x16x32_bf16 v[108:111], a[224:227], v[44:47], v[108:111]
s_add_u32 m0, s53, 12288
ds_read_b128 a[224:227], v248 offset:18560
v_cvt_pk_bf16_f32 v128, v128, v129
v_mfma_f32_16x16x32_bf16 v[108:111], a[220:223], v[28:31], v[108:111]
s_add_u32 s60, s60, 12288
v_exp_f32 v130, v130
v_mfma_f32_16x16x32_bf16 v[108:111], a[216:219], v[12:15], v[108:111]
s_waitcnt lgkmcnt(11)
buffer_load_dwordx4 v239, s[24:27], s60 offen lds
v_mfma_f32_16x16x32_bf16 a[248:251], v[160:163], v[176:179], 0
s_waitcnt lgkmcnt(9)
ds_read_b128 a[216:219], v248 offset:18432
v_add_f32 v228, v228, v130
v_mfma_f32_16x16x32_bf16 a[248:251], v[164:167], v[180:183], a[248:251]
v_exp_f32 v131, v131
v_mfma_f32_16x16x32_bf16 v[212:215], v[164:167], v[188:191], 0
ds_read_b64_tr_b16 v[164:165], v235 offset:36992
v_add_f32 v228, v228, v131
v_mfma_f32_16x16x32_bf16 v[212:215], v[160:163], v[184:187], v[212:215]
s_waitcnt lgkmcnt(6)
ds_read_b64_tr_b16 v[160:161], v235 offset:24704
v_cvt_pk_bf16_f32 v129, v130, v131
v_mfma_f32_16x16x32_bf16 a[96:99], v[168:171], v[144:147], a[96:99]
s_waitcnt lgkmcnt(6)
ds_read_b64_tr_b16 v[162:163], v235 offset:30848
v_mfma_f32_16x16x32_bf16 a[96:99], v[172:175], v[112:115], a[96:99]
ds_read_b64_tr_b16 v[166:167], v235 offset:43136
v_mfma_f32_16x16x32_bf16 a[100:103], v[172:175], v[116:119], a[100:103]
buffer_load_dwordx4 v240, s[24:27], s60 offen offset:1024 lds
v_mfma_f32_16x16x32_bf16 a[100:103], v[168:171], v[148:151], a[100:103]
v_exp_f32 v96, v96
v_mfma_f32_16x16x32_bf16 a[104:107], v[168:171], v[152:155], a[104:107]
v_exp_f32 v97, v97
v_mfma_f32_16x16x32_bf16 a[104:107], v[172:175], v[120:123], a[104:107]
ds_read_b128 a[220:223], v249 offset:18432
v_cvt_pk_bf16_f32 v130, v96, v97
v_mfma_f32_16x16x32_bf16 a[108:111], v[172:175], v[124:127], a[108:111]
buffer_load_dwordx4 v241, s[24:27], s60 offen offset:2048 lds
v_mfma_f32_16x16x32_bf16 a[108:111], v[168:171], v[156:159], a[108:111]
s_waitcnt lgkmcnt(2)
v_exp_f32 v98, v98
v_mfma_f32_16x16x32_bf16 a[124:127], v[160:163], v[156:159], a[124:127]
s_waitcnt lgkmcnt(1)
ds_read_b64_tr_b16 v[168:169], v232 offset:24832
v_add_f32 v228, v228, v98
v_mfma_f32_16x16x32_bf16 a[124:127], v[164:167], v[124:127], a[124:127]
s_and_b32 s3, s1, 1073807359
ds_read_b64_tr_b16 v[170:171], v232 offset:30976
v_mfma_f32_16x16x32_bf16 a[120:123], v[164:167], v[120:123], a[120:123]
s_add_u32 s3, s3, 131072
ds_read_b64_tr_b16 v[172:173], v232 offset:37120
ds_read_b64_tr_b16 v[174:175], v232 offset:43264
v_mfma_f32_16x16x32_bf16 a[120:123], v[160:163], v[152:155], a[120:123]
buffer_load_dword v254, v253, s[24:27], s3 offen
v_mfma_f32_16x16x32_bf16 a[116:119], v[160:163], v[148:151], a[116:119]
v_exp_f32 v99, v99
v_mfma_f32_16x16x32_bf16 a[116:119], v[164:167], v[116:119], a[116:119]
ds_read_b128 a[232:235], v248 offset:18688
v_add_f32 v228, v228, v99
v_mfma_f32_16x16x32_bf16 a[112:115], v[164:167], v[112:115], a[112:115]
ds_read_b64_tr_b16 v[164:165], v247 offset:5248
v_cvt_pk_bf16_f32 v131, v98, v99
v_mfma_f32_16x16x32_bf16 a[112:115], v[160:163], v[144:147], a[112:115]
s_waitcnt lgkmcnt(4)
ds_read_b64_tr_b16 v[160:161], v247 offset:128
v_add_f32 v228, v228, v96
v_mfma_f32_16x16x32_bf16 a[128:131], v[168:171], v[144:147], a[128:131]
s_waitcnt lgkmcnt(3)
ds_read_b64_tr_b16 v[162:163], v247 offset:1408
v_add_f32 v228, v228, v97
v_mfma_f32_16x16x32_bf16 a[128:131], v[172:175], v[112:115], a[128:131]
L_walk1_8:
s_cbranch_execz L_ret1
ds_read_b64_tr_b16 v[166:167], v247 offset:6528
v_mfma_f32_16x16x32_bf16 a[132:135], v[172:175], v[116:119], a[132:135]
v_exp_f32 v132, v132
v_mfma_f32_16x16x32_bf16 a[132:135], v[168:171], v[148:151], a[132:135]
v_exp_f32 v133, v133
v_mfma_f32_16x16x32_bf16 a[136:139], v[168:171], v[152:155], a[136:139]
v_exp_f32 v134, v134
v_mfma_f32_16x16x32_bf16 a[136:139], v[172:175], v[120:123], a[136:139]
v_exp_f32 v135, v135
v_mfma_f32_16x16x32_bf16 a[140:143], v[172:175], v[124:127], a[140:143]
ds_read_b64_tr_b16 v[172:173], v233 offset:37120
ds_read_b64_tr_b16 v[174:175], v233 offset:43264
v_mfma_f32_16x16x32_bf16 a[140:143], v[168:171], v[156:159], a[140:143]
s_waitcnt lgkmcnt(3)
ds_read_b64_tr_b16 v[168:169], v233 offset:24832
ds_read_b64_tr_b16 v[170:171], v233 offset:30976
v_mfma_f32_16x16x32_bf16 a[252:255], v[160:163], v[176:179], 0
s_waitcnt lgkmcnt(4)
v_exp_f32 v100, v100
v_mfma_f32_16x16x32_bf16 a[252:255], v[164:167], v[180:183], a[252:255]
v_exp_f32 v101, v101
v_mfma_f32_16x16x32_bf16 v[224:227], v[164:167], v[188:191], 0
ds_read_b64_tr_b16 v[164:165], v234 offset:37120
v_add_f32 v229, v229, v132
v_mfma_f32_16x16x32_bf16 v[224:227], v[160:163], v[184:187], v[224:227]
s_waitcnt lgkmcnt(1)
ds_read_b64_tr_b16 v[160:161], v234 offset:24832
v_add_f32 v229, v229, v133
v_mfma_f32_16x16x32_bf16 a[156:159], v[168:171], v[156:159], a[156:159]
ds_read_b64_tr_b16 v[162:163], v234 offset:30976
v_cvt_pk_bf16_f32 v132, v132, v133
v_mfma_f32_16x16x32_bf16 a[156:159], v[172:175], v[124:127], a[156:159]
ds_read_b64_tr_b16 v[166:167], v234 offset:43264
v_add_f32 v229, v229, v134
v_mfma_f32_16x16x32_bf16 a[152:155], v[172:175], v[120:123], a[152:155]
v_exp_f32 v102, v102
v_mfma_f32_16x16x32_bf16 a[152:155], v[168:171], v[152:155], a[152:155]
v_exp_f32 v103, v103
v_mfma_f32_16x16x32_bf16 a[148:151], v[168:171], v[148:151], a[148:151]
v_and_b32 v253, 512, v250
v_mul_u32_u24 v253, 7680, v253
v_mfma_f32_16x16x32_bf16 a[148:151], v[172:175], v[116:119], a[148:151]
v_add_f32 v229, v229, v135
v_lshl_add_u32 v253, v250, 9, v253
v_mfma_f32_16x16x32_bf16 a[144:147], v[172:175], v[112:115], a[144:147]
ds_read_b64_tr_b16 v[172:173], v235 offset:37120
v_cvt_pk_bf16_f32 v133, v134, v135
v_mfma_f32_16x16x32_bf16 a[144:147], v[168:171], v[144:147], a[144:147]
s_waitcnt lgkmcnt(2)
ds_read_b64_tr_b16 v[168:169], v235 offset:24832
v_add_f32 v229, v229, v102
v_mfma_f32_16x16x32_bf16 a[160:163], v[160:163], v[144:147], a[160:163]
s_waitcnt lgkmcnt(2)
ds_read_b64_tr_b16 v[170:171], v235 offset:30976
v_add_f32 v229, v229, v103
v_mfma_f32_16x16x32_bf16 a[160:163], v[164:167], v[112:115], a[160:163]
ds_read_b64_tr_b16 v[174:175], v235 offset:43264
v_cvt_pk_bf16_f32 v135, v102, v103
v_mfma_f32_16x16x32_bf16 a[164:167], v[164:167], v[116:119], a[164:167]
v_add_f32 v229, v229, v100
v_add_f32 v229, v229, v101
v_mfma_f32_16x16x32_bf16 a[164:167], v[160:163], v[148:151], a[164:167]
v_exp_f32 v136, v136
v_mfma_f32_16x16x32_bf16 a[168:171], v[160:163], v[152:155], a[168:171]
v_add_f32 v230, v230, v136
v_cvt_pk_bf16_f32 v134, v100, v101
v_mfma_f32_16x16x32_bf16 a[168:171], v[164:167], v[120:123], a[168:171]
v_exp_f32 v137, v137
v_mfma_f32_16x16x32_bf16 a[172:175], v[164:167], v[124:127], a[172:175]
v_exp_f32 v138, v138
v_mfma_f32_16x16x32_bf16 a[172:175], v[160:163], v[156:159], a[172:175]
s_waitcnt lgkmcnt(1)
v_exp_f32 v139, v139
v_mfma_f32_16x16x32_bf16 a[188:191], v[168:171], v[156:159], a[188:191]
s_waitcnt lgkmcnt(0)
v_exp_f32 v104, v104
v_mfma_f32_16x16x32_bf16 a[188:191], v[172:175], v[124:127], a[188:191]
v_exp_f32 v105, v105
v_mfma_f32_16x16x32_bf16 a[184:187], v[172:175], v[120:123], a[184:187]
v_exp_f32 v106, v106
v_mfma_f32_16x16x32_bf16 a[184:187], v[168:171], v[152:155], a[184:187]
v_exp_f32 v107, v107
v_mfma_f32_16x16x32_bf16 a[180:183], v[168:171], v[148:151], a[180:183]
v_add_f32 v230, v230, v137
v_cvt_pk_bf16_f32 v136, v136, v137
v_mfma_f32_16x16x32_bf16 a[180:183], v[172:175], v[116:119], a[180:183]
v_add_f32 v230, v230, v138
v_add_f32 v230, v230, v139
v_mfma_f32_16x16x32_bf16 a[176:179], v[172:175], v[112:115], a[176:179]
v_cvt_pk_bf16_f32 v137, v138, v139
v_add_f32 v230, v230, v106
v_mfma_f32_16x16x32_bf16 a[176:179], v[168:171], v[144:147], a[176:179]
v_add_f32 v230, v230, v107
v_cvt_pk_bf16_f32 v139, v106, v107
v_mfma_f32_16x16x32_bf16 v[144:147], a[192:195], v[0:3], 0
s_waitcnt vmcnt(16)
s_barrier
v_mfma_f32_16x16x32_bf16 v[144:147], a[196:199], v[16:19], v[144:147]
ds_read_b64_tr_b16 v[160:161], v247 offset:20480
v_add_f32 v230, v230, v104
v_mfma_f32_16x16x32_bf16 v[144:147], a[200:203], v[32:35], v[144:147]
ds_read_b64_tr_b16 v[162:163], v247 offset:21760
v_add_f32 v230, v230, v105
v_mfma_f32_16x16x32_bf16 v[144:147], a[204:207], v[48:51], v[144:147]
s_add_u32 s90, s65, 32768
ds_read_b64_tr_b16 v[164:165], v247 offset:25600
v_cvt_pk_bf16_f32 v138, v104, v105
v_mfma_f32_16x16x32_bf16 v[144:147], a[208:211], v[64:67], v[144:147]
buffer_load_dwordx4 v[176:179], v250, s[4:7], s90 offen sc1
v_mfma_f32_16x16x32_bf16 v[144:147], a[212:215], v[80:83], v[144:147]
ds_read_b64_tr_b16 v[166:167], v247 offset:26880
v_mfma_f32_16x16x32_bf16 v[148:151], a[212:215], v[84:87], 0
v_exp_f32 v140, v140
v_mfma_f32_16x16x32_bf16 v[148:151], a[208:211], v[68:71], v[148:151]
s_add_u32 s90, s65, 36864
ds_read_b64_tr_b16 v[168:169], v247 offset:20512
v_add_f32 v231, v231, v140
v_mfma_f32_16x16x32_bf16 v[148:151], a[204:207], v[52:55], v[148:151]
buffer_load_dwordx4 v[180:183], v250, s[4:7], s90 offen sc1
v_mfma_f32_16x16x32_bf16 v[148:151], a[200:203], v[36:39], v[148:151]
v_exp_f32 v141, v141
v_mfma_f32_16x16x32_bf16 v[148:151], a[196:199], v[20:23], v[148:151]
s_add_u32 s90, s66, 32768
ds_read_b64_tr_b16 v[170:171], v247 offset:21792
v_add_f32 v231, v231, v141
v_mfma_f32_16x16x32_bf16 v[148:151], a[192:195], v[4:7], v[148:151]
s_waitcnt vmcnt(14) lgkmcnt(4)
ds_read_b64_tr_b16 v[172:173], v247 offset:25632
v_cvt_pk_bf16_f32 v140, v140, v141
v_mfma_f32_16x16x32_bf16 a[236:239], v[160:163], v[192:195], a[236:239]
s_waitcnt vmcnt(13) lgkmcnt(3)
buffer_load_dwordx4 v[184:187], v250, s[4:7], s90 offen sc1
v_mfma_f32_16x16x32_bf16 a[236:239], v[164:167], v[196:199], a[236:239]
s_waitcnt vmcnt(12)
v_exp_f32 v142, v142
v_mfma_f32_16x16x32_bf16 v[216:219], v[164:167], v[204:207], v[216:219]
ds_read_b64_tr_b16 v[174:175], v247 offset:26912
v_add_f32 v231, v231, v142
v_mfma_f32_16x16x32_bf16 v[216:219], v[160:163], v[200:203], v[216:219]
s_add_u32 s90, s66, 36864
v_exp_f32 v143, v143
v_mfma_f32_16x16x32_bf16 v[152:155], a[192:195], v[8:11], 0
buffer_load_dwordx4 v[188:191], v250, s[4:7], s90 offen sc1
v_mfma_f32_16x16x32_bf16 v[152:155], a[196:199], v[24:27], v[152:155]
v_exp_f32 v108, v108
v_mfma_f32_16x16x32_bf16 v[152:155], a[200:203], v[40:43], v[152:155]
v_exp_f32 v109, v109
v_mfma_f32_16x16x32_bf16 v[152:155], a[204:207], v[56:59], v[152:155]
v_exp_f32 v110, v110
v_mfma_f32_16x16x32_bf16 v[152:155], a[208:211], v[72:75], v[152:155]
ds_read_b64_tr_b16 v[160:161], v247 offset:20544
v_add_f32 v231, v231, v143
v_mfma_f32_16x16x32_bf16 v[152:155], a[212:215], v[88:91], v[152:155]
ds_read_b64_tr_b16 v[162:163], v247 offset:21824
v_cvt_pk_bf16_f32 v141, v142, v143
v_mfma_f32_16x16x32_bf16 v[156:159], a[212:215], v[92:95], 0
ds_read_b128 a[212:215], v249 offset:18688
v_add_f32 v231, v231, v110
v_mfma_f32_16x16x32_bf16 v[156:159], a[208:211], v[76:79], v[156:159]
ds_read_b64_tr_b16 v[164:165], v247 offset:25664
v_cvt_pk_bf16_f32 v142, v108, v109
v_mfma_f32_16x16x32_bf16 v[156:159], a[204:207], v[60:63], v[156:159]
v_exp_f32 v111, v111
v_mfma_f32_16x16x32_bf16 v[156:159], a[200:203], v[44:47], v[156:159]
ds_read_b64_tr_b16 v[166:167], v247 offset:26944
v_add_f32 v231, v231, v111
v_mfma_f32_16x16x32_bf16 v[156:159], a[196:199], v[28:31], v[156:159]
buffer_load_dword v254, v253, s[4:7], s64 offen offset:12 sc1
v_mfma_f32_16x16x32_bf16 v[156:159], a[192:195], v[12:15], v[156:159]
s_waitcnt lgkmcnt(7)
ds_read_b128 a[192:195], v248 offset:24576
v_cvt_pk_bf16_f32 v143, v110, v111
v_mfma_f32_16x16x32_bf16 a[240:243], v[168:171], v[192:195], a[240:243]
s_waitcnt lgkmcnt(6)
ds_read_b128 a[196:199], v249 offset:24576
v_add_f32 v231, v231, v108
v_mfma_f32_16x16x32_bf16 a[240:243], v[172:175], v[196:199], a[240:243]
ds_read_b128 a[200:203], v248 offset:24704
v_add_f32 v231, v231, v109
v_mfma_f32_16x16x32_bf16 v[220:223], v[172:175], v[204:207], v[220:223]
s_add_u32 m0, s55, 102400
v_exp_f32 v144, v144
v_mfma_f32_16x16x32_bf16 v[220:223], v[168:171], v[200:203], v[220:223]
s_add_u32 s61, s61, s44
ds_read_b128 a[204:207], v249 offset:24704
v_add_f32 v228, v228, v144
v_mfma_f32_16x16x32_bf16 v[96:99], a[216:219], v[0:3], 0
buffer_load_dwordx4 v242, s[32:35], s61 offen lds
v_mfma_f32_16x16x32_bf16 v[96:99], a[220:223], v[16:19], v[96:99]
v_exp_f32 v145, v145
v_mfma_f32_16x16x32_bf16 v[96:99], a[224:227], v[32:35], v[96:99]
ds_read_b128 a[208:211], v248 offset:24832
v_add_f32 v228, v228, v145
v_mfma_f32_16x16x32_bf16 v[96:99], a[228:231], v[48:51], v[96:99]
v_exp_f32 v146, v146
v_mfma_f32_16x16x32_bf16 v[96:99], a[232:235], v[64:67], v[96:99]
s_waitcnt lgkmcnt(7)
buffer_load_dwordx4 v243, s[32:35], s61 offen offset:1024 lds
v_mfma_f32_16x16x32_bf16 v[96:99], a[212:215], v[80:83], v[96:99]
ds_read_b64_tr_b16 v[168:169], v247 offset:20576
v_cvt_pk_bf16_f32 v144, v144, v145
v_mfma_f32_16x16x32_bf16 v[100:103], a[212:215], v[84:87], 0
ds_read_b64_tr_b16 v[170:171], v247 offset:21856
v_add_f32 v228, v228, v146
v_mfma_f32_16x16x32_bf16 v[100:103], a[232:235], v[68:71], v[100:103]
v_exp_f32 v147, v147
v_mfma_f32_16x16x32_bf16 v[100:103], a[228:231], v[52:55], v[100:103]
buffer_load_dwordx4 v244, s[32:35], s61 offen offset:2048 lds
v_mfma_f32_16x16x32_bf16 v[100:103], a[224:227], v[36:39], v[100:103]
ds_read_b64_tr_b16 v[172:173], v247 offset:25696
v_add_f32 v228, v228, v147
v_mfma_f32_16x16x32_bf16 v[100:103], a[220:223], v[20:23], v[100:103]
ds_read_b64_tr_b16 v[174:175], v247 offset:26976
v_cvt_pk_bf16_f32 v145, v146, v147
v_mfma_f32_16x16x32_bf16 v[100:103], a[216:219], v[4:7], v[100:103]
v_exp_f32 v96, v96
v_mfma_f32_16x16x32_bf16 a[244:247], v[160:163], v[192:195], a[244:247]
s_waitcnt lgkmcnt(9)
buffer_load_dwordx4 v245, s[32:35], s61 offen offset:3072 lds
v_mfma_f32_16x16x32_bf16 a[244:247], v[164:167], v[196:199], a[244:247]
v_exp_f32 v97, v97
v_mfma_f32_16x16x32_bf16 v[208:211], v[164:167], v[204:207], v[208:211]
ds_read_b64_tr_b16 v[164:165], v232 offset:0
v_cvt_pk_bf16_f32 v146, v96, v97
v_mfma_f32_16x16x32_bf16 v[208:211], v[160:163], v[200:203], v[208:211]
v_exp_f32 v98, v98
v_mfma_f32_16x16x32_bf16 v[104:107], a[216:219], v[8:11], 0
s_add_u32 m0, s55, 106496
ds_read_b64_tr_b16 v[160:161], v232 offset:36864
v_add_f32 v228, v228, v98
v_mfma_f32_16x16x32_bf16 v[104:107], a[220:223], v[24:27], v[104:107]
buffer_load_dwordx4 v246, s[32:35], s61 offen lds
v_mfma_f32_16x16x32_bf16 v[104:107], a[224:227], v[40:43], v[104:107]
v_exp_f32 v99, v99
v_mfma_f32_16x16x32_bf16 v[104:107], a[228:231], v[56:59], v[104:107]
ds_read_b64_tr_b16 v[162:163], v232 offset:43008
v_add_f32 v228, v228, v99
v_mfma_f32_16x16x32_bf16 v[104:107], a[232:235], v[72:75], v[104:107]
ds_read_b64_tr_b16 v[166:167], v232 offset:6144
v_cvt_pk_bf16_f32 v147, v98, v99
v_mfma_f32_16x16x32_bf16 v[104:107], a[212:215], v[88:91], v[104:107]
v_add_f32 v228, v228, v96
v_add_f32 v228, v228, v97
v_mfma_f32_16x16x32_bf16 v[108:111], a[212:215], v[92:95], 0
v_exp_f32 v148, v148
v_mfma_f32_16x16x32_bf16 v[108:111], a[232:235], v[76:79], v[108:111]
ds_read_b128 a[212:215], v249 offset:24832
v_add_f32 v229, v229, v148
v_mfma_f32_16x16x32_bf16 v[108:111], a[228:231], v[60:63], v[108:111]
v_exp_f32 v149, v149
v_mfma_f32_16x16x32_bf16 v[108:111], a[224:227], v[44:47], v[108:111]
ds_read_b128 a[224:227], v248 offset:30848
v_add_f32 v229, v229, v149
v_mfma_f32_16x16x32_bf16 v[108:111], a[220:223], v[28:31], v[108:111]
ds_read_b128 a[220:223], v249 offset:30720
v_cvt_pk_bf16_f32 v148, v148, v149
v_mfma_f32_16x16x32_bf16 v[108:111], a[216:219], v[12:15], v[108:111]
s_waitcnt lgkmcnt(9)
v_exp_f32 v150, v150
v_mfma_f32_16x16x32_bf16 a[248:251], v[168:171], v[192:195], a[248:251]
s_waitcnt lgkmcnt(7)
ds_read_b128 a[216:219], v248 offset:30720
v_add_f32 v229, v229, v150
v_mfma_f32_16x16x32_bf16 a[248:251], v[172:175], v[196:199], a[248:251]
v_exp_f32 v151, v151
v_mfma_f32_16x16x32_bf16 v[212:215], v[172:175], v[204:207], v[212:215]
s_add_u32 m0, s53, 24576
ds_read_b64_tr_b16 v[172:173], v233 offset:0
v_add_f32 v229, v229, v151
v_mfma_f32_16x16x32_bf16 v[212:215], v[168:171], v[200:203], v[212:215]
s_waitcnt lgkmcnt(6)
ds_read_b64_tr_b16 v[168:169], v233 offset:36864
v_cvt_pk_bf16_f32 v149, v150, v151
v_mfma_f32_16x16x32_bf16 a[0:3], v[160:163], v[112:115], a[0:3]
s_waitcnt lgkmcnt(6)
ds_read_b64_tr_b16 v[170:171], v233 offset:43008
v_mfma_f32_16x16x32_bf16 a[0:3], v[164:167], v[128:131], a[0:3]
s_add_u32 s60, s60, 12288
ds_read_b64_tr_b16 v[174:175], v233 offset:6144
v_mfma_f32_16x16x32_bf16 a[4:7], v[164:167], v[132:135], a[4:7]
buffer_load_dwordx4 v239, s[24:27], s60 offen lds
v_mfma_f32_16x16x32_bf16 a[4:7], v[160:163], v[116:119], a[4:7]
v_exp_f32 v100, v100
v_mfma_f32_16x16x32_bf16 a[8:11], v[160:163], v[120:123], a[8:11]
v_exp_f32 v101, v101
v_mfma_f32_16x16x32_bf16 a[8:11], v[164:167], v[136:139], a[8:11]
ds_read_b128 a[228:231], v249 offset:30848
v_cvt_pk_bf16_f32 v150, v100, v101
v_mfma_f32_16x16x32_bf16 a[12:15], v[164:167], v[140:143], a[12:15]
buffer_load_dwordx4 v240, s[24:27], s60 offen offset:1024 lds
v_mfma_f32_16x16x32_bf16 a[12:15], v[160:163], v[124:127], a[12:15]
s_waitcnt lgkmcnt(2)
v_exp_f32 v102, v102
v_mfma_f32_16x16x32_bf16 a[28:31], v[168:171], v[124:127], a[28:31]
s_waitcnt lgkmcnt(1)
ds_read_b64_tr_b16 v[160:161], v234 offset:36864
v_add_f32 v229, v229, v102
v_mfma_f32_16x16x32_bf16 a[28:31], v[172:175], v[140:143], a[28:31]
ds_read_b64_tr_b16 v[162:163], v234 offset:43008
v_mfma_f32_16x16x32_bf16 a[24:27], v[172:175], v[136:139], a[24:27]
ds_read_b64_tr_b16 v[164:165], v234 offset:0
ds_read_b64_tr_b16 v[166:167], v234 offset:6144
v_mfma_f32_16x16x32_bf16 a[24:27], v[168:171], v[120:123], a[24:27]
buffer_load_dwordx4 v241, s[24:27], s60 offen offset:2048 lds
v_mfma_f32_16x16x32_bf16 a[20:23], v[168:171], v[116:119], a[20:23]
v_exp_f32 v103, v103
v_mfma_f32_16x16x32_bf16 a[20:23], v[172:175], v[132:135], a[20:23]
ds_read_b128 a[232:235], v248 offset:30976
v_add_f32 v229, v229, v103
v_mfma_f32_16x16x32_bf16 a[16:19], v[172:175], v[128:131], a[16:19]
s_add_u32 m0, s53, 49152
ds_read_b64_tr_b16 v[172:173], v247 offset:25728
v_cvt_pk_bf16_f32 v151, v102, v103
v_mfma_f32_16x16x32_bf16 a[16:19], v[168:171], v[112:115], a[16:19]
s_waitcnt lgkmcnt(4)
ds_read_b64_tr_b16 v[168:169], v247 offset:20608
v_add_f32 v229, v229, v100
v_mfma_f32_16x16x32_bf16 a[32:35], v[160:163], v[112:115], a[32:35]
s_waitcnt lgkmcnt(3)
ds_read_b64_tr_b16 v[170:171], v247 offset:21888
v_add_f32 v229, v229, v101
v_mfma_f32_16x16x32_bf16 a[32:35], v[164:167], v[128:131], a[32:35]
s_add_u32 s59, s59, 12288
ds_read_b64_tr_b16 v[174:175], v247 offset:27008
v_mfma_f32_16x16x32_bf16 a[36:39], v[164:167], v[132:135], a[36:39]
buffer_load_dwordx4 v236, s[20:23], s59 offen lds
v_mfma_f32_16x16x32_bf16 a[36:39], v[160:163], v[116:119], a[36:39]
v_exp_f32 v152, v152
v_mfma_f32_16x16x32_bf16 a[40:43], v[160:163], v[120:123], a[40:43]
v_exp_f32 v153, v153
v_mfma_f32_16x16x32_bf16 a[40:43], v[164:167], v[136:139], a[40:43]
v_exp_f32 v154, v154
v_mfma_f32_16x16x32_bf16 a[44:47], v[164:167], v[140:143], a[44:47]
ds_read_b64_tr_b16 v[164:165], v235 offset:0
ds_read_b64_tr_b16 v[166:167], v235 offset:6144
v_mfma_f32_16x16x32_bf16 a[44:47], v[160:163], v[124:127], a[44:47]
s_waitcnt lgkmcnt(3)
ds_read_b64_tr_b16 v[160:161], v235 offset:36864
ds_read_b64_tr_b16 v[162:163], v235 offset:43008
v_mfma_f32_16x16x32_bf16 a[252:255], v[168:171], v[192:195], a[252:255]
s_waitcnt lgkmcnt(4)
buffer_load_dwordx4 v237, s[20:23], s59 offen offset:1024 lds
v_mfma_f32_16x16x32_bf16 a[252:255], v[172:175], v[196:199], a[252:255]
s_waitcnt vmcnt(10)
v_sub_u32 v254, v251, v254
v_cmp_lt_u32 vcc, 1, v254
v_mfma_f32_16x16x32_bf16 v[224:227], v[172:175], v[204:207], v[224:227]
ds_read_b64_tr_b16 v[172:173], v232 offset:128
v_add_f32 v230, v230, v152
v_mfma_f32_16x16x32_bf16 v[224:227], v[168:171], v[200:203], v[224:227]
s_waitcnt lgkmcnt(1)
ds_read_b64_tr_b16 v[168:169], v232 offset:36992
v_add_f32 v230, v230, v153
v_mfma_f32_16x16x32_bf16 a[60:63], v[160:163], v[124:127], a[60:63]
ds_read_b64_tr_b16 v[170:171], v232 offset:43136
v_cvt_pk_bf16_f32 v152, v152, v153
v_mfma_f32_16x16x32_bf16 a[60:63], v[164:167], v[140:143], a[60:63]
ds_read_b64_tr_b16 v[174:175], v232 offset:6272
v_add_f32 v230, v230, v154
v_mfma_f32_16x16x32_bf16 a[56:59], v[164:167], v[136:139], a[56:59]
buffer_load_dwordx4 v238, s[20:23], s59 offen offset:2048 lds
v_mfma_f32_16x16x32_bf16 a[56:59], v[160:163], v[120:123], a[56:59]
v_exp_f32 v155, v155
v_mfma_f32_16x16x32_bf16 a[52:55], v[160:163], v[116:119], a[52:55]
s_cbranch_vccnz L_spin_0
L_back_0:
v_add_f32 v230, v230, v155
v_mfma_f32_16x16x32_bf16 a[52:55], v[164:167], v[132:135], a[52:55]
v_cmp_eq_u32 vcc, 1, v254
v_lshrrev_b32 v253, 6, v250
v_mfma_f32_16x16x32_bf16 a[48:51], v[164:167], v[128:131], a[48:51]
s_and_b32 s3, s0, 1074003967
ds_read_b64_tr_b16 v[164:165], v233 offset:128
v_lshlrev_b32 v253, 7, v253
v_mfma_f32_16x16x32_bf16 a[48:51], v[160:163], v[112:115], a[48:51]
s_waitcnt lgkmcnt(2)
ds_read_b64_tr_b16 v[160:161], v233 offset:36992
v_cvt_pk_bf16_f32 v153, v154, v155
v_mfma_f32_16x16x32_bf16 a[64:67], v[168:171], v[112:115], a[64:67]
s_waitcnt lgkmcnt(2)
s_lshr_b64 s[94:95], vcc, s94
ds_read_b64_tr_b16 v[162:163], v233 offset:43136
v_mfma_f32_16x16x32_bf16 a[64:67], v[172:175], v[128:131], a[64:67]
s_add_u32 s3, s3, s91
s_bcnt1_i32_b32 s94, s94
ds_read_b64_tr_b16 v[166:167], v233 offset:6272
v_mfma_f32_16x16x32_bf16 a[68:71], v[172:175], v[132:135], a[68:71]
buffer_load_dword v254, v253, s[28:31], s3 offen
v_mfma_f32_16x16x32_bf16 a[68:71], v[168:171], v[116:119], a[68:71]
v_exp_f32 v104, v104
v_mfma_f32_16x16x32_bf16 a[72:75], v[168:171], v[120:123], a[72:75]
v_exp_f32 v105, v105
v_mfma_f32_16x16x32_bf16 a[72:75], v[172:175], v[136:139], a[72:75]
v_exp_f32 v106, v106
v_mfma_f32_16x16x32_bf16 a[76:79], v[172:175], v[140:143], a[76:79]
v_exp_f32 v107, v107
v_mfma_f32_16x16x32_bf16 a[76:79], v[168:171], v[124:127], a[76:79]
s_waitcnt lgkmcnt(1)
v_add_f32 v230, v230, v106
v_add_f32 v230, v230, v107
v_mfma_f32_16x16x32_bf16 a[92:95], v[160:163], v[124:127], a[92:95]
s_waitcnt lgkmcnt(0)
v_cvt_pk_bf16_f32 v155, v106, v107
v_add_f32 v230, v230, v104
v_mfma_f32_16x16x32_bf16 a[92:95], v[164:167], v[140:143], a[92:95]
v_add_f32 v230, v230, v105
v_cvt_pk_bf16_f32 v154, v104, v105
v_mfma_f32_16x16x32_bf16 a[88:91], v[164:167], v[136:139], a[88:91]
v_exp_f32 v156, v156
v_mfma_f32_16x16x32_bf16 a[88:91], v[160:163], v[120:123], a[88:91]
v_exp_f32 v157, v157
v_mfma_f32_16x16x32_bf16 a[84:87], v[160:163], v[116:119], a[84:87]
v_exp_f32 v158, v158
v_mfma_f32_16x16x32_bf16 a[84:87], v[164:167], v[132:135], a[84:87]
v_exp_f32 v159, v159
v_mfma_f32_16x16x32_bf16 a[80:83], v[164:167], v[128:131], a[80:83]
v_exp_f32 v108, v108
v_mfma_f32_16x16x32_bf16 a[80:83], v[160:163], v[112:115], a[80:83]
v_exp_f32 v109, v109
v_mfma_f32_16x16x32_bf16 v[112:115], a[192:195], v[0:3], 0
s_barrier
v_mfma_f32_16x16x32_bf16 v[112:115], a[196:199], v[16:19], v[112:115]
ds_read_b64_tr_b16 v[168:169], v247 offset:40960
v_add_f32 v231, v231, v156
v_mfma_f32_16x16x32_bf16 v[112:115], a[200:203], v[32:35], v[112:115]
ds_read_b64_tr_b16 v[170:171], v247 offset:42240
v_add_f32 v231, v231, v157
v_mfma_f32_16x16x32_bf16 v[112:115], a[204:207], v[48:51], v[112:115]
s_add_u32 s65, s65, s80
ds_read_b64_tr_b16 v[172:173], v247 offset:46080
v_cvt_pk_bf16_f32 v156, v156, v157
v_mfma_f32_16x16x32_bf16 v[112:115], a[208:211], v[64:67], v[112:115]
s_add_u32 s90, s65, 0
ds_read_b64_tr_b16 v[174:175], v247 offset:47360
v_add_f32 v231, v231, v158
v_mfma_f32_16x16x32_bf16 v[112:115], a[212:215], v[80:83], v[112:115]
buffer_load_dwordx4 v[192:195], v250, s[4:7], s90 offen sc1
v_mfma_f32_16x16x32_bf16 v[116:119], a[212:215], v[84:87], 0
ds_read_b64_tr_b16 v[160:161], v247 offset:40992
v_add_f32 v231, v231, v159
v_mfma_f32_16x16x32_bf16 v[116:119], a[208:211], v[68:71], v[116:119]
ds_read_b64_tr_b16 v[162:163], v247 offset:42272
v_cvt_pk_bf16_f32 v157, v158, v159
v_mfma_f32_16x16x32_bf16 v[116:119], a[204:207], v[52:55], v[116:119]
s_add_u32 s90, s65, 4096
ds_read_b64_tr_b16 v[164:165], v247 offset:46112
v_cvt_pk_bf16_f32 v158, v108, v109
v_mfma_f32_16x16x32_bf16 v[116:119], a[200:203], v[36:39], v[116:119]
buffer_load_dwordx4 v[196:199], v250, s[4:7], s90 offen sc1
v_mfma_f32_16x16x32_bf16 v[116:119], a[196:199], v[20:23], v[116:119]
s_add_u32 s66, s66, s80
s_add_u32 s90, s66, 0
s_add_u32 s94, s94, 15
ds_read_b64_tr_b16 v[166:167], v247 offset:47392
v_mfma_f32_16x16x32_bf16 v[116:119], a[192:195], v[4:7], v[116:119]
s_waitcnt lgkmcnt(6)
v_exp_f32 v110, v110
v_mfma_f32_16x16x32_bf16 a[236:239], v[168:171], v[176:179], a[236:239]
s_waitcnt lgkmcnt(4)
v_exp_f32 v111, v111
v_mfma_f32_16x16x32_bf16 a[236:239], v[172:175], v[180:183], a[236:239]
buffer_load_dwordx4 v[200:203], v250, s[4:7], s90 offen sc1
v_mfma_f32_16x16x32_bf16 v[216:219], v[172:175], v[188:191], v[216:219]
v_add_f32 v231, v231, v110
v_add_f32 v231, v231, v111
v_mfma_f32_16x16x32_bf16 v[216:219], v[168:171], v[184:187], v[216:219]
v_cvt_pk_bf16_f32 v159, v110, v111
v_add_f32 v231, v231, v108
v_mfma_f32_16x16x32_bf16 v[120:123], a[192:195], v[8:11], 0
s_add_u32 s90, s66, 4096
s_lshl_b32 s94, s94, 8
v_add_f32 v231, v231, v109
v_mfma_f32_16x16x32_bf16 v[120:123], a[196:199], v[24:27], v[120:123]
buffer_load_dwordx4 v[204:207], v250, s[4:7], s90 offen sc1
v_mfma_f32_16x16x32_bf16 v[120:123], a[200:203], v[40:43], v[120:123]
v_exp_f32 v112, v112
v_mfma_f32_16x16x32_bf16 v[120:123], a[204:207], v[56:59], v[120:123]
s_and_b32 s94, s94, 8192
v_add_f32 v228, v228, v112
v_mfma_f32_16x16x32_bf16 v[120:123], a[208:211], v[72:75], v[120:123]
s_xor_b32 s94, s94, 262144
ds_read_b64_tr_b16 v[168:169], v247 offset:41024
v_mfma_f32_16x16x32_bf16 v[120:123], a[212:215], v[88:91], v[120:123]
s_xor_b32 s68, s68, s94
ds_read_b64_tr_b16 v[170:171], v247 offset:42304
v_mfma_f32_16x16x32_bf16 v[124:127], a[212:215], v[92:95], 0
s_xor_b32 s76, s68, 1572864
ds_read_b128 a[212:215], v249 offset:30976
v_mfma_f32_16x16x32_bf16 v[124:127], a[208:211], v[76:79], v[124:127]
s_andn2_b32 s71, s68, 49152
ds_read_b64_tr_b16 v[172:173], v247 offset:46144
v_mfma_f32_16x16x32_bf16 v[124:127], a[204:207], v[60:63], v[124:127]
s_add_u32 m0, s55, 122880
s_andn2_b32 s77, s76, 65536
ds_read_b64_tr_b16 v[174:175], v247 offset:47424
v_mfma_f32_16x16x32_bf16 v[124:127], a[200:203], v[44:47], v[124:127]
s_add_u32 s61, s61, 163840
s_andn2_b32 s70, s68, 204800
ds_read_b128 a[200:203], v248 offset:36992
v_mfma_f32_16x16x32_bf16 v[124:127], a[196:199], v[28:31], v[124:127]
buffer_load_dwordx4 v242, s[32:35], s61 offen lds
v_mfma_f32_16x16x32_bf16 v[124:127], a[192:195], v[12:15], v[124:127]
s_waitcnt lgkmcnt(8)
v_exp_f32 v113, v113
v_mfma_f32_16x16x32_bf16 a[240:243], v[160:163], v[176:179], a[240:243]
s_waitcnt lgkmcnt(6)
ds_read_b128 a[192:195], v248 offset:36864
v_add_f32 v228, v228, v113
v_mfma_f32_16x16x32_bf16 a[240:243], v[164:167], v[180:183], a[240:243]
ds_read_b128 a[196:199], v249 offset:36864
v_cvt_pk_bf16_f32 v112, v112, v113
v_mfma_f32_16x16x32_bf16 v[220:223], v[164:167], v[188:191], v[220:223]
buffer_load_dwordx4 v243, s[32:35], s61 offen offset:1024 lds
v_mfma_f32_16x16x32_bf16 v[220:223], v[160:163], v[184:187], v[220:223]
v_exp_f32 v114, v114
v_mfma_f32_16x16x32_bf16 v[96:99], a[216:219], v[0:3], 0
ds_read_b128 a[204:207], v249 offset:36992
v_add_f32 v228, v228, v114
v_mfma_f32_16x16x32_bf16 v[96:99], a[220:223], v[16:19], v[96:99]
v_exp_f32 v115, v115
v_mfma_f32_16x16x32_bf16 v[96:99], a[224:227], v[32:35], v[96:99]
buffer_load_dwordx4 v244, s[32:35], s61 offen offset:2048 lds
v_mfma_f32_16x16x32_bf16 v[96:99], a[228:231], v[48:51], v[96:99]
ds_read_b128 a[208:211], v248 offset:37120
v_add_f32 v228, v228, v115
v_mfma_f32_16x16x32_bf16 v[96:99], a[232:235], v[64:67], v[96:99]
s_waitcnt lgkmcnt(7)
ds_read_b64_tr_b16 v[160:161], v247 offset:41056
v_cvt_pk_bf16_f32 v113, v114, v115
v_mfma_f32_16x16x32_bf16 v[96:99], a[212:215], v[80:83], v[96:99]
v_exp_f32 v116, v116
v_mfma_f32_16x16x32_bf16 v[100:103], a[212:215], v[84:87], 0
ds_read_b64_tr_b16 v[162:163], v247 offset:42336
v_add_f32 v229, v229, v116
v_mfma_f32_16x16x32_bf16 v[100:103], a[232:235], v[68:71], v[100:103]
buffer_load_dwordx4 v245, s[32:35], s61 offen offset:3072 lds
v_mfma_f32_16x16x32_bf16 v[100:103], a[228:231], v[52:55], v[100:103]
v_exp_f32 v117, v117
v_mfma_f32_16x16x32_bf16 v[100:103], a[224:227], v[36:39], v[100:103]
ds_read_b64_tr_b16 v[164:165], v247 offset:46176
v_add_f32 v229, v229, v117
v_mfma_f32_16x16x32_bf16 v[100:103], a[220:223], v[20:23], v[100:103]
s_add_u32 m0, s55, 126976
ds_read_b64_tr_b16 v[166:167], v247 offset:47456
v_cvt_pk_bf16_f32 v116, v116, v117
v_mfma_f32_16x16x32_bf16 v[100:103], a[216:219], v[4:7], v[100:103]
buffer_load_dwordx4 v246, s[32:35], s61 offen lds
v_mfma_f32_16x16x32_bf16 a[244:247], v[168:171], v[176:179], a[244:247]
s_waitcnt lgkmcnt(9)
v_exp_f32 v96, v96
v_mfma_f32_16x16x32_bf16 a[244:247], v[172:175], v[180:183], a[244:247]
v_exp_f32 v97, v97
v_mfma_f32_16x16x32_bf16 v[208:211], v[172:175], v[188:191], v[208:211]
ds_read_b64_tr_b16 v[172:173], v234 offset:12416
v_cvt_pk_bf16_f32 v114, v96, v97
v_mfma_f32_16x16x32_bf16 v[208:211], v[168:171], v[184:187], v[208:211]
v_exp_f32 v98, v98
v_mfma_f32_16x16x32_bf16 v[104:107], a[216:219], v[8:11], 0
ds_read_b64_tr_b16 v[168:169], v234 offset:128
v_add_f32 v228, v228, v98
v_mfma_f32_16x16x32_bf16 v[104:107], a[220:223], v[24:27], v[104:107]
v_exp_f32 v99, v99
v_mfma_f32_16x16x32_bf16 v[104:107], a[224:227], v[40:43], v[104:107]
ds_read_b64_tr_b16 v[170:171], v234 offset:6272
v_add_f32 v228, v228, v99
v_mfma_f32_16x16x32_bf16 v[104:107], a[228:231], v[56:59], v[104:107]
ds_read_b64_tr_b16 v[174:175], v234 offset:18560
v_cvt_pk_bf16_f32 v115, v98, v99
v_mfma_f32_16x16x32_bf16 v[104:107], a[232:235], v[72:75], v[104:107]
v_add_f32 v228, v228, v96
v_add_f32 v228, v228, v97
v_mfma_f32_16x16x32_bf16 v[104:107], a[212:215], v[88:91], v[104:107]
v_exp_f32 v118, v118
v_mfma_f32_16x16x32_bf16 v[108:111], a[212:215], v[92:95], 0
s_add_u32 m0, s53, 36864
ds_read_b128 a[212:215], v249 offset:37120
v_add_f32 v229, v229, v118
v_mfma_f32_16x16x32_bf16 v[108:111], a[232:235], v[76:79], v[108:111]
s_add_u32 s60, s60, 12288
v_exp_f32 v119, v119
v_mfma_f32_16x16x32_bf16 v[108:111], a[228:231], v[60:63], v[108:111]
buffer_load_dwordx4 v239, s[24:27], s60 offen lds
v_mfma_f32_16x16x32_bf16 v[108:111], a[224:227], v[44:47], v[108:111]
ds_read_b128 a[224:227], v248 offset:43136
v_add_f32 v229, v229, v119
v_mfma_f32_16x16x32_bf16 v[108:111], a[220:223], v[28:31], v[108:111]
ds_read_b128 a[220:223], v249 offset:43008
v_cvt_pk_bf16_f32 v117, v118, v119
v_mfma_f32_16x16x32_bf16 v[108:111], a[216:219], v[12:15], v[108:111]
s_waitcnt lgkmcnt(9)
v_exp_f32 v100, v100
v_mfma_f32_16x16x32_bf16 a[248:251], v[160:163], v[176:179], a[248:251]
s_waitcnt lgkmcnt(7)
buffer_load_dwordx4 v240, s[24:27], s60 offen offset:1024 lds
v_mfma_f32_16x16x32_bf16 a[248:251], v[164:167], v[180:183], a[248:251]
v_exp_f32 v101, v101
v_mfma_f32_16x16x32_bf16 v[212:215], v[164:167], v[188:191], v[212:215]
ds_read_b64_tr_b16 v[164:165], v235 offset:12416
v_cvt_pk_bf16_f32 v118, v100, v101
v_mfma_f32_16x16x32_bf16 v[212:215], v[160:163], v[184:187], v[212:215]
s_waitcnt lgkmcnt(5)
v_exp_f32 v102, v102
v_mfma_f32_16x16x32_bf16 a[96:99], v[168:171], v[128:131], a[96:99]
s_waitcnt lgkmcnt(4)
ds_read_b64_tr_b16 v[160:161], v235 offset:128
v_add_f32 v229, v229, v102
v_mfma_f32_16x16x32_bf16 a[96:99], v[172:175], v[144:147], a[96:99]
ds_read_b64_tr_b16 v[162:163], v235 offset:6272
v_mfma_f32_16x16x32_bf16 a[100:103], v[172:175], v[148:151], a[100:103]
L_walk1_9:
s_cbranch_execz L_ret1
ds_read_b64_tr_b16 v[166:167], v235 offset:18560
v_mfma_f32_16x16x32_bf16 a[100:103], v[168:171], v[132:135], a[100:103]
buffer_load_dwordx4 v241, s[24:27], s60 offen offset:2048 lds
v_mfma_f32_16x16x32_bf16 a[104:107], v[168:171], v[136:139], a[104:107]
v_exp_f32 v103, v103
v_mfma_f32_16x16x32_bf16 a[104:107], v[172:175], v[152:155], a[104:107]
ds_read_b128 a[216:219], v248 offset:43008
v_add_f32 v229, v229, v103
v_mfma_f32_16x16x32_bf16 a[108:111], v[172:175], v[156:159], a[108:111]
s_add_u32 m0, s53, 61440
ds_read_b64_tr_b16 v[172:173], v232 offset:12544
v_cvt_pk_bf16_f32 v119, v102, v103
v_mfma_f32_16x16x32_bf16 a[108:111], v[168:171], v[140:143], a[108:111]
s_waitcnt lgkmcnt(3)
ds_read_b64_tr_b16 v[168:169], v232 offset:256
v_add_f32 v229, v229, v100
v_mfma_f32_16x16x32_bf16 a[124:127], v[160:163], v[140:143], a[124:127]
s_waitcnt lgkmcnt(3)
ds_read_b64_tr_b16 v[170:171], v232 offset:6400
v_add_f32 v229, v229, v101
v_mfma_f32_16x16x32_bf16 a[124:127], v[164:167], v[156:159], a[124:127]
s_add_u32 s59, s59, 12288
ds_read_b64_tr_b16 v[174:175], v232 offset:18688
v_mfma_f32_16x16x32_bf16 a[120:123], v[164:167], v[152:155], a[120:123]
buffer_load_dwordx4 v236, s[20:23], s59 offen lds
v_mfma_f32_16x16x32_bf16 a[120:123], v[160:163], v[136:139], a[120:123]
v_exp_f32 v120, v120
v_mfma_f32_16x16x32_bf16 a[116:119], v[160:163], v[132:135], a[116:119]
ds_read_b128 a[228:231], v249 offset:43136
v_add_f32 v230, v230, v120
v_mfma_f32_16x16x32_bf16 a[116:119], v[164:167], v[148:151], a[116:119]
v_exp_f32 v121, v121
v_mfma_f32_16x16x32_bf16 a[112:115], v[164:167], v[144:147], a[112:115]
ds_read_b64_tr_b16 v[164:165], v247 offset:46208
v_add_f32 v230, v230, v121
v_mfma_f32_16x16x32_bf16 a[112:115], v[160:163], v[128:131], a[112:115]
s_waitcnt lgkmcnt(3)
ds_read_b64_tr_b16 v[160:161], v247 offset:41088
v_cvt_pk_bf16_f32 v120, v120, v121
v_mfma_f32_16x16x32_bf16 a[128:131], v[168:171], v[128:131], a[128:131]
s_waitcnt lgkmcnt(3)
ds_read_b64_tr_b16 v[162:163], v247 offset:42368
v_mfma_f32_16x16x32_bf16 a[128:131], v[172:175], v[144:147], a[128:131]
ds_read_b64_tr_b16 v[166:167], v247 offset:47488
v_mfma_f32_16x16x32_bf16 a[132:135], v[172:175], v[148:151], a[132:135]
buffer_load_dwordx4 v237, s[20:23], s59 offen offset:1024 lds
v_mfma_f32_16x16x32_bf16 a[132:135], v[168:171], v[132:135], a[132:135]
v_exp_f32 v122, v122
v_mfma_f32_16x16x32_bf16 a[136:139], v[168:171], v[136:139], a[136:139]
ds_read_b128 a[232:235], v248 offset:43264
v_add_f32 v230, v230, v122
v_mfma_f32_16x16x32_bf16 a[136:139], v[172:175], v[152:155], a[136:139]
v_exp_f32 v123, v123
v_mfma_f32_16x16x32_bf16 a[140:143], v[172:175], v[156:159], a[140:143]
ds_read_b64_tr_b16 v[172:173], v233 offset:12544
ds_read_b64_tr_b16 v[174:175], v233 offset:18688
v_mfma_f32_16x16x32_bf16 a[140:143], v[168:171], v[140:143], a[140:143]
s_waitcnt lgkmcnt(4)
ds_read_b64_tr_b16 v[168:169], v233 offset:256
ds_read_b64_tr_b16 v[170:171], v233 offset:6400
v_mfma_f32_16x16x32_bf16 a[252:255], v[160:163], v[176:179], a[252:255]
s_waitcnt lgkmcnt(5)
buffer_load_dwordx4 v238, s[20:23], s59 offen offset:2048 lds
v_mfma_f32_16x16x32_bf16 a[252:255], v[164:167], v[180:183], a[252:255]
v_exp_f32 v104, v104
v_mfma_f32_16x16x32_bf16 v[224:227], v[164:167], v[188:191], v[224:227]
s_add_u32 s91, s91, 262144
ds_read_b64_tr_b16 v[164:165], v234 offset:12544
v_add_f32 v230, v230, v123
v_mfma_f32_16x16x32_bf16 v[224:227], v[160:163], v[184:187], v[224:227]
s_waitcnt lgkmcnt(1)
ds_read_b64_tr_b16 v[160:161], v234 offset:256
v_cvt_pk_bf16_f32 v121, v122, v123
v_mfma_f32_16x16x32_bf16 a[156:159], v[168:171], v[140:143], a[156:159]
s_and_b32 s3, s1, 1074003967
ds_read_b64_tr_b16 v[162:163], v234 offset:6400
v_mfma_f32_16x16x32_bf16 a[156:159], v[172:175], v[156:159], a[156:159]
s_add_u32 s3, s3, s91
ds_read_b64_tr_b16 v[166:167], v234 offset:18688
v_mfma_f32_16x16x32_bf16 a[152:155], v[172:175], v[152:155], a[152:155]
buffer_load_dword v254, v253, s[28:31], s3 offen
v_mfma_f32_16x16x32_bf16 a[152:155], v[168:171], v[136:139], a[152:155]
v_exp_f32 v105, v105
v_mfma_f32_16x16x32_bf16 a[148:151], v[168:171], v[132:135], a[148:151]
v_exp_f32 v106, v106
v_mfma_f32_16x16x32_bf16 a[148:151], v[172:175], v[148:151], a[148:151]
s_xor_b32 s3, s76, 786432
v_exp_f32 v107, v107
v_mfma_f32_16x16x32_bf16 a[144:147], v[172:175], v[144:147], a[144:147]
buffer_store_dwordx4 v[250:253], v250, s[4:7], s3 offen offset:1024 sc1
v_mfma_f32_16x16x32_bf16 a[144:147], v[168:171], v[128:131], a[144:147]
s_waitcnt lgkmcnt(1)
ds_read_b64_tr_b16 v[168:169], v235 offset:256
v_add_f32 v230, v230, v106
v_mfma_f32_16x16x32_bf16 a[160:163], v[160:163], v[128:131], a[160:163]
s_waitcnt lgkmcnt(1)
ds_read_b64_tr_b16 v[170:171], v235 offset:6400
v_add_f32 v230, v230, v107
v_mfma_f32_16x16x32_bf16 a[160:163], v[164:167], v[144:147], a[160:163]
ds_read_b64_tr_b16 v[172:173], v235 offset:12544
v_cvt_pk_bf16_f32 v123, v106, v107
v_mfma_f32_16x16x32_bf16 a[164:167], v[164:167], v[148:151], a[164:167]
ds_read_b64_tr_b16 v[174:175], v235 offset:18688
v_add_f32 v230, v230, v104
v_mfma_f32_16x16x32_bf16 a[164:167], v[160:163], v[132:135], a[164:167]
v_add_f32 v230, v230, v105
v_cvt_pk_bf16_f32 v122, v104, v105
v_mfma_f32_16x16x32_bf16 a[168:171], v[160:163], v[136:139], a[168:171]
v_exp_f32 v124, v124
v_mfma_f32_16x16x32_bf16 a[168:171], v[164:167], v[152:155], a[168:171]
v_exp_f32 v125, v125
v_mfma_f32_16x16x32_bf16 a[172:175], v[164:167], v[156:159], a[172:175]
v_exp_f32 v126, v126
v_mfma_f32_16x16x32_bf16 a[172:175], v[160:163], v[140:143], a[172:175]
s_waitcnt lgkmcnt(2)
v_exp_f32 v127, v127
v_mfma_f32_16x16x32_bf16 a[188:191], v[168:171], v[140:143], a[188:191]
s_waitcnt lgkmcnt(0)
v_exp_f32 v108, v108
v_mfma_f32_16x16x32_bf16 a[188:191], v[172:175], v[156:159], a[188:191]
v_exp_f32 v109, v109
v_mfma_f32_16x16x32_bf16 a[184:187], v[172:175], v[152:155], a[184:187]
v_exp_f32 v110, v110
v_mfma_f32_16x16x32_bf16 a[184:187], v[168:171], v[136:139], a[184:187]
v_exp_f32 v111, v111
v_mfma_f32_16x16x32_bf16 a[180:183], v[168:171], v[132:135], a[180:183]
v_add_f32 v231, v231, v124
v_add_f32 v231, v231, v125
v_mfma_f32_16x16x32_bf16 a[180:183], v[172:175], v[148:151], a[180:183]
v_cvt_pk_bf16_f32 v124, v124, v125
v_add_f32 v231, v231, v126
v_mfma_f32_16x16x32_bf16 a[176:179], v[172:175], v[144:147], a[176:179]
v_add_f32 v231, v231, v127
v_cvt_pk_bf16_f32 v125, v126, v127
v_mfma_f32_16x16x32_bf16 a[176:179], v[168:171], v[128:131], a[176:179]
v_add_f32 v231, v231, v110
v_add_f32 v231, v231, v111
v_mfma_f32_16x16x32_bf16 v[128:131], a[192:195], v[0:3], 0
s_waitcnt vmcnt(18)
s_barrier
v_mfma_f32_16x16x32_bf16 v[128:131], a[196:199], v[16:19], v[128:131]
ds_read_b64_tr_b16 v[160:161], v247 offset:0
v_cvt_pk_bf16_f32 v127, v110, v111
v_mfma_f32_16x16x32_bf16 v[128:131], a[200:203], v[32:35], v[128:131]
ds_read_b64_tr_b16 v[162:163], v247 offset:1280
v_add_f32 v231, v231, v108
v_mfma_f32_16x16x32_bf16 v[128:131], a[204:207], v[48:51], v[128:131]
ds_read_b64_tr_b16 v[164:165], v247 offset:5120
v_add_f32 v231, v231, v109
v_mfma_f32_16x16x32_bf16 v[128:131], a[208:211], v[64:67], v[128:131]
s_add_u32 s90, s65, 16384
ds_read_b64_tr_b16 v[166:167], v247 offset:6400
v_cvt_pk_bf16_f32 v126, v108, v109
v_mfma_f32_16x16x32_bf16 v[128:131], a[212:215], v[80:83], v[128:131]
buffer_load_dwordx4 v[176:179], v250, s[4:7], s90 offen sc1
v_mfma_f32_16x16x32_bf16 v[132:135], a[212:215], v[84:87], 0
ds_read_b64_tr_b16 v[168:169], v247 offset:32
v_mfma_f32_16x16x32_bf16 v[132:135], a[208:211], v[68:71], v[132:135]
ds_read_b64_tr_b16 v[170:171], v247 offset:1312
v_mfma_f32_16x16x32_bf16 v[132:135], a[204:207], v[52:55], v[132:135]
s_add_u32 s90, s65, 20480
ds_read_b64_tr_b16 v[172:173], v247 offset:5152
v_mfma_f32_16x16x32_bf16 v[132:135], a[200:203], v[36:39], v[132:135]
buffer_load_dwordx4 v[180:183], v250, s[4:7], s90 offen sc1
v_mfma_f32_16x16x32_bf16 v[132:135], a[196:199], v[20:23], v[132:135]
s_add_u32 s90, s66, 16384
v_exp_f32 v128, v128
v_mfma_f32_16x16x32_bf16 v[132:135], a[192:195], v[4:7], v[132:135]
s_waitcnt vmcnt(18) lgkmcnt(5)
ds_read_b64_tr_b16 v[174:175], v247 offset:6432
v_add_f32 v228, v228, v128
v_mfma_f32_16x16x32_bf16 a[236:239], v[160:163], v[192:195], a[236:239]
s_waitcnt vmcnt(17) lgkmcnt(4)
v_exp_f32 v129, v129
v_mfma_f32_16x16x32_bf16 a[236:239], v[164:167], v[196:199], a[236:239]
s_waitcnt vmcnt(15)
buffer_load_dwordx4 v[184:187], v250, s[4:7], s90 offen sc1
v_mfma_f32_16x16x32_bf16 v[216:219], v[164:167], v[204:207], v[216:219]
v_exp_f32 v130, v130
v_mfma_f32_16x16x32_bf16 v[216:219], v[160:163], v[200:203], v[216:219]
v_exp_f32 v131, v131
v_mfma_f32_16x16x32_bf16 v[136:139], a[192:195], v[8:11], 0
s_add_u32 s90, s66, 20480
v_add_f32 v228, v228, v129
v_cvt_pk_bf16_f32 v128, v128, v129
v_mfma_f32_16x16x32_bf16 v[136:139], a[196:199], v[24:27], v[136:139]
buffer_load_dwordx4 v[188:191], v250, s[4:7], s90 offen sc1
v_mfma_f32_16x16x32_bf16 v[136:139], a[200:203], v[40:43], v[136:139]
v_add_f32 v228, v228, v130
v_add_f32 v228, v228, v131
v_mfma_f32_16x16x32_bf16 v[136:139], a[204:207], v[56:59], v[136:139]
v_exp_f32 v132, v132
v_mfma_f32_16x16x32_bf16 v[136:139], a[208:211], v[72:75], v[136:139]
ds_read_b64_tr_b16 v[160:161], v247 offset:64
v_cvt_pk_bf16_f32 v129, v130, v131
v_mfma_f32_16x16x32_bf16 v[136:139], a[212:215], v[88:91], v[136:139]
ds_read_b64_tr_b16 v[162:163], v247 offset:1344
v_add_f32 v229, v229, v132
v_mfma_f32_16x16x32_bf16 v[140:143], a[212:215], v[92:95], 0
v_exp_f32 v133, v133
v_mfma_f32_16x16x32_bf16 v[140:143], a[208:211], v[76:79], v[140:143]
ds_read_b128 a[212:215], v249 offset:43264
v_add_f32 v229, v229, v133
v_mfma_f32_16x16x32_bf16 v[140:143], a[204:207], v[60:63], v[140:143]
s_add_u32 m0, s55, 143360
ds_read_b64_tr_b16 v[164:165], v247 offset:5184
v_cvt_pk_bf16_f32 v132, v132, v133
v_mfma_f32_16x16x32_bf16 v[140:143], a[200:203], v[44:47], v[140:143]
s_add_u32 s61, s61, 163840
v_exp_f32 v134, v134
v_mfma_f32_16x16x32_bf16 v[140:143], a[196:199], v[28:31], v[140:143]
buffer_load_dwordx4 v242, s[32:35], s61 offen lds
v_mfma_f32_16x16x32_bf16 v[140:143], a[192:195], v[12:15], v[140:143]
s_waitcnt lgkmcnt(6)
ds_read_b64_tr_b16 v[166:167], v247 offset:6464
v_add_f32 v229, v229, v134
v_mfma_f32_16x16x32_bf16 a[240:243], v[168:171], v[192:195], a[240:243]
s_waitcnt lgkmcnt(5)
v_exp_f32 v135, v135
v_mfma_f32_16x16x32_bf16 a[240:243], v[172:175], v[196:199], a[240:243]
ds_read_b128 a[192:195], v248 offset:0
v_add_f32 v229, v229, v135
v_mfma_f32_16x16x32_bf16 v[220:223], v[172:175], v[204:207], v[220:223]
buffer_load_dwordx4 v243, s[32:35], s61 offen offset:1024 lds
v_mfma_f32_16x16x32_bf16 v[220:223], v[168:171], v[200:203], v[220:223]
ds_read_b128 a[196:199], v249 offset:0
v_cvt_pk_bf16_f32 v133, v134, v135
v_mfma_f32_16x16x32_bf16 v[96:99], a[216:219], v[0:3], 0
v_exp_f32 v136, v136
v_mfma_f32_16x16x32_bf16 v[96:99], a[220:223], v[16:19], v[96:99]
ds_read_b128 a[200:203], v248 offset:128
v_add_f32 v230, v230, v136
v_mfma_f32_16x16x32_bf16 v[96:99], a[224:227], v[32:35], v[96:99]
buffer_load_dwordx4 v244, s[32:35], s61 offen offset:2048 lds
v_mfma_f32_16x16x32_bf16 v[96:99], a[228:231], v[48:51], v[96:99]
v_exp_f32 v137, v137
v_mfma_f32_16x16x32_bf16 v[96:99], a[232:235], v[64:67], v[96:99]
s_waitcnt lgkmcnt(5)
ds_read_b64_tr_b16 v[168:169], v247 offset:96
v_add_f32 v230, v230, v137
v_mfma_f32_16x16x32_bf16 v[96:99], a[212:215], v[80:83], v[96:99]
ds_read_b64_tr_b16 v[170:171], v247 offset:1376
v_cvt_pk_bf16_f32 v136, v136, v137
v_mfma_f32_16x16x32_bf16 v[100:103], a[212:215], v[84:87], 0
buffer_load_dwordx4 v245, s[32:35], s61 offen offset:3072 lds
v_mfma_f32_16x16x32_bf16 v[100:103], a[232:235], v[68:71], v[100:103]
v_exp_f32 v138, v138
v_mfma_f32_16x16x32_bf16 v[100:103], a[228:231], v[52:55], v[100:103]
ds_read_b64_tr_b16 v[172:173], v247 offset:5216
v_add_f32 v230, v230, v138
v_mfma_f32_16x16x32_bf16 v[100:103], a[224:227], v[36:39], v[100:103]
s_add_u32 m0, s55, 147456
v_exp_f32 v96, v96
v_mfma_f32_16x16x32_bf16 v[100:103], a[220:223], v[20:23], v[100:103]
buffer_load_dwordx4 v246, s[32:35], s61 offen lds
v_mfma_f32_16x16x32_bf16 v[100:103], a[216:219], v[4:7], v[100:103]
v_exp_f32 v97, v97
v_mfma_f32_16x16x32_bf16 a[244:247], v[160:163], v[192:195], a[244:247]
s_waitcnt lgkmcnt(6)
ds_read_b64_tr_b16 v[174:175], v247 offset:6496
v_cvt_pk_bf16_f32 v130, v96, v97
v_mfma_f32_16x16x32_bf16 a[244:247], v[164:167], v[196:199], a[244:247]
v_exp_f32 v98, v98
v_mfma_f32_16x16x32_bf16 v[208:211], v[164:167], v[204:207], v[208:211]
ds_read_b64_tr_b16 v[164:165], v232 offset:24576
v_add_f32 v228, v228, v98
v_mfma_f32_16x16x32_bf16 v[208:211], v[160:163], v[200:203], v[208:211]
v_exp_f32 v99, v99
v_mfma_f32_16x16x32_bf16 v[104:107], a[216:219], v[8:11], 0
ds_read_b64_tr_b16 v[160:161], v232 offset:12288
v_add_f32 v228, v228, v99
v_mfma_f32_16x16x32_bf16 v[104:107], a[220:223], v[24:27], v[104:107]
ds_read_b64_tr_b16 v[162:163], v232 offset:18432
v_cvt_pk_bf16_f32 v131, v98, v99
v_mfma_f32_16x16x32_bf16 v[104:107], a[224:227], v[40:43], v[104:107]
ds_read_b64_tr_b16 v[166:167], v232 offset:30720
v_add_f32 v228, v228, v96
v_mfma_f32_16x16x32_bf16 v[104:107], a[228:231], v[56:59], v[104:107]
ds_read_b128 a[204:207], v249 offset:128
v_add_f32 v228, v228, v97
v_mfma_f32_16x16x32_bf16 v[104:107], a[232:235], v[72:75], v[104:107]
v_exp_f32 v100, v100
v_mfma_f32_16x16x32_bf16 v[104:107], a[212:215], v[88:91], v[104:107]
v_exp_f32 v101, v101
v_mfma_f32_16x16x32_bf16 v[108:111], a[212:215], v[92:95], 0
s_add_u32 m0, s53, 0
ds_read_b128 a[208:211], v248 offset:256
v_cvt_pk_bf16_f32 v134, v100, v101
v_mfma_f32_16x16x32_bf16 v[108:111], a[232:235], v[76:79], v[108:111]
s_add_u32 s60, s60, 12288
v_exp_f32 v102, v102
v_mfma_f32_16x16x32_bf16 v[108:111], a[228:231], v[60:63], v[108:111]
buffer_load_dwordx4 v239, s[24:27], s60 offen lds
v_mfma_f32_16x16x32_bf16 v[108:111], a[224:227], v[44:47], v[108:111]
ds_read_b128 a[212:215], v249 offset:256
v_add_f32 v229, v229, v102
v_mfma_f32_16x16x32_bf16 v[108:111], a[220:223], v[28:31], v[108:111]
v_exp_f32 v103, v103
v_mfma_f32_16x16x32_bf16 v[108:111], a[216:219], v[12:15], v[108:111]
s_waitcnt lgkmcnt(9)
ds_read_b128 a[216:219], v248 offset:6144
v_add_f32 v229, v229, v103
v_mfma_f32_16x16x32_bf16 a[248:251], v[168:171], v[192:195], a[248:251]
s_waitcnt lgkmcnt(8)
buffer_load_dwordx4 v240, s[24:27], s60 offen offset:1024 lds
v_mfma_f32_16x16x32_bf16 a[248:251], v[172:175], v[196:199], a[248:251]
ds_read_b128 a[220:223], v249 offset:6144
v_cvt_pk_bf16_f32 v135, v102, v103
v_mfma_f32_16x16x32_bf16 v[212:215], v[172:175], v[204:207], v[212:215]
ds_read_b64_tr_b16 v[172:173], v233 offset:24576
v_add_f32 v229, v229, v100
v_mfma_f32_16x16x32_bf16 v[212:215], v[168:171], v[200:203], v[212:215]
s_waitcnt lgkmcnt(7)
ds_read_b64_tr_b16 v[168:169], v233 offset:12288
v_add_f32 v229, v229, v101
v_mfma_f32_16x16x32_bf16 a[0:3], v[160:163], v[144:147], a[0:3]
s_waitcnt lgkmcnt(7)
ds_read_b64_tr_b16 v[170:171], v233 offset:18432
v_mfma_f32_16x16x32_bf16 a[0:3], v[164:167], v[112:115], a[0:3]
ds_read_b64_tr_b16 v[174:175], v233 offset:30720
v_mfma_f32_16x16x32_bf16 a[4:7], v[164:167], v[116:119], a[4:7]
buffer_load_dwordx4 v241, s[24:27], s60 offen offset:2048 lds
v_mfma_f32_16x16x32_bf16 a[4:7], v[160:163], v[148:151], a[4:7]
v_exp_f32 v139, v139
v_mfma_f32_16x16x32_bf16 a[8:11], v[160:163], v[152:155], a[8:11]
ds_read_b128 a[224:227], v248 offset:6272
v_add_f32 v230, v230, v139
v_mfma_f32_16x16x32_bf16 a[8:11], v[164:167], v[120:123], a[8:11]
ds_read_b128 a[228:231], v249 offset:6272
v_cvt_pk_bf16_f32 v137, v138, v139
v_mfma_f32_16x16x32_bf16 a[12:15], v[164:167], v[124:127], a[12:15]
v_exp_f32 v104, v104
v_mfma_f32_16x16x32_bf16 a[12:15], v[160:163], v[156:159], a[12:15]
s_waitcnt lgkmcnt(3)
v_exp_f32 v105, v105
v_mfma_f32_16x16x32_bf16 a[28:31], v[168:171], v[156:159], a[28:31]
s_waitcnt lgkmcnt(2)
ds_read_b64_tr_b16 v[160:161], v234 offset:12288
v_cvt_pk_bf16_f32 v138, v104, v105
v_mfma_f32_16x16x32_bf16 a[28:31], v[172:175], v[124:127], a[28:31]
s_add_u32 m0, s53, 73728
ds_read_b64_tr_b16 v[162:163], v234 offset:18432
v_mfma_f32_16x16x32_bf16 a[24:27], v[172:175], v[120:123], a[24:27]
s_add_u32 s59, s59, 12288
ds_read_b64_tr_b16 v[164:165], v234 offset:24576
ds_read_b64_tr_b16 v[166:167], v234 offset:30720
v_mfma_f32_16x16x32_bf16 a[24:27], v[168:171], v[152:155], a[24:27]
buffer_load_dwordx4 v236, s[20:23], s59 offen lds
v_mfma_f32_16x16x32_bf16 a[20:23], v[168:171], v[148:151], a[20:23]
v_exp_f32 v106, v106
v_mfma_f32_16x16x32_bf16 a[20:23], v[172:175], v[116:119], a[20:23]
ds_read_b128 a[232:235], v248 offset:6400
v_add_f32 v230, v230, v106
v_mfma_f32_16x16x32_bf16 a[16:19], v[172:175], v[112:115], a[16:19]
v_exp_f32 v107, v107
v_mfma_f32_16x16x32_bf16 a[16:19], v[168:171], v[144:147], a[16:19]
s_waitcnt lgkmcnt(3)
ds_read_b64_tr_b16 v[168:169], v247 offset:128
v_add_f32 v230, v230, v107
v_mfma_f32_16x16x32_bf16 a[32:35], v[160:163], v[144:147], a[32:35]
s_waitcnt lgkmcnt(2)
ds_read_b64_tr_b16 v[170:171], v247 offset:1408
v_cvt_pk_bf16_f32 v139, v106, v107
v_mfma_f32_16x16x32_bf16 a[32:35], v[164:167], v[112:115], a[32:35]
ds_read_b64_tr_b16 v[172:173], v247 offset:5248
v_add_f32 v230, v230, v104
v_mfma_f32_16x16x32_bf16 a[36:39], v[164:167], v[116:119], a[36:39]
ds_read_b64_tr_b16 v[174:175], v247 offset:6528
v_add_f32 v230, v230, v105
v_mfma_f32_16x16x32_bf16 a[36:39], v[160:163], v[148:151], a[36:39]
buffer_load_dwordx4 v237, s[20:23], s59 offen offset:1024 lds
v_mfma_f32_16x16x32_bf16 a[40:43], v[160:163], v[152:155], a[40:43]
v_exp_f32 v140, v140
v_mfma_f32_16x16x32_bf16 a[40:43], v[164:167], v[120:123], a[40:43]
v_exp_f32 v141, v141
v_mfma_f32_16x16x32_bf16 a[44:47], v[164:167], v[124:127], a[44:47]
ds_read_b64_tr_b16 v[164:165], v235 offset:24576
ds_read_b64_tr_b16 v[166:167], v235 offset:30720
v_mfma_f32_16x16x32_bf16 a[44:47], v[160:163], v[156:159], a[44:47]
s_waitcnt lgkmcnt(4)
ds_read_b64_tr_b16 v[160:161], v235 offset:12288
ds_read_b64_tr_b16 v[162:163], v235 offset:18432
v_mfma_f32_16x16x32_bf16 a[252:255], v[168:171], v[192:195], a[252:255]
s_waitcnt lgkmcnt(4)
buffer_load_dwordx4 v238, s[20:23], s59 offen offset:2048 lds
v_mfma_f32_16x16x32_bf16 a[252:255], v[172:175], v[196:199], a[252:255]
v_exp_f32 v142, v142
v_mfma_f32_16x16x32_bf16 v[224:227], v[172:175], v[204:207], v[224:227]
s_add_u32 s91, s91, 262144
ds_read_b64_tr_b16 v[172:173], v232 offset:24704
v_add_f32 v231, v231, v140
v_mfma_f32_16x16x32_bf16 v[224:227], v[168:171], v[200:203], v[224:227]
s_waitcnt lgkmcnt(1)
ds_read_b64_tr_b16 v[168:169], v232 offset:12416
v_add_f32 v231, v231, v141
v_mfma_f32_16x16x32_bf16 a[60:63], v[160:163], v[156:159], a[60:63]
s_and_b32 s3, s0, 1074003967
ds_read_b64_tr_b16 v[170:171], v232 offset:18560
v_cvt_pk_bf16_f32 v140, v140, v141
v_mfma_f32_16x16x32_bf16 a[60:63], v[164:167], v[124:127], a[60:63]
s_add_u32 s3, s3, s91
ds_read_b64_tr_b16 v[174:175], v232 offset:30848
v_add_f32 v231, v231, v142
v_mfma_f32_16x16x32_bf16 a[56:59], v[164:167], v[120:123], a[56:59]
buffer_load_dword v254, v253, s[28:31], s3 offen
v_mfma_f32_16x16x32_bf16 a[56:59], v[160:163], v[152:155], a[56:59]
v_exp_f32 v143, v143
v_mfma_f32_16x16x32_bf16 a[52:55], v[160:163], v[148:151], a[52:55]
v_exp_f32 v108, v108
v_mfma_f32_16x16x32_bf16 a[52:55], v[164:167], v[116:119], a[52:55]
s_xor_b32 s3, s76, 786432
v_exp_f32 v109, v109
v_mfma_f32_16x16x32_bf16 a[48:51], v[164:167], v[112:115], a[48:51]
buffer_store_dwordx4 v[250:253], v250, s[4:7], s3 offen offset:2048 sc1
v_mfma_f32_16x16x32_bf16 a[48:51], v[160:163], v[144:147], a[48:51]
s_waitcnt lgkmcnt(1)
ds_read_b64_tr_b16 v[160:161], v233 offset:12416
v_add_f32 v231, v231, v143
v_mfma_f32_16x16x32_bf16 a[64:67], v[168:171], v[144:147], a[64:67]
s_waitcnt lgkmcnt(1)
ds_read_b64_tr_b16 v[162:163], v233 offset:18560
v_cvt_pk_bf16_f32 v141, v142, v143
v_mfma_f32_16x16x32_bf16 a[64:67], v[172:175], v[112:115], a[64:67]
ds_read_b64_tr_b16 v[164:165], v233 offset:24704
v_cvt_pk_bf16_f32 v142, v108, v109
v_mfma_f32_16x16x32_bf16 a[68:71], v[172:175], v[116:119], a[68:71]
ds_read_b64_tr_b16 v[166:167], v233 offset:30848
v_mfma_f32_16x16x32_bf16 a[68:71], v[168:171], v[148:151], a[68:71]
v_exp_f32 v110, v110
v_mfma_f32_16x16x32_bf16 a[72:75], v[168:171], v[152:155], a[72:75]
v_exp_f32 v111, v111
v_mfma_f32_16x16x32_bf16 a[72:75], v[172:175], v[120:123], a[72:75]
v_add_f32 v231, v231, v110
v_add_f32 v231, v231, v111
v_mfma_f32_16x16x32_bf16 a[76:79], v[172:175], v[124:127], a[76:79]
v_cvt_pk_bf16_f32 v143, v110, v111
v_add_f32 v231, v231, v108
v_mfma_f32_16x16x32_bf16 a[76:79], v[168:171], v[156:159], a[76:79]
s_waitcnt lgkmcnt(2)
v_add_f32 v231, v231, v109
v_mfma_f32_16x16x32_bf16 a[92:95], v[160:163], v[156:159], a[92:95]
s_waitcnt lgkmcnt(0)
v_mfma_f32_16x16x32_bf16 a[92:95], v[164:167], v[124:127], a[92:95]
v_mfma_f32_16x16x32_bf16 a[88:91], v[164:167], v[120:123], a[88:91]
v_mfma_f32_16x16x32_bf16 a[88:91], v[160:163], v[152:155], a[88:91]
v_mfma_f32_16x16x32_bf16 a[84:87], v[160:163], v[148:151], a[84:87]
v_mfma_f32_16x16x32_bf16 a[84:87], v[164:167], v[116:119], a[84:87]
v_mfma_f32_16x16x32_bf16 a[80:83], v[164:167], v[112:115], a[80:83]
v_mfma_f32_16x16x32_bf16 a[80:83], v[160:163], v[144:147], a[80:83]
v_mfma_f32_16x16x32_bf16 v[144:147], a[192:195], v[0:3], 0
s_waitcnt vmcnt(19)
s_barrier
v_mfma_f32_16x16x32_bf16 v[144:147], a[196:199], v[16:19], v[144:147]
s_add_u32 s90, s65, 32768
ds_read_b64_tr_b16 v[168:169], v247 offset:20480
v_mfma_f32_16x16x32_bf16 v[144:147], a[200:203], v[32:35], v[144:147]
buffer_load_dwordx4 v[192:195], v250, s[4:7], s90 offen sc1
v_mfma_f32_16x16x32_bf16 v[144:147], a[204:207], v[48:51], v[144:147]
ds_read_b64_tr_b16 v[170:171], v247 offset:21760
v_mfma_f32_16x16x32_bf16 v[144:147], a[208:211], v[64:67], v[144:147]
ds_read_b64_tr_b16 v[172:173], v247 offset:25600
v_mfma_f32_16x16x32_bf16 v[144:147], a[212:215], v[80:83], v[144:147]
s_add_u32 s90, s65, 36864
ds_read_b64_tr_b16 v[174:175], v247 offset:26880
v_mfma_f32_16x16x32_bf16 v[148:151], a[212:215], v[84:87], 0
buffer_load_dwordx4 v[196:199], v250, s[4:7], s90 offen sc1
v_mfma_f32_16x16x32_bf16 v[148:151], a[208:211], v[68:71], v[148:151]
ds_read_b64_tr_b16 v[160:161], v247 offset:20512
v_mfma_f32_16x16x32_bf16 v[148:151], a[204:207], v[52:55], v[148:151]
ds_read_b64_tr_b16 v[162:163], v247 offset:21792
v_mfma_f32_16x16x32_bf16 v[148:151], a[200:203], v[36:39], v[148:151]
v_exp_f32 v144, v144
v_mfma_f32_16x16x32_bf16 v[148:151], a[196:199], v[20:23], v[148:151]
s_add_u32 s90, s66, 32768
ds_read_b64_tr_b16 v[164:165], v247 offset:25632
v_add_f32 v228, v228, v144
v_mfma_f32_16x16x32_bf16 v[148:151], a[192:195], v[4:7], v[148:151]
s_waitcnt vmcnt(18) lgkmcnt(5)
buffer_load_dwordx4 v[200:203], v250, s[4:7], s90 offen sc1
v_mfma_f32_16x16x32_bf16 a[236:239], v[168:171], v[176:179], a[236:239]
s_waitcnt vmcnt(18) lgkmcnt(3)
v_exp_f32 v145, v145
v_mfma_f32_16x16x32_bf16 a[236:239], v[172:175], v[180:183], a[236:239]
s_waitcnt vmcnt(16)
ds_read_b64_tr_b16 v[166:167], v247 offset:26912
v_add_f32 v228, v228, v145
v_mfma_f32_16x16x32_bf16 v[216:219], v[172:175], v[188:191], v[216:219]
s_add_u32 s90, s66, 36864
v_exp_f32 v146, v146
v_mfma_f32_16x16x32_bf16 v[216:219], v[168:171], v[184:187], v[216:219]
buffer_load_dwordx4 v[204:207], v250, s[4:7], s90 offen sc1
v_mfma_f32_16x16x32_bf16 v[152:155], a[192:195], v[8:11], 0
v_exp_f32 v147, v147
v_mfma_f32_16x16x32_bf16 v[152:155], a[196:199], v[24:27], v[152:155]
v_cvt_pk_bf16_f32 v144, v144, v145
v_add_f32 v228, v228, v146
v_mfma_f32_16x16x32_bf16 v[152:155], a[200:203], v[40:43], v[152:155]
v_add_f32 v228, v228, v147
v_cvt_pk_bf16_f32 v145, v146, v147
v_mfma_f32_16x16x32_bf16 v[152:155], a[204:207], v[56:59], v[152:155]
v_exp_f32 v148, v148
v_mfma_f32_16x16x32_bf16 v[152:155], a[208:211], v[72:75], v[152:155]
ds_read_b64_tr_b16 v[168:169], v247 offset:20544
v_add_f32 v229, v229, v148
v_mfma_f32_16x16x32_bf16 v[152:155], a[212:215], v[88:91], v[152:155]
v_exp_f32 v149, v149
v_mfma_f32_16x16x32_bf16 v[156:159], a[212:215], v[92:95], 0
ds_read_b128 a[212:215], v249 offset:6400
v_add_f32 v229, v229, v149
v_mfma_f32_16x16x32_bf16 v[156:159], a[208:211], v[76:79], v[156:159]
ds_read_b64_tr_b16 v[170:171], v247 offset:21824
v_cvt_pk_bf16_f32 v148, v148, v149
v_mfma_f32_16x16x32_bf16 v[156:159], a[204:207], v[60:63], v[156:159]
s_add_u32 m0, s55, 102400
v_exp_f32 v150, v150
v_mfma_f32_16x16x32_bf16 v[156:159], a[200:203], v[44:47], v[156:159]
s_add_u32 s61, s61, s45
ds_read_b64_tr_b16 v[172:173], v247 offset:25664
v_add_f32 v229, v229, v150
v_mfma_f32_16x16x32_bf16 v[156:159], a[196:199], v[28:31], v[156:159]
buffer_load_dwordx4 v242, s[32:35], s61 offen lds
v_mfma_f32_16x16x32_bf16 v[156:159], a[192:195], v[12:15], v[156:159]
s_waitcnt lgkmcnt(6)
v_exp_f32 v151, v151
v_mfma_f32_16x16x32_bf16 a[240:243], v[160:163], v[176:179], a[240:243]
s_waitcnt lgkmcnt(4)
ds_read_b64_tr_b16 v[174:175], v247 offset:26944
v_add_f32 v229, v229, v151
v_mfma_f32_16x16x32_bf16 a[240:243], v[164:167], v[180:183], a[240:243]
ds_read_b128 a[192:195], v248 offset:12288
v_cvt_pk_bf16_f32 v149, v150, v151
v_mfma_f32_16x16x32_bf16 v[220:223], v[164:167], v[188:191], v[220:223]
buffer_load_dwordx4 v243, s[32:35], s61 offen offset:1024 lds
v_mfma_f32_16x16x32_bf16 v[220:223], v[160:163], v[184:187], v[220:223]
v_exp_f32 v152, v152
v_mfma_f32_16x16x32_bf16 v[96:99], a[216:219], v[0:3], 0
ds_read_b128 a[196:199], v249 offset:12288
v_add_f32 v230, v230, v152
v_mfma_f32_16x16x32_bf16 v[96:99], a[220:223], v[16:19], v[96:99]
v_exp_f32 v153, v153
v_mfma_f32_16x16x32_bf16 v[96:99], a[224:227], v[32:35], v[96:99]
buffer_load_dwordx4 v244, s[32:35], s61 offen offset:2048 lds
v_mfma_f32_16x16x32_bf16 v[96:99], a[228:231], v[48:51], v[96:99]
ds_read_b128 a[200:203], v248 offset:12416
v_add_f32 v230, v230, v153
v_mfma_f32_16x16x32_bf16 v[96:99], a[232:235], v[64:67], v[96:99]
s_waitcnt lgkmcnt(6)
ds_read_b64_tr_b16 v[160:161], v247 offset:20576
v_cvt_pk_bf16_f32 v152, v152, v153
v_mfma_f32_16x16x32_bf16 v[96:99], a[212:215], v[80:83], v[96:99]
v_exp_f32 v154, v154
v_mfma_f32_16x16x32_bf16 v[100:103], a[212:215], v[84:87], 0
ds_read_b64_tr_b16 v[162:163], v247 offset:21856
v_add_f32 v230, v230, v154
v_mfma_f32_16x16x32_bf16 v[100:103], a[232:235], v[68:71], v[100:103]
buffer_load_dwordx4 v245, s[32:35], s61 offen offset:3072 lds
v_mfma_f32_16x16x32_bf16 v[100:103], a[228:231], v[52:55], v[100:103]
v_exp_f32 v155, v155
v_mfma_f32_16x16x32_bf16 v[100:103], a[224:227], v[36:39], v[100:103]
ds_read_b64_tr_b16 v[164:165], v247 offset:25696
v_add_f32 v230, v230, v155
v_mfma_f32_16x16x32_bf16 v[100:103], a[220:223], v[20:23], v[100:103]
s_add_u32 m0, s55, 106496
ds_read_b64_tr_b16 v[166:167], v247 offset:26976
v_cvt_pk_bf16_f32 v153, v154, v155
v_mfma_f32_16x16x32_bf16 v[100:103], a[216:219], v[4:7], v[100:103]
s_waitcnt lgkmcnt(9)
buffer_load_dwordx4 v246, s[32:35], s61 offen lds
v_mfma_f32_16x16x32_bf16 a[244:247], v[168:171], v[176:179], a[244:247]
s_waitcnt lgkmcnt(7)
v_exp_f32 v96, v96
v_mfma_f32_16x16x32_bf16 a[244:247], v[172:175], v[180:183], a[244:247]
v_exp_f32 v97, v97
v_mfma_f32_16x16x32_bf16 v[208:211], v[172:175], v[188:191], v[208:211]
ds_read_b64_tr_b16 v[172:173], v234 offset:36992
v_cvt_pk_bf16_f32 v146, v96, v97
v_mfma_f32_16x16x32_bf16 v[208:211], v[168:171], v[184:187], v[208:211]
v_exp_f32 v98, v98
v_mfma_f32_16x16x32_bf16 v[104:107], a[216:219], v[8:11], 0
ds_read_b64_tr_b16 v[168:169], v234 offset:24704
v_add_f32 v228, v228, v98
v_mfma_f32_16x16x32_bf16 v[104:107], a[220:223], v[24:27], v[104:107]
v_exp_f32 v99, v99
v_mfma_f32_16x16x32_bf16 v[104:107], a[224:227], v[40:43], v[104:107]
ds_read_b64_tr_b16 v[170:171], v234 offset:30848
v_add_f32 v228, v228, v99
v_mfma_f32_16x16x32_bf16 v[104:107], a[228:231], v[56:59], v[104:107]
ds_read_b64_tr_b16 v[174:175], v234 offset:43136
v_cvt_pk_bf16_f32 v147, v98, v99
v_mfma_f32_16x16x32_bf16 v[104:107], a[232:235], v[72:75], v[104:107]
ds_read_b128 a[204:207], v249 offset:12416
v_add_f32 v228, v228, v96
v_mfma_f32_16x16x32_bf16 v[104:107], a[212:215], v[88:91], v[104:107]
ds_read_b128 a[208:211], v248 offset:12544
v_add_f32 v228, v228, v97
v_mfma_f32_16x16x32_bf16 v[108:111], a[212:215], v[92:95], 0
s_add_u32 m0, s53, 12288
v_exp_f32 v100, v100
v_mfma_f32_16x16x32_bf16 v[108:111], a[232:235], v[76:79], v[108:111]
s_add_u32 s60, s60, 12288
v_exp_f32 v101, v101
v_mfma_f32_16x16x32_bf16 v[108:111], a[228:231], v[60:63], v[108:111]
L_walk1_10:
s_cbranch_execz L_ret1
buffer_load_dwordx4 v239, s[24:27], s60 offen lds
v_mfma_f32_16x16x32_bf16 v[108:111], a[224:227], v[44:47], v[108:111]
ds_read_b128 a[212:215], v249 offset:12544
v_cvt_pk_bf16_f32 v150, v100, v101
v_mfma_f32_16x16x32_bf16 v[108:111], a[220:223], v[28:31], v[108:111]
v_exp_f32 v102, v102
v_mfma_f32_16x16x32_bf16 v[108:111], a[216:219], v[12:15], v[108:111]
s_waitcnt lgkmcnt(9)
ds_read_b128 a[216:219], v248 offset:18432
v_add_f32 v229, v229, v102
v_mfma_f32_16x16x32_bf16 a[248:251], v[160:163], v[176:179], a[248:251]
s_waitcnt lgkmcnt(8)
buffer_load_dwordx4 v240, s[24:27], s60 offen offset:1024 lds
v_mfma_f32_16x16x32_bf16 a[248:251], v[164:167], v[180:183], a[248:251]
v_exp_f32 v103, v103
v_mfma_f32_16x16x32_bf16 v[212:215], v[164:167], v[188:191], v[212:215]
ds_read_b64_tr_b16 v[164:165], v235 offset:36992
v_add_f32 v229, v229, v103
v_mfma_f32_16x16x32_bf16 v[212:215], v[160:163], v[184:187], v[212:215]
s_waitcnt lgkmcnt(6)
ds_read_b64_tr_b16 v[160:161], v235 offset:24704
v_cvt_pk_bf16_f32 v151, v102, v103
v_mfma_f32_16x16x32_bf16 a[96:99], v[168:171], v[112:115], a[96:99]
s_waitcnt lgkmcnt(6)
ds_read_b64_tr_b16 v[162:163], v235 offset:30848
v_add_f32 v229, v229, v100
v_mfma_f32_16x16x32_bf16 a[96:99], v[172:175], v[128:131], a[96:99]
ds_read_b64_tr_b16 v[166:167], v235 offset:43136
v_add_f32 v229, v229, v101
v_mfma_f32_16x16x32_bf16 a[100:103], v[172:175], v[132:135], a[100:103]
buffer_load_dwordx4 v241, s[24:27], s60 offen offset:2048 lds
v_mfma_f32_16x16x32_bf16 a[100:103], v[168:171], v[116:119], a[100:103]
v_exp_f32 v104, v104
v_mfma_f32_16x16x32_bf16 a[104:107], v[168:171], v[120:123], a[104:107]
v_exp_f32 v105, v105
v_mfma_f32_16x16x32_bf16 a[104:107], v[172:175], v[136:139], a[104:107]
ds_read_b128 a[220:223], v249 offset:18432
v_cvt_pk_bf16_f32 v154, v104, v105
v_mfma_f32_16x16x32_bf16 a[108:111], v[172:175], v[140:143], a[108:111]
v_exp_f32 v106, v106
v_mfma_f32_16x16x32_bf16 a[108:111], v[168:171], v[124:127], a[108:111]
s_waitcnt lgkmcnt(2)
ds_read_b64_tr_b16 v[168:169], v232 offset:24832
v_add_f32 v230, v230, v106
v_mfma_f32_16x16x32_bf16 a[124:127], v[160:163], v[124:127], a[124:127]
s_waitcnt lgkmcnt(2)
ds_read_b64_tr_b16 v[170:171], v232 offset:30976
v_mfma_f32_16x16x32_bf16 a[124:127], v[164:167], v[140:143], a[124:127]
s_add_u32 m0, s53, 86016
ds_read_b64_tr_b16 v[172:173], v232 offset:37120
v_mfma_f32_16x16x32_bf16 a[120:123], v[164:167], v[136:139], a[120:123]
s_add_u32 s59, s59, 12288
ds_read_b64_tr_b16 v[174:175], v232 offset:43264
v_mfma_f32_16x16x32_bf16 a[120:123], v[160:163], v[120:123], a[120:123]
buffer_load_dwordx4 v236, s[20:23], s59 offen lds
v_mfma_f32_16x16x32_bf16 a[116:119], v[160:163], v[116:119], a[116:119]
v_exp_f32 v107, v107
v_mfma_f32_16x16x32_bf16 a[116:119], v[164:167], v[132:135], a[116:119]
ds_read_b128 a[224:227], v248 offset:18560
v_add_f32 v230, v230, v107
v_mfma_f32_16x16x32_bf16 a[112:115], v[164:167], v[128:131], a[112:115]
ds_read_b64_tr_b16 v[164:165], v247 offset:25728
v_cvt_pk_bf16_f32 v155, v106, v107
v_mfma_f32_16x16x32_bf16 a[112:115], v[160:163], v[112:115], a[112:115]
s_waitcnt lgkmcnt(4)
ds_read_b64_tr_b16 v[160:161], v247 offset:20608
v_add_f32 v230, v230, v104
v_mfma_f32_16x16x32_bf16 a[128:131], v[168:171], v[112:115], a[128:131]
s_waitcnt lgkmcnt(3)
ds_read_b64_tr_b16 v[162:163], v247 offset:21888
v_add_f32 v230, v230, v105
v_mfma_f32_16x16x32_bf16 a[128:131], v[172:175], v[128:131], a[128:131]
ds_read_b64_tr_b16 v[166:167], v247 offset:27008
v_mfma_f32_16x16x32_bf16 a[132:135], v[172:175], v[132:135], a[132:135]
buffer_load_dwordx4 v237, s[20:23], s59 offen offset:1024 lds
v_mfma_f32_16x16x32_bf16 a[132:135], v[168:171], v[116:119], a[132:135]
v_exp_f32 v156, v156
v_mfma_f32_16x16x32_bf16 a[136:139], v[168:171], v[120:123], a[136:139]
ds_read_b128 a[228:231], v249 offset:18560
v_add_f32 v231, v231, v156
v_mfma_f32_16x16x32_bf16 a[136:139], v[172:175], v[136:139], a[136:139]
v_exp_f32 v157, v157
v_mfma_f32_16x16x32_bf16 a[140:143], v[172:175], v[140:143], a[140:143]
ds_read_b64_tr_b16 v[172:173], v233 offset:37120
ds_read_b64_tr_b16 v[174:175], v233 offset:43264
v_mfma_f32_16x16x32_bf16 a[140:143], v[168:171], v[124:127], a[140:143]
s_waitcnt lgkmcnt(4)
ds_read_b64_tr_b16 v[168:169], v233 offset:24832
ds_read_b64_tr_b16 v[170:171], v233 offset:30976
v_mfma_f32_16x16x32_bf16 a[252:255], v[160:163], v[176:179], a[252:255]
s_waitcnt lgkmcnt(5)
buffer_load_dwordx4 v238, s[20:23], s59 offen offset:2048 lds
v_mfma_f32_16x16x32_bf16 a[252:255], v[164:167], v[180:183], a[252:255]
ds_read_b128 a[232:235], v248 offset:18688
v_add_f32 v231, v231, v157
v_mfma_f32_16x16x32_bf16 v[224:227], v[164:167], v[188:191], v[224:227]
ds_read_b64_tr_b16 v[164:165], v234 offset:37120
v_cvt_pk_bf16_f32 v156, v156, v157
v_mfma_f32_16x16x32_bf16 v[224:227], v[160:163], v[184:187], v[224:227]
s_waitcnt lgkmcnt(2)
v_exp_f32 v158, v158
v_mfma_f32_16x16x32_bf16 a[156:159], v[168:171], v[124:127], a[156:159]
s_add_u32 s91, s91, 262144
ds_read_b64_tr_b16 v[160:161], v234 offset:24832
v_add_f32 v231, v231, v158
v_mfma_f32_16x16x32_bf16 a[156:159], v[172:175], v[140:143], a[156:159]
s_and_b32 s3, s1, 1074003967
ds_read_b64_tr_b16 v[162:163], v234 offset:30976
v_mfma_f32_16x16x32_bf16 a[152:155], v[172:175], v[136:139], a[152:155]
s_add_u32 s3, s3, s91
ds_read_b64_tr_b16 v[166:167], v234 offset:43264
v_mfma_f32_16x16x32_bf16 a[152:155], v[168:171], v[120:123], a[152:155]
buffer_load_dword v254, v253, s[28:31], s3 offen
v_mfma_f32_16x16x32_bf16 a[148:151], v[168:171], v[116:119], a[148:151]
v_exp_f32 v159, v159
v_mfma_f32_16x16x32_bf16 a[148:151], v[172:175], v[132:135], a[148:151]
v_exp_f32 v108, v108
v_mfma_f32_16x16x32_bf16 a[144:147], v[172:175], v[128:131], a[144:147]
s_xor_b32 s3, s76, 786432
ds_read_b64_tr_b16 v[172:173], v235 offset:37120
v_add_f32 v231, v231, v159
v_mfma_f32_16x16x32_bf16 a[144:147], v[168:171], v[112:115], a[144:147]
s_waitcnt lgkmcnt(2)
buffer_store_dwordx4 v[250:253], v250, s[4:7], s3 offen offset:3072 sc1
v_mfma_f32_16x16x32_bf16 a[160:163], v[160:163], v[112:115], a[160:163]
s_waitcnt lgkmcnt(1)
ds_read_b64_tr_b16 v[168:169], v235 offset:24832
v_cvt_pk_bf16_f32 v157, v158, v159
v_mfma_f32_16x16x32_bf16 a[160:163], v[164:167], v[128:131], a[160:163]
ds_read_b64_tr_b16 v[170:171], v235 offset:30976
v_mfma_f32_16x16x32_bf16 a[164:167], v[164:167], v[132:135], a[164:167]
ds_read_b64_tr_b16 v[174:175], v235 offset:43264
v_mfma_f32_16x16x32_bf16 a[164:167], v[160:163], v[116:119], a[164:167]
v_exp_f32 v109, v109
v_mfma_f32_16x16x32_bf16 a[168:171], v[160:163], v[120:123], a[168:171]
v_exp_f32 v110, v110
v_mfma_f32_16x16x32_bf16 a[168:171], v[164:167], v[136:139], a[168:171]
v_exp_f32 v111, v111
v_mfma_f32_16x16x32_bf16 a[172:175], v[164:167], v[140:143], a[172:175]
v_add_f32 v231, v231, v110
v_add_f32 v231, v231, v111
v_mfma_f32_16x16x32_bf16 a[172:175], v[160:163], v[124:127], a[172:175]
s_waitcnt lgkmcnt(1)
v_cvt_pk_bf16_f32 v159, v110, v111
v_add_f32 v231, v231, v108
v_mfma_f32_16x16x32_bf16 a[188:191], v[168:171], v[124:127], a[188:191]
s_waitcnt lgkmcnt(0)
v_add_f32 v231, v231, v109
v_cvt_pk_bf16_f32 v158, v108, v109
v_mfma_f32_16x16x32_bf16 a[188:191], v[172:175], v[140:143], a[188:191]
v_mfma_f32_16x16x32_bf16 a[184:187], v[172:175], v[136:139], a[184:187]
v_mfma_f32_16x16x32_bf16 a[184:187], v[168:171], v[120:123], a[184:187]
v_mfma_f32_16x16x32_bf16 a[180:183], v[168:171], v[116:119], a[180:183]
v_mfma_f32_16x16x32_bf16 a[180:183], v[172:175], v[132:135], a[180:183]
v_mfma_f32_16x16x32_bf16 a[176:179], v[172:175], v[128:131], a[176:179]
v_mfma_f32_16x16x32_bf16 a[176:179], v[168:171], v[112:115], a[176:179]
s_add_u32 s65, s65, s81
v_mfma_f32_16x16x32_bf16 v[112:115], a[192:195], v[0:3], 0
s_waitcnt vmcnt(19)
s_barrier
v_mfma_f32_16x16x32_bf16 v[112:115], a[196:199], v[16:19], v[112:115]
s_add_u32 s90, s65, 0
ds_read_b64_tr_b16 v[160:161], v247 offset:40960
v_mfma_f32_16x16x32_bf16 v[112:115], a[200:203], v[32:35], v[112:115]
buffer_load_dwordx4 v[176:179], v250, s[4:7], s90 offen sc1
v_mfma_f32_16x16x32_bf16 v[112:115], a[204:207], v[48:51], v[112:115]
ds_read_b64_tr_b16 v[162:163], v247 offset:42240
v_mfma_f32_16x16x32_bf16 v[112:115], a[208:211], v[64:67], v[112:115]
ds_read_b64_tr_b16 v[164:165], v247 offset:46080
v_mfma_f32_16x16x32_bf16 v[112:115], a[212:215], v[80:83], v[112:115]
s_add_u32 s90, s65, 4096
ds_read_b64_tr_b16 v[166:167], v247 offset:47360
v_mfma_f32_16x16x32_bf16 v[116:119], a[212:215], v[84:87], 0
buffer_load_dwordx4 v[180:183], v250, s[4:7], s90 offen sc1
v_mfma_f32_16x16x32_bf16 v[116:119], a[208:211], v[68:71], v[116:119]
ds_read_b64_tr_b16 v[168:169], v247 offset:40992
v_mfma_f32_16x16x32_bf16 v[116:119], a[204:207], v[52:55], v[116:119]
ds_read_b64_tr_b16 v[170:171], v247 offset:42272
v_mfma_f32_16x16x32_bf16 v[116:119], a[200:203], v[36:39], v[116:119]
s_add_u32 s66, s66, s81
v_exp_f32 v112, v112
v_mfma_f32_16x16x32_bf16 v[116:119], a[196:199], v[20:23], v[116:119]
s_add_u32 s90, s66, 0
ds_read_b64_tr_b16 v[172:173], v247 offset:46112
v_add_f32 v228, v228, v112
v_mfma_f32_16x16x32_bf16 v[116:119], a[192:195], v[4:7], v[116:119]
s_waitcnt vmcnt(18) lgkmcnt(5)
buffer_load_dwordx4 v[184:187], v250, s[4:7], s90 offen sc1
v_mfma_f32_16x16x32_bf16 a[236:239], v[160:163], v[192:195], a[236:239]
s_waitcnt vmcnt(18) lgkmcnt(3)
v_exp_f32 v113, v113
v_mfma_f32_16x16x32_bf16 a[236:239], v[164:167], v[196:199], a[236:239]
s_waitcnt vmcnt(16)
ds_read_b64_tr_b16 v[174:175], v247 offset:47392
v_add_f32 v228, v228, v113
v_mfma_f32_16x16x32_bf16 v[216:219], v[164:167], v[204:207], v[216:219]
s_add_u32 s90, s66, 4096
v_exp_f32 v114, v114
v_mfma_f32_16x16x32_bf16 v[216:219], v[160:163], v[200:203], v[216:219]
buffer_load_dwordx4 v[188:191], v250, s[4:7], s90 offen sc1
v_mfma_f32_16x16x32_bf16 v[120:123], a[192:195], v[8:11], 0
v_exp_f32 v115, v115
v_mfma_f32_16x16x32_bf16 v[120:123], a[196:199], v[24:27], v[120:123]
v_cvt_pk_bf16_f32 v112, v112, v113
v_add_f32 v228, v228, v114
v_mfma_f32_16x16x32_bf16 v[120:123], a[200:203], v[40:43], v[120:123]
v_add_f32 v228, v228, v115
v_cvt_pk_bf16_f32 v113, v114, v115
v_mfma_f32_16x16x32_bf16 v[120:123], a[204:207], v[56:59], v[120:123]
v_exp_f32 v116, v116
v_mfma_f32_16x16x32_bf16 v[120:123], a[208:211], v[72:75], v[120:123]
ds_read_b64_tr_b16 v[160:161], v247 offset:41024
v_add_f32 v229, v229, v116
v_mfma_f32_16x16x32_bf16 v[120:123], a[212:215], v[88:91], v[120:123]
v_exp_f32 v117, v117
v_mfma_f32_16x16x32_bf16 v[124:127], a[212:215], v[92:95], 0
ds_read_b128 a[212:215], v249 offset:18688
v_add_f32 v229, v229, v117
v_mfma_f32_16x16x32_bf16 v[124:127], a[208:211], v[76:79], v[124:127]
ds_read_b64_tr_b16 v[162:163], v247 offset:42304
v_cvt_pk_bf16_f32 v116, v116, v117
v_mfma_f32_16x16x32_bf16 v[124:127], a[204:207], v[60:63], v[124:127]
s_add_u32 m0, s55, 122880
v_exp_f32 v118, v118
v_mfma_f32_16x16x32_bf16 v[124:127], a[200:203], v[44:47], v[124:127]
s_add_u32 s61, s61, 163840
ds_read_b64_tr_b16 v[164:165], v247 offset:46144
v_add_f32 v229, v229, v118
v_mfma_f32_16x16x32_bf16 v[124:127], a[196:199], v[28:31], v[124:127]
buffer_load_dwordx4 v242, s[32:35], s61 offen lds
v_mfma_f32_16x16x32_bf16 v[124:127], a[192:195], v[12:15], v[124:127]
s_waitcnt lgkmcnt(6)
v_exp_f32 v119, v119
v_mfma_f32_16x16x32_bf16 a[240:243], v[168:171], v[192:195], a[240:243]
s_waitcnt lgkmcnt(4)
ds_read_b64_tr_b16 v[166:167], v247 offset:47424
v_add_f32 v229, v229, v119
v_mfma_f32_16x16x32_bf16 a[240:243], v[172:175], v[196:199], a[240:243]
ds_read_b128 a[192:195], v248 offset:24576
v_cvt_pk_bf16_f32 v117, v118, v119
v_mfma_f32_16x16x32_bf16 v[220:223], v[172:175], v[204:207], v[220:223]
buffer_load_dwordx4 v243, s[32:35], s61 offen offset:1024 lds
v_mfma_f32_16x16x32_bf16 v[220:223], v[168:171], v[200:203], v[220:223]
v_exp_f32 v120, v120
v_mfma_f32_16x16x32_bf16 v[96:99], a[216:219], v[0:3], 0
ds_read_b128 a[196:199], v249 offset:24576
v_add_f32 v230, v230, v120
v_mfma_f32_16x16x32_bf16 v[96:99], a[220:223], v[16:19], v[96:99]
v_exp_f32 v121, v121
v_mfma_f32_16x16x32_bf16 v[96:99], a[224:227], v[32:35], v[96:99]
buffer_load_dwordx4 v244, s[32:35], s61 offen offset:2048 lds
v_mfma_f32_16x16x32_bf16 v[96:99], a[228:231], v[48:51], v[96:99]
ds_read_b128 a[200:203], v248 offset:24704
v_add_f32 v230, v230, v121
v_mfma_f32_16x16x32_bf16 v[96:99], a[232:235], v[64:67], v[96:99]
s_waitcnt lgkmcnt(6)
ds_read_b64_tr_b16 v[168:169], v247 offset:41056
v_cvt_pk_bf16_f32 v120, v120, v121
v_mfma_f32_16x16x32_bf16 v[96:99], a[212:215], v[80:83], v[96:99]
v_exp_f32 v122, v122
v_mfma_f32_16x16x32_bf16 v[100:103], a[212:215], v[84:87], 0
ds_read_b64_tr_b16 v[170:171], v247 offset:42336
v_add_f32 v230, v230, v122
v_mfma_f32_16x16x32_bf16 v[100:103], a[232:235], v[68:71], v[100:103]
buffer_load_dwordx4 v245, s[32:35], s61 offen offset:3072 lds
v_mfma_f32_16x16x32_bf16 v[100:103], a[228:231], v[52:55], v[100:103]
v_exp_f32 v123, v123
v_mfma_f32_16x16x32_bf16 v[100:103], a[224:227], v[36:39], v[100:103]
ds_read_b64_tr_b16 v[172:173], v247 offset:46176
v_add_f32 v230, v230, v123
v_mfma_f32_16x16x32_bf16 v[100:103], a[220:223], v[20:23], v[100:103]
s_add_u32 m0, s55, 126976
ds_read_b64_tr_b16 v[174:175], v247 offset:47456
v_cvt_pk_bf16_f32 v121, v122, v123
v_mfma_f32_16x16x32_bf16 v[100:103], a[216:219], v[4:7], v[100:103]
s_waitcnt lgkmcnt(9)
buffer_load_dwordx4 v246, s[32:35], s61 offen lds
v_mfma_f32_16x16x32_bf16 a[244:247], v[160:163], v[192:195], a[244:247]
s_waitcnt lgkmcnt(7)
v_exp_f32 v96, v96
v_mfma_f32_16x16x32_bf16 a[244:247], v[164:167], v[196:199], a[244:247]
v_exp_f32 v97, v97
v_mfma_f32_16x16x32_bf16 v[208:211], v[164:167], v[204:207], v[208:211]
ds_read_b64_tr_b16 v[164:165], v232 offset:0
v_cvt_pk_bf16_f32 v114, v96, v97
v_mfma_f32_16x16x32_bf16 v[208:211], v[160:163], v[200:203], v[208:211]
v_exp_f32 v98, v98
v_mfma_f32_16x16x32_bf16 v[104:107], a[216:219], v[8:11], 0
ds_read_b64_tr_b16 v[160:161], v232 offset:36864
v_add_f32 v228, v228, v98
v_mfma_f32_16x16x32_bf16 v[104:107], a[220:223], v[24:27], v[104:107]
v_exp_f32 v99, v99
v_mfma_f32_16x16x32_bf16 v[104:107], a[224:227], v[40:43], v[104:107]
ds_read_b64_tr_b16 v[162:163], v232 offset:43008
v_add_f32 v228, v228, v99
v_mfma_f32_16x16x32_bf16 v[104:107], a[228:231], v[56:59], v[104:107]
ds_read_b64_tr_b16 v[166:167], v232 offset:6144
v_cvt_pk_bf16_f32 v115, v98, v99
v_mfma_f32_16x16x32_bf16 v[104:107], a[232:235], v[72:75], v[104:107]
ds_read_b128 a[204:207], v249 offset:24704
v_add_f32 v228, v228, v96
v_mfma_f32_16x16x32_bf16 v[104:107], a[212:215], v[88:91], v[104:107]
ds_read_b128 a[208:211], v248 offset:24832
v_add_f32 v228, v228, v97
v_mfma_f32_16x16x32_bf16 v[108:111], a[212:215], v[92:95], 0
s_add_u32 m0, s53, 24576
v_exp_f32 v100, v100
v_mfma_f32_16x16x32_bf16 v[108:111], a[232:235], v[76:79], v[108:111]
s_add_u32 s60, s60, 12288
v_exp_f32 v101, v101
v_mfma_f32_16x16x32_bf16 v[108:111], a[228:231], v[60:63], v[108:111]
buffer_load_dwordx4 v239, s[24:27], s60 offen lds
v_mfma_f32_16x16x32_bf16 v[108:111], a[224:227], v[44:47], v[108:111]
ds_read_b128 a[212:215], v249 offset:24832
v_cvt_pk_bf16_f32 v118, v100, v101
v_mfma_f32_16x16x32_bf16 v[108:111], a[220:223], v[28:31], v[108:111]
v_exp_f32 v102, v102
v_mfma_f32_16x16x32_bf16 v[108:111], a[216:219], v[12:15], v[108:111]
s_waitcnt lgkmcnt(9)
ds_read_b128 a[216:219], v248 offset:30720
v_add_f32 v229, v229, v102
v_mfma_f32_16x16x32_bf16 a[248:251], v[168:171], v[192:195], a[248:251]
s_waitcnt lgkmcnt(8)
buffer_load_dwordx4 v240, s[24:27], s60 offen offset:1024 lds
v_mfma_f32_16x16x32_bf16 a[248:251], v[172:175], v[196:199], a[248:251]
v_exp_f32 v103, v103
v_mfma_f32_16x16x32_bf16 v[212:215], v[172:175], v[204:207], v[212:215]
ds_read_b64_tr_b16 v[172:173], v233 offset:0
v_add_f32 v229, v229, v103
v_mfma_f32_16x16x32_bf16 v[212:215], v[168:171], v[200:203], v[212:215]
s_waitcnt lgkmcnt(6)
ds_read_b64_tr_b16 v[168:169], v233 offset:36864
v_cvt_pk_bf16_f32 v119, v102, v103
v_mfma_f32_16x16x32_bf16 a[0:3], v[160:163], v[128:131], a[0:3]
s_waitcnt lgkmcnt(6)
ds_read_b64_tr_b16 v[170:171], v233 offset:43008
v_add_f32 v229, v229, v100
v_mfma_f32_16x16x32_bf16 a[0:3], v[164:167], v[144:147], a[0:3]
ds_read_b64_tr_b16 v[174:175], v233 offset:6144
v_add_f32 v229, v229, v101
v_mfma_f32_16x16x32_bf16 a[4:7], v[164:167], v[148:151], a[4:7]
buffer_load_dwordx4 v241, s[24:27], s60 offen offset:2048 lds
v_mfma_f32_16x16x32_bf16 a[4:7], v[160:163], v[132:135], a[4:7]
v_exp_f32 v104, v104
v_mfma_f32_16x16x32_bf16 a[8:11], v[160:163], v[136:139], a[8:11]
v_exp_f32 v105, v105
v_mfma_f32_16x16x32_bf16 a[8:11], v[164:167], v[152:155], a[8:11]
ds_read_b128 a[220:223], v249 offset:30720
v_cvt_pk_bf16_f32 v122, v104, v105
v_mfma_f32_16x16x32_bf16 a[12:15], v[164:167], v[156:159], a[12:15]
v_exp_f32 v106, v106
v_mfma_f32_16x16x32_bf16 a[12:15], v[160:163], v[140:143], a[12:15]
s_waitcnt lgkmcnt(2)
ds_read_b64_tr_b16 v[160:161], v234 offset:36864
v_add_f32 v230, v230, v106
v_mfma_f32_16x16x32_bf16 a[28:31], v[168:171], v[140:143], a[28:31]
s_waitcnt lgkmcnt(2)
ds_read_b64_tr_b16 v[162:163], v234 offset:43008
v_mfma_f32_16x16x32_bf16 a[28:31], v[172:175], v[156:159], a[28:31]
s_add_u32 m0, s53, 49152
ds_read_b64_tr_b16 v[164:165], v234 offset:0
v_mfma_f32_16x16x32_bf16 a[24:27], v[172:175], v[152:155], a[24:27]
s_add_u32 s59, s59, 12288
ds_read_b64_tr_b16 v[166:167], v234 offset:6144
v_mfma_f32_16x16x32_bf16 a[24:27], v[168:171], v[136:139], a[24:27]
buffer_load_dwordx4 v236, s[20:23], s59 offen lds
v_mfma_f32_16x16x32_bf16 a[20:23], v[168:171], v[132:135], a[20:23]
v_exp_f32 v107, v107
v_mfma_f32_16x16x32_bf16 a[20:23], v[172:175], v[148:151], a[20:23]
ds_read_b128 a[224:227], v248 offset:30848
v_add_f32 v230, v230, v107
v_mfma_f32_16x16x32_bf16 a[16:19], v[172:175], v[144:147], a[16:19]
ds_read_b64_tr_b16 v[172:173], v247 offset:46208
v_cvt_pk_bf16_f32 v123, v106, v107
v_mfma_f32_16x16x32_bf16 a[16:19], v[168:171], v[128:131], a[16:19]
s_waitcnt lgkmcnt(4)
ds_read_b64_tr_b16 v[168:169], v247 offset:41088
v_add_f32 v230, v230, v104
v_mfma_f32_16x16x32_bf16 a[32:35], v[160:163], v[128:131], a[32:35]
s_waitcnt lgkmcnt(3)
ds_read_b64_tr_b16 v[170:171], v247 offset:42368
v_add_f32 v230, v230, v105
v_mfma_f32_16x16x32_bf16 a[32:35], v[164:167], v[144:147], a[32:35]
ds_read_b64_tr_b16 v[174:175], v247 offset:47488
v_mfma_f32_16x16x32_bf16 a[36:39], v[164:167], v[148:151], a[36:39]
buffer_load_dwordx4 v237, s[20:23], s59 offen offset:1024 lds
v_mfma_f32_16x16x32_bf16 a[36:39], v[160:163], v[132:135], a[36:39]
v_exp_f32 v124, v124
v_mfma_f32_16x16x32_bf16 a[40:43], v[160:163], v[136:139], a[40:43]
ds_read_b128 a[228:231], v249 offset:30848
v_add_f32 v231, v231, v124
v_mfma_f32_16x16x32_bf16 a[40:43], v[164:167], v[152:155], a[40:43]
v_exp_f32 v125, v125
v_mfma_f32_16x16x32_bf16 a[44:47], v[164:167], v[156:159], a[44:47]
ds_read_b64_tr_b16 v[164:165], v235 offset:0
ds_read_b64_tr_b16 v[166:167], v235 offset:6144
v_mfma_f32_16x16x32_bf16 a[44:47], v[160:163], v[140:143], a[44:47]
s_waitcnt lgkmcnt(4)
ds_read_b64_tr_b16 v[160:161], v235 offset:36864
ds_read_b64_tr_b16 v[162:163], v235 offset:43008
v_mfma_f32_16x16x32_bf16 a[252:255], v[168:171], v[192:195], a[252:255]
s_waitcnt lgkmcnt(5)
buffer_load_dwordx4 v238, s[20:23], s59 offen offset:2048 lds
v_mfma_f32_16x16x32_bf16 a[252:255], v[172:175], v[196:199], a[252:255]
ds_read_b128 a[232:235], v248 offset:30976
v_add_f32 v231, v231, v125
v_mfma_f32_16x16x32_bf16 v[224:227], v[172:175], v[204:207], v[224:227]
ds_read_b64_tr_b16 v[172:173], v232 offset:128
v_cvt_pk_bf16_f32 v124, v124, v125
v_mfma_f32_16x16x32_bf16 v[224:227], v[168:171], v[200:203], v[224:227]
s_waitcnt lgkmcnt(2)
v_exp_f32 v126, v126
v_mfma_f32_16x16x32_bf16 a[60:63], v[160:163], v[140:143], a[60:63]
ds_read_b64_tr_b16 v[168:169], v232 offset:36992
v_add_f32 v231, v231, v126
v_mfma_f32_16x16x32_bf16 a[60:63], v[164:167], v[156:159], a[60:63]
ds_read_b64_tr_b16 v[170:171], v232 offset:43136
v_mfma_f32_16x16x32_bf16 a[56:59], v[164:167], v[152:155], a[56:59]
s_xor_b32 s3, s76, 1048576
ds_read_b64_tr_b16 v[174:175], v232 offset:6272
v_mfma_f32_16x16x32_bf16 a[56:59], v[160:163], v[136:139], a[56:59]
buffer_store_dwordx4 v[250:253], v250, s[4:7], s3 offen offset:1024 sc1
v_mfma_f32_16x16x32_bf16 a[52:55], v[160:163], v[132:135], a[52:55]
v_exp_f32 v127, v127
v_mfma_f32_16x16x32_bf16 a[52:55], v[164:167], v[148:151], a[52:55]
v_exp_f32 v108, v108
v_mfma_f32_16x16x32_bf16 a[48:51], v[164:167], v[144:147], a[48:51]
ds_read_b64_tr_b16 v[164:165], v233 offset:128
v_add_f32 v231, v231, v127
v_mfma_f32_16x16x32_bf16 a[48:51], v[160:163], v[128:131], a[48:51]
s_waitcnt lgkmcnt(2)
ds_read_b64_tr_b16 v[160:161], v233 offset:36992
v_cvt_pk_bf16_f32 v125, v126, v127
v_mfma_f32_16x16x32_bf16 a[64:67], v[168:171], v[128:131], a[64:67]
s_waitcnt lgkmcnt(2)
ds_read_b64_tr_b16 v[162:163], v233 offset:43136
v_mfma_f32_16x16x32_bf16 a[64:67], v[172:175], v[144:147], a[64:67]
ds_read_b64_tr_b16 v[166:167], v233 offset:6272
v_mfma_f32_16x16x32_bf16 a[68:71], v[172:175], v[148:151], a[68:71]
v_exp_f32 v109, v109
v_mfma_f32_16x16x32_bf16 a[68:71], v[168:171], v[132:135], a[68:71]
v_exp_f32 v110, v110
v_mfma_f32_16x16x32_bf16 a[72:75], v[168:171], v[136:139], a[72:75]
v_exp_f32 v111, v111
v_mfma_f32_16x16x32_bf16 a[72:75], v[172:175], v[152:155], a[72:75]
v_add_f32 v231, v231, v110
v_add_f32 v231, v231, v111
v_mfma_f32_16x16x32_bf16 a[76:79], v[172:175], v[156:159], a[76:79]
v_cvt_pk_bf16_f32 v127, v110, v111
v_add_f32 v231, v231, v108
v_mfma_f32_16x16x32_bf16 a[76:79], v[168:171], v[140:143], a[76:79]
s_waitcnt lgkmcnt(1)
v_add_f32 v231, v231, v109
v_cvt_pk_bf16_f32 v126, v108, v109
v_mfma_f32_16x16x32_bf16 a[92:95], v[160:163], v[140:143], a[92:95]
s_waitcnt lgkmcnt(0)
v_mfma_f32_16x16x32_bf16 a[92:95], v[164:167], v[156:159], a[92:95]
v_mfma_f32_16x16x32_bf16 a[88:91], v[164:167], v[152:155], a[88:91]
v_mfma_f32_16x16x32_bf16 a[88:91], v[160:163], v[136:139], a[88:91]
v_mfma_f32_16x16x32_bf16 a[84:87], v[160:163], v[132:135], a[84:87]
v_mfma_f32_16x16x32_bf16 a[84:87], v[164:167], v[148:151], a[84:87]
v_mfma_f32_16x16x32_bf16 a[80:83], v[164:167], v[144:147], a[80:83]
v_mfma_f32_16x16x32_bf16 a[80:83], v[160:163], v[128:131], a[80:83]
s_mov_b64 exec, 0
s_cmp_eq_u32 s48, 0
s_cbranch_scc1 L_walk2_0
s_cmp_eq_u32 s48, 1
s_cbranch_scc1 L_walk2_1
s_cmp_eq_u32 s48, 2
s_cbranch_scc1 L_walk2_2
s_branch L_walk2_3
L_ret2:
s_mov_b64 exec, -1
v_mfma_f32_16x16x32_bf16 v[128:131], a[192:195], v[0:3], 0
s_waitcnt vmcnt(18)
s_barrier
v_mfma_f32_16x16x32_bf16 v[128:131], a[196:199], v[16:19], v[128:131]
s_add_u32 s90, s65, 16384
ds_read_b64_tr_b16 v[168:169], v247 offset:0
v_mfma_f32_16x16x32_bf16 v[128:131], a[200:203], v[32:35], v[128:131]
buffer_load_dwordx4 v[192:195], v250, s[4:7], s90 offen sc1
v_mfma_f32_16x16x32_bf16 v[128:131], a[204:207], v[48:51], v[128:131]
ds_read_b64_tr_b16 v[170:171], v247 offset:1280
v_mfma_f32_16x16x32_bf16 v[128:131], a[208:211], v[64:67], v[128:131]
ds_read_b64_tr_b16 v[172:173], v247 offset:5120
v_mfma_f32_16x16x32_bf16 v[128:131], a[212:215], v[80:83], v[128:131]
s_add_u32 s90, s65, 20480
ds_read_b64_tr_b16 v[174:175], v247 offset:6400
v_mfma_f32_16x16x32_bf16 v[132:135], a[212:215], v[84:87], 0
buffer_load_dwordx4 v[196:199], v250, s[4:7], s90 offen sc1
v_mfma_f32_16x16x32_bf16 v[132:135], a[208:211], v[68:71], v[132:135]
ds_read_b64_tr_b16 v[160:161], v247 offset:32
v_mfma_f32_16x16x32_bf16 v[132:135], a[204:207], v[52:55], v[132:135]
ds_read_b64_tr_b16 v[162:163], v247 offset:1312
v_mfma_f32_16x16x32_bf16 v[132:135], a[200:203], v[36:39], v[132:135]
v_exp_f32 v128, v128
v_mfma_f32_16x16x32_bf16 v[132:135], a[196:199], v[20:23], v[132:135]
s_add_u32 s90, s66, 16384
ds_read_b64_tr_b16 v[164:165], v247 offset:5152
v_add_f32 v228, v228, v128
v_mfma_f32_16x16x32_bf16 v[132:135], a[192:195], v[4:7], v[132:135]
s_waitcnt vmcnt(17) lgkmcnt(5)
buffer_load_dwordx4 v[200:203], v250, s[4:7], s90 offen sc1
v_mfma_f32_16x16x32_bf16 a[236:239], v[168:171], v[176:179], a[236:239]
s_waitcnt vmcnt(17) lgkmcnt(3)
v_exp_f32 v129, v129
v_mfma_f32_16x16x32_bf16 a[236:239], v[172:175], v[180:183], a[236:239]
s_waitcnt vmcnt(15)
ds_read_b64_tr_b16 v[166:167], v247 offset:6432
v_add_f32 v228, v228, v129
v_mfma_f32_16x16x32_bf16 v[216:219], v[172:175], v[188:191], v[216:219]
s_add_u32 s90, s66, 20480
v_exp_f32 v130, v130
v_mfma_f32_16x16x32_bf16 v[216:219], v[168:171], v[184:187], v[216:219]
buffer_load_dwordx4 v[204:207], v250, s[4:7], s90 offen sc1
v_mfma_f32_16x16x32_bf16 v[136:139], a[192:195], v[8:11], 0
v_exp_f32 v131, v131
v_mfma_f32_16x16x32_bf16 v[136:139], a[196:199], v[24:27], v[136:139]
v_cvt_pk_bf16_f32 v128, v128, v129
v_add_f32 v228, v228, v130
v_mfma_f32_16x16x32_bf16 v[136:139], a[200:203], v[40:43], v[136:139]
v_add_f32 v228, v228, v131
v_cvt_pk_bf16_f32 v129, v130, v131
v_mfma_f32_16x16x32_bf16 v[136:139], a[204:207], v[56:59], v[136:139]
v_exp_f32 v132, v132
v_mfma_f32_16x16x32_bf16 v[136:139], a[208:211], v[72:75], v[136:139]
ds_read_b64_tr_b16 v[168:169], v247 offset:64
v_add_f32 v229, v229, v132
v_mfma_f32_16x16x32_bf16 v[136:139], a[212:215], v[88:91], v[136:139]
v_exp_f32 v133, v133
v_mfma_f32_16x16x32_bf16 v[140:143], a[212:215], v[92:95], 0
ds_read_b128 a[212:215], v249 offset:30976
v_add_f32 v229, v229, v133
v_mfma_f32_16x16x32_bf16 v[140:143], a[208:211], v[76:79], v[140:143]
ds_read_b64_tr_b16 v[170:171], v247 offset:1344
v_cvt_pk_bf16_f32 v132, v132, v133
v_mfma_f32_16x16x32_bf16 v[140:143], a[204:207], v[60:63], v[140:143]
s_add_u32 m0, s55, 143360
v_exp_f32 v134, v134
v_mfma_f32_16x16x32_bf16 v[140:143], a[200:203], v[44:47], v[140:143]
s_add_u32 s61, s61, 163840
ds_read_b64_tr_b16 v[172:173], v247 offset:5184
v_add_f32 v229, v229, v134
v_mfma_f32_16x16x32_bf16 v[140:143], a[196:199], v[28:31], v[140:143]
buffer_load_dwordx4 v242, s[32:35], s61 offen lds
v_mfma_f32_16x16x32_bf16 v[140:143], a[192:195], v[12:15], v[140:143]
s_waitcnt lgkmcnt(6)
v_exp_f32 v135, v135
v_mfma_f32_16x16x32_bf16 a[240:243], v[160:163], v[176:179], a[240:243]
s_waitcnt lgkmcnt(4)
ds_read_b64_tr_b16 v[174:175], v247 offset:6464
v_add_f32 v229, v229, v135
v_mfma_f32_16x16x32_bf16 a[240:243], v[164:167], v[180:183], a[240:243]
ds_read_b128 a[192:195], v248 offset:36864
v_cvt_pk_bf16_f32 v133, v134, v135
v_mfma_f32_16x16x32_bf16 v[220:223], v[164:167], v[188:191], v[220:223]
buffer_load_dwordx4 v243, s[32:35], s61 offen offset:1024 lds
v_mfma_f32_16x16x32_bf16 v[220:223], v[160:163], v[184:187], v[220:223]
v_exp_f32 v136, v136
v_mfma_f32_16x16x32_bf16 v[96:99], a[216:219], v[0:3], 0
ds_read_b128 a[196:199], v249 offset:36864
v_add_f32 v230, v230, v136
v_mfma_f32_16x16x32_bf16 v[96:99], a[220:223], v[16:19], v[96:99]
v_exp_f32 v137, v137
v_mfma_f32_16x16x32_bf16 v[96:99], a[224:227], v[32:35], v[96:99]
buffer_load_dwordx4 v244, s[32:35], s61 offen offset:2048 lds
v_mfma_f32_16x16x32_bf16 v[96:99], a[228:231], v[48:51], v[96:99]
ds_read_b128 a[200:203], v248 offset:36992
v_add_f32 v230, v230, v137
v_mfma_f32_16x16x32_bf16 v[96:99], a[232:235], v[64:67], v[96:99]
s_waitcnt lgkmcnt(6)
ds_read_b64_tr_b16 v[160:161], v247 offset:96
v_cvt_pk_bf16_f32 v136, v136, v137
v_mfma_f32_16x16x32_bf16 v[96:99], a[212:215], v[80:83], v[96:99]
v_exp_f32 v138, v138
v_mfma_f32_16x16x32_bf16 v[100:103], a[212:215], v[84:87], 0
ds_read_b64_tr_b16 v[162:163], v247 offset:1376
v_add_f32 v230, v230, v138
v_mfma_f32_16x16x32_bf16 v[100:103], a[232:235], v[68:71], v[100:103]
buffer_load_dwordx4 v245, s[32:35], s61 offen offset:3072 lds
v_mfma_f32_16x16x32_bf16 v[100:103], a[228:231], v[52:55], v[100:103]
v_exp_f32 v139, v139
v_mfma_f32_16x16x32_bf16 v[100:103], a[224:227], v[36:39], v[100:103]
ds_read_b64_tr_b16 v[164:165], v247 offset:5216
v_add_f32 v230, v230, v139
v_mfma_f32_16x16x32_bf16 v[100:103], a[220:223], v[20:23], v[100:103]
s_add_u32 m0, s55, 147456
ds_read_b64_tr_b16 v[166:167], v247 offset:6496
v_cvt_pk_bf16_f32 v137, v138, v139
v_mfma_f32_16x16x32_bf16 v[100:103], a[216:219], v[4:7], v[100:103]
s_waitcnt lgkmcnt(9)
buffer_load_dwordx4 v246, s[32:35], s61 offen lds
v_mfma_f32_16x16x32_bf16 a[244:247], v[168:171], v[176:179], a[244:247]
s_waitcnt lgkmcnt(7)
v_exp_f32 v96, v96
v_mfma_f32_16x16x32_bf16 a[244:247], v[172:175], v[180:183], a[244:247]
v_exp_f32 v97, v97
v_mfma_f32_16x16x32_bf16 v[208:211], v[172:175], v[188:191], v[208:211]
ds_read_b64_tr_b16 v[172:173], v234 offset:12416
v_cvt_pk_bf16_f32 v130, v96, v97
v_mfma_f32_16x16x32_bf16 v[208:211], v[168:171], v[184:187], v[208:211]
v_exp_f32 v98, v98
v_mfma_f32_16x16x32_bf16 v[104:107], a[216:219], v[8:11], 0
ds_read_b64_tr_b16 v[168:169], v234 offset:128
v_add_f32 v228, v228, v98
v_mfma_f32_16x16x32_bf16 v[104:107], a[220:223], v[24:27], v[104:107]
L_walk1_11:
s_cbranch_execz L_ret1
v_exp_f32 v99, v99
v_mfma_f32_16x16x32_bf16 v[104:107], a[224:227], v[40:43], v[104:107]
ds_read_b64_tr_b16 v[170:171], v234 offset:6272
v_add_f32 v228, v228, v99
v_mfma_f32_16x16x32_bf16 v[104:107], a[228:231], v[56:59], v[104:107]
ds_read_b64_tr_b16 v[174:175], v234 offset:18560
v_cvt_pk_bf16_f32 v131, v98, v99
v_mfma_f32_16x16x32_bf16 v[104:107], a[232:235], v[72:75], v[104:107]
ds_read_b128 a[204:207], v249 offset:36992
v_add_f32 v228, v228, v96
v_mfma_f32_16x16x32_bf16 v[104:107], a[212:215], v[88:91], v[104:107]
ds_read_b128 a[208:211], v248 offset:37120
v_add_f32 v228, v228, v97
v_mfma_f32_16x16x32_bf16 v[108:111], a[212:215], v[92:95], 0
s_add_u32 m0, s53, 36864
v_exp_f32 v100, v100
v_mfma_f32_16x16x32_bf16 v[108:111], a[232:235], v[76:79], v[108:111]
s_add_u32 s60, s60, 12288
v_exp_f32 v101, v101
v_mfma_f32_16x16x32_bf16 v[108:111], a[228:231], v[60:63], v[108:111]
buffer_load_dwordx4 v239, s[24:27], s60 offen lds
v_mfma_f32_16x16x32_bf16 v[108:111], a[224:227], v[44:47], v[108:111]
ds_read_b128 a[212:215], v249 offset:37120
v_cvt_pk_bf16_f32 v134, v100, v101
v_mfma_f32_16x16x32_bf16 v[108:111], a[220:223], v[28:31], v[108:111]
v_exp_f32 v102, v102
v_mfma_f32_16x16x32_bf16 v[108:111], a[216:219], v[12:15], v[108:111]
s_waitcnt lgkmcnt(9)
ds_read_b128 a[216:219], v248 offset:43008
v_add_f32 v229, v229, v102
v_mfma_f32_16x16x32_bf16 a[248:251], v[160:163], v[176:179], a[248:251]
s_waitcnt lgkmcnt(8)
buffer_load_dwordx4 v240, s[24:27], s60 offen offset:1024 lds
v_mfma_f32_16x16x32_bf16 a[248:251], v[164:167], v[180:183], a[248:251]
v_exp_f32 v103, v103
v_mfma_f32_16x16x32_bf16 v[212:215], v[164:167], v[188:191], v[212:215]
ds_read_b64_tr_b16 v[164:165], v235 offset:12416
v_add_f32 v229, v229, v103
v_mfma_f32_16x16x32_bf16 v[212:215], v[160:163], v[184:187], v[212:215]
s_waitcnt lgkmcnt(6)
ds_read_b64_tr_b16 v[160:161], v235 offset:128
v_cvt_pk_bf16_f32 v135, v102, v103
v_mfma_f32_16x16x32_bf16 a[96:99], v[168:171], v[144:147], a[96:99]
s_waitcnt lgkmcnt(6)
ds_read_b64_tr_b16 v[162:163], v235 offset:6272
v_add_f32 v229, v229, v100
v_mfma_f32_16x16x32_bf16 a[96:99], v[172:175], v[112:115], a[96:99]
ds_read_b64_tr_b16 v[166:167], v235 offset:18560
v_add_f32 v229, v229, v101
v_mfma_f32_16x16x32_bf16 a[100:103], v[172:175], v[116:119], a[100:103]
buffer_load_dwordx4 v241, s[24:27], s60 offen offset:2048 lds
v_mfma_f32_16x16x32_bf16 a[100:103], v[168:171], v[148:151], a[100:103]
v_exp_f32 v104, v104
v_mfma_f32_16x16x32_bf16 a[104:107], v[168:171], v[152:155], a[104:107]
v_exp_f32 v105, v105
v_mfma_f32_16x16x32_bf16 a[104:107], v[172:175], v[120:123], a[104:107]
ds_read_b128 a[220:223], v249 offset:43008
v_cvt_pk_bf16_f32 v138, v104, v105
v_mfma_f32_16x16x32_bf16 a[108:111], v[172:175], v[124:127], a[108:111]
v_exp_f32 v106, v106
v_mfma_f32_16x16x32_bf16 a[108:111], v[168:171], v[156:159], a[108:111]
s_waitcnt lgkmcnt(2)
ds_read_b64_tr_b16 v[168:169], v232 offset:256
v_add_f32 v230, v230, v106
v_mfma_f32_16x16x32_bf16 a[124:127], v[160:163], v[156:159], a[124:127]
s_waitcnt lgkmcnt(2)
ds_read_b64_tr_b16 v[170:171], v232 offset:6400
v_mfma_f32_16x16x32_bf16 a[124:127], v[164:167], v[124:127], a[124:127]
s_add_u32 m0, s53, 61440
ds_read_b64_tr_b16 v[172:173], v232 offset:12544
v_mfma_f32_16x16x32_bf16 a[120:123], v[164:167], v[120:123], a[120:123]
s_add_u32 s59, s59, 12288
ds_read_b64_tr_b16 v[174:175], v232 offset:18688
v_mfma_f32_16x16x32_bf16 a[120:123], v[160:163], v[152:155], a[120:123]
buffer_load_dwordx4 v236, s[20:23], s59 offen lds
v_mfma_f32_16x16x32_bf16 a[116:119], v[160:163], v[148:151], a[116:119]
v_exp_f32 v107, v107
v_mfma_f32_16x16x32_bf16 a[116:119], v[164:167], v[116:119], a[116:119]
ds_read_b128 a[224:227], v248 offset:43136
v_add_f32 v230, v230, v107
v_mfma_f32_16x16x32_bf16 a[112:115], v[164:167], v[112:115], a[112:115]
ds_read_b64_tr_b16 v[164:165], v247 offset:5248
v_cvt_pk_bf16_f32 v139, v106, v107
v_mfma_f32_16x16x32_bf16 a[112:115], v[160:163], v[144:147], a[112:115]
s_waitcnt lgkmcnt(4)
ds_read_b64_tr_b16 v[160:161], v247 offset:128
v_add_f32 v230, v230, v104
v_mfma_f32_16x16x32_bf16 a[128:131], v[168:171], v[144:147], a[128:131]
s_waitcnt lgkmcnt(3)
ds_read_b64_tr_b16 v[162:163], v247 offset:1408
v_add_f32 v230, v230, v105
v_mfma_f32_16x16x32_bf16 a[128:131], v[172:175], v[112:115], a[128:131]
ds_read_b64_tr_b16 v[166:167], v247 offset:6528
v_mfma_f32_16x16x32_bf16 a[132:135], v[172:175], v[116:119], a[132:135]
buffer_load_dwordx4 v237, s[20:23], s59 offen offset:1024 lds
v_mfma_f32_16x16x32_bf16 a[132:135], v[168:171], v[148:151], a[132:135]
v_exp_f32 v140, v140
v_mfma_f32_16x16x32_bf16 a[136:139], v[168:171], v[152:155], a[136:139]
ds_read_b128 a[228:231], v249 offset:43136
v_add_f32 v231, v231, v140
v_mfma_f32_16x16x32_bf16 a[136:139], v[172:175], v[120:123], a[136:139]
v_exp_f32 v141, v141
v_mfma_f32_16x16x32_bf16 a[140:143], v[172:175], v[124:127], a[140:143]
ds_read_b64_tr_b16 v[172:173], v233 offset:12544
ds_read_b64_tr_b16 v[174:175], v233 offset:18688
v_mfma_f32_16x16x32_bf16 a[140:143], v[168:171], v[156:159], a[140:143]
s_waitcnt lgkmcnt(4)
ds_read_b64_tr_b16 v[168:169], v233 offset:256
ds_read_b64_tr_b16 v[170:171], v233 offset:6400
v_mfma_f32_16x16x32_bf16 a[252:255], v[160:163], v[176:179], a[252:255]
s_waitcnt lgkmcnt(5)
buffer_load_dwordx4 v238, s[20:23], s59 offen offset:2048 lds
v_mfma_f32_16x16x32_bf16 a[252:255], v[164:167], v[180:183], a[252:255]
ds_read_b128 a[232:235], v248 offset:43264
v_add_f32 v231, v231, v141
v_mfma_f32_16x16x32_bf16 v[224:227], v[164:167], v[188:191], v[224:227]
ds_read_b64_tr_b16 v[164:165], v234 offset:12544
v_cvt_pk_bf16_f32 v140, v140, v141
v_mfma_f32_16x16x32_bf16 v[224:227], v[160:163], v[184:187], v[224:227]
s_waitcnt lgkmcnt(2)
v_exp_f32 v142, v142
v_mfma_f32_16x16x32_bf16 a[156:159], v[168:171], v[156:159], a[156:159]
ds_read_b64_tr_b16 v[160:161], v234 offset:256
v_add_f32 v231, v231, v142
v_mfma_f32_16x16x32_bf16 a[156:159], v[172:175], v[124:127], a[156:159]
ds_read_b64_tr_b16 v[162:163], v234 offset:6400
v_mfma_f32_16x16x32_bf16 a[152:155], v[172:175], v[120:123], a[152:155]
s_xor_b32 s3, s76, 1048576
ds_read_b64_tr_b16 v[166:167], v234 offset:18688
v_mfma_f32_16x16x32_bf16 a[152:155], v[168:171], v[152:155], a[152:155]
buffer_store_dwordx4 v[250:253], v250, s[4:7], s3 offen offset:2048 sc1
v_mfma_f32_16x16x32_bf16 a[148:151], v[168:171], v[148:151], a[148:151]
v_exp_f32 v143, v143
v_mfma_f32_16x16x32_bf16 a[148:151], v[172:175], v[116:119], a[148:151]
v_exp_f32 v108, v108
v_mfma_f32_16x16x32_bf16 a[144:147], v[172:175], v[112:115], a[144:147]
ds_read_b64_tr_b16 v[172:173], v235 offset:12544
v_add_f32 v231, v231, v143
v_mfma_f32_16x16x32_bf16 a[144:147], v[168:171], v[144:147], a[144:147]
s_waitcnt lgkmcnt(2)
ds_read_b64_tr_b16 v[168:169], v235 offset:256
v_cvt_pk_bf16_f32 v141, v142, v143
v_mfma_f32_16x16x32_bf16 a[160:163], v[160:163], v[144:147], a[160:163]
s_waitcnt lgkmcnt(2)
ds_read_b64_tr_b16 v[170:171], v235 offset:6400
v_mfma_f32_16x16x32_bf16 a[160:163], v[164:167], v[112:115], a[160:163]
ds_read_b64_tr_b16 v[174:175], v235 offset:18688
v_mfma_f32_16x16x32_bf16 a[164:167], v[164:167], v[116:119], a[164:167]
v_exp_f32 v109, v109
v_mfma_f32_16x16x32_bf16 a[164:167], v[160:163], v[148:151], a[164:167]
v_exp_f32 v110, v110
v_mfma_f32_16x16x32_bf16 a[168:171], v[160:163], v[152:155], a[168:171]
v_exp_f32 v111, v111
v_mfma_f32_16x16x32_bf16 a[168:171], v[164:167], v[120:123], a[168:171]
v_add_f32 v231, v231, v110
v_add_f32 v231, v231, v111
v_mfma_f32_16x16x32_bf16 a[172:175], v[164:167], v[124:127], a[172:175]
v_cvt_pk_bf16_f32 v143, v110, v111
v_add_f32 v231, v231, v108
v_mfma_f32_16x16x32_bf16 a[172:175], v[160:163], v[156:159], a[172:175]
s_waitcnt lgkmcnt(1)
v_add_f32 v231, v231, v109
v_cvt_pk_bf16_f32 v142, v108, v109
v_mfma_f32_16x16x32_bf16 a[188:191], v[168:171], v[156:159], a[188:191]
s_waitcnt lgkmcnt(0)
v_mfma_f32_16x16x32_bf16 a[188:191], v[172:175], v[124:127], a[188:191]
v_mfma_f32_16x16x32_bf16 a[184:187], v[172:175], v[120:123], a[184:187]
v_mfma_f32_16x16x32_bf16 a[184:187], v[168:171], v[152:155], a[184:187]
v_mfma_f32_16x16x32_bf16 a[180:183], v[168:171], v[148:151], a[180:183]
v_mfma_f32_16x16x32_bf16 a[180:183], v[172:175], v[116:119], a[180:183]
v_mfma_f32_16x16x32_bf16 a[176:179], v[172:175], v[112:115], a[176:179]
v_mfma_f32_16x16x32_bf16 a[176:179], v[168:171], v[144:147], a[176:179]
v_mfma_f32_16x16x32_bf16 v[144:147], a[192:195], v[0:3], 0
s_waitcnt vmcnt(17)
s_barrier
v_mfma_f32_16x16x32_bf16 v[144:147], a[196:199], v[16:19], v[144:147]
s_add_u32 s90, s65, 32768
ds_read_b64_tr_b16 v[160:161], v247 offset:20480
v_mfma_f32_16x16x32_bf16 v[144:147], a[200:203], v[32:35], v[144:147]
buffer_load_dwordx4 v[176:179], v250, s[4:7], s90 offen sc1
v_mfma_f32_16x16x32_bf16 v[144:147], a[204:207], v[48:51], v[144:147]
ds_read_b64_tr_b16 v[162:163], v247 offset:21760
v_mfma_f32_16x16x32_bf16 v[144:147], a[208:211], v[64:67], v[144:147]
ds_read_b64_tr_b16 v[164:165], v247 offset:25600
v_mfma_f32_16x16x32_bf16 v[144:147], a[212:215], v[80:83], v[144:147]
s_add_u32 s90, s65, 36864
ds_read_b64_tr_b16 v[166:167], v247 offset:26880
v_mfma_f32_16x16x32_bf16 v[148:151], a[212:215], v[84:87], 0
buffer_load_dwordx4 v[180:183], v250, s[4:7], s90 offen sc1
v_mfma_f32_16x16x32_bf16 v[148:151], a[208:211], v[68:71], v[148:151]
ds_read_b64_tr_b16 v[168:169], v247 offset:20512
v_mfma_f32_16x16x32_bf16 v[148:151], a[204:207], v[52:55], v[148:151]
ds_read_b64_tr_b16 v[170:171], v247 offset:21792
v_mfma_f32_16x16x32_bf16 v[148:151], a[200:203], v[36:39], v[148:151]
v_exp_f32 v144, v144
v_mfma_f32_16x16x32_bf16 v[148:151], a[196:199], v[20:23], v[148:151]
s_add_u32 s90, s66, 32768
ds_read_b64_tr_b16 v[172:173], v247 offset:25632
v_add_f32 v228, v228, v144
v_mfma_f32_16x16x32_bf16 v[148:151], a[192:195], v[4:7], v[148:151]
s_waitcnt vmcnt(17) lgkmcnt(5)
buffer_load_dwordx4 v[184:187], v250, s[4:7], s90 offen sc1
v_mfma_f32_16x16x32_bf16 a[236:239], v[160:163], v[192:195], a[236:239]
s_waitcnt vmcnt(17) lgkmcnt(3)
v_exp_f32 v145, v145
v_mfma_f32_16x16x32_bf16 a[236:239], v[164:167], v[196:199], a[236:239]
s_waitcnt vmcnt(15)
ds_read_b64_tr_b16 v[174:175], v247 offset:26912
v_add_f32 v228, v228, v145
v_mfma_f32_16x16x32_bf16 v[216:219], v[164:167], v[204:207], v[216:219]
s_add_u32 s90, s66, 36864
v_exp_f32 v146, v146
v_mfma_f32_16x16x32_bf16 v[216:219], v[160:163], v[200:203], v[216:219]
buffer_load_dwordx4 v[188:191], v250, s[4:7], s90 offen sc1
v_mfma_f32_16x16x32_bf16 v[152:155], a[192:195], v[8:11], 0
v_exp_f32 v147, v147
v_mfma_f32_16x16x32_bf16 v[152:155], a[196:199], v[24:27], v[152:155]
v_cvt_pk_bf16_f32 v144, v144, v145
v_add_f32 v228, v228, v146
v_mfma_f32_16x16x32_bf16 v[152:155], a[200:203], v[40:43], v[152:155]
v_add_f32 v228, v228, v147
v_cvt_pk_bf16_f32 v145, v146, v147
v_mfma_f32_16x16x32_bf16 v[152:155], a[204:207], v[56:59], v[152:155]
v_exp_f32 v148, v148
v_mfma_f32_16x16x32_bf16 v[152:155], a[208:211], v[72:75], v[152:155]
ds_read_b64_tr_b16 v[160:161], v247 offset:20544
v_add_f32 v229, v229, v148
v_mfma_f32_16x16x32_bf16 v[152:155], a[212:215], v[88:91], v[152:155]
v_exp_f32 v149, v149
v_mfma_f32_16x16x32_bf16 v[156:159], a[212:215], v[92:95], 0
ds_read_b128 a[212:215], v249 offset:43264
v_add_f32 v229, v229, v149
v_mfma_f32_16x16x32_bf16 v[156:159], a[208:211], v[76:79], v[156:159]
ds_read_b64_tr_b16 v[162:163], v247 offset:21824
v_cvt_pk_bf16_f32 v148, v148, v149
v_mfma_f32_16x16x32_bf16 v[156:159], a[204:207], v[60:63], v[156:159]
s_add_u32 m0, s55, 102400
v_exp_f32 v150, v150
v_mfma_f32_16x16x32_bf16 v[156:159], a[200:203], v[44:47], v[156:159]
s_add_u32 s61, s61, s46
ds_read_b64_tr_b16 v[164:165], v247 offset:25664
v_add_f32 v229, v229, v150
v_mfma_f32_16x16x32_bf16 v[156:159], a[196:199], v[28:31], v[156:159]
buffer_load_dwordx4 v242, s[32:35], s61 offen lds
v_mfma_f32_16x16x32_bf16 v[156:159], a[192:195], v[12:15], v[156:159]
s_waitcnt lgkmcnt(6)
v_exp_f32 v151, v151
v_mfma_f32_16x16x32_bf16 a[240:243], v[168:171], v[192:195], a[240:243]
s_waitcnt lgkmcnt(4)
ds_read_b64_tr_b16 v[166:167], v247 offset:26944
v_add_f32 v229, v229, v151
v_mfma_f32_16x16x32_bf16 a[240:243], v[172:175], v[196:199], a[240:243]
ds_read_b128 a[192:195], v248 offset:0
v_cvt_pk_bf16_f32 v149, v150, v151
v_mfma_f32_16x16x32_bf16 v[220:223], v[172:175], v[204:207], v[220:223]
buffer_load_dwordx4 v243, s[32:35], s61 offen offset:1024 lds
v_mfma_f32_16x16x32_bf16 v[220:223], v[168:171], v[200:203], v[220:223]
v_exp_f32 v152, v152
v_mfma_f32_16x16x32_bf16 v[96:99], a[216:219], v[0:3], 0
ds_read_b128 a[196:199], v249 offset:0
v_add_f32 v230, v230, v152
v_mfma_f32_16x16x32_bf16 v[96:99], a[220:223], v[16:19], v[96:99]
v_exp_f32 v153, v153
v_mfma_f32_16x16x32_bf16 v[96:99], a[224:227], v[32:35], v[96:99]
buffer_load_dwordx4 v244, s[32:35], s61 offen offset:2048 lds
v_mfma_f32_16x16x32_bf16 v[96:99], a[228:231], v[48:51], v[96:99]
ds_read_b128 a[200:203], v248 offset:128
v_add_f32 v230, v230, v153
v_mfma_f32_16x16x32_bf16 v[96:99], a[232:235], v[64:67], v[96:99]
s_waitcnt lgkmcnt(6)
ds_read_b64_tr_b16 v[168:169], v247 offset:20576
v_cvt_pk_bf16_f32 v152, v152, v153
v_mfma_f32_16x16x32_bf16 v[96:99], a[212:215], v[80:83], v[96:99]
v_exp_f32 v154, v154
v_mfma_f32_16x16x32_bf16 v[100:103], a[212:215], v[84:87], 0
ds_read_b64_tr_b16 v[170:171], v247 offset:21856
v_add_f32 v230, v230, v154
v_mfma_f32_16x16x32_bf16 v[100:103], a[232:235], v[68:71], v[100:103]
buffer_load_dwordx4 v245, s[32:35], s61 offen offset:3072 lds
v_mfma_f32_16x16x32_bf16 v[100:103], a[228:231], v[52:55], v[100:103]
v_exp_f32 v155, v155
v_mfma_f32_16x16x32_bf16 v[100:103], a[224:227], v[36:39], v[100:103]
ds_read_b64_tr_b16 v[172:173], v247 offset:25696
v_add_f32 v230, v230, v155
v_mfma_f32_16x16x32_bf16 v[100:103], a[220:223], v[20:23], v[100:103]
s_add_u32 m0, s55, 106496
ds_read_b64_tr_b16 v[174:175], v247 offset:26976
v_cvt_pk_bf16_f32 v153, v154, v155
v_mfma_f32_16x16x32_bf16 v[100:103], a[216:219], v[4:7], v[100:103]
s_waitcnt lgkmcnt(9)
buffer_load_dwordx4 v246, s[32:35], s61 offen lds
v_mfma_f32_16x16x32_bf16 a[244:247], v[160:163], v[192:195], a[244:247]
s_waitcnt lgkmcnt(7)
v_exp_f32 v96, v96
v_mfma_f32_16x16x32_bf16 a[244:247], v[164:167], v[196:199], a[244:247]
v_exp_f32 v97, v97
v_mfma_f32_16x16x32_bf16 v[208:211], v[164:167], v[204:207], v[208:211]
ds_read_b64_tr_b16 v[164:165], v232 offset:24576
v_cvt_pk_bf16_f32 v146, v96, v97
v_mfma_f32_16x16x32_bf16 v[208:211], v[160:163], v[200:203], v[208:211]
v_exp_f32 v98, v98
v_mfma_f32_16x16x32_bf16 v[104:107], a[216:219], v[8:11], 0
ds_read_b64_tr_b16 v[160:161], v232 offset:12288
v_add_f32 v228, v228, v98
v_mfma_f32_16x16x32_bf16 v[104:107], a[220:223], v[24:27], v[104:107]
v_exp_f32 v99, v99
v_mfma_f32_16x16x32_bf16 v[104:107], a[224:227], v[40:43], v[104:107]
ds_read_b64_tr_b16 v[162:163], v232 offset:18432
v_add_f32 v228, v228, v99
v_mfma_f32_16x16x32_bf16 v[104:107], a[228:231], v[56:59], v[104:107]
ds_read_b64_tr_b16 v[166:167], v232 offset:30720
v_cvt_pk_bf16_f32 v147, v98, v99
v_mfma_f32_16x16x32_bf16 v[104:107], a[232:235], v[72:75], v[104:107]
ds_read_b128 a[204:207], v249 offset:128
v_add_f32 v228, v228, v96
v_mfma_f32_16x16x32_bf16 v[104:107], a[212:215], v[88:91], v[104:107]
ds_read_b128 a[208:211], v248 offset:256
v_add_f32 v228, v228, v97
v_mfma_f32_16x16x32_bf16 v[108:111], a[212:215], v[92:95], 0
s_add_u32 m0, s53, 0
v_exp_f32 v100, v100
v_mfma_f32_16x16x32_bf16 v[108:111], a[232:235], v[76:79], v[108:111]
s_add_u32 s60, s60, 12288
v_exp_f32 v101, v101
v_mfma_f32_16x16x32_bf16 v[108:111], a[228:231], v[60:63], v[108:111]
buffer_load_dwordx4 v239, s[24:27], s60 offen lds
v_mfma_f32_16x16x32_bf16 v[108:111], a[224:227], v[44:47], v[108:111]
ds_read_b128 a[212:215], v249 offset:256
v_cvt_pk_bf16_f32 v150, v100, v101
v_mfma_f32_16x16x32_bf16 v[108:111], a[220:223], v[28:31], v[108:111]
v_exp_f32 v102, v102
v_mfma_f32_16x16x32_bf16 v[108:111], a[216:219], v[12:15], v[108:111]
s_waitcnt lgkmcnt(9)
ds_read_b128 a[216:219], v248 offset:6144
v_add_f32 v229, v229, v102
v_mfma_f32_16x16x32_bf16 a[248:251], v[168:171], v[192:195], a[248:251]
s_waitcnt lgkmcnt(8)
buffer_load_dwordx4 v240, s[24:27], s60 offen offset:1024 lds
v_mfma_f32_16x16x32_bf16 a[248:251], v[172:175], v[196:199], a[248:251]
v_exp_f32 v103, v103
v_mfma_f32_16x16x32_bf16 v[212:215], v[172:175], v[204:207], v[212:215]
ds_read_b64_tr_b16 v[172:173], v233 offset:24576
v_add_f32 v229, v229, v103
v_mfma_f32_16x16x32_bf16 v[212:215], v[168:171], v[200:203], v[212:215]
s_waitcnt lgkmcnt(6)
ds_read_b64_tr_b16 v[168:169], v233 offset:12288
v_cvt_pk_bf16_f32 v151, v102, v103
v_mfma_f32_16x16x32_bf16 a[0:3], v[160:163], v[112:115], a[0:3]
s_waitcnt lgkmcnt(6)
ds_read_b64_tr_b16 v[170:171], v233 offset:18432
v_add_f32 v229, v229, v100
v_mfma_f32_16x16x32_bf16 a[0:3], v[164:167], v[128:131], a[0:3]
ds_read_b64_tr_b16 v[174:175], v233 offset:30720
v_add_f32 v229, v229, v101
v_mfma_f32_16x16x32_bf16 a[4:7], v[164:167], v[132:135], a[4:7]
buffer_load_dwordx4 v241, s[24:27], s60 offen offset:2048 lds
v_mfma_f32_16x16x32_bf16 a[4:7], v[160:163], v[116:119], a[4:7]
v_exp_f32 v104, v104
v_mfma_f32_16x16x32_bf16 a[8:11], v[160:163], v[120:123], a[8:11]
v_exp_f32 v105, v105
v_mfma_f32_16x16x32_bf16 a[8:11], v[164:167], v[136:139], a[8:11]
ds_read_b128 a[220:223], v249 offset:6144
v_cvt_pk_bf16_f32 v154, v104, v105
v_mfma_f32_16x16x32_bf16 a[12:15], v[164:167], v[140:143], a[12:15]
v_exp_f32 v106, v106
v_mfma_f32_16x16x32_bf16 a[12:15], v[160:163], v[124:127], a[12:15]
s_waitcnt lgkmcnt(2)
ds_read_b64_tr_b16 v[160:161], v234 offset:12288
v_add_f32 v230, v230, v106
v_mfma_f32_16x16x32_bf16 a[28:31], v[168:171], v[124:127], a[28:31]
s_waitcnt lgkmcnt(2)
ds_read_b64_tr_b16 v[162:163], v234 offset:18432
v_mfma_f32_16x16x32_bf16 a[28:31], v[172:175], v[140:143], a[28:31]
s_add_u32 m0, s53, 73728
ds_read_b64_tr_b16 v[164:165], v234 offset:24576
v_mfma_f32_16x16x32_bf16 a[24:27], v[172:175], v[136:139], a[24:27]
s_add_u32 s59, s59, 12288
ds_read_b64_tr_b16 v[166:167], v234 offset:30720
v_mfma_f32_16x16x32_bf16 a[24:27], v[168:171], v[120:123], a[24:27]
buffer_load_dwordx4 v236, s[20:23], s59 offen lds
v_mfma_f32_16x16x32_bf16 a[20:23], v[168:171], v[116:119], a[20:23]
v_exp_f32 v107, v107
v_mfma_f32_16x16x32_bf16 a[20:23], v[172:175], v[132:135], a[20:23]
ds_read_b128 a[224:227], v248 offset:6272
v_add_f32 v230, v230, v107
v_mfma_f32_16x16x32_bf16 a[16:19], v[172:175], v[128:131], a[16:19]
ds_read_b64_tr_b16 v[172:173], v247 offset:25728
v_cvt_pk_bf16_f32 v155, v106, v107
v_mfma_f32_16x16x32_bf16 a[16:19], v[168:171], v[112:115], a[16:19]
s_waitcnt lgkmcnt(4)
ds_read_b64_tr_b16 v[168:169], v247 offset:20608
v_add_f32 v230, v230, v104
v_mfma_f32_16x16x32_bf16 a[32:35], v[160:163], v[112:115], a[32:35]
s_waitcnt lgkmcnt(3)
ds_read_b64_tr_b16 v[170:171], v247 offset:21888
v_add_f32 v230, v230, v105
v_mfma_f32_16x16x32_bf16 a[32:35], v[164:167], v[128:131], a[32:35]
ds_read_b64_tr_b16 v[174:175], v247 offset:27008
v_mfma_f32_16x16x32_bf16 a[36:39], v[164:167], v[132:135], a[36:39]
buffer_load_dwordx4 v237, s[20:23], s59 offen offset:1024 lds
v_mfma_f32_16x16x32_bf16 a[36:39], v[160:163], v[116:119], a[36:39]
v_exp_f32 v156, v156
v_mfma_f32_16x16x32_bf16 a[40:43], v[160:163], v[120:123], a[40:43]
ds_read_b128 a[228:231], v249 offset:6272
v_add_f32 v231, v231, v156
v_mfma_f32_16x16x32_bf16 a[40:43], v[164:167], v[136:139], a[40:43]
v_exp_f32 v157, v157
v_mfma_f32_16x16x32_bf16 a[44:47], v[164:167], v[140:143], a[44:47]
ds_read_b64_tr_b16 v[164:165], v235 offset:24576
ds_read_b64_tr_b16 v[166:167], v235 offset:30720
v_mfma_f32_16x16x32_bf16 a[44:47], v[160:163], v[124:127], a[44:47]
s_waitcnt lgkmcnt(4)
ds_read_b64_tr_b16 v[160:161], v235 offset:12288
ds_read_b64_tr_b16 v[162:163], v235 offset:18432
v_mfma_f32_16x16x32_bf16 a[252:255], v[168:171], v[192:195], a[252:255]
s_waitcnt lgkmcnt(5)
buffer_load_dwordx4 v238, s[20:23], s59 offen offset:2048 lds
v_mfma_f32_16x16x32_bf16 a[252:255], v[172:175], v[196:199], a[252:255]
ds_read_b128 a[232:235], v248 offset:6400
v_add_f32 v231, v231, v157
v_mfma_f32_16x16x32_bf16 v[224:227], v[172:175], v[204:207], v[224:227]
ds_read_b64_tr_b16 v[172:173], v232 offset:24704
v_cvt_pk_bf16_f32 v156, v156, v157
v_mfma_f32_16x16x32_bf16 v[224:227], v[168:171], v[200:203], v[224:227]
s_waitcnt lgkmcnt(2)
v_exp_f32 v158, v158
v_mfma_f32_16x16x32_bf16 a[60:63], v[160:163], v[124:127], a[60:63]
ds_read_b64_tr_b16 v[168:169], v232 offset:12416
v_add_f32 v231, v231, v158
v_mfma_f32_16x16x32_bf16 a[60:63], v[164:167], v[140:143], a[60:63]
ds_read_b64_tr_b16 v[170:171], v232 offset:18560
v_mfma_f32_16x16x32_bf16 a[56:59], v[164:167], v[136:139], a[56:59]
s_xor_b32 s3, s76, 1048576
ds_read_b64_tr_b16 v[174:175], v232 offset:30848
v_mfma_f32_16x16x32_bf16 a[56:59], v[160:163], v[120:123], a[56:59]
buffer_store_dwordx4 v[250:253], v250, s[4:7], s3 offen offset:3072 sc1
v_mfma_f32_16x16x32_bf16 a[52:55], v[160:163], v[116:119], a[52:55]
v_exp_f32 v159, v159
v_mfma_f32_16x16x32_bf16 a[52:55], v[164:167], v[132:135], a[52:55]
v_exp_f32 v108, v108
v_mfma_f32_16x16x32_bf16 a[48:51], v[164:167], v[128:131], a[48:51]
ds_read_b64_tr_b16 v[164:165], v233 offset:24704
v_add_f32 v231, v231, v159
v_mfma_f32_16x16x32_bf16 a[48:51], v[160:163], v[112:115], a[48:51]
s_waitcnt lgkmcnt(2)
ds_read_b64_tr_b16 v[160:161], v233 offset:12416
v_cvt_pk_bf16_f32 v157, v158, v159
v_mfma_f32_16x16x32_bf16 a[64:67], v[168:171], v[112:115], a[64:67]
s_waitcnt lgkmcnt(2)
ds_read_b64_tr_b16 v[162:163], v233 offset:18560
v_mfma_f32_16x16x32_bf16 a[64:67], v[172:175], v[128:131], a[64:67]
ds_read_b64_tr_b16 v[166:167], v233 offset:30848
v_mfma_f32_16x16x32_bf16 a[68:71], v[172:175], v[132:135], a[68:71]
v_exp_f32 v109, v109
v_mfma_f32_16x16x32_bf16 a[68:71], v[168:171], v[116:119], a[68:71]
v_exp_f32 v110, v110
v_mfma_f32_16x16x32_bf16 a[72:75], v[168:171], v[120:123], a[72:75]
v_exp_f32 v111, v111
v_mfma_f32_16x16x32_bf16 a[72:75], v[172:175], v[136:139], a[72:75]
v_add_f32 v231, v231, v110
v_add_f32 v231, v231, v111
v_mfma_f32_16x16x32_bf16 a[76:79], v[172:175], v[140:143], a[76:79]
v_cvt_pk_bf16_f32 v159, v110, v111
v_add_f32 v231, v231, v108
v_mfma_f32_16x16x32_bf16 a[76:79], v[168:171], v[124:127], a[76:79]
s_waitcnt lgkmcnt(1)
v_add_f32 v231, v231, v109
v_cvt_pk_bf16_f32 v158, v108, v109
v_mfma_f32_16x16x32_bf16 a[92:95], v[160:163], v[124:127], a[92:95]
s_waitcnt lgkmcnt(0)
v_mfma_f32_16x16x32_bf16 a[92:95], v[164:167], v[140:143], a[92:95]
v_mfma_f32_16x16x32_bf16 a[88:91], v[164:167], v[136:139], a[88:91]
v_mfma_f32_16x16x32_bf16 a[88:91], v[160:163], v[120:123], a[88:91]
v_mfma_f32_16x16x32_bf16 a[84:87], v[160:163], v[116:119], a[84:87]
v_mfma_f32_16x16x32_bf16 a[84:87], v[164:167], v[132:135], a[84:87]
v_mfma_f32_16x16x32_bf16 a[80:83], v[164:167], v[128:131], a[80:83]
v_mfma_f32_16x16x32_bf16 a[80:83], v[160:163], v[112:115], a[80:83]
s_sub_u32 s65, s65, s80
v_mfma_f32_16x16x32_bf16 v[112:115], a[192:195], v[0:3], 0
s_waitcnt vmcnt(17)
s_barrier
v_mfma_f32_16x16x32_bf16 v[112:115], a[196:199], v[16:19], v[112:115]
s_add_u32 s90, s65, 0
ds_read_b64_tr_b16 v[168:169], v247 offset:40960
v_mfma_f32_16x16x32_bf16 v[112:115], a[200:203], v[32:35], v[112:115]
buffer_load_dwordx4 v[192:195], v250, s[4:7], s90 offen sc1
v_mfma_f32_16x16x32_bf16 v[112:115], a[204:207], v[48:51], v[112:115]
ds_read_b64_tr_b16 v[170:171], v247 offset:42240
v_mfma_f32_16x16x32_bf16 v[112:115], a[208:211], v[64:67], v[112:115]
ds_read_b64_tr_b16 v[172:173], v247 offset:46080
v_mfma_f32_16x16x32_bf16 v[112:115], a[212:215], v[80:83], v[112:115]
s_add_u32 s90, s65, 4096
ds_read_b64_tr_b16 v[174:175], v247 offset:47360
v_mfma_f32_16x16x32_bf16 v[116:119], a[212:215], v[84:87], 0
buffer_load_dwordx4 v[196:199], v250, s[4:7], s90 offen sc1
v_mfma_f32_16x16x32_bf16 v[116:119], a[208:211], v[68:71], v[116:119]
ds_read_b64_tr_b16 v[160:161], v247 offset:40992
v_mfma_f32_16x16x32_bf16 v[116:119], a[204:207], v[52:55], v[116:119]
ds_read_b64_tr_b16 v[162:163], v247 offset:42272
v_mfma_f32_16x16x32_bf16 v[116:119], a[200:203], v[36:39], v[116:119]
s_sub_u32 s66, s66, s80
v_exp_f32 v112, v112
v_mfma_f32_16x16x32_bf16 v[116:119], a[196:199], v[20:23], v[116:119]
s_add_u32 s90, s66, 0
ds_read_b64_tr_b16 v[164:165], v247 offset:46112
v_add_f32 v228, v228, v112
v_mfma_f32_16x16x32_bf16 v[116:119], a[192:195], v[4:7], v[116:119]
s_waitcnt vmcnt(17) lgkmcnt(5)
buffer_load_dwordx4 v[200:203], v250, s[4:7], s90 offen sc1
v_mfma_f32_16x16x32_bf16 a[236:239], v[168:171], v[176:179], a[236:239]
s_waitcnt vmcnt(17) lgkmcnt(3)
v_exp_f32 v113, v113
v_mfma_f32_16x16x32_bf16 a[236:239], v[172:175], v[180:183], a[236:239]
s_waitcnt vmcnt(15)
ds_read_b64_tr_b16 v[166:167], v247 offset:47392
v_add_f32 v228, v228, v113
v_mfma_f32_16x16x32_bf16 v[216:219], v[172:175], v[188:191], v[216:219]
s_add_u32 s90, s66, 4096
v_exp_f32 v114, v114
v_mfma_f32_16x16x32_bf16 v[216:219], v[168:171], v[184:187], v[216:219]
buffer_load_dwordx4 v[204:207], v250, s[4:7], s90 offen sc1
v_mfma_f32_16x16x32_bf16 v[120:123], a[192:195], v[8:11], 0
v_exp_f32 v115, v115
v_mfma_f32_16x16x32_bf16 v[120:123], a[196:199], v[24:27], v[120:123]
v_cvt_pk_bf16_f32 v112, v112, v113
v_add_f32 v228, v228, v114
v_mfma_f32_16x16x32_bf16 v[120:123], a[200:203], v[40:43], v[120:123]
v_add_f32 v228, v228, v115
v_cvt_pk_bf16_f32 v113, v114, v115
v_mfma_f32_16x16x32_bf16 v[120:123], a[204:207], v[56:59], v[120:123]
v_exp_f32 v116, v116
v_mfma_f32_16x16x32_bf16 v[120:123], a[208:211], v[72:75], v[120:123]
ds_read_b64_tr_b16 v[168:169], v247 offset:41024
v_add_f32 v229, v229, v116
v_mfma_f32_16x16x32_bf16 v[120:123], a[212:215], v[88:91], v[120:123]
v_exp_f32 v117, v117
v_mfma_f32_16x16x32_bf16 v[124:127], a[212:215], v[92:95], 0
ds_read_b128 a[212:215], v249 offset:6400
v_add_f32 v229, v229, v117
v_mfma_f32_16x16x32_bf16 v[124:127], a[208:211], v[76:79], v[124:127]
ds_read_b64_tr_b16 v[170:171], v247 offset:42304
v_cvt_pk_bf16_f32 v116, v116, v117
v_mfma_f32_16x16x32_bf16 v[124:127], a[204:207], v[60:63], v[124:127]
s_add_u32 m0, s55, 122880
v_exp_f32 v118, v118
v_mfma_f32_16x16x32_bf16 v[124:127], a[200:203], v[44:47], v[124:127]
s_add_u32 s61, s61, 163840
ds_read_b64_tr_b16 v[172:173], v247 offset:46144
v_add_f32 v229, v229, v118
v_mfma_f32_16x16x32_bf16 v[124:127], a[196:199], v[28:31], v[124:127]
buffer_load_dwordx4 v242, s[32:35], s61 offen lds
v_mfma_f32_16x16x32_bf16 v[124:127], a[192:195], v[12:15], v[124:127]
s_waitcnt lgkmcnt(6)
v_exp_f32 v119, v119
v_mfma_f32_16x16x32_bf16 a[240:243], v[160:163], v[176:179], a[240:243]
s_waitcnt lgkmcnt(4)
ds_read_b64_tr_b16 v[174:175], v247 offset:47424
v_add_f32 v229, v229, v119
v_mfma_f32_16x16x32_bf16 a[240:243], v[164:167], v[180:183], a[240:243]
ds_read_b128 a[192:195], v248 offset:12288
v_cvt_pk_bf16_f32 v117, v118, v119
v_mfma_f32_16x16x32_bf16 v[220:223], v[164:167], v[188:191], v[220:223]
buffer_load_dwordx4 v243, s[32:35], s61 offen offset:1024 lds
v_mfma_f32_16x16x32_bf16 v[220:223], v[160:163], v[184:187], v[220:223]
v_exp_f32 v120, v120
v_mfma_f32_16x16x32_bf16 v[96:99], a[216:219], v[0:3], 0
ds_read_b128 a[196:199], v249 offset:12288
v_add_f32 v230, v230, v120
v_mfma_f32_16x16x32_bf16 v[96:99], a[220:223], v[16:19], v[96:99]
v_exp_f32 v121, v121
v_mfma_f32_16x16x32_bf16 v[96:99], a[224:227], v[32:35], v[96:99]
buffer_load_dwordx4 v244, s[32:35], s61 offen offset:2048 lds
v_mfma_f32_16x16x32_bf16 v[96:99], a[228:231], v[48:51], v[96:99]
ds_read_b128 a[200:203], v248 offset:12416
v_add_f32 v230, v230, v121
v_mfma_f32_16x16x32_bf16 v[96:99], a[232:235], v[64:67], v[96:99]
s_waitcnt lgkmcnt(6)
ds_read_b64_tr_b16 v[160:161], v247 offset:41056
v_cvt_pk_bf16_f32 v120, v120, v121
v_mfma_f32_16x16x32_bf16 v[96:99], a[212:215], v[80:83], v[96:99]
v_exp_f32 v122, v122
v_mfma_f32_16x16x32_bf16 v[100:103], a[212:215], v[84:87], 0
ds_read_b64_tr_b16 v[162:163], v247 offset:42336
v_add_f32 v230, v230, v122
v_mfma_f32_16x16x32_bf16 v[100:103], a[232:235], v[68:71], v[100:103]
buffer_load_dwordx4 v245, s[32:35], s61 offen offset:3072 lds
v_mfma_f32_16x16x32_bf16 v[100:103], a[228:231], v[52:55], v[100:103]
v_exp_f32 v123, v123
v_mfma_f32_16x16x32_bf16 v[100:103], a[224:227], v[36:39], v[100:103]
ds_read_b64_tr_b16 v[164:165], v247 offset:46176
v_add_f32 v230, v230, v123
v_mfma_f32_16x16x32_bf16 v[100:103], a[220:223], v[20:23], v[100:103]
s_add_u32 m0, s55, 126976
ds_read_b64_tr_b16 v[166:167], v247 offset:47456
v_cvt_pk_bf16_f32 v121, v122, v123
v_mfma_f32_16x16x32_bf16 v[100:103], a[216:219], v[4:7], v[100:103]
s_waitcnt lgkmcnt(9)
buffer_load_dwordx4 v246, s[32:35], s61 offen lds
v_mfma_f32_16x16x32_bf16 a[244:247], v[168:171], v[176:179], a[244:247]
s_waitcnt lgkmcnt(7)
v_exp_f32 v96, v96
v_mfma_f32_16x16x32_bf16 a[244:247], v[172:175], v[180:183], a[244:247]
L_walk2_0:
s_cbranch_execz L_walk2_4
v_exp_f32 v97, v97
v_mfma_f32_16x16x32_bf16 v[208:211], v[172:175], v[188:191], v[208:211]
ds_read_b64_tr_b16 v[172:173], v234 offset:36992
v_cvt_pk_bf16_f32 v114, v96, v97
v_mfma_f32_16x16x32_bf16 v[208:211], v[168:171], v[184:187], v[208:211]
v_exp_f32 v98, v98
v_mfma_f32_16x16x32_bf16 v[104:107], a[216:219], v[8:11], 0
ds_read_b64_tr_b16 v[168:169], v234 offset:24704
v_add_f32 v228, v228, v98
v_mfma_f32_16x16x32_bf16 v[104:107], a[220:223], v[24:27], v[104:107]
v_exp_f32 v99, v99
v_mfma_f32_16x16x32_bf16 v[104:107], a[224:227], v[40:43], v[104:107]
ds_read_b64_tr_b16 v[170:171], v234 offset:30848
v_add_f32 v228, v228, v99
v_mfma_f32_16x16x32_bf16 v[104:107], a[228:231], v[56:59], v[104:107]
ds_read_b64_tr_b16 v[174:175], v234 offset:43136
v_cvt_pk_bf16_f32 v115, v98, v99
v_mfma_f32_16x16x32_bf16 v[104:107], a[232:235], v[72:75], v[104:107]
ds_read_b128 a[204:207], v249 offset:12416
v_add_f32 v228, v228, v96
v_mfma_f32_16x16x32_bf16 v[104:107], a[212:215], v[88:91], v[104:107]
ds_read_b128 a[208:211], v248 offset:12544
v_add_f32 v228, v228, v97
v_mfma_f32_16x16x32_bf16 v[108:111], a[212:215], v[92:95], 0
s_add_u32 m0, s53, 12288
v_exp_f32 v100, v100
v_mfma_f32_16x16x32_bf16 v[108:111], a[232:235], v[76:79], v[108:111]
s_add_u32 s60, s60, 12288
v_exp_f32 v101, v101
v_mfma_f32_16x16x32_bf16 v[108:111], a[228:231], v[60:63], v[108:111]
buffer_load_dwordx4 v239, s[24:27], s60 offen lds
v_mfma_f32_16x16x32_bf16 v[108:111], a[224:227], v[44:47], v[108:111]
ds_read_b128 a[212:215], v249 offset:12544
v_cvt_pk_bf16_f32 v118, v100, v101
v_mfma_f32_16x16x32_bf16 v[108:111], a[220:223], v[28:31], v[108:111]
v_exp_f32 v102, v102
v_mfma_f32_16x16x32_bf16 v[108:111], a[216:219], v[12:15], v[108:111]
s_waitcnt lgkmcnt(9)
ds_read_b128 a[216:219], v248 offset:18432
v_add_f32 v229, v229, v102
v_mfma_f32_16x16x32_bf16 a[248:251], v[160:163], v[176:179], a[248:251]
s_waitcnt lgkmcnt(8)
buffer_load_dwordx4 v240, s[24:27], s60 offen offset:1024 lds
v_mfma_f32_16x16x32_bf16 a[248:251], v[164:167], v[180:183], a[248:251]
v_exp_f32 v103, v103
v_mfma_f32_16x16x32_bf16 v[212:215], v[164:167], v[188:191], v[212:215]
ds_read_b64_tr_b16 v[164:165], v235 offset:36992
v_add_f32 v229, v229, v103
v_mfma_f32_16x16x32_bf16 v[212:215], v[160:163], v[184:187], v[212:215]
s_waitcnt lgkmcnt(6)
ds_read_b64_tr_b16 v[160:161], v235 offset:24704
v_cvt_pk_bf16_f32 v119, v102, v103
v_mfma_f32_16x16x32_bf16 a[96:99], v[168:171], v[128:131], a[96:99]
s_waitcnt lgkmcnt(6)
ds_read_b64_tr_b16 v[162:163], v235 offset:30848
v_add_f32 v229, v229, v100
v_mfma_f32_16x16x32_bf16 a[96:99], v[172:175], v[144:147], a[96:99]
ds_read_b64_tr_b16 v[166:167], v235 offset:43136
v_add_f32 v229, v229, v101
v_mfma_f32_16x16x32_bf16 a[100:103], v[172:175], v[148:151], a[100:103]
buffer_load_dwordx4 v241, s[24:27], s60 offen offset:2048 lds
v_mfma_f32_16x16x32_bf16 a[100:103], v[168:171], v[132:135], a[100:103]
v_exp_f32 v104, v104
v_mfma_f32_16x16x32_bf16 a[104:107], v[168:171], v[136:139], a[104:107]
v_exp_f32 v105, v105
v_mfma_f32_16x16x32_bf16 a[104:107], v[172:175], v[152:155], a[104:107]
ds_read_b128 a[220:223], v249 offset:18432
v_cvt_pk_bf16_f32 v122, v104, v105
v_mfma_f32_16x16x32_bf16 a[108:111], v[172:175], v[156:159], a[108:111]
v_exp_f32 v106, v106
v_mfma_f32_16x16x32_bf16 a[108:111], v[168:171], v[140:143], a[108:111]
s_waitcnt lgkmcnt(2)
ds_read_b64_tr_b16 v[168:169], v232 offset:24832
v_add_f32 v230, v230, v106
v_mfma_f32_16x16x32_bf16 a[124:127], v[160:163], v[140:143], a[124:127]
s_waitcnt lgkmcnt(2)
ds_read_b64_tr_b16 v[170:171], v232 offset:30976
v_mfma_f32_16x16x32_bf16 a[124:127], v[164:167], v[156:159], a[124:127]
s_add_u32 m0, s53, 86016
ds_read_b64_tr_b16 v[172:173], v232 offset:37120
v_mfma_f32_16x16x32_bf16 a[120:123], v[164:167], v[152:155], a[120:123]
s_add_u32 s59, s59, 12288
ds_read_b64_tr_b16 v[174:175], v232 offset:43264
v_mfma_f32_16x16x32_bf16 a[120:123], v[160:163], v[136:139], a[120:123]
buffer_load_dwordx4 v236, s[20:23], s59 offen lds
v_mfma_f32_16x16x32_bf16 a[116:119], v[160:163], v[132:135], a[116:119]
v_exp_f32 v107, v107
v_mfma_f32_16x16x32_bf16 a[116:119], v[164:167], v[148:151], a[116:119]
ds_read_b128 a[224:227], v248 offset:18560
v_add_f32 v230, v230, v107
v_mfma_f32_16x16x32_bf16 a[112:115], v[164:167], v[144:147], a[112:115]
ds_read_b64_tr_b16 v[164:165], v247 offset:46208
v_cvt_pk_bf16_f32 v123, v106, v107
v_mfma_f32_16x16x32_bf16 a[112:115], v[160:163], v[128:131], a[112:115]
s_waitcnt lgkmcnt(4)
ds_read_b64_tr_b16 v[160:161], v247 offset:41088
v_add_f32 v230, v230, v104
v_mfma_f32_16x16x32_bf16 a[128:131], v[168:171], v[128:131], a[128:131]
s_waitcnt lgkmcnt(3)
ds_read_b64_tr_b16 v[162:163], v247 offset:42368
v_add_f32 v230, v230, v105
v_mfma_f32_16x16x32_bf16 a[128:131], v[172:175], v[144:147], a[128:131]
ds_read_b64_tr_b16 v[166:167], v247 offset:47488
v_mfma_f32_16x16x32_bf16 a[132:135], v[172:175], v[148:151], a[132:135]
buffer_load_dwordx4 v237, s[20:23], s59 offen offset:1024 lds
v_mfma_f32_16x16x32_bf16 a[132:135], v[168:171], v[132:135], a[132:135]
v_exp_f32 v124, v124
v_mfma_f32_16x16x32_bf16 a[136:139], v[168:171], v[136:139], a[136:139]
ds_read_b128 a[228:231], v249 offset:18560
v_add_f32 v231, v231, v124
v_mfma_f32_16x16x32_bf16 a[136:139], v[172:175], v[152:155], a[136:139]
v_exp_f32 v125, v125
v_mfma_f32_16x16x32_bf16 a[140:143], v[172:175], v[156:159], a[140:143]
ds_read_b64_tr_b16 v[172:173], v233 offset:37120
ds_read_b64_tr_b16 v[174:175], v233 offset:43264
v_mfma_f32_16x16x32_bf16 a[140:143], v[168:171], v[140:143], a[140:143]
s_waitcnt lgkmcnt(4)
ds_read_b64_tr_b16 v[168:169], v233 offset:24832
ds_read_b64_tr_b16 v[170:171], v233 offset:30976
v_mfma_f32_16x16x32_bf16 a[252:255], v[160:163], v[176:179], a[252:255]
s_waitcnt lgkmcnt(5)
buffer_load_dwordx4 v238, s[20:23], s59 offen offset:2048 lds
v_mfma_f32_16x16x32_bf16 a[252:255], v[164:167], v[180:183], a[252:255]
ds_read_b128 a[232:235], v248 offset:18688
v_add_f32 v231, v231, v125
v_mfma_f32_16x16x32_bf16 v[224:227], v[164:167], v[188:191], v[224:227]
ds_read_b64_tr_b16 v[164:165], v234 offset:37120
v_cvt_pk_bf16_f32 v124, v124, v125
v_mfma_f32_16x16x32_bf16 v[224:227], v[160:163], v[184:187], v[224:227]
s_waitcnt lgkmcnt(2)
v_exp_f32 v126, v126
v_mfma_f32_16x16x32_bf16 a[156:159], v[168:171], v[140:143], a[156:159]
ds_read_b64_tr_b16 v[160:161], v234 offset:24832
v_add_f32 v231, v231, v126
v_mfma_f32_16x16x32_bf16 a[156:159], v[172:175], v[156:159], a[156:159]
ds_read_b64_tr_b16 v[162:163], v234 offset:30976
v_mfma_f32_16x16x32_bf16 a[152:155], v[172:175], v[152:155], a[152:155]
s_xor_b32 s3, s76, 1310720
ds_read_b64_tr_b16 v[166:167], v234 offset:43264
v_mfma_f32_16x16x32_bf16 a[152:155], v[168:171], v[136:139], a[152:155]
buffer_store_dwordx4 v[250:253], v250, s[4:7], s3 offen offset:1024 sc1
v_mfma_f32_16x16x32_bf16 a[148:151], v[168:171], v[132:135], a[148:151]
v_exp_f32 v127, v127
v_mfma_f32_16x16x32_bf16 a[148:151], v[172:175], v[148:151], a[148:151]
v_exp_f32 v108, v108
v_mfma_f32_16x16x32_bf16 a[144:147], v[172:175], v[144:147], a[144:147]
ds_read_b64_tr_b16 v[172:173], v235 offset:37120
v_add_f32 v231, v231, v127
v_mfma_f32_16x16x32_bf16 a[144:147], v[168:171], v[128:131], a[144:147]
s_waitcnt lgkmcnt(2)
ds_read_b64_tr_b16 v[168:169], v235 offset:24832
v_cvt_pk_bf16_f32 v125, v126, v127
v_mfma_f32_16x16x32_bf16 a[160:163], v[160:163], v[128:131], a[160:163]
s_waitcnt lgkmcnt(2)
ds_read_b64_tr_b16 v[170:171], v235 offset:30976
v_mfma_f32_16x16x32_bf16 a[160:163], v[164:167], v[144:147], a[160:163]
ds_read_b64_tr_b16 v[174:175], v235 offset:43264
v_mfma_f32_16x16x32_bf16 a[164:167], v[164:167], v[148:151], a[164:167]
v_exp_f32 v109, v109
v_mfma_f32_16x16x32_bf16 a[164:167], v[160:163], v[132:135], a[164:167]
v_exp_f32 v110, v110
v_mfma_f32_16x16x32_bf16 a[168:171], v[160:163], v[136:139], a[168:171]
v_exp_f32 v111, v111
v_mfma_f32_16x16x32_bf16 a[168:171], v[164:167], v[152:155], a[168:171]
v_add_f32 v231, v231, v110
v_add_f32 v231, v231, v111
v_mfma_f32_16x16x32_bf16 a[172:175], v[164:167], v[156:159], a[172:175]
v_cvt_pk_bf16_f32 v127, v110, v111
v_add_f32 v231, v231, v108
v_mfma_f32_16x16x32_bf16 a[172:175], v[160:163], v[140:143], a[172:175]
s_waitcnt lgkmcnt(1)
v_add_f32 v231, v231, v109
v_cvt_pk_bf16_f32 v126, v108, v109
v_mfma_f32_16x16x32_bf16 a[188:191], v[168:171], v[140:143], a[188:191]
s_waitcnt lgkmcnt(0)
v_mfma_f32_16x16x32_bf16 a[188:191], v[172:175], v[156:159], a[188:191]
v_mfma_f32_16x16x32_bf16 a[184:187], v[172:175], v[152:155], a[184:187]
v_mfma_f32_16x16x32_bf16 a[184:187], v[168:171], v[136:139], a[184:187]
v_mfma_f32_16x16x32_bf16 a[180:183], v[168:171], v[132:135], a[180:183]
v_mfma_f32_16x16x32_bf16 a[180:183], v[172:175], v[148:151], a[180:183]
v_mfma_f32_16x16x32_bf16 a[176:179], v[172:175], v[144:147], a[176:179]
v_mfma_f32_16x16x32_bf16 a[176:179], v[168:171], v[128:131], a[176:179]
v_mfma_f32_16x16x32_bf16 v[128:131], a[192:195], v[0:3], 0
s_waitcnt vmcnt(17)
s_barrier
v_mfma_f32_16x16x32_bf16 v[128:131], a[196:199], v[16:19], v[128:131]
s_add_u32 s90, s65, 16384
ds_read_b64_tr_b16 v[160:161], v247 offset:0
v_mfma_f32_16x16x32_bf16 v[128:131], a[200:203], v[32:35], v[128:131]
buffer_load_dwordx4 v[176:179], v250, s[4:7], s90 offen sc1
v_mfma_f32_16x16x32_bf16 v[128:131], a[204:207], v[48:51], v[128:131]
ds_read_b64_tr_b16 v[162:163], v247 offset:1280
v_mfma_f32_16x16x32_bf16 v[128:131], a[208:211], v[64:67], v[128:131]
ds_read_b64_tr_b16 v[164:165], v247 offset:5120
v_mfma_f32_16x16x32_bf16 v[128:131], a[212:215], v[80:83], v[128:131]
s_add_u32 s90, s65, 20480
ds_read_b64_tr_b16 v[166:167], v247 offset:6400
v_mfma_f32_16x16x32_bf16 v[132:135], a[212:215], v[84:87], 0
buffer_load_dwordx4 v[180:183], v250, s[4:7], s90 offen sc1
v_mfma_f32_16x16x32_bf16 v[132:135], a[208:211], v[68:71], v[132:135]
ds_read_b64_tr_b16 v[168:169], v247 offset:32
v_mfma_f32_16x16x32_bf16 v[132:135], a[204:207], v[52:55], v[132:135]
ds_read_b64_tr_b16 v[170:171], v247 offset:1312
v_mfma_f32_16x16x32_bf16 v[132:135], a[200:203], v[36:39], v[132:135]
v_exp_f32 v128, v128
v_mfma_f32_16x16x32_bf16 v[132:135], a[196:199], v[20:23], v[132:135]
s_add_u32 s90, s66, 16384
ds_read_b64_tr_b16 v[172:173], v247 offset:5152
v_add_f32 v228, v228, v128
v_mfma_f32_16x16x32_bf16 v[132:135], a[192:195], v[4:7], v[132:135]
s_waitcnt vmcnt(17) lgkmcnt(5)
buffer_load_dwordx4 v[184:187], v250, s[4:7], s90 offen sc1
v_mfma_f32_16x16x32_bf16 a[236:239], v[160:163], v[192:195], a[236:239]
s_waitcnt vmcnt(17) lgkmcnt(3)
v_exp_f32 v129, v129
v_mfma_f32_16x16x32_bf16 a[236:239], v[164:167], v[196:199], a[236:239]
s_waitcnt vmcnt(15)
ds_read_b64_tr_b16 v[174:175], v247 offset:6432
v_add_f32 v228, v228, v129
v_mfma_f32_16x16x32_bf16 v[216:219], v[164:167], v[204:207], v[216:219]
s_add_u32 s90, s66, 20480
ds_read_b64_tr_b16 v[164:165], v247 offset:5184
v_cvt_pk_bf16_f32 v128, v128, v129
v_mfma_f32_16x16x32_bf16 v[216:219], v[160:163], v[200:203], v[216:219]
buffer_load_dwordx4 v[188:191], v250, s[4:7], s90 offen sc1
v_mfma_f32_16x16x32_bf16 v[136:139], a[192:195], v[8:11], 0
v_exp_f32 v130, v130
v_mfma_f32_16x16x32_bf16 v[136:139], a[196:199], v[24:27], v[136:139]
ds_read_b64_tr_b16 v[160:161], v247 offset:64
v_add_f32 v228, v228, v130
v_mfma_f32_16x16x32_bf16 v[136:139], a[200:203], v[40:43], v[136:139]
v_exp_f32 v131, v131
v_mfma_f32_16x16x32_bf16 v[136:139], a[204:207], v[56:59], v[136:139]
ds_read_b64_tr_b16 v[162:163], v247 offset:1344
v_add_f32 v228, v228, v131
v_mfma_f32_16x16x32_bf16 v[136:139], a[208:211], v[72:75], v[136:139]
ds_read_b64_tr_b16 v[166:167], v247 offset:6464
v_cvt_pk_bf16_f32 v129, v130, v131
v_mfma_f32_16x16x32_bf16 v[136:139], a[212:215], v[88:91], v[136:139]
v_exp_f32 v132, v132
v_mfma_f32_16x16x32_bf16 v[140:143], a[212:215], v[92:95], 0
ds_read_b128 a[212:215], v249 offset:18688
v_add_f32 v229, v229, v132
v_mfma_f32_16x16x32_bf16 v[140:143], a[208:211], v[76:79], v[140:143]
v_exp_f32 v133, v133
v_mfma_f32_16x16x32_bf16 v[140:143], a[204:207], v[60:63], v[140:143]
s_add_u32 m0, s55, 143360
ds_read_b128 a[204:207], v249 offset:24704
v_add_f32 v229, v229, v133
v_mfma_f32_16x16x32_bf16 v[140:143], a[200:203], v[44:47], v[140:143]
s_add_u32 s61, s61, 163840
ds_read_b128 a[200:203], v248 offset:24704
v_cvt_pk_bf16_f32 v132, v132, v133
v_mfma_f32_16x16x32_bf16 v[140:143], a[196:199], v[28:31], v[140:143]
buffer_load_dwordx4 v242, s[32:35], s61 offen lds
v_mfma_f32_16x16x32_bf16 v[140:143], a[192:195], v[12:15], v[140:143]
s_waitcnt lgkmcnt(9)
v_exp_f32 v134, v134
v_mfma_f32_16x16x32_bf16 a[240:243], v[168:171], v[192:195], a[240:243]
s_waitcnt lgkmcnt(7)
ds_read_b128 a[192:195], v248 offset:24576
v_add_f32 v229, v229, v134
v_mfma_f32_16x16x32_bf16 a[240:243], v[172:175], v[196:199], a[240:243]
v_exp_f32 v135, v135
v_mfma_f32_16x16x32_bf16 v[220:223], v[172:175], v[204:207], v[220:223]
buffer_load_dwordx4 v243, s[32:35], s61 offen offset:1024 lds
v_mfma_f32_16x16x32_bf16 v[220:223], v[168:171], v[200:203], v[220:223]
ds_read_b64_tr_b16 v[168:169], v247 offset:96
v_add_f32 v229, v229, v135
v_mfma_f32_16x16x32_bf16 v[96:99], a[216:219], v[0:3], 0
ds_read_b64_tr_b16 v[170:171], v247 offset:1376
v_cvt_pk_bf16_f32 v133, v134, v135
v_mfma_f32_16x16x32_bf16 v[96:99], a[220:223], v[16:19], v[96:99]
v_exp_f32 v136, v136
v_mfma_f32_16x16x32_bf16 v[96:99], a[224:227], v[32:35], v[96:99]
buffer_load_dwordx4 v244, s[32:35], s61 offen offset:2048 lds
v_mfma_f32_16x16x32_bf16 v[96:99], a[228:231], v[48:51], v[96:99]
ds_read_b64_tr_b16 v[172:173], v247 offset:5216
v_add_f32 v230, v230, v136
v_mfma_f32_16x16x32_bf16 v[96:99], a[232:235], v[64:67], v[96:99]
s_waitcnt lgkmcnt(6)
v_exp_f32 v137, v137
v_mfma_f32_16x16x32_bf16 v[96:99], a[212:215], v[80:83], v[96:99]
ds_read_b64_tr_b16 v[174:175], v247 offset:6496
v_add_f32 v230, v230, v137
v_mfma_f32_16x16x32_bf16 a[244:247], v[160:163], v[192:195], a[244:247]
buffer_load_dwordx4 v245, s[32:35], s61 offen offset:3072 lds
v_mfma_f32_16x16x32_bf16 a[244:247], v[164:167], v[196:199], a[244:247]
ds_read_b128 a[196:199], v249 offset:24576
v_cvt_pk_bf16_f32 v136, v136, v137
v_mfma_f32_16x16x32_bf16 v[208:211], v[164:167], v[204:207], v[208:211]
v_exp_f32 v138, v138
v_mfma_f32_16x16x32_bf16 v[208:211], v[160:163], v[200:203], v[208:211]
s_add_u32 m0, s55, 147456
ds_read_b64_tr_b16 v[160:161], v247 offset:128
v_add_f32 v230, v230, v138
v_mfma_f32_16x16x32_bf16 v[100:103], a[212:215], v[84:87], 0
buffer_load_dwordx4 v246, s[32:35], s61 offen lds
v_mfma_f32_16x16x32_bf16 v[100:103], a[232:235], v[68:71], v[100:103]
v_exp_f32 v96, v96
v_mfma_f32_16x16x32_bf16 v[100:103], a[228:231], v[52:55], v[100:103]
v_exp_f32 v97, v97
v_mfma_f32_16x16x32_bf16 v[100:103], a[224:227], v[36:39], v[100:103]
ds_read_b64_tr_b16 v[162:163], v247 offset:1408
v_cvt_pk_bf16_f32 v130, v96, v97
v_mfma_f32_16x16x32_bf16 v[100:103], a[220:223], v[20:23], v[100:103]
v_exp_f32 v98, v98
v_mfma_f32_16x16x32_bf16 v[100:103], a[216:219], v[4:7], v[100:103]
ds_read_b64_tr_b16 v[164:165], v247 offset:5248
v_add_f32 v228, v228, v98
v_mfma_f32_16x16x32_bf16 v[104:107], a[216:219], v[8:11], 0
v_exp_f32 v99, v99
v_mfma_f32_16x16x32_bf16 v[104:107], a[220:223], v[24:27], v[104:107]
ds_read_b64_tr_b16 v[166:167], v247 offset:6528
v_add_f32 v228, v228, v99
v_mfma_f32_16x16x32_bf16 v[104:107], a[224:227], v[40:43], v[104:107]
ds_read_b128 a[208:211], v248 offset:24832
v_cvt_pk_bf16_f32 v131, v98, v99
v_mfma_f32_16x16x32_bf16 v[104:107], a[228:231], v[56:59], v[104:107]
v_add_f32 v228, v228, v96
v_add_f32 v228, v228, v97
v_mfma_f32_16x16x32_bf16 v[104:107], a[232:235], v[72:75], v[104:107]
v_exp_f32 v100, v100
v_mfma_f32_16x16x32_bf16 v[104:107], a[212:215], v[88:91], v[104:107]
s_waitcnt lgkmcnt(8)
v_exp_f32 v101, v101
v_mfma_f32_16x16x32_bf16 a[248:251], v[168:171], v[192:195], a[248:251]
s_waitcnt lgkmcnt(6)
v_exp_f32 v102, v102
v_mfma_f32_16x16x32_bf16 a[248:251], v[172:175], v[196:199], a[248:251]
v_exp_f32 v103, v103
v_mfma_f32_16x16x32_bf16 v[212:215], v[172:175], v[204:207], v[212:215]
buffer_store_dwordx4 v[248:251], v250, s[4:7], s68 offen sc1
v_mfma_f32_16x16x32_bf16 v[212:215], v[168:171], v[200:203], v[212:215]
ds_read_b64_tr_b16 v[168:169], v232 offset:36864
v_add_f32 v229, v229, v102
v_mfma_f32_16x16x32_bf16 v[108:111], a[212:215], v[92:95], 0
ds_read_b64_tr_b16 v[170:171], v232 offset:43008
v_add_f32 v229, v229, v103
v_mfma_f32_16x16x32_bf16 v[108:111], a[232:235], v[76:79], v[108:111]
s_add_u32 m0, s53, 24576
ds_read_b64_tr_b16 v[172:173], v233 offset:36864
v_cvt_pk_bf16_f32 v135, v102, v103
v_mfma_f32_16x16x32_bf16 v[108:111], a[228:231], v[60:63], v[108:111]
s_add_u32 s60, s60, 12288
ds_read_b64_tr_b16 v[174:175], v233 offset:43008
v_add_f32 v229, v229, v100
v_mfma_f32_16x16x32_bf16 v[108:111], a[224:227], v[44:47], v[108:111]
buffer_load_dwordx4 v239, s[24:27], s60 offen lds
v_mfma_f32_16x16x32_bf16 v[108:111], a[220:223], v[28:31], v[108:111]
ds_read_b128 a[212:215], v249 offset:24832
v_add_f32 v229, v229, v101
v_mfma_f32_16x16x32_bf16 v[108:111], a[216:219], v[12:15], v[108:111]
s_waitcnt lgkmcnt(8)
ds_read_b128 a[216:219], v248 offset:30720
v_cvt_pk_bf16_f32 v134, v100, v101
v_mfma_f32_16x16x32_bf16 a[252:255], v[160:163], v[192:195], a[252:255]
s_waitcnt lgkmcnt(7)
v_exp_f32 v139, v139
v_mfma_f32_16x16x32_bf16 a[252:255], v[164:167], v[196:199], a[252:255]
buffer_load_dwordx4 v240, s[24:27], s60 offen offset:1024 lds
v_mfma_f32_16x16x32_bf16 v[224:227], v[164:167], v[204:207], v[224:227]
ds_read_b64_tr_b16 v[164:165], v235 offset:36864
v_add_f32 v230, v230, v139
v_mfma_f32_16x16x32_bf16 v[224:227], v[160:163], v[200:203], v[224:227]
s_waitcnt lgkmcnt(5)
ds_read_b64_tr_b16 v[160:161], v234 offset:36864
v_cvt_pk_bf16_f32 v137, v138, v139
v_mfma_f32_16x16x32_bf16 a[0:3], v[168:171], v[144:147], a[0:3]
ds_read_b64_tr_b16 v[162:163], v234 offset:43008
v_mfma_f32_16x16x32_bf16 a[4:7], v[168:171], v[148:151], a[4:7]
buffer_load_dwordx4 v241, s[24:27], s60 offen offset:2048 lds
v_mfma_f32_16x16x32_bf16 a[8:11], v[168:171], v[152:155], a[8:11]
v_exp_f32 v104, v104
v_mfma_f32_16x16x32_bf16 a[12:15], v[168:171], v[156:159], a[12:15]
s_waitcnt lgkmcnt(5)
v_exp_f32 v105, v105
v_mfma_f32_16x16x32_bf16 a[28:31], v[172:175], v[156:159], a[28:31]
ds_read_b64_tr_b16 v[166:167], v235 offset:43008
v_cvt_pk_bf16_f32 v138, v104, v105
v_mfma_f32_16x16x32_bf16 a[24:27], v[172:175], v[152:155], a[24:27]
v_exp_f32 v106, v106
v_mfma_f32_16x16x32_bf16 a[20:23], v[172:175], v[148:151], a[20:23]
ds_read_b64_tr_b16 v[168:169], v232 offset:36992
v_add_f32 v230, v230, v106
v_mfma_f32_16x16x32_bf16 a[16:19], v[172:175], v[144:147], a[16:19]
s_waitcnt lgkmcnt(2)
v_exp_f32 v107, v107
v_mfma_f32_16x16x32_bf16 a[32:35], v[160:163], v[144:147], a[32:35]
ds_read_b64_tr_b16 v[170:171], v232 offset:43136
v_add_f32 v230, v230, v107
v_mfma_f32_16x16x32_bf16 a[36:39], v[160:163], v[148:151], a[36:39]
ds_read_b64_tr_b16 v[172:173], v233 offset:36992
v_cvt_pk_bf16_f32 v139, v106, v107
v_mfma_f32_16x16x32_bf16 a[40:43], v[160:163], v[152:155], a[40:43]
s_xor_b32 s3, s76, 1310720
ds_read_b64_tr_b16 v[174:175], v233 offset:43136
v_add_f32 v230, v230, v104
v_mfma_f32_16x16x32_bf16 a[44:47], v[160:163], v[156:159], a[44:47]
s_waitcnt lgkmcnt(4)
buffer_store_dwordx4 v[250:253], v250, s[4:7], s3 offen offset:3072 sc1
v_mfma_f32_16x16x32_bf16 a[60:63], v[164:167], v[156:159], a[60:63]
ds_read_b128 a[220:223], v249 offset:30720
v_add_u32 v253, 98304, v250
v_mfma_f32_16x16x32_bf16 a[56:59], v[164:167], v[152:155], a[56:59]
ds_read_b128 a[224:227], v248 offset:30848
v_add_f32 v230, v230, v105
v_mfma_f32_16x16x32_bf16 a[52:55], v[164:167], v[148:151], a[52:55]
v_exp_f32 v140, v140
v_mfma_f32_16x16x32_bf16 a[48:51], v[164:167], v[144:147], a[48:51]
s_waitcnt lgkmcnt(4)
ds_read_b128 a[228:231], v249 offset:30848
v_add_f32 v231, v231, v140
v_mfma_f32_16x16x32_bf16 a[64:67], v[168:171], v[144:147], a[64:67]
v_exp_f32 v141, v141
v_mfma_f32_16x16x32_bf16 a[68:71], v[168:171], v[148:151], a[68:71]
ds_read_b128 a[232:235], v248 offset:30976
v_add_f32 v231, v231, v141
v_mfma_f32_16x16x32_bf16 a[72:75], v[168:171], v[152:155], a[72:75]
v_exp_f32 v142, v142
v_mfma_f32_16x16x32_bf16 a[76:79], v[168:171], v[156:159], a[76:79]
s_waitcnt lgkmcnt(4)
v_exp_f32 v143, v143
v_mfma_f32_16x16x32_bf16 a[92:95], v[172:175], v[156:159], a[92:95]
v_exp_f32 v108, v108
v_mfma_f32_16x16x32_bf16 a[88:91], v[172:175], v[152:155], a[88:91]
v_exp_f32 v109, v109
v_mfma_f32_16x16x32_bf16 a[84:87], v[172:175], v[148:151], a[84:87]
v_exp_f32 v110, v110
v_mfma_f32_16x16x32_bf16 a[80:83], v[172:175], v[144:147], a[80:83]
v_exp_f32 v111, v111
v_mfma_f32_16x16x32_bf16 v[144:147], a[192:195], v[0:3], 0
s_waitcnt vmcnt(15)
s_barrier
v_mfma_f32_16x16x32_bf16 v[144:147], a[196:199], v[16:19], v[144:147]
ds_read_b64_tr_b16 v[160:161], v247 offset:20480
v_cvt_pk_bf16_f32 v140, v140, v141
v_mfma_f32_16x16x32_bf16 v[144:147], a[200:203], v[32:35], v[144:147]
ds_read_b64_tr_b16 v[162:163], v247 offset:21760
v_add_f32 v231, v231, v142
v_mfma_f32_16x16x32_bf16 v[144:147], a[204:207], v[48:51], v[144:147]
ds_read_b64_tr_b16 v[164:165], v247 offset:25600
v_add_f32 v231, v231, v143
v_mfma_f32_16x16x32_bf16 v[144:147], a[208:211], v[64:67], v[144:147]
s_add_u32 s90, s65, 32768
ds_read_b64_tr_b16 v[166:167], v247 offset:26880
v_cvt_pk_bf16_f32 v141, v142, v143
v_mfma_f32_16x16x32_bf16 v[144:147], a[212:215], v[80:83], v[144:147]
buffer_load_dwordx4 v[192:195], v250, s[4:7], s90 offen sc1
v_mfma_f32_16x16x32_bf16 v[148:151], a[212:215], v[84:87], 0
ds_read_b64_tr_b16 v[168:169], v247 offset:20512
v_add_f32 v231, v231, v110
v_mfma_f32_16x16x32_bf16 v[148:151], a[208:211], v[68:71], v[148:151]
ds_read_b64_tr_b16 v[170:171], v247 offset:21792
v_add_f32 v231, v231, v111
v_mfma_f32_16x16x32_bf16 v[148:151], a[204:207], v[52:55], v[148:151]
s_add_u32 s90, s65, 36864
ds_read_b64_tr_b16 v[172:173], v247 offset:25632
v_cvt_pk_bf16_f32 v143, v110, v111
v_mfma_f32_16x16x32_bf16 v[148:151], a[200:203], v[36:39], v[148:151]
buffer_load_dwordx4 v[196:199], v250, s[4:7], s90 offen sc1
v_mfma_f32_16x16x32_bf16 v[148:151], a[196:199], v[20:23], v[148:151]
s_add_u32 s90, s66, 32768
ds_read_b64_tr_b16 v[174:175], v247 offset:26912
v_add_f32 v231, v231, v108
v_mfma_f32_16x16x32_bf16 v[148:151], a[192:195], v[4:7], v[148:151]
s_waitcnt vmcnt(15) lgkmcnt(6)
ds_read_b96 v[244:246], v253 offset:2048
v_add_f32 v231, v231, v109
v_mfma_f32_16x16x32_bf16 a[236:239], v[160:163], v[176:179], a[236:239]
s_waitcnt vmcnt(14) lgkmcnt(5)
v_exp_f32 v144, v144
v_mfma_f32_16x16x32_bf16 a[236:239], v[164:167], v[180:183], a[236:239]
s_waitcnt vmcnt(12)
buffer_load_dwordx4 v[200:203], v250, s[4:7], s90 offen sc1
v_mfma_f32_16x16x32_bf16 v[216:219], v[164:167], v[188:191], v[216:219]
ds_read_b64_tr_b16 v[164:165], v247 offset:25664
v_cvt_pk_bf16_f32 v142, v108, v109
v_mfma_f32_16x16x32_bf16 v[216:219], v[160:163], v[184:187], v[216:219]
ds_read_b64_tr_b16 v[160:161], v247 offset:20544
v_add_f32 v228, v228, v144
v_mfma_f32_16x16x32_bf16 v[152:155], a[192:195], v[8:11], 0
s_add_u32 s90, s66, 36864
v_exp_f32 v145, v145
v_mfma_f32_16x16x32_bf16 v[152:155], a[196:199], v[24:27], v[152:155]
buffer_load_dwordx4 v[204:207], v250, s[4:7], s90 offen sc1
v_mfma_f32_16x16x32_bf16 v[152:155], a[200:203], v[40:43], v[152:155]
ds_read_b64_tr_b16 v[162:163], v247 offset:21824
v_add_f32 v228, v228, v145
v_mfma_f32_16x16x32_bf16 v[152:155], a[204:207], v[56:59], v[152:155]
ds_read_b64_tr_b16 v[166:167], v247 offset:26944
v_cvt_pk_bf16_f32 v144, v144, v145
v_mfma_f32_16x16x32_bf16 v[152:155], a[208:211], v[72:75], v[152:155]
v_exp_f32 v146, v146
v_mfma_f32_16x16x32_bf16 v[152:155], a[212:215], v[88:91], v[152:155]
v_exp_f32 v147, v147
v_mfma_f32_16x16x32_bf16 v[156:159], a[212:215], v[92:95], 0
ds_read_b128 a[212:215], v249 offset:30976
v_add_f32 v228, v228, v146
v_mfma_f32_16x16x32_bf16 v[156:159], a[208:211], v[76:79], v[156:159]
ds_read_b128 a[208:211], v248 offset:37120
v_add_f32 v228, v228, v147
v_mfma_f32_16x16x32_bf16 v[156:159], a[204:207], v[60:63], v[156:159]
s_add_u32 m0, s53, 36864
ds_read_b128 a[204:207], v249 offset:36992
v_cvt_pk_bf16_f32 v145, v146, v147
v_mfma_f32_16x16x32_bf16 v[156:159], a[200:203], v[44:47], v[156:159]
s_add_u32 s60, s60, 12288
v_exp_f32 v148, v148
v_mfma_f32_16x16x32_bf16 v[156:159], a[196:199], v[28:31], v[156:159]
buffer_load_dwordx4 v239, s[24:27], s60 offen lds
v_mfma_f32_16x16x32_bf16 v[156:159], a[192:195], v[12:15], v[156:159]
s_waitcnt lgkmcnt(10)
ds_read_b128 v[236:239], v253 offset:0
v_add_f32 v229, v229, v148
v_mfma_f32_16x16x32_bf16 a[240:243], v[168:171], v[176:179], a[240:243]
s_waitcnt lgkmcnt(9)
v_exp_f32 v149, v149
v_mfma_f32_16x16x32_bf16 a[240:243], v[172:175], v[180:183], a[240:243]
ds_read_b128 a[192:195], v248 offset:36864
v_add_f32 v229, v229, v149
v_mfma_f32_16x16x32_bf16 v[220:223], v[172:175], v[188:191], v[220:223]
buffer_load_dwordx4 v240, s[24:27], s60 offen offset:1024 lds
v_mfma_f32_16x16x32_bf16 v[220:223], v[168:171], v[184:187], v[220:223]
ds_read_b64_tr_b16 v[168:169], v247 offset:20576
v_cvt_pk_bf16_f32 v148, v148, v149
v_mfma_f32_16x16x32_bf16 v[96:99], a[216:219], v[0:3], 0
v_exp_f32 v150, v150
v_mfma_f32_16x16x32_bf16 v[96:99], a[220:223], v[16:19], v[96:99]
ds_read_b64_tr_b16 v[170:171], v247 offset:21856
v_add_f32 v229, v229, v150
v_mfma_f32_16x16x32_bf16 v[96:99], a[224:227], v[32:35], v[96:99]
buffer_load_dwordx4 v241, s[24:27], s60 offen offset:2048 lds
v_mfma_f32_16x16x32_bf16 v[96:99], a[228:231], v[48:51], v[96:99]
v_exp_f32 v151, v151
v_mfma_f32_16x16x32_bf16 v[96:99], a[232:235], v[64:67], v[96:99]
s_waitcnt lgkmcnt(6)
ds_read_b128 v[240:243], v253 offset:1024
v_add_f32 v229, v229, v151
v_mfma_f32_16x16x32_bf16 v[96:99], a[212:215], v[80:83], v[96:99]
ds_read_b64_tr_b16 v[172:173], v247 offset:25696
v_cvt_pk_bf16_f32 v149, v150, v151
v_mfma_f32_16x16x32_bf16 a[244:247], v[160:163], v[176:179], a[244:247]
ds_read_b64_tr_b16 v[174:175], v247 offset:26976
v_and_b32 v253, 0x300, v250
v_mfma_f32_16x16x32_bf16 a[244:247], v[164:167], v[180:183], a[244:247]
ds_read_b128 a[196:199], v249 offset:36864
v_lshlrev_b32 v253, 6, v253
v_mfma_f32_16x16x32_bf16 v[208:211], v[164:167], v[188:191], v[208:211]
v_exp_f32 v152, v152
v_mfma_f32_16x16x32_bf16 v[208:211], v[160:163], v[184:187], v[208:211]
ds_read_b64_tr_b16 v[160:161], v247 offset:20608
v_add_f32 v230, v230, v152
v_mfma_f32_16x16x32_bf16 v[100:103], a[212:215], v[84:87], 0
s_add_u32 m0, s55, 102400
v_exp_f32 v96, v96
v_mfma_f32_16x16x32_bf16 v[100:103], a[232:235], v[68:71], v[100:103]
s_add_u32 s3, s72, 0
v_exp_f32 v97, v97
v_mfma_f32_16x16x32_bf16 v[100:103], a[228:231], v[52:55], v[100:103]
s_waitcnt lgkmcnt(4)
buffer_load_dwordx4 v242, s[28:31], s3 offen lds
v_mfma_f32_16x16x32_bf16 v[100:103], a[224:227], v[36:39], v[100:103]
ds_read_b64_tr_b16 v[162:163], v247 offset:21888
v_cvt_pk_bf16_f32 v146, v96, v97
v_mfma_f32_16x16x32_bf16 v[100:103], a[220:223], v[20:23], v[100:103]
v_exp_f32 v98, v98
v_mfma_f32_16x16x32_bf16 v[100:103], a[216:219], v[4:7], v[100:103]
ds_read_b64_tr_b16 v[164:165], v247 offset:25728
v_add_f32 v228, v228, v98
v_mfma_f32_16x16x32_bf16 v[104:107], a[216:219], v[8:11], 0
buffer_load_dwordx4 v243, s[28:31], s3 offen offset:1024 lds
v_mfma_f32_16x16x32_bf16 v[104:107], a[220:223], v[24:27], v[104:107]
v_exp_f32 v99, v99
v_mfma_f32_16x16x32_bf16 v[104:107], a[224:227], v[40:43], v[104:107]
ds_read_b64_tr_b16 v[166:167], v247 offset:27008
v_add_f32 v228, v228, v99
v_mfma_f32_16x16x32_bf16 v[104:107], a[228:231], v[56:59], v[104:107]
ds_read_b128 a[200:203], v248 offset:36992
v_cvt_pk_bf16_f32 v147, v98, v99
v_mfma_f32_16x16x32_bf16 v[104:107], a[232:235], v[72:75], v[104:107]
buffer_load_dwordx4 v244, s[28:31], s3 offen offset:2048 lds
v_mfma_f32_16x16x32_bf16 v[104:107], a[212:215], v[88:91], v[104:107]
v_add_f32 v228, v228, v96
v_add_f32 v228, v228, v97
v_mfma_f32_16x16x32_bf16 a[248:251], v[168:171], v[176:179], a[248:251]
s_waitcnt lgkmcnt(6)
v_exp_f32 v100, v100
v_mfma_f32_16x16x32_bf16 a[248:251], v[172:175], v[180:183], a[248:251]
v_exp_f32 v101, v101
v_mfma_f32_16x16x32_bf16 v[212:215], v[172:175], v[188:191], v[212:215]
buffer_load_dwordx4 v245, s[28:31], s3 offen offset:3072 lds
v_mfma_f32_16x16x32_bf16 v[212:215], v[168:171], v[184:187], v[212:215]
v_exp_f32 v102, v102
v_mfma_f32_16x16x32_bf16 v[108:111], a[212:215], v[92:95], 0
ds_read_b128 a[212:215], v249 offset:37120
v_add_f32 v229, v229, v102
v_mfma_f32_16x16x32_bf16 v[108:111], a[232:235], v[76:79], v[108:111]
s_add_u32 m0, s55, 106496
ds_read_b128 a[232:235], v248 offset:43264
v_cvt_pk_bf16_f32 v150, v100, v101
v_mfma_f32_16x16x32_bf16 v[108:111], a[228:231], v[60:63], v[108:111]
L_walk2_1:
s_cbranch_execz L_walk2_5
buffer_load_dwordx4 v246, s[28:31], s3 offen lds
v_mfma_f32_16x16x32_bf16 v[108:111], a[224:227], v[44:47], v[108:111]
v_exp_f32 v103, v103
v_mfma_f32_16x16x32_bf16 v[108:111], a[220:223], v[28:31], v[108:111]
ds_read_b128 a[220:223], v249 offset:43008
v_add_f32 v229, v229, v103
v_mfma_f32_16x16x32_bf16 v[108:111], a[216:219], v[12:15], v[108:111]
s_waitcnt lgkmcnt(6)
ds_read_b128 a[216:219], v248 offset:43008
v_cvt_pk_bf16_f32 v151, v102, v103
v_mfma_f32_16x16x32_bf16 a[252:255], v[160:163], v[176:179], a[252:255]
s_waitcnt lgkmcnt(5)
ds_read_b128 a[224:227], v248 offset:43136
v_add_f32 v229, v229, v100
v_mfma_f32_16x16x32_bf16 a[252:255], v[164:167], v[180:183], a[252:255]
ds_read_b128 a[228:231], v249 offset:43136
v_add_f32 v229, v229, v101
v_mfma_f32_16x16x32_bf16 v[224:227], v[164:167], v[188:191], v[224:227]
v_exp_f32 v153, v153
v_mfma_f32_16x16x32_bf16 v[224:227], v[160:163], v[184:187], v[224:227]
v_exp_f32 v154, v154
v_mfma_f32_16x16x32_bf16 v[176:179], a[192:195], v[0:3], 0
s_waitcnt vmcnt(13)
s_barrier
v_mfma_f32_16x16x32_bf16 v[176:179], a[196:199], v[16:19], v[176:179]
s_waitcnt lgkmcnt(6)
ds_read_b64_tr_b16 v[168:169], v247 offset:40960
v_add_f32 v230, v230, v153
v_mfma_f32_16x16x32_bf16 v[176:179], a[200:203], v[32:35], v[176:179]
s_add_u32 m0, s55, 61440
ds_read_b64_tr_b16 v[170:171], v247 offset:42240
v_cvt_pk_bf16_f32 v152, v152, v153
v_mfma_f32_16x16x32_bf16 v[176:179], a[204:207], v[48:51], v[176:179]
s_add_u32 s3, s72, 81920
ds_read_b64_tr_b16 v[172:173], v247 offset:46080
v_add_f32 v230, v230, v154
v_mfma_f32_16x16x32_bf16 v[176:179], a[208:211], v[64:67], v[176:179]
s_waitcnt lgkmcnt(8)
buffer_load_dwordx4 v242, s[28:31], s3 offen lds
v_mfma_f32_16x16x32_bf16 v[176:179], a[212:215], v[80:83], v[176:179]
ds_read_b64_tr_b16 v[174:175], v247 offset:47360
v_mfma_f32_16x16x32_bf16 v[180:183], a[212:215], v[84:87], 0
v_exp_f32 v155, v155
v_mfma_f32_16x16x32_bf16 v[180:183], a[208:211], v[68:71], v[180:183]
ds_read_b64_tr_b16 v[160:161], v247 offset:40992
v_add_f32 v230, v230, v155
v_mfma_f32_16x16x32_bf16 v[180:183], a[204:207], v[52:55], v[180:183]
buffer_load_dwordx4 v243, s[28:31], s3 offen offset:1024 lds
v_mfma_f32_16x16x32_bf16 v[180:183], a[200:203], v[36:39], v[180:183]
ds_read_b64_tr_b16 v[162:163], v247 offset:42272
v_cvt_pk_bf16_f32 v153, v154, v155
v_mfma_f32_16x16x32_bf16 v[180:183], a[196:199], v[20:23], v[180:183]
v_exp_f32 v104, v104
v_mfma_f32_16x16x32_bf16 v[180:183], a[192:195], v[4:7], v[180:183]
s_waitcnt vmcnt(13) lgkmcnt(4)
v_exp_f32 v105, v105
v_mfma_f32_16x16x32_bf16 a[236:239], v[168:171], v[192:195], a[236:239]
s_waitcnt vmcnt(12) lgkmcnt(2)
buffer_load_dwordx4 v244, s[28:31], s3 offen offset:2048 lds
v_mfma_f32_16x16x32_bf16 a[236:239], v[172:175], v[196:199], a[236:239]
s_waitcnt vmcnt(11)
ds_read_b64_tr_b16 v[164:165], v247 offset:46112
v_cvt_pk_bf16_f32 v154, v104, v105
v_mfma_f32_16x16x32_bf16 v[216:219], v[172:175], v[204:207], v[216:219]
v_exp_f32 v106, v106
v_mfma_f32_16x16x32_bf16 v[216:219], v[168:171], v[200:203], v[216:219]
ds_read_b64_tr_b16 v[166:167], v247 offset:47392
v_add_f32 v230, v230, v106
v_mfma_f32_16x16x32_bf16 v[184:187], a[192:195], v[8:11], 0
buffer_load_dwordx4 v245, s[28:31], s3 offen offset:3072 lds
v_mfma_f32_16x16x32_bf16 v[184:187], a[196:199], v[24:27], v[184:187]
v_exp_f32 v107, v107
v_mfma_f32_16x16x32_bf16 v[184:187], a[200:203], v[40:43], v[184:187]
ds_read_b64_tr_b16 v[168:169], v247 offset:41024
v_add_f32 v230, v230, v107
v_mfma_f32_16x16x32_bf16 v[184:187], a[204:207], v[56:59], v[184:187]
s_add_u32 m0, s55, 65536
ds_read_b64_tr_b16 v[170:171], v247 offset:42304
v_cvt_pk_bf16_f32 v155, v106, v107
v_mfma_f32_16x16x32_bf16 v[184:187], a[208:211], v[72:75], v[184:187]
buffer_load_dwordx4 v246, s[28:31], s3 offen lds
v_mfma_f32_16x16x32_bf16 v[184:187], a[212:215], v[88:91], v[184:187]
ds_read_b64_tr_b16 v[172:173], v247 offset:46144
v_add_f32 v230, v230, v104
v_mfma_f32_16x16x32_bf16 v[188:191], a[212:215], v[92:95], 0
ds_read_b128 a[212:215], v249 offset:43264
v_add_f32 v230, v230, v105
v_mfma_f32_16x16x32_bf16 v[188:191], a[208:211], v[76:79], v[188:191]
v_exp_f32 v156, v156
v_mfma_f32_16x16x32_bf16 v[188:191], a[204:207], v[60:63], v[188:191]
ds_read_b64_tr_b16 v[174:175], v247 offset:47424
v_add_f32 v231, v231, v156
v_mfma_f32_16x16x32_bf16 v[188:191], a[200:203], v[44:47], v[188:191]
s_add_u32 m0, s55, 122880
v_exp_f32 v157, v157
v_mfma_f32_16x16x32_bf16 v[188:191], a[196:199], v[28:31], v[188:191]
s_add_u32 s3, s72, 163840
v_exp_f32 v158, v158
v_mfma_f32_16x16x32_bf16 v[188:191], a[192:195], v[12:15], v[188:191]
s_waitcnt lgkmcnt(7)
buffer_load_dwordx4 v242, s[28:31], s3 offen lds
v_mfma_f32_16x16x32_bf16 a[240:243], v[160:163], v[192:195], a[240:243]
s_waitcnt lgkmcnt(5)
v_exp_f32 v159, v159
v_mfma_f32_16x16x32_bf16 a[240:243], v[164:167], v[196:199], a[240:243]
v_exp_f32 v108, v108
v_mfma_f32_16x16x32_bf16 v[220:223], v[164:167], v[204:207], v[220:223]
ds_read_b64_tr_b16 v[164:165], v247 offset:46176
v_add_f32 v231, v231, v157
v_mfma_f32_16x16x32_bf16 v[220:223], v[160:163], v[200:203], v[220:223]
buffer_load_dwordx4 v243, s[28:31], s3 offen offset:1024 lds
v_mfma_f32_16x16x32_bf16 v[96:99], a[216:219], v[0:3], 0
ds_read_b64_tr_b16 v[160:161], v247 offset:41056
v_cvt_pk_bf16_f32 v156, v156, v157
v_mfma_f32_16x16x32_bf16 v[96:99], a[220:223], v[16:19], v[96:99]
ds_read_b64_tr_b16 v[162:163], v247 offset:42336
v_add_f32 v231, v231, v158
v_mfma_f32_16x16x32_bf16 v[96:99], a[224:227], v[32:35], v[96:99]
ds_read_b64_tr_b16 v[166:167], v247 offset:47456
v_add_f32 v231, v231, v159
v_mfma_f32_16x16x32_bf16 v[96:99], a[228:231], v[48:51], v[96:99]
buffer_load_dwordx4 v244, s[28:31], s3 offen offset:2048 lds
v_mfma_f32_16x16x32_bf16 v[96:99], a[232:235], v[64:67], v[96:99]
s_waitcnt lgkmcnt(5)
v_exp_f32 v109, v109
v_mfma_f32_16x16x32_bf16 v[96:99], a[212:215], v[80:83], v[96:99]
v_exp_f32 v110, v110
v_mfma_f32_16x16x32_bf16 a[244:247], v[168:171], v[192:195], a[244:247]
s_waitcnt lgkmcnt(4)
v_exp_f32 v111, v111
v_mfma_f32_16x16x32_bf16 a[244:247], v[172:175], v[196:199], a[244:247]
buffer_load_dwordx4 v245, s[28:31], s3 offen offset:3072 lds
v_mfma_f32_16x16x32_bf16 v[208:211], v[172:175], v[204:207], v[208:211]
ds_read_b64_tr_b16 v[172:173], v247 offset:46208
v_cvt_pk_bf16_f32 v157, v158, v159
v_mfma_f32_16x16x32_bf16 v[208:211], v[168:171], v[200:203], v[208:211]
ds_read_b64_tr_b16 v[168:169], v247 offset:41088
v_add_f32 v231, v231, v110
v_mfma_f32_16x16x32_bf16 v[100:103], a[212:215], v[84:87], 0
ds_read_b64_tr_b16 v[170:171], v247 offset:42368
v_add_f32 v231, v231, v111
v_mfma_f32_16x16x32_bf16 v[100:103], a[232:235], v[68:71], v[100:103]
ds_read_b64_tr_b16 v[174:175], v247 offset:47488
v_cvt_pk_bf16_f32 v159, v110, v111
v_mfma_f32_16x16x32_bf16 v[100:103], a[228:231], v[52:55], v[100:103]
ds_read_b64_tr_b16 a[192:193], v232 offset:0
v_add_f32 v231, v231, v108
v_mfma_f32_16x16x32_bf16 v[100:103], a[224:227], v[36:39], v[100:103]
ds_read_b64_tr_b16 a[194:195], v232 offset:6144
v_add_f32 v231, v231, v109
v_mfma_f32_16x16x32_bf16 v[100:103], a[220:223], v[20:23], v[100:103]
s_add_u32 m0, s55, 126976
ds_read_b64_tr_b16 a[196:197], v232 offset:12288
v_cvt_pk_bf16_f32 v158, v108, v109
v_mfma_f32_16x16x32_bf16 v[100:103], a[216:219], v[4:7], v[100:103]
buffer_load_dwordx4 v246, s[28:31], s3 offen lds
v_mfma_f32_16x16x32_bf16 v[104:107], a[216:219], v[8:11], 0
ds_read_b64_tr_b16 a[198:199], v232 offset:18432
v_add_u32 v247, s67, v250
v_mfma_f32_16x16x32_bf16 v[104:107], a[220:223], v[24:27], v[104:107]
v_exp_f32 v176, v176
v_mfma_f32_16x16x32_bf16 v[104:107], a[224:227], v[40:43], v[104:107]
ds_read_b64_tr_b16 a[200:201], v232 offset:24576
v_add_f32 v228, v228, v176
v_mfma_f32_16x16x32_bf16 v[104:107], a[228:231], v[56:59], v[104:107]
v_exp_f32 v177, v177
v_mfma_f32_16x16x32_bf16 v[104:107], a[232:235], v[72:75], v[104:107]
ds_read_b64_tr_b16 a[202:203], v232 offset:30720
v_add_f32 v228, v228, v177
v_mfma_f32_16x16x32_bf16 v[104:107], a[212:215], v[88:91], v[104:107]
s_waitcnt lgkmcnt(11)
v_exp_f32 v178, v178
v_mfma_f32_16x16x32_bf16 a[248:251], v[160:163], v[192:195], a[248:251]
s_waitcnt lgkmcnt(10)
v_exp_f32 v179, v179
v_mfma_f32_16x16x32_bf16 a[248:251], v[164:167], v[196:199], a[248:251]
v_exp_f32 v96, v96
v_mfma_f32_16x16x32_bf16 v[212:215], v[164:167], v[204:207], v[212:215]
v_exp_f32 v97, v97
v_mfma_f32_16x16x32_bf16 v[212:215], v[160:163], v[200:203], v[212:215]
v_exp_f32 v98, v98
v_mfma_f32_16x16x32_bf16 v[108:111], a[212:215], v[92:95], 0
s_waitcnt vmcnt(15) lgkmcnt(6)
s_barrier
v_mfma_f32_16x16x32_bf16 v[108:111], a[232:235], v[76:79], v[108:111]
s_add_u32 m0, s55, 81920
ds_read_b64_tr_b16 a[204:205], v232 offset:36864
v_add_f32 v228, v228, v178
v_mfma_f32_16x16x32_bf16 v[108:111], a[228:231], v[60:63], v[108:111]
s_add_u32 s3, s73, 0
ds_read_b64_tr_b16 a[206:207], v232 offset:43008
v_add_f32 v228, v228, v179
v_mfma_f32_16x16x32_bf16 v[108:111], a[224:227], v[44:47], v[108:111]
buffer_load_dwordx4 v242, s[28:31], s3 offen lds
v_mfma_f32_16x16x32_bf16 v[108:111], a[220:223], v[28:31], v[108:111]
v_exp_f32 v99, v99
v_mfma_f32_16x16x32_bf16 v[108:111], a[216:219], v[12:15], v[108:111]
v_exp_f32 v180, v180
v_mfma_f32_16x16x32_bf16 a[252:255], v[168:171], v[192:195], a[252:255]
v_exp_f32 v181, v181
v_mfma_f32_16x16x32_bf16 a[252:255], v[172:175], v[196:199], a[252:255]
v_exp_f32 v182, v182
v_mfma_f32_16x16x32_bf16 v[224:227], v[172:175], v[204:207], v[224:227]
v_exp_f32 v183, v183
v_mfma_f32_16x16x32_bf16 v[224:227], v[168:171], v[200:203], v[224:227]
s_waitcnt lgkmcnt(6)
ds_read_b64_tr_b16 a[208:209], v233 offset:0
v_add_f32 v228, v228, v98
v_mfma_f32_16x16x32_bf16 a[0:3], a[192:195], v[112:115], a[0:3]
s_waitcnt lgkmcnt(5)
v_add_f32 v228, v228, v99
v_cvt_pk_bf16_f32 v99, v98, v99
v_mfma_f32_16x16x32_bf16 a[0:3], a[196:199], v[128:131], a[0:3]
v_add_f32 v228, v228, v96
v_add_f32 v228, v228, v97
v_cvt_pk_bf16_f32 v98, v96, v97
v_cvt_pk_bf16_f32 v96, v176, v177
v_cvt_pk_bf16_f32 v97, v178, v179
v_exp_f32 v100, v100
v_exp_f32 v101, v101
v_exp_f32 v102, v102
v_exp_f32 v103, v103
s_waitcnt lgkmcnt(3)
v_mfma_f32_16x16x32_bf16 a[0:3], a[200:203], v[144:147], a[0:3]
v_add_f32 v229, v229, v180
v_add_f32 v229, v229, v181
v_add_f32 v229, v229, v182
v_add_f32 v229, v229, v183
v_add_f32 v229, v229, v102
v_add_f32 v229, v229, v103
v_cvt_pk_bf16_f32 v103, v102, v103
v_add_f32 v229, v229, v100
v_add_f32 v229, v229, v101
v_cvt_pk_bf16_f32 v102, v100, v101
v_cvt_pk_bf16_f32 v100, v180, v181
v_cvt_pk_bf16_f32 v101, v182, v183
s_waitcnt lgkmcnt(1)
v_mfma_f32_16x16x32_bf16 a[0:3], a[204:207], v[96:99], a[0:3]
buffer_load_dwordx4 v243, s[28:31], s3 offen offset:1024 lds
v_mfma_f32_16x16x32_bf16 a[4:7], a[204:207], v[100:103], a[4:7]
v_exp_f32 v184, v184
v_mfma_f32_16x16x32_bf16 a[4:7], a[200:203], v[148:151], a[4:7]
v_exp_f32 v185, v185
v_mfma_f32_16x16x32_bf16 a[4:7], a[196:199], v[132:135], a[4:7]
v_exp_f32 v186, v186
v_mfma_f32_16x16x32_bf16 a[4:7], a[192:195], v[116:119], a[4:7]
v_exp_f32 v187, v187
v_mfma_f32_16x16x32_bf16 a[8:11], a[192:195], v[120:123], a[8:11]
v_exp_f32 v104, v104
v_exp_f32 v105, v105
v_exp_f32 v106, v106
v_exp_f32 v107, v107
v_mfma_f32_16x16x32_bf16 a[8:11], a[196:199], v[136:139], a[8:11]
v_add_f32 v230, v230, v184
v_add_f32 v230, v230, v185
v_add_f32 v230, v230, v186
v_add_f32 v230, v230, v187
v_exp_f32 v188, v188
v_exp_f32 v189, v189
v_exp_f32 v190, v190
v_exp_f32 v191, v191
v_add_f32 v230, v230, v106
v_add_f32 v230, v230, v107
v_cvt_pk_bf16_f32 v107, v106, v107
v_add_f32 v230, v230, v104
v_add_f32 v230, v230, v105
v_cvt_pk_bf16_f32 v106, v104, v105
v_cvt_pk_bf16_f32 v104, v184, v185
v_cvt_pk_bf16_f32 v105, v186, v187
v_exp_f32 v108, v108
v_exp_f32 v109, v109
v_exp_f32 v110, v110
v_exp_f32 v111, v111
buffer_load_dwordx4 v244, s[28:31], s3 offen offset:2048 lds
ds_read_b64_tr_b16 a[210:211], v233 offset:6144
v_mfma_f32_16x16x32_bf16 a[8:11], a[200:203], v[152:155], a[8:11]
v_add_f32 v231, v231, v188
v_add_f32 v231, v231, v189
v_add_f32 v231, v231, v190
v_add_f32 v231, v231, v191
v_add_f32 v231, v231, v110
v_add_f32 v231, v231, v111
v_cvt_pk_bf16_f32 v111, v110, v111
v_add_f32 v231, v231, v108
v_add_f32 v231, v231, v109
v_cvt_pk_bf16_f32 v110, v108, v109
v_cvt_pk_bf16_f32 v108, v188, v189
v_cvt_pk_bf16_f32 v109, v190, v191
ds_read_b64_tr_b16 a[212:213], v233 offset:12288
ds_read_b64_tr_b16 a[214:215], v233 offset:18432
v_mfma_f32_16x16x32_bf16 a[8:11], a[204:207], v[104:107], a[8:11]
ds_read_b64_tr_b16 a[216:217], v233 offset:24576
ds_read_b64_tr_b16 a[218:219], v233 offset:30720
v_mfma_f32_16x16x32_bf16 a[12:15], a[204:207], v[108:111], a[12:15]
ds_read_b64_tr_b16 a[220:221], v233 offset:36864
ds_read_b64_tr_b16 a[222:223], v233 offset:43008
v_mfma_f32_16x16x32_bf16 a[12:15], a[200:203], v[156:159], a[12:15]
buffer_load_dwordx4 v245, s[28:31], s3 offen offset:3072 lds
v_mfma_f32_16x16x32_bf16 a[12:15], a[196:199], v[140:143], a[12:15]
s_add_u32 m0, s55, 86016
ds_read_b64_tr_b16 a[224:225], v234 offset:0
v_mov_b32 v160, v228
v_mfma_f32_16x16x32_bf16 a[12:15], a[192:195], v[124:127], a[12:15]
s_waitcnt lgkmcnt(7)
ds_read_b64_tr_b16 a[226:227], v234 offset:6144
v_mov_b32 v161, v229
v_mfma_f32_16x16x32_bf16 a[28:31], a[208:211], v[124:127], a[28:31]
s_waitcnt lgkmcnt(6)
ds_read_b64_tr_b16 a[228:229], v234 offset:12288
v_mov_b32 v162, v230
v_mfma_f32_16x16x32_bf16 a[28:31], a[212:215], v[140:143], a[28:31]
s_waitcnt lgkmcnt(5)
buffer_load_dwordx4 v246, s[28:31], s3 offen lds
v_mfma_f32_16x16x32_bf16 a[28:31], a[216:219], v[156:159], a[28:31]
s_waitcnt lgkmcnt(3)
ds_read_b64_tr_b16 a[230:231], v234 offset:18432
v_mov_b32 v163, v231
v_mfma_f32_16x16x32_bf16 a[28:31], a[220:223], v[108:111], a[28:31]
s_add_u32 m0, s55, 143360
ds_read_b64_tr_b16 a[232:233], v234 offset:24576
v_permlane16_swap_b32 v160, v228
v_mfma_f32_16x16x32_bf16 a[24:27], a[220:223], v[104:107], a[24:27]
s_add_u32 s3, s74, 0
ds_read_b64_tr_b16 a[234:235], v234 offset:30720
v_permlane16_swap_b32 v161, v229
v_mfma_f32_16x16x32_bf16 a[24:27], a[216:219], v[152:155], a[24:27]
buffer_load_dwordx4 v242, s[28:31], s3 offen lds
v_mfma_f32_16x16x32_bf16 a[24:27], a[212:215], v[136:139], a[24:27]
ds_read_b64_tr_b16 a[192:193], v234 offset:36864
v_permlane16_swap_b32 v162, v230
v_mfma_f32_16x16x32_bf16 a[24:27], a[208:211], v[120:123], a[24:27]
ds_read_b64_tr_b16 a[194:195], v234 offset:43008
v_permlane16_swap_b32 v163, v231
v_mfma_f32_16x16x32_bf16 a[20:23], a[208:211], v[116:119], a[20:23]
ds_write_b128 v247, v[224:227] offset:57344
v_add_f32 v228, v160, v228
v_mfma_f32_16x16x32_bf16 a[20:23], a[212:215], v[132:135], a[20:23]
buffer_load_dwordx4 v243, s[28:31], s3 offen offset:1024 lds
v_mfma_f32_16x16x32_bf16 a[20:23], a[216:219], v[148:151], a[20:23]
ds_read_b64_tr_b16 a[196:197], v235 offset:0
v_add_f32 v229, v161, v229
v_mfma_f32_16x16x32_bf16 a[20:23], a[220:223], v[100:103], a[20:23]
ds_read_b64_tr_b16 a[198:199], v235 offset:6144
v_add_f32 v230, v162, v230
v_mfma_f32_16x16x32_bf16 a[16:19], a[220:223], v[96:99], a[16:19]
ds_read_b64_tr_b16 a[200:201], v235 offset:12288
v_add_f32 v231, v163, v231
v_mfma_f32_16x16x32_bf16 a[16:19], a[216:219], v[144:147], a[16:19]
v_mov_b32 v160, v228
v_mov_b32 v161, v229
v_mfma_f32_16x16x32_bf16 a[16:19], a[212:215], v[128:131], a[16:19]
v_mov_b32 v162, v230
v_mov_b32 v163, v231
v_mfma_f32_16x16x32_bf16 a[16:19], a[208:211], v[112:115], a[16:19]
v_permlane32_swap_b32 v160, v228
v_permlane32_swap_b32 v161, v229
v_permlane32_swap_b32 v162, v230
v_permlane32_swap_b32 v163, v231
v_add_f32 v228, v160, v228
v_add_f32 v229, v161, v229
v_add_f32 v230, v162, v230
v_add_f32 v231, v163, v231
v_max3_f32 v160, v228, v229, v230
v_max_f32 v160, v160, v231
s_waitcnt lgkmcnt(10)
v_mfma_f32_16x16x32_bf16 a[32:35], a[224:227], v[112:115], a[32:35]
s_waitcnt lgkmcnt(8)
v_rcp_f32 v228, v228
v_rcp_f32 v229, v229
v_rcp_f32 v230, v230
v_rcp_f32 v231, v231
v_mfma_f32_16x16x32_bf16 a[32:35], a[228:231], v[128:131], a[32:35]
s_waitcnt lgkmcnt(6)
v_max3_f32 v160, v160, v228, v229
v_max3_f32 v160, v160, v230, v231
v_cmp_lt_f32 vcc, 0x4b800000, v160
v_mfma_f32_16x16x32_bf16 a[32:35], a[232:235], v[144:147], a[32:35]
s_cbranch_vccnz L_fallback
L_join:
buffer_load_dwordx4 v244, s[28:31], s3 offen offset:2048 lds
s_waitcnt lgkmcnt(4)
v_mfma_f32_16x16x32_bf16 a[32:35], a[192:195], v[96:99], a[32:35]
ds_read_b64_tr_b16 a[202:203], v235 offset:18432
v_accvgpr_read_b32 v224, a0
v_mfma_f32_16x16x32_bf16 a[36:39], a[192:195], v[100:103], a[36:39]
ds_read_b64_tr_b16 a[204:205], v235 offset:24576
v_accvgpr_read_b32 v225, a1
v_mfma_f32_16x16x32_bf16 a[36:39], a[232:235], v[148:151], a[36:39]
ds_read_b64_tr_b16 a[206:207], v235 offset:30720
v_accvgpr_read_b32 v226, a2
v_mfma_f32_16x16x32_bf16 a[36:39], a[228:231], v[132:135], a[36:39]
buffer_load_dwordx4 v245, s[28:31], s3 offen offset:3072 lds
v_mfma_f32_16x16x32_bf16 a[36:39], a[224:227], v[116:119], a[36:39]
ds_read_b64_tr_b16 a[208:209], v235 offset:36864
v_accvgpr_read_b32 v227, a3
v_mfma_f32_16x16x32_bf16 a[40:43], a[224:227], v[120:123], a[40:43]
ds_read_b64_tr_b16 a[210:211], v235 offset:43008
v_mul_f32 v224, v224, v228
v_mfma_f32_16x16x32_bf16 a[40:43], a[228:231], v[136:139], a[40:43]
s_add_u32 m0, s55, 147456
ds_read_b64_tr_b16 a[212:213], v232 offset:128
v_mul_f32 v225, v225, v228
v_mfma_f32_16x16x32_bf16 a[40:43], a[232:235], v[152:155], a[40:43]
buffer_load_dwordx4 v246, s[28:31], s3 offen lds
v_mfma_f32_16x16x32_bf16 a[40:43], a[192:195], v[104:107], a[40:43]
ds_read_b64_tr_b16 a[214:215], v232 offset:6272
v_mul_f32 v226, v226, v228
v_mfma_f32_16x16x32_bf16 a[44:47], a[192:195], v[108:111], a[44:47]
ds_read_b64_tr_b16 a[216:217], v232 offset:12416
v_mul_f32 v227, v227, v228
v_mfma_f32_16x16x32_bf16 a[44:47], a[232:235], v[156:159], a[44:47]
ds_read_b64_tr_b16 a[218:219], v232 offset:18560
v_cvt_pk_bf16_f32 v160, v224, v225
v_mfma_f32_16x16x32_bf16 a[44:47], a[228:231], v[140:143], a[44:47]
s_xor_b32 s91, s76, 0
v_cvt_pk_bf16_f32 v161, v226, v227
v_accvgpr_read_b32 v224, a16
v_mfma_f32_16x16x32_bf16 a[44:47], a[224:227], v[124:127], a[44:47]
v_accvgpr_read_b32 v225, a17
v_accvgpr_read_b32 v226, a18
v_accvgpr_read_b32 v227, a19
v_mul_f32 v224, v224, v228
v_mul_f32 v225, v225, v228
v_mul_f32 v226, v226, v228
v_mul_f32 v227, v227, v228
v_cvt_pk_bf16_f32 v162, v224, v225
v_cvt_pk_bf16_f32 v163, v226, v227
s_waitcnt lgkmcnt(10)
v_mfma_f32_16x16x32_bf16 a[60:63], a[196:199], v[124:127], a[60:63]
s_waitcnt lgkmcnt(8)
buffer_store_dwordx4 v[160:163], v250, s[4:7], s91 offen sc1
v_mfma_f32_16x16x32_bf16 a[60:63], a[200:203], v[140:143], a[60:63]
s_waitcnt lgkmcnt(6)
ds_read_b64_tr_b16 a[220:221], v232 offset:24704
v_accvgpr_read_b32 v224, a4
v_mfma_f32_16x16x32_bf16 a[60:63], a[204:207], v[156:159], a[60:63]
s_waitcnt lgkmcnt(5)
ds_read_b64_tr_b16 a[222:223], v232 offset:30848
v_accvgpr_read_b32 v225, a5
v_mfma_f32_16x16x32_bf16 a[60:63], a[208:211], v[108:111], a[60:63]
ds_read_b64_tr_b16 a[224:225], v232 offset:36992
v_accvgpr_read_b32 v226, a6
v_mfma_f32_16x16x32_bf16 a[56:59], a[208:211], v[104:107], a[56:59]
ds_read_b64_tr_b16 a[226:227], v232 offset:43136
v_accvgpr_read_b32 v227, a7
v_mfma_f32_16x16x32_bf16 a[56:59], a[204:207], v[152:155], a[56:59]
ds_write_b128 v247, v[208:211] offset:49152
v_mul_f32 v224, v224, v229
v_mfma_f32_16x16x32_bf16 a[56:59], a[200:203], v[136:139], a[56:59]
ds_write_b128 v247, v[212:215] offset:53248
v_mul_f32 v225, v225, v229
v_mfma_f32_16x16x32_bf16 a[56:59], a[196:199], v[120:123], a[56:59]
v_mul_f32 v226, v226, v229
v_mul_f32 v227, v227, v229
v_mfma_f32_16x16x32_bf16 a[52:55], a[196:199], v[116:119], a[52:55]
ds_read_b64_tr_b16 a[228:229], v233 offset:128
v_cvt_pk_bf16_f32 v164, v224, v225
v_mfma_f32_16x16x32_bf16 a[52:55], a[200:203], v[132:135], a[52:55]
ds_read_b64_tr_b16 a[230:231], v233 offset:6272
v_cvt_pk_bf16_f32 v165, v226, v227
v_mfma_f32_16x16x32_bf16 a[52:55], a[204:207], v[148:151], a[52:55]
ds_read_b64_tr_b16 a[232:233], v233 offset:12416
v_accvgpr_read_b32 v224, a20
v_mfma_f32_16x16x32_bf16 a[52:55], a[208:211], v[100:103], a[52:55]
v_accvgpr_read_b32 v225, a21
v_accvgpr_read_b32 v226, a22
v_mfma_f32_16x16x32_bf16 a[48:51], a[208:211], v[96:99], a[48:51]
v_accvgpr_read_b32 v227, a23
v_mul_f32 v224, v224, v229
v_mul_f32 v225, v225, v229
v_mul_f32 v226, v226, v229
v_mul_f32 v227, v227, v229
v_cvt_pk_bf16_f32 v166, v224, v225
v_cvt_pk_bf16_f32 v167, v226, v227
v_mfma_f32_16x16x32_bf16 a[48:51], a[204:207], v[144:147], a[48:51]
buffer_store_dwordx4 v[164:167], v250, s[4:7], s91 offen offset:1024 sc1
v_mfma_f32_16x16x32_bf16 a[48:51], a[200:203], v[128:131], a[48:51]
ds_read_b64_tr_b16 a[234:235], v233 offset:18560
v_accvgpr_read_b32 v224, a8
v_mfma_f32_16x16x32_bf16 a[48:51], a[196:199], v[112:115], a[48:51]
s_waitcnt lgkmcnt(12)
ds_read_b64_tr_b16 a[192:193], v233 offset:24704
v_accvgpr_read_b32 v225, a9
v_mfma_f32_16x16x32_bf16 a[64:67], a[212:215], v[112:115], a[64:67]
s_waitcnt lgkmcnt(11)
ds_read_b64_tr_b16 a[194:195], v233 offset:30848
v_accvgpr_read_b32 v226, a10
v_mfma_f32_16x16x32_bf16 a[64:67], a[216:219], v[128:131], a[64:67]
s_waitcnt lgkmcnt(10)
ds_read_b64_tr_b16 a[196:197], v233 offset:36992
v_accvgpr_read_b32 v227, a11
v_mfma_f32_16x16x32_bf16 a[64:67], a[220:223], v[144:147], a[64:67]
s_waitcnt lgkmcnt(9)
ds_read_b64_tr_b16 a[198:199], v233 offset:43136
v_mul_f32 v224, v224, v230
v_mfma_f32_16x16x32_bf16 a[64:67], a[224:227], v[96:99], a[64:67]
v_mul_f32 v225, v225, v230
v_mul_f32 v226, v226, v230
v_mfma_f32_16x16x32_bf16 a[68:71], a[224:227], v[100:103], a[68:71]
v_mul_f32 v227, v227, v230
v_cvt_pk_bf16_f32 v168, v224, v225
v_mfma_f32_16x16x32_bf16 a[68:71], a[220:223], v[148:151], a[68:71]
v_cvt_pk_bf16_f32 v169, v226, v227
v_accvgpr_read_b32 v224, a24
v_mfma_f32_16x16x32_bf16 a[68:71], a[216:219], v[132:135], a[68:71]
v_accvgpr_read_b32 v225, a25
v_accvgpr_read_b32 v226, a26
v_mfma_f32_16x16x32_bf16 a[68:71], a[212:215], v[116:119], a[68:71]
v_accvgpr_read_b32 v227, a27
v_mul_f32 v224, v224, v230
v_mfma_f32_16x16x32_bf16 a[72:75], a[212:215], v[120:123], a[72:75]
v_mul_f32 v225, v225, v230
v_mul_f32 v226, v226, v230
v_mfma_f32_16x16x32_bf16 a[72:75], a[216:219], v[136:139], a[72:75]
v_mul_f32 v227, v227, v230
v_cvt_pk_bf16_f32 v170, v224, v225
v_cvt_pk_bf16_f32 v171, v226, v227
v_mfma_f32_16x16x32_bf16 a[72:75], a[220:223], v[152:155], a[72:75]
buffer_store_dwordx4 v[168:171], v250, s[4:7], s91 offen offset:2048 sc1
v_mfma_f32_16x16x32_bf16 a[72:75], a[224:227], v[104:107], a[72:75]
ds_read_b64_tr_b16 a[200:201], v234 offset:128
v_accvgpr_read_b32 v224, a12
v_mfma_f32_16x16x32_bf16 a[76:79], a[224:227], v[108:111], a[76:79]
ds_read_b64_tr_b16 a[202:203], v234 offset:6272
v_accvgpr_read_b32 v225, a13
v_mfma_f32_16x16x32_bf16 a[76:79], a[220:223], v[156:159], a[76:79]
ds_read_b64_tr_b16 a[204:205], v234 offset:12416
v_accvgpr_read_b32 v226, a14
v_mfma_f32_16x16x32_bf16 a[76:79], a[216:219], v[140:143], a[76:79]
ds_read_b64_tr_b16 a[206:207], v234 offset:18560
v_accvgpr_read_b32 v227, a15
v_mfma_f32_16x16x32_bf16 a[76:79], a[212:215], v[124:127], a[76:79]
s_waitcnt lgkmcnt(10)
ds_read_b64_tr_b16 a[208:209], v234 offset:24704
v_mul_f32 v224, v224, v231
v_mfma_f32_16x16x32_bf16 a[92:95], a[228:231], v[124:127], a[92:95]
s_waitcnt lgkmcnt(9)
ds_read_b64_tr_b16 a[210:211], v234 offset:30848
v_mul_f32 v225, v225, v231
v_mfma_f32_16x16x32_bf16 a[92:95], a[232:235], v[140:143], a[92:95]
s_waitcnt lgkmcnt(8)
ds_read_b64_tr_b16 a[212:213], v234 offset:36992
v_mul_f32 v226, v226, v231
v_mfma_f32_16x16x32_bf16 a[92:95], a[192:195], v[156:159], a[92:95]
s_waitcnt lgkmcnt(7)
ds_read_b64_tr_b16 a[214:215], v234 offset:43136
v_mul_f32 v227, v227, v231
v_mfma_f32_16x16x32_bf16 a[92:95], a[196:199], v[108:111], a[92:95]
v_cvt_pk_bf16_f32 v172, v224, v225
v_cvt_pk_bf16_f32 v173, v226, v227
v_mfma_f32_16x16x32_bf16 a[88:91], a[196:199], v[104:107], a[88:91]
v_accvgpr_read_b32 v224, a28
v_accvgpr_read_b32 v225, a29
v_mfma_f32_16x16x32_bf16 a[88:91], a[192:195], v[152:155], a[88:91]
v_accvgpr_read_b32 v226, a30
v_accvgpr_read_b32 v227, a31
v_mfma_f32_16x16x32_bf16 a[88:91], a[232:235], v[136:139], a[88:91]
v_mul_f32 v224, v224, v231
v_mul_f32 v225, v225, v231
v_mul_f32 v226, v226, v231
v_mul_f32 v227, v227, v231
v_cvt_pk_bf16_f32 v174, v224, v225
v_cvt_pk_bf16_f32 v175, v226, v227
v_mfma_f32_16x16x32_bf16 a[88:91], a[228:231], v[120:123], a[88:91]
buffer_store_dwordx4 v[172:175], v250, s[4:7], s91 offen offset:3072 sc1
v_mfma_f32_16x16x32_bf16 a[84:87], a[228:231], v[116:119], a[84:87]
ds_read_b64_tr_b16 a[216:217], v235 offset:128
v_accvgpr_read_b32 v224, a32
v_mfma_f32_16x16x32_bf16 a[84:87], a[232:235], v[132:135], a[84:87]
ds_read_b64_tr_b16 a[218:219], v235 offset:6272
v_accvgpr_read_b32 v225, a33
v_mfma_f32_16x16x32_bf16 a[84:87], a[192:195], v[148:151], a[84:87]
ds_read_b64_tr_b16 a[220:221], v235 offset:12416
v_accvgpr_read_b32 v226, a34
v_mfma_f32_16x16x32_bf16 a[84:87], a[196:199], v[100:103], a[84:87]
ds_read_b64_tr_b16 a[222:223], v235 offset:18560
v_accvgpr_read_b32 v227, a35
v_mfma_f32_16x16x32_bf16 a[80:83], a[196:199], v[96:99], a[80:83]
ds_read_b64_tr_b16 a[224:225], v235 offset:24704
v_mul_f32 v224, v224, v228
v_mfma_f32_16x16x32_bf16 a[80:83], a[192:195], v[144:147], a[80:83]
ds_read_b64_tr_b16 a[226:227], v235 offset:30848
v_mul_f32 v225, v225, v228
v_mfma_f32_16x16x32_bf16 a[80:83], a[232:235], v[128:131], a[80:83]
v_mul_f32 v226, v226, v228
v_mul_f32 v227, v227, v228
v_mfma_f32_16x16x32_bf16 a[80:83], a[228:231], v[112:115], a[80:83]
s_waitcnt lgkmcnt(12)
ds_read_b64_tr_b16 a[228:229], v235 offset:36992
v_cvt_pk_bf16_f32 v176, v224, v225
v_mfma_f32_16x16x32_bf16 a[96:99], a[200:203], v[112:115], a[96:99]
s_waitcnt lgkmcnt(11)
ds_read_b64_tr_b16 a[230:231], v235 offset:43136
v_cvt_pk_bf16_f32 v177, v226, v227
v_mfma_f32_16x16x32_bf16 a[96:99], a[204:207], v[128:131], a[96:99]
s_waitcnt lgkmcnt(10)
v_accvgpr_read_b32 v224, a48
v_accvgpr_read_b32 v225, a49
v_mfma_f32_16x16x32_bf16 a[96:99], a[208:211], v[144:147], a[96:99]
s_waitcnt lgkmcnt(8)
v_accvgpr_read_b32 v226, a50
v_accvgpr_read_b32 v227, a51
v_mfma_f32_16x16x32_bf16 a[96:99], a[212:215], v[96:99], a[96:99]
s_xor_b32 s91, s76, 4096
v_mul_f32 v224, v224, v228
v_mul_f32 v225, v225, v228
v_mul_f32 v226, v226, v228
v_mul_f32 v227, v227, v228
v_cvt_pk_bf16_f32 v178, v224, v225
v_cvt_pk_bf16_f32 v179, v226, v227
v_mfma_f32_16x16x32_bf16 a[100:103], a[212:215], v[100:103], a[100:103]
buffer_store_dwordx4 v[176:179], v250, s[4:7], s91 offen sc1
v_mfma_f32_16x16x32_bf16 a[100:103], a[208:211], v[148:151], a[100:103]
v_accvgpr_read_b32 v224, a36
v_accvgpr_read_b32 v225, a37
v_mfma_f32_16x16x32_bf16 a[100:103], a[204:207], v[132:135], a[100:103]
v_accvgpr_read_b32 v226, a38
v_accvgpr_read_b32 v227, a39
v_mfma_f32_16x16x32_bf16 a[100:103], a[200:203], v[116:119], a[100:103]
L_walk2_2:
s_cbranch_execz L_walk2_6
v_mul_f32 v224, v224, v229
v_mul_f32 v225, v225, v229
v_mfma_f32_16x16x32_bf16 a[104:107], a[200:203], v[120:123], a[104:107]
ds_read_b64_tr_b16 a[232:233], v232 offset:256
v_mul_f32 v226, v226, v229
v_mfma_f32_16x16x32_bf16 a[104:107], a[204:207], v[136:139], a[104:107]
ds_read_b64_tr_b16 a[234:235], v232 offset:6400
v_mul_f32 v227, v227, v229
v_mfma_f32_16x16x32_bf16 a[104:107], a[208:211], v[152:155], a[104:107]
ds_read_b64_tr_b16 a[192:193], v232 offset:12544
v_cvt_pk_bf16_f32 v180, v224, v225
v_mfma_f32_16x16x32_bf16 a[104:107], a[212:215], v[104:107], a[104:107]
ds_read_b64_tr_b16 a[194:195], v232 offset:18688
v_cvt_pk_bf16_f32 v181, v226, v227
v_mfma_f32_16x16x32_bf16 a[108:111], a[212:215], v[108:111], a[108:111]
ds_read_b64_tr_b16 a[196:197], v232 offset:24832
v_accvgpr_read_b32 v224, a52
v_mfma_f32_16x16x32_bf16 a[108:111], a[208:211], v[156:159], a[108:111]
ds_read_b64_tr_b16 a[198:199], v232 offset:30976
v_accvgpr_read_b32 v225, a53
v_mfma_f32_16x16x32_bf16 a[108:111], a[204:207], v[140:143], a[108:111]
v_accvgpr_read_b32 v226, a54
v_accvgpr_read_b32 v227, a55
v_mfma_f32_16x16x32_bf16 a[108:111], a[200:203], v[124:127], a[108:111]
s_waitcnt lgkmcnt(12)
v_mul_f32 v224, v224, v229
v_mul_f32 v225, v225, v229
v_mfma_f32_16x16x32_bf16 a[124:127], a[216:219], v[124:127], a[124:127]
s_waitcnt lgkmcnt(10)
v_mul_f32 v226, v226, v229
v_mul_f32 v227, v227, v229
v_cvt_pk_bf16_f32 v182, v224, v225
v_cvt_pk_bf16_f32 v183, v226, v227
v_mfma_f32_16x16x32_bf16 a[124:127], a[220:223], v[140:143], a[124:127]
s_waitcnt lgkmcnt(8)
buffer_store_dwordx4 v[180:183], v250, s[4:7], s91 offen offset:1024 sc1
v_mfma_f32_16x16x32_bf16 a[124:127], a[224:227], v[156:159], a[124:127]
s_waitcnt lgkmcnt(6)
ds_read_b64_tr_b16 a[200:201], v232 offset:37120
v_accvgpr_read_b32 v224, a40
v_mfma_f32_16x16x32_bf16 a[124:127], a[228:231], v[108:111], a[124:127]
ds_read_b64_tr_b16 a[202:203], v232 offset:43264
v_accvgpr_read_b32 v225, a41
v_mfma_f32_16x16x32_bf16 a[120:123], a[228:231], v[104:107], a[120:123]
v_accvgpr_read_b32 v226, a42
v_accvgpr_read_b32 v227, a43
v_mfma_f32_16x16x32_bf16 a[120:123], a[224:227], v[152:155], a[120:123]
v_mul_f32 v224, v224, v230
v_mul_f32 v225, v225, v230
v_mfma_f32_16x16x32_bf16 a[120:123], a[220:223], v[136:139], a[120:123]
v_mul_f32 v226, v226, v230
v_mul_f32 v227, v227, v230
v_mfma_f32_16x16x32_bf16 a[120:123], a[216:219], v[120:123], a[120:123]
v_cvt_pk_bf16_f32 v184, v224, v225
v_cvt_pk_bf16_f32 v185, v226, v227
v_mfma_f32_16x16x32_bf16 a[116:119], a[216:219], v[116:119], a[116:119]
ds_read_b64_tr_b16 a[204:205], v233 offset:256
v_accvgpr_read_b32 v224, a56
v_mfma_f32_16x16x32_bf16 a[116:119], a[220:223], v[132:135], a[116:119]
ds_read_b64_tr_b16 a[206:207], v233 offset:6400
v_accvgpr_read_b32 v225, a57
v_mfma_f32_16x16x32_bf16 a[116:119], a[224:227], v[148:151], a[116:119]
ds_read_b64_tr_b16 a[208:209], v233 offset:12544
v_accvgpr_read_b32 v226, a58
v_mfma_f32_16x16x32_bf16 a[116:119], a[228:231], v[100:103], a[116:119]
ds_read_b64_tr_b16 a[210:211], v233 offset:18688
v_accvgpr_read_b32 v227, a59
v_mfma_f32_16x16x32_bf16 a[112:115], a[228:231], v[96:99], a[112:115]
v_mul_f32 v224, v224, v230
v_mul_f32 v225, v225, v230
v_mfma_f32_16x16x32_bf16 a[112:115], a[224:227], v[144:147], a[112:115]
v_mul_f32 v226, v226, v230
v_mul_f32 v227, v227, v230
v_cvt_pk_bf16_f32 v186, v224, v225
v_cvt_pk_bf16_f32 v187, v226, v227
v_mfma_f32_16x16x32_bf16 a[112:115], a[220:223], v[128:131], a[112:115]
buffer_store_dwordx4 v[184:187], v250, s[4:7], s91 offen offset:2048 sc1
v_mfma_f32_16x16x32_bf16 a[112:115], a[216:219], v[112:115], a[112:115]
s_waitcnt lgkmcnt(10)
ds_read_b64_tr_b16 a[212:213], v233 offset:24832
v_accvgpr_read_b32 v224, a44
v_mfma_f32_16x16x32_bf16 a[128:131], a[232:235], v[112:115], a[128:131]
s_waitcnt lgkmcnt(9)
ds_read_b64_tr_b16 a[214:215], v233 offset:30976
v_accvgpr_read_b32 v225, a45
v_mfma_f32_16x16x32_bf16 a[128:131], a[192:195], v[128:131], a[128:131]
s_waitcnt lgkmcnt(8)
ds_read_b64_tr_b16 a[216:217], v233 offset:37120
v_accvgpr_read_b32 v226, a46
v_mfma_f32_16x16x32_bf16 a[128:131], a[196:199], v[144:147], a[128:131]
s_waitcnt lgkmcnt(7)
ds_read_b64_tr_b16 a[218:219], v233 offset:43264
v_accvgpr_read_b32 v227, a47
v_mfma_f32_16x16x32_bf16 a[128:131], a[200:203], v[96:99], a[128:131]
v_mul_f32 v224, v224, v231
v_mul_f32 v225, v225, v231
v_mfma_f32_16x16x32_bf16 a[132:135], a[200:203], v[100:103], a[132:135]
s_waitcnt vmcnt(3)
buffer_store_dwordx4 v[250:253], v252, s[4:7], s68 offen offset:128 sc1
v_mfma_f32_16x16x32_bf16 a[132:135], a[196:199], v[148:151], a[132:135]
v_mul_f32 v226, v226, v231
v_mul_f32 v227, v227, v231
v_mfma_f32_16x16x32_bf16 a[132:135], a[192:195], v[132:135], a[132:135]
v_cvt_pk_bf16_f32 v188, v224, v225
v_cvt_pk_bf16_f32 v189, v226, v227
v_mfma_f32_16x16x32_bf16 a[132:135], a[232:235], v[116:119], a[132:135]
v_accvgpr_read_b32 v224, a60
v_accvgpr_read_b32 v225, a61
v_mfma_f32_16x16x32_bf16 a[136:139], a[232:235], v[120:123], a[136:139]
ds_read_b64_tr_b16 a[220:221], v234 offset:256
v_accvgpr_read_b32 v226, a62
v_mfma_f32_16x16x32_bf16 a[136:139], a[192:195], v[136:139], a[136:139]
v_accvgpr_read_b32 v227, a63
v_mul_f32 v224, v224, v231
v_mfma_f32_16x16x32_bf16 a[136:139], a[196:199], v[152:155], a[136:139]
v_mul_f32 v225, v225, v231
v_mul_f32 v226, v226, v231
v_mul_f32 v227, v227, v231
v_cvt_pk_bf16_f32 v190, v224, v225
v_cvt_pk_bf16_f32 v191, v226, v227
v_mfma_f32_16x16x32_bf16 a[136:139], a[200:203], v[104:107], a[136:139]
buffer_store_dwordx4 v[188:191], v250, s[4:7], s91 offen offset:3072 sc1
v_mfma_f32_16x16x32_bf16 a[140:143], a[200:203], v[108:111], a[140:143]
ds_read_b64_tr_b16 a[222:223], v234 offset:6400
v_accvgpr_read_b32 v224, a64
v_mfma_f32_16x16x32_bf16 a[140:143], a[196:199], v[156:159], a[140:143]
ds_read_b64_tr_b16 a[224:225], v234 offset:12544
v_accvgpr_read_b32 v225, a65
v_mfma_f32_16x16x32_bf16 a[140:143], a[192:195], v[140:143], a[140:143]
ds_read_b64_tr_b16 a[226:227], v234 offset:18688
v_accvgpr_read_b32 v226, a66
v_mfma_f32_16x16x32_bf16 a[140:143], a[232:235], v[124:127], a[140:143]
s_waitcnt lgkmcnt(10)
ds_read_b64_tr_b16 a[228:229], v234 offset:24832
v_accvgpr_read_b32 v227, a67
v_mfma_f32_16x16x32_bf16 a[156:159], a[204:207], v[124:127], a[156:159]
s_waitcnt lgkmcnt(9)
ds_read_b64_tr_b16 a[230:231], v234 offset:30976
v_mul_f32 v224, v224, v228
v_mfma_f32_16x16x32_bf16 a[156:159], a[208:211], v[140:143], a[156:159]
s_waitcnt lgkmcnt(8)
ds_read_b64_tr_b16 a[232:233], v234 offset:37120
v_mul_f32 v225, v225, v228
v_mfma_f32_16x16x32_bf16 a[156:159], a[212:215], v[156:159], a[156:159]
s_waitcnt lgkmcnt(7)
ds_read_b64_tr_b16 a[234:235], v234 offset:43264
v_mul_f32 v226, v226, v228
v_mfma_f32_16x16x32_bf16 a[156:159], a[216:219], v[108:111], a[156:159]
v_mul_f32 v227, v227, v228
v_cvt_pk_bf16_f32 v192, v224, v225
v_mfma_f32_16x16x32_bf16 a[152:155], a[216:219], v[104:107], a[152:155]
v_cvt_pk_bf16_f32 v193, v226, v227
v_accvgpr_read_b32 v224, a80
v_mfma_f32_16x16x32_bf16 a[152:155], a[212:215], v[152:155], a[152:155]
v_accvgpr_read_b32 v225, a81
v_accvgpr_read_b32 v226, a82
v_mfma_f32_16x16x32_bf16 a[152:155], a[208:211], v[136:139], a[152:155]
v_accvgpr_read_b32 v227, a83
v_mul_f32 v224, v224, v228
v_mfma_f32_16x16x32_bf16 a[152:155], a[204:207], v[120:123], a[152:155]
s_xor_b32 s91, s76, 262144
v_mul_f32 v225, v225, v228
v_mul_f32 v226, v226, v228
v_mul_f32 v227, v227, v228
v_cvt_pk_bf16_f32 v194, v224, v225
v_cvt_pk_bf16_f32 v195, v226, v227
v_mfma_f32_16x16x32_bf16 a[148:151], a[204:207], v[116:119], a[148:151]
buffer_store_dwordx4 v[192:195], v250, s[4:7], s91 offen sc1
v_mfma_f32_16x16x32_bf16 a[148:151], a[208:211], v[132:135], a[148:151]
ds_read_b64_tr_b16 a[192:193], v235 offset:256
v_accvgpr_read_b32 v224, a68
v_mfma_f32_16x16x32_bf16 a[148:151], a[212:215], v[148:151], a[148:151]
ds_read_b64_tr_b16 a[194:195], v235 offset:6400
v_accvgpr_read_b32 v225, a69
v_mfma_f32_16x16x32_bf16 a[148:151], a[216:219], v[100:103], a[148:151]
ds_read_b64_tr_b16 a[196:197], v235 offset:12544
v_accvgpr_read_b32 v226, a70
v_mfma_f32_16x16x32_bf16 a[144:147], a[216:219], v[96:99], a[144:147]
ds_read_b64_tr_b16 a[198:199], v235 offset:18688
v_accvgpr_read_b32 v227, a71
v_mfma_f32_16x16x32_bf16 a[144:147], a[212:215], v[144:147], a[144:147]
ds_read_b64_tr_b16 a[200:201], v235 offset:24832
v_mul_f32 v224, v224, v229
v_mfma_f32_16x16x32_bf16 a[144:147], a[208:211], v[128:131], a[144:147]
ds_read_b64_tr_b16 a[202:203], v235 offset:30976
v_mul_f32 v225, v225, v229
v_mfma_f32_16x16x32_bf16 a[144:147], a[204:207], v[112:115], a[144:147]
s_waitcnt lgkmcnt(12)
ds_read_b64_tr_b16 a[204:205], v235 offset:37120
v_mul_f32 v226, v226, v229
v_mfma_f32_16x16x32_bf16 a[160:163], a[220:223], v[112:115], a[160:163]
s_waitcnt lgkmcnt(11)
ds_read_b64_tr_b16 a[206:207], v235 offset:43264
v_mul_f32 v227, v227, v229
v_mfma_f32_16x16x32_bf16 a[160:163], a[224:227], v[128:131], a[160:163]
s_waitcnt lgkmcnt(10)
v_cvt_pk_bf16_f32 v196, v224, v225
v_cvt_pk_bf16_f32 v197, v226, v227
v_mfma_f32_16x16x32_bf16 a[160:163], a[228:231], v[144:147], a[160:163]
s_waitcnt lgkmcnt(8)
v_accvgpr_read_b32 v224, a84
v_accvgpr_read_b32 v225, a85
v_mfma_f32_16x16x32_bf16 a[160:163], a[232:235], v[96:99], a[160:163]
v_accvgpr_read_b32 v226, a86
v_accvgpr_read_b32 v227, a87
v_mfma_f32_16x16x32_bf16 a[164:167], a[232:235], v[100:103], a[164:167]
v_mul_f32 v224, v224, v229
v_mul_f32 v225, v225, v229
v_mfma_f32_16x16x32_bf16 a[164:167], a[228:231], v[148:151], a[164:167]
v_mul_f32 v226, v226, v229
v_mul_f32 v227, v227, v229
v_cvt_pk_bf16_f32 v198, v224, v225
v_cvt_pk_bf16_f32 v199, v226, v227
v_mfma_f32_16x16x32_bf16 a[164:167], a[224:227], v[132:135], a[164:167]
buffer_store_dwordx4 v[196:199], v250, s[4:7], s91 offen offset:1024 sc1
v_mfma_f32_16x16x32_bf16 a[164:167], a[220:223], v[116:119], a[164:167]
v_accvgpr_read_b32 v224, a96
v_accvgpr_read_b32 v225, a97
v_mfma_f32_16x16x32_bf16 a[168:171], a[220:223], v[120:123], a[168:171]
v_accvgpr_read_b32 v226, a98
v_accvgpr_read_b32 v227, a99
v_mfma_f32_16x16x32_bf16 a[168:171], a[224:227], v[136:139], a[168:171]
v_mul_f32 v224, v224, v228
v_mul_f32 v225, v225, v228
v_mfma_f32_16x16x32_bf16 a[168:171], a[228:231], v[152:155], a[168:171]
v_mul_f32 v226, v226, v228
v_mul_f32 v227, v227, v228
v_mfma_f32_16x16x32_bf16 a[168:171], a[232:235], v[104:107], a[168:171]
v_cvt_pk_bf16_f32 v208, v224, v225
v_cvt_pk_bf16_f32 v209, v226, v227
v_mfma_f32_16x16x32_bf16 a[172:175], a[232:235], v[108:111], a[172:175]
v_accvgpr_read_b32 v224, a112
v_accvgpr_read_b32 v225, a113
v_mfma_f32_16x16x32_bf16 a[172:175], a[228:231], v[156:159], a[172:175]
v_accvgpr_read_b32 v226, a114
v_accvgpr_read_b32 v227, a115
v_mfma_f32_16x16x32_bf16 a[172:175], a[224:227], v[140:143], a[172:175]
s_xor_b32 s91, s76, 266240
v_mul_f32 v224, v224, v228
v_mul_f32 v225, v225, v228
v_mfma_f32_16x16x32_bf16 a[172:175], a[220:223], v[124:127], a[172:175]
s_waitcnt lgkmcnt(6)
v_mul_f32 v226, v226, v228
v_mul_f32 v227, v227, v228
v_mfma_f32_16x16x32_bf16 a[188:191], a[192:195], v[124:127], a[188:191]
s_waitcnt lgkmcnt(4)
v_cvt_pk_bf16_f32 v210, v224, v225
v_cvt_pk_bf16_f32 v211, v226, v227
v_mfma_f32_16x16x32_bf16 a[188:191], a[196:199], v[140:143], a[188:191]
s_waitcnt lgkmcnt(2)
buffer_store_dwordx4 v[208:211], v250, s[4:7], s91 offen sc1
v_mfma_f32_16x16x32_bf16 a[188:191], a[200:203], v[156:159], a[188:191]
s_waitcnt lgkmcnt(0)
s_barrier
v_mfma_f32_16x16x32_bf16 a[188:191], a[204:207], v[108:111], a[188:191]
ds_read_b64_tr_b16 a[208:209], v238 offset:40960
v_accvgpr_read_b32 v224, a100
v_mfma_f32_16x16x32_bf16 a[184:187], a[204:207], v[104:107], a[184:187]
ds_read_b64_tr_b16 a[210:211], v238 offset:46080
v_accvgpr_read_b32 v225, a101
v_mfma_f32_16x16x32_bf16 a[184:187], a[200:203], v[152:155], a[184:187]
ds_read_b64_tr_b16 a[212:213], v238 offset:51200
v_accvgpr_read_b32 v226, a102
v_mfma_f32_16x16x32_bf16 a[184:187], a[196:199], v[136:139], a[184:187]
ds_read_b64_tr_b16 a[214:215], v238 offset:56320
v_accvgpr_read_b32 v227, a103
v_mfma_f32_16x16x32_bf16 a[184:187], a[192:195], v[120:123], a[184:187]
v_mul_f32 v224, v224, v229
v_mul_f32 v225, v225, v229
v_mfma_f32_16x16x32_bf16 a[180:183], a[192:195], v[116:119], a[180:183]
ds_read_b64_tr_b16 a[216:217], v239 offset:40992
v_mul_f32 v226, v226, v229
v_mfma_f32_16x16x32_bf16 a[180:183], a[196:199], v[132:135], a[180:183]
ds_read_b64_tr_b16 a[218:219], v239 offset:46112
v_mul_f32 v227, v227, v229
v_mfma_f32_16x16x32_bf16 a[180:183], a[200:203], v[148:151], a[180:183]
v_cvt_pk_bf16_f32 v212, v224, v225
v_cvt_pk_bf16_f32 v213, v226, v227
v_mfma_f32_16x16x32_bf16 a[180:183], a[204:207], v[100:103], a[180:183]
v_accvgpr_read_b32 v224, a116
v_accvgpr_read_b32 v225, a117
v_accvgpr_read_b32 v226, a118
v_accvgpr_read_b32 v227, a119
v_mul_f32 v224, v224, v229
v_mul_f32 v225, v225, v229
v_mul_f32 v226, v226, v229
v_mul_f32 v227, v227, v229
v_cvt_pk_bf16_f32 v214, v224, v225
v_cvt_pk_bf16_f32 v215, v226, v227
v_mfma_f32_16x16x32_bf16 a[176:179], a[204:207], v[96:99], a[176:179]
ds_read_b64_tr_b16 a[220:221], v239 offset:51232
v_accvgpr_read_b32 v224, a72
v_mfma_f32_16x16x32_bf16 a[176:179], a[200:203], v[144:147], a[176:179]
ds_read_b64_tr_b16 a[222:223], v239 offset:56352
v_accvgpr_read_b32 v225, a73
v_mfma_f32_16x16x32_bf16 a[176:179], a[196:199], v[128:131], a[176:179]
v_accvgpr_read_b32 v226, a74
v_accvgpr_read_b32 v227, a75
v_mfma_f32_16x16x32_bf16 a[176:179], a[192:195], v[112:115], a[176:179]
s_waitcnt lgkmcnt(6)
v_mul_f32 v224, v224, v230
v_mul_f32 v225, v225, v230
v_mfma_f32_16x16x32_bf16 v[12:15], a[208:211], v[172:175], 0
s_waitcnt lgkmcnt(4)
buffer_store_dwordx4 v[212:215], v250, s[4:7], s91 offen offset:1024 sc1
v_mfma_f32_16x16x32_bf16 v[12:15], a[212:215], v[188:191], v[12:15]
ds_read_b64_tr_b16 a[224:225], v238 offset:41024
v_mul_f32 v226, v226, v230
v_mfma_f32_16x16x32_bf16 v[8:11], a[212:215], v[184:187], 0
s_waitcnt vmcnt(4)
buffer_store_dwordx4 v[250:253], v252, s[4:7], s68 offen offset:256 sc1
s_barrier
v_mfma_f32_16x16x32_bf16 v[8:11], a[208:211], v[168:171], v[8:11]
s_add_u32 m0, s55, 0
ds_read_b64_tr_b16 a[226:227], v238 offset:46144
v_mul_f32 v227, v227, v230
v_mfma_f32_16x16x32_bf16 v[4:7], a[208:211], v[164:167], 0
s_add_u32 s3, s75, 40960
ds_read_b64_tr_b16 a[228:229], v238 offset:51264
v_cvt_pk_bf16_f32 v200, v224, v225
v_mfma_f32_16x16x32_bf16 v[4:7], a[212:215], v[180:183], v[4:7]
buffer_load_dwordx4 v242, s[28:31], s3 offen lds
v_mfma_f32_16x16x32_bf16 v[0:3], a[212:215], v[176:179], 0
ds_read_b64_tr_b16 a[230:231], v238 offset:56384
v_cvt_pk_bf16_f32 v201, v226, v227
v_mfma_f32_16x16x32_bf16 v[0:3], a[208:211], v[160:163], v[0:3]
s_waitcnt lgkmcnt(6)
ds_write_b128 v247, v[216:219] offset:40960
v_accvgpr_read_b32 v224, a88
v_mfma_f32_16x16x32_bf16 v[16:19], a[216:219], v[160:163], 0
s_waitcnt lgkmcnt(5)
ds_read_b64_tr_b16 a[232:233], v239 offset:41056
v_accvgpr_read_b32 v225, a89
v_mfma_f32_16x16x32_bf16 v[16:19], a[220:223], v[176:179], v[16:19]
ds_read_b64_tr_b16 a[234:235], v239 offset:46176
v_accvgpr_read_b32 v226, a90
v_mfma_f32_16x16x32_bf16 v[20:23], a[220:223], v[180:183], 0
ds_read_b64_tr_b16 a[192:193], v239 offset:51296
v_accvgpr_read_b32 v227, a91
v_mfma_f32_16x16x32_bf16 v[20:23], a[216:219], v[164:167], v[20:23]
ds_read_b64_tr_b16 a[194:195], v239 offset:56416
v_mul_f32 v224, v224, v230
v_mfma_f32_16x16x32_bf16 v[24:27], a[216:219], v[168:171], 0
ds_write_b128 v247, v[220:223] offset:45056
v_mul_f32 v225, v225, v230
v_mfma_f32_16x16x32_bf16 v[24:27], a[220:223], v[184:187], v[24:27]
buffer_load_dwordx4 v243, s[28:31], s3 offen offset:1024 lds
v_mfma_f32_16x16x32_bf16 v[28:31], a[220:223], v[188:191], 0
v_mul_f32 v226, v226, v230
v_mul_f32 v227, v227, v230
v_mfma_f32_16x16x32_bf16 v[28:31], a[216:219], v[172:175], v[28:31]
s_waitcnt lgkmcnt(8)
v_cvt_pk_bf16_f32 v202, v224, v225
v_cvt_pk_bf16_f32 v203, v226, v227
v_mfma_f32_16x16x32_bf16 v[44:47], a[224:227], v[172:175], 0
s_waitcnt lgkmcnt(6)
ds_read_b64_tr_b16 a[196:197], v238 offset:41088
v_accvgpr_read_b32 v224, a76
v_mfma_f32_16x16x32_bf16 v[44:47], a[228:231], v[188:191], v[44:47]
ds_read_b64_tr_b16 a[198:199], v238 offset:46208
v_accvgpr_read_b32 v225, a77
v_mfma_f32_16x16x32_bf16 v[40:43], a[228:231], v[184:187], 0
ds_read_b64_tr_b16 a[200:201], v238 offset:51328
v_accvgpr_read_b32 v226, a78
v_mfma_f32_16x16x32_bf16 v[40:43], a[224:227], v[168:171], v[40:43]
ds_read_b64_tr_b16 a[202:203], v238 offset:56448
v_accvgpr_read_b32 v227, a79
v_mfma_f32_16x16x32_bf16 v[36:39], a[224:227], v[164:167], 0
v_mul_f32 v224, v224, v231
v_mul_f32 v225, v225, v231
v_mfma_f32_16x16x32_bf16 v[36:39], a[228:231], v[180:183], v[36:39]
buffer_load_dwordx4 v244, s[28:31], s3 offen offset:2048 lds
v_mfma_f32_16x16x32_bf16 v[32:35], a[228:231], v[176:179], 0
v_mul_f32 v226, v226, v231
v_mul_f32 v227, v227, v231
v_mfma_f32_16x16x32_bf16 v[32:35], a[224:227], v[160:163], v[32:35]
s_waitcnt lgkmcnt(7)
v_cvt_pk_bf16_f32 v204, v224, v225
v_cvt_pk_bf16_f32 v205, v226, v227
v_mfma_f32_16x16x32_bf16 v[48:51], a[232:235], v[160:163], 0
s_waitcnt lgkmcnt(5)
ds_read_b64_tr_b16 a[204:205], v239 offset:41120
v_accvgpr_read_b32 v224, a92
v_mfma_f32_16x16x32_bf16 v[48:51], a[192:195], v[176:179], v[48:51]
ds_read_b64_tr_b16 a[206:207], v239 offset:46240
v_accvgpr_read_b32 v225, a93
v_mfma_f32_16x16x32_bf16 v[52:55], a[192:195], v[180:183], 0
ds_read_b64_tr_b16 a[208:209], v239 offset:51360
v_accvgpr_read_b32 v226, a94
v_mfma_f32_16x16x32_bf16 v[52:55], a[232:235], v[164:167], v[52:55]
ds_read_b64_tr_b16 a[210:211], v239 offset:56480
v_accvgpr_read_b32 v227, a95
v_mfma_f32_16x16x32_bf16 v[56:59], a[232:235], v[168:171], 0
v_mul_f32 v224, v224, v231
v_mul_f32 v225, v225, v231
v_mfma_f32_16x16x32_bf16 v[56:59], a[192:195], v[184:187], v[56:59]
buffer_load_dwordx4 v245, s[28:31], s3 offen offset:3072 lds
v_mfma_f32_16x16x32_bf16 v[60:63], a[192:195], v[188:191], 0
v_mul_f32 v226, v226, v231
v_mul_f32 v227, v227, v231
v_mfma_f32_16x16x32_bf16 v[60:63], a[232:235], v[172:175], v[60:63]
s_waitcnt lgkmcnt(6)
buffer_load_dword v254, v253, s[4:7], s71 offen offset:132 sc1
v_mfma_f32_16x16x32_bf16 v[76:79], a[196:199], v[172:175], 0
s_waitcnt lgkmcnt(4)
ds_read_b64_tr_b16 a[212:213], v238 offset:41152
v_cvt_pk_bf16_f32 v206, v224, v225
v_mfma_f32_16x16x32_bf16 v[76:79], a[200:203], v[188:191], v[76:79]
ds_read_b64_tr_b16 a[214:215], v238 offset:46272
v_cvt_pk_bf16_f32 v207, v226, v227
v_mfma_f32_16x16x32_bf16 v[72:75], a[200:203], v[184:187], 0
ds_read_b64_tr_b16 a[216:217], v238 offset:51392
v_accvgpr_read_b32 v224, a104
v_mfma_f32_16x16x32_bf16 v[72:75], a[196:199], v[168:171], v[72:75]
ds_read_b64_tr_b16 a[218:219], v238 offset:56512
v_accvgpr_read_b32 v225, a105
v_mfma_f32_16x16x32_bf16 v[68:71], a[196:199], v[164:167], 0
s_add_u32 m0, s55, 4096
v_accvgpr_read_b32 v226, a106
v_accvgpr_read_b32 v227, a107
v_mfma_f32_16x16x32_bf16 v[68:71], a[200:203], v[180:183], v[68:71]
buffer_load_dwordx4 v246, s[28:31], s3 offen lds
v_mfma_f32_16x16x32_bf16 v[64:67], a[200:203], v[176:179], 0
s_xor_b32 s91, s76, 262144
v_mul_f32 v224, v224, v230
v_mul_f32 v225, v225, v230
v_mfma_f32_16x16x32_bf16 v[64:67], a[196:199], v[160:163], v[64:67]
s_waitcnt lgkmcnt(6)
v_mul_f32 v226, v226, v230
v_mul_f32 v227, v227, v230
v_mfma_f32_16x16x32_bf16 v[80:83], a[204:207], v[160:163], 0
s_waitcnt lgkmcnt(4)
buffer_store_dwordx4 v[200:203], v250, s[4:7], s91 offen offset:2048 sc1
v_mfma_f32_16x16x32_bf16 v[80:83], a[208:211], v[176:179], v[80:83]
ds_read_b64_tr_b16 a[220:221], v239 offset:41184
v_cvt_pk_bf16_f32 v216, v224, v225
v_mfma_f32_16x16x32_bf16 v[84:87], a[208:211], v[180:183], 0
ds_read_b64_tr_b16 a[222:223], v239 offset:46304
v_cvt_pk_bf16_f32 v217, v226, v227
v_mfma_f32_16x16x32_bf16 v[84:87], a[204:207], v[164:167], v[84:87]
s_add_u32 m0, s55, 20480
ds_read_b64_tr_b16 a[224:225], v239 offset:51424
v_accvgpr_read_b32 v224, a120
v_mfma_f32_16x16x32_bf16 v[88:91], a[204:207], v[168:171], 0
s_add_u32 s3, s73, 81920
ds_read_b64_tr_b16 a[226:227], v239 offset:56544
v_accvgpr_read_b32 v225, a121
v_mfma_f32_16x16x32_bf16 v[88:91], a[208:211], v[184:187], v[88:91]
buffer_load_dwordx4 v242, s[28:31], s3 offen lds
v_mfma_f32_16x16x32_bf16 v[92:95], a[208:211], v[188:191], 0
v_accvgpr_read_b32 v226, a122
v_accvgpr_read_b32 v227, a123
v_mfma_f32_16x16x32_bf16 v[92:95], a[204:207], v[172:175], v[92:95]
s_waitcnt lgkmcnt(6)
v_mul_f32 v224, v224, v230
v_mul_f32 v225, v225, v230
v_mfma_f32_16x16x32_bf16 v[108:111], a[212:215], v[172:175], 0
s_waitcnt lgkmcnt(4)
ds_read_b64_tr_b16 a[228:229], v238 offset:41216
v_mul_f32 v226, v226, v230
v_mfma_f32_16x16x32_bf16 v[108:111], a[216:219], v[188:191], v[108:111]
ds_read_b64_tr_b16 a[230:231], v238 offset:46336
v_mul_f32 v227, v227, v230
v_mfma_f32_16x16x32_bf16 v[104:107], a[216:219], v[184:187], 0
ds_read_b64_tr_b16 a[232:233], v238 offset:51456
v_cvt_pk_bf16_f32 v218, v224, v225
v_mfma_f32_16x16x32_bf16 v[104:107], a[212:215], v[168:171], v[104:107]
ds_read_b64_tr_b16 a[234:235], v238 offset:56576
v_cvt_pk_bf16_f32 v219, v226, v227
v_mfma_f32_16x16x32_bf16 v[100:103], a[212:215], v[164:167], 0
v_accvgpr_read_b32 v224, a108
v_accvgpr_read_b32 v225, a109
v_mfma_f32_16x16x32_bf16 v[100:103], a[216:219], v[180:183], v[100:103]
buffer_load_dwordx4 v243, s[28:31], s3 offen offset:1024 lds
v_mfma_f32_16x16x32_bf16 v[96:99], a[216:219], v[176:179], 0
v_accvgpr_read_b32 v226, a110
v_accvgpr_read_b32 v227, a111
v_mfma_f32_16x16x32_bf16 v[96:99], a[212:215], v[160:163], v[96:99]
s_waitcnt lgkmcnt(6)
v_mul_f32 v224, v224, v231
v_mul_f32 v225, v225, v231
v_mfma_f32_16x16x32_bf16 v[112:115], a[220:223], v[160:163], 0
s_waitcnt lgkmcnt(4)
ds_read_b64_tr_b16 a[192:193], v239 offset:41248
v_mul_f32 v226, v226, v231
v_mfma_f32_16x16x32_bf16 v[112:115], a[224:227], v[176:179], v[112:115]
ds_read_b64_tr_b16 a[194:195], v239 offset:46368
v_mul_f32 v227, v227, v231
v_mfma_f32_16x16x32_bf16 v[116:119], a[224:227], v[180:183], 0
buffer_store_dwordx4 v[204:207], v250, s[4:7], s91 offen offset:3072 sc1
v_mfma_f32_16x16x32_bf16 v[116:119], a[220:223], v[164:167], v[116:119]
ds_read_b64_tr_b16 a[196:197], v239 offset:51488
v_cvt_pk_bf16_f32 v220, v224, v225
v_mfma_f32_16x16x32_bf16 v[120:123], a[220:223], v[168:171], 0
ds_read_b64_tr_b16 a[198:199], v239 offset:56608
v_cvt_pk_bf16_f32 v221, v226, v227
v_mfma_f32_16x16x32_bf16 v[120:123], a[224:227], v[184:187], v[120:123]
buffer_load_dwordx4 v244, s[28:31], s3 offen offset:2048 lds
v_mfma_f32_16x16x32_bf16 v[124:127], a[224:227], v[188:191], 0
v_accvgpr_read_b32 v224, a124
v_accvgpr_read_b32 v225, a125
v_mfma_f32_16x16x32_bf16 v[124:127], a[220:223], v[172:175], v[124:127]
s_waitcnt lgkmcnt(6)
v_accvgpr_read_b32 v226, a126
v_accvgpr_read_b32 v227, a127
v_mfma_f32_16x16x32_bf16 v[140:143], a[228:231], v[172:175], 0
s_waitcnt lgkmcnt(4)
ds_read_b64_tr_b16 a[200:201], v238 offset:0
v_mul_f32 v224, v224, v231
v_mfma_f32_16x16x32_bf16 v[140:143], a[232:235], v[188:191], v[140:143]
ds_read_b64_tr_b16 a[202:203], v238 offset:5120
v_mul_f32 v225, v225, v231
v_mfma_f32_16x16x32_bf16 v[136:139], a[232:235], v[184:187], 0
ds_read_b64_tr_b16 a[204:205], v238 offset:10240
v_mul_f32 v226, v226, v231
v_mfma_f32_16x16x32_bf16 v[136:139], a[228:231], v[168:171], v[136:139]
ds_read_b64_tr_b16 a[206:207], v238 offset:15360
v_mul_f32 v227, v227, v231
v_mfma_f32_16x16x32_bf16 v[132:135], a[228:231], v[164:167], 0
v_cvt_pk_bf16_f32 v222, v224, v225
v_cvt_pk_bf16_f32 v223, v226, v227
v_mfma_f32_16x16x32_bf16 v[132:135], a[232:235], v[180:183], v[132:135]
buffer_load_dwordx4 v245, s[28:31], s3 offen offset:3072 lds
v_mfma_f32_16x16x32_bf16 v[128:131], a[232:235], v[176:179], 0
v_accvgpr_read_b32 v224, a128
v_accvgpr_read_b32 v225, a129
v_mfma_f32_16x16x32_bf16 v[128:131], a[228:231], v[160:163], v[128:131]
s_waitcnt lgkmcnt(6)
v_accvgpr_read_b32 v226, a130
v_accvgpr_read_b32 v227, a131
v_mfma_f32_16x16x32_bf16 v[144:147], a[192:195], v[160:163], 0
s_waitcnt lgkmcnt(4)
ds_read_b64_tr_b16 a[208:209], v239 offset:32
v_mul_f32 v224, v224, v228
v_mfma_f32_16x16x32_bf16 v[144:147], a[196:199], v[176:179], v[144:147]
ds_read_b64_tr_b16 a[210:211], v239 offset:5152
v_mul_f32 v225, v225, v228
v_mfma_f32_16x16x32_bf16 v[148:151], a[196:199], v[180:183], 0
ds_read_b64_tr_b16 a[212:213], v239 offset:10272
v_mul_f32 v226, v226, v228
v_mfma_f32_16x16x32_bf16 v[148:151], a[192:195], v[164:167], v[148:151]
ds_read_b64_tr_b16 a[214:215], v239 offset:15392
v_mul_f32 v227, v227, v228
v_mfma_f32_16x16x32_bf16 v[152:155], a[192:195], v[168:171], 0
s_add_u32 m0, s55, 24576
v_cvt_pk_bf16_f32 v160, v224, v225
v_cvt_pk_bf16_f32 v161, v226, v227
v_mfma_f32_16x16x32_bf16 v[152:155], a[196:199], v[184:187], v[152:155]
s_waitcnt vmcnt(7)
buffer_load_dwordx4 v246, s[28:31], s3 offen lds
v_cmp_ne_u32 vcc, v254, v251
v_mfma_f32_16x16x32_bf16 v[156:159], a[196:199], v[188:191], 0
s_xor_b32 s90, s76, 16384
s_cbranch_vccnz L_spin_1
L_back_1:
v_accvgpr_read_b32 v224, a144
v_mfma_f32_16x16x32_bf16 v[156:159], a[192:195], v[172:175], v[156:159]
s_waitcnt lgkmcnt(6)
v_accvgpr_read_b32 v225, a145
v_accvgpr_read_b32 v226, a146
v_mfma_f32_16x16x32_bf16 v[12:15], a[200:203], v[204:207], v[12:15]
s_waitcnt lgkmcnt(4)
buffer_load_dwordx4 a[0:3], v250, s[4:7], s90 offen sc1
v_mfma_f32_16x16x32_bf16 v[12:15], a[204:207], v[220:223], v[12:15]
ds_read_b64_tr_b16 a[216:217], v238 offset:64
v_accvgpr_read_b32 v227, a147
v_mfma_f32_16x16x32_bf16 v[8:11], a[204:207], v[216:219], v[8:11]
s_barrier
v_mfma_f32_16x16x32_bf16 v[8:11], a[200:203], v[200:203], v[8:11]
v_mul_f32 v224, v224, v228
v_mul_f32 v225, v225, v228
v_mul_f32 v226, v226, v228
v_mul_f32 v227, v227, v228
v_cvt_pk_bf16_f32 v162, v224, v225
v_cvt_pk_bf16_f32 v163, v226, v227
v_mfma_f32_16x16x32_bf16 v[4:7], a[200:203], v[196:199], v[4:7]
ds_read_b64_tr_b16 a[218:219], v238 offset:5184
v_accvgpr_read_b32 v224, a132
v_mfma_f32_16x16x32_bf16 v[4:7], a[204:207], v[212:215], v[4:7]
ds_read_b64_tr_b16 a[220:221], v238 offset:10304
v_accvgpr_read_b32 v225, a133
v_mfma_f32_16x16x32_bf16 v[0:3], a[204:207], v[208:211], v[0:3]
buffer_load_dwordx4 a[4:7], v250, s[4:7], s90 offen offset:1024 sc1
v_mfma_f32_16x16x32_bf16 v[0:3], a[200:203], v[192:195], v[0:3]
s_waitcnt lgkmcnt(5)
ds_read_b64_tr_b16 a[222:223], v238 offset:15424
v_accvgpr_read_b32 v226, a134
v_mfma_f32_16x16x32_bf16 v[16:19], a[208:211], v[192:195], v[16:19]
s_waitcnt lgkmcnt(4)
ds_read_b64_tr_b16 a[224:225], v239 offset:96
v_accvgpr_read_b32 v227, a135
v_mfma_f32_16x16x32_bf16 v[16:19], a[212:215], v[208:211], v[16:19]
L_walk2_3:
s_cbranch_execz L_walk2_7
ds_read_b64_tr_b16 a[226:227], v239 offset:5216
v_mul_f32 v224, v224, v229
v_mfma_f32_16x16x32_bf16 v[20:23], a[212:215], v[212:215], v[20:23]
ds_read_b64_tr_b16 a[228:229], v239 offset:10336
v_mul_f32 v225, v225, v229
v_mfma_f32_16x16x32_bf16 v[20:23], a[208:211], v[196:199], v[20:23]
ds_read_b64_tr_b16 a[230:231], v239 offset:15456
v_mul_f32 v226, v226, v229
v_mfma_f32_16x16x32_bf16 v[24:27], a[208:211], v[200:203], v[24:27]
buffer_load_dwordx4 a[8:11], v250, s[4:7], s90 offen offset:2048 sc1
v_mfma_f32_16x16x32_bf16 v[24:27], a[212:215], v[216:219], v[24:27]
v_mul_f32 v227, v227, v229
v_cvt_pk_bf16_f32 v164, v224, v225
v_mfma_f32_16x16x32_bf16 v[28:31], a[212:215], v[220:223], v[28:31]
v_cvt_pk_bf16_f32 v165, v226, v227
v_accvgpr_read_b32 v224, a148
v_mfma_f32_16x16x32_bf16 v[28:31], a[208:211], v[204:207], v[28:31]
v_accvgpr_read_b32 v225, a149
v_accvgpr_read_b32 v226, a150
v_accvgpr_read_b32 v227, a151
v_mul_f32 v224, v224, v229
v_mul_f32 v225, v225, v229
v_mul_f32 v226, v226, v229
v_mul_f32 v227, v227, v229
v_cvt_pk_bf16_f32 v166, v224, v225
v_cvt_pk_bf16_f32 v167, v226, v227
s_waitcnt lgkmcnt(6)
v_mfma_f32_16x16x32_bf16 v[44:47], a[216:219], v[204:207], v[44:47]
s_waitcnt lgkmcnt(4)
ds_read_b64_tr_b16 a[232:233], v238 offset:128
v_accvgpr_read_b32 v224, a160
v_mfma_f32_16x16x32_bf16 v[44:47], a[220:223], v[220:223], v[44:47]
ds_read_b64_tr_b16 a[234:235], v238 offset:5248
v_accvgpr_read_b32 v225, a161
v_mfma_f32_16x16x32_bf16 v[40:43], a[220:223], v[216:219], v[40:43]
buffer_load_dwordx4 a[12:15], v250, s[4:7], s90 offen offset:3072 sc1
v_mfma_f32_16x16x32_bf16 v[40:43], a[216:219], v[200:203], v[40:43]
s_xor_b32 s91, s76, 524288
ds_read_b64_tr_b16 a[192:193], v238 offset:10368
v_accvgpr_read_b32 v226, a162
v_mfma_f32_16x16x32_bf16 v[36:39], a[216:219], v[196:199], v[36:39]
buffer_store_dwordx4 v[160:163], v250, s[4:7], s91 offen sc1
v_mfma_f32_16x16x32_bf16 v[36:39], a[220:223], v[212:215], v[36:39]
ds_read_b64_tr_b16 a[194:195], v238 offset:15488
v_accvgpr_read_b32 v227, a163
v_mfma_f32_16x16x32_bf16 v[32:35], a[220:223], v[208:211], v[32:35]
s_xor_b32 s90, s76, 32768
v_mul_f32 v224, v224, v228
v_mul_f32 v225, v225, v228
v_mfma_f32_16x16x32_bf16 v[32:35], a[216:219], v[192:195], v[32:35]
s_waitcnt lgkmcnt(6)
v_mul_f32 v226, v226, v228
v_mul_f32 v227, v227, v228
v_mfma_f32_16x16x32_bf16 v[48:51], a[224:227], v[192:195], v[48:51]
s_waitcnt lgkmcnt(4)
buffer_load_dwordx4 a[16:19], v250, s[4:7], s90 offen sc1
v_mfma_f32_16x16x32_bf16 v[48:51], a[228:231], v[208:211], v[48:51]
ds_read_b64_tr_b16 a[196:197], v239 offset:160
v_cvt_pk_bf16_f32 v176, v224, v225
v_mfma_f32_16x16x32_bf16 v[52:55], a[228:231], v[212:215], v[52:55]
ds_read_b64_tr_b16 a[198:199], v239 offset:5280
v_cvt_pk_bf16_f32 v177, v226, v227
v_mfma_f32_16x16x32_bf16 v[52:55], a[224:227], v[196:199], v[52:55]
ds_read_b64_tr_b16 a[200:201], v239 offset:10400
v_accvgpr_read_b32 v224, a176
v_mfma_f32_16x16x32_bf16 v[56:59], a[224:227], v[200:203], v[56:59]
ds_read_b64_tr_b16 a[202:203], v239 offset:15520
v_accvgpr_read_b32 v225, a177
v_mfma_f32_16x16x32_bf16 v[56:59], a[228:231], v[216:219], v[56:59]
v_accvgpr_read_b32 v226, a178
v_accvgpr_read_b32 v227, a179
v_mfma_f32_16x16x32_bf16 v[60:63], a[228:231], v[220:223], v[60:63]
buffer_load_dwordx4 a[20:23], v250, s[4:7], s90 offen offset:1024 sc1
v_mfma_f32_16x16x32_bf16 v[60:63], a[224:227], v[204:207], v[60:63]
s_waitcnt lgkmcnt(6)
v_mul_f32 v224, v224, v228
v_mul_f32 v225, v225, v228
v_mfma_f32_16x16x32_bf16 v[76:79], a[232:235], v[204:207], v[76:79]
s_waitcnt lgkmcnt(4)
ds_read_b64_tr_b16 a[204:205], v238 offset:192
v_mul_f32 v226, v226, v228
v_mfma_f32_16x16x32_bf16 v[76:79], a[192:195], v[220:223], v[76:79]
ds_read_b64_tr_b16 a[206:207], v238 offset:5312
v_mul_f32 v227, v227, v228
v_mfma_f32_16x16x32_bf16 v[72:75], a[192:195], v[216:219], v[72:75]
v_cvt_pk_bf16_f32 v178, v224, v225
v_cvt_pk_bf16_f32 v179, v226, v227
v_mfma_f32_16x16x32_bf16 v[72:75], a[232:235], v[200:203], v[72:75]
ds_read_b64_tr_b16 a[208:209], v238 offset:10432
v_accvgpr_read_b32 v224, a164
v_mfma_f32_16x16x32_bf16 v[68:71], a[232:235], v[196:199], v[68:71]
buffer_store_dwordx4 v[164:167], v250, s[4:7], s91 offen offset:1024 sc1
v_mfma_f32_16x16x32_bf16 v[68:71], a[192:195], v[212:215], v[68:71]
ds_read_b64_tr_b16 a[210:211], v238 offset:15552
v_accvgpr_read_b32 v225, a165
v_mfma_f32_16x16x32_bf16 v[64:67], a[192:195], v[208:211], v[64:67]
buffer_load_dwordx4 a[24:27], v250, s[4:7], s90 offen offset:2048 sc1
v_mfma_f32_16x16x32_bf16 v[64:67], a[232:235], v[192:195], v[64:67]
s_waitcnt lgkmcnt(6)
v_accvgpr_read_b32 v226, a166
v_accvgpr_read_b32 v227, a167
v_mfma_f32_16x16x32_bf16 v[80:83], a[196:199], v[192:195], v[80:83]
s_waitcnt lgkmcnt(4)
ds_read_b64_tr_b16 a[212:213], v239 offset:224
v_mul_f32 v224, v224, v229
v_mfma_f32_16x16x32_bf16 v[80:83], a[200:203], v[208:211], v[80:83]
ds_read_b64_tr_b16 a[214:215], v239 offset:5344
v_mul_f32 v225, v225, v229
v_mfma_f32_16x16x32_bf16 v[84:87], a[200:203], v[212:215], v[84:87]
buffer_load_dwordx4 a[28:31], v250, s[4:7], s90 offen offset:3072 sc1
v_mfma_f32_16x16x32_bf16 v[84:87], a[196:199], v[196:199], v[84:87]
ds_read_b64_tr_b16 a[216:217], v239 offset:10464
v_mul_f32 v226, v226, v229
v_mfma_f32_16x16x32_bf16 v[88:91], a[196:199], v[200:203], v[88:91]
ds_read_b64_tr_b16 a[218:219], v239 offset:15584
v_mul_f32 v227, v227, v229
v_mfma_f32_16x16x32_bf16 v[88:91], a[200:203], v[216:219], v[88:91]
v_cvt_pk_bf16_f32 v180, v224, v225
v_cvt_pk_bf16_f32 v181, v226, v227
v_mfma_f32_16x16x32_bf16 v[92:95], a[200:203], v[220:223], v[92:95]
s_xor_b32 s90, s76, 49152
v_accvgpr_read_b32 v224, a180
v_accvgpr_read_b32 v225, a181
v_mfma_f32_16x16x32_bf16 v[92:95], a[196:199], v[204:207], v[92:95]
s_waitcnt lgkmcnt(6)
v_accvgpr_read_b32 v226, a182
v_accvgpr_read_b32 v227, a183
v_mfma_f32_16x16x32_bf16 v[108:111], a[204:207], v[204:207], v[108:111]
s_waitcnt lgkmcnt(4)
buffer_load_dwordx4 a[32:35], v250, s[4:7], s90 offen sc1
v_mfma_f32_16x16x32_bf16 v[108:111], a[208:211], v[220:223], v[108:111]
s_add_u32 m0, s55, 102400
s_add_u32 s3, s74, 81920
ds_read_b64_tr_b16 a[220:221], v238 offset:256
v_mul_f32 v224, v224, v229
v_mfma_f32_16x16x32_bf16 v[104:107], a[208:211], v[216:219], v[104:107]
buffer_load_dwordx4 v242, s[28:31], s3 offen lds
v_mfma_f32_16x16x32_bf16 v[104:107], a[204:207], v[200:203], v[104:107]
s_xor_b32 s91, s76, 528384
ds_read_b64_tr_b16 a[222:223], v238 offset:5376
v_mul_f32 v225, v225, v229
v_mfma_f32_16x16x32_bf16 v[100:103], a[204:207], v[196:199], v[100:103]
buffer_store_dwordx4 v[176:179], v250, s[4:7], s91 offen sc1
v_mfma_f32_16x16x32_bf16 v[100:103], a[208:211], v[212:215], v[100:103]
ds_read_b64_tr_b16 a[224:225], v238 offset:10496
v_mul_f32 v226, v226, v229
v_mfma_f32_16x16x32_bf16 v[96:99], a[208:211], v[208:211], v[96:99]
buffer_load_dwordx4 a[36:39], v250, s[4:7], s90 offen offset:1024 sc1
v_mfma_f32_16x16x32_bf16 v[96:99], a[204:207], v[192:195], v[96:99]
s_waitcnt lgkmcnt(5)
ds_read_b64_tr_b16 a[226:227], v238 offset:15616
v_mul_f32 v227, v227, v229
v_mfma_f32_16x16x32_bf16 v[112:115], a[212:215], v[192:195], v[112:115]
s_waitcnt lgkmcnt(4)
ds_read_b64_tr_b16 a[228:229], v239 offset:288
v_cvt_pk_bf16_f32 v182, v224, v225
v_mfma_f32_16x16x32_bf16 v[112:115], a[216:219], v[208:211], v[112:115]
ds_read_b64_tr_b16 a[230:231], v239 offset:5408
v_cvt_pk_bf16_f32 v183, v226, v227
v_mfma_f32_16x16x32_bf16 v[116:119], a[216:219], v[212:215], v[116:119]
buffer_load_dwordx4 v243, s[28:31], s3 offen offset:1024 lds
v_mfma_f32_16x16x32_bf16 v[116:119], a[212:215], v[196:199], v[116:119]
ds_read_b64_tr_b16 a[232:233], v239 offset:10528
v_accvgpr_read_b32 v224, a136
v_mfma_f32_16x16x32_bf16 v[120:123], a[212:215], v[200:203], v[120:123]
buffer_load_dwordx4 a[40:43], v250, s[4:7], s90 offen offset:2048 sc1
v_mfma_f32_16x16x32_bf16 v[120:123], a[216:219], v[216:219], v[120:123]
ds_read_b64_tr_b16 a[234:235], v239 offset:15648
v_accvgpr_read_b32 v225, a137
v_mfma_f32_16x16x32_bf16 v[124:127], a[216:219], v[220:223], v[124:127]
v_accvgpr_read_b32 v226, a138
v_accvgpr_read_b32 v227, a139
v_mfma_f32_16x16x32_bf16 v[124:127], a[212:215], v[204:207], v[124:127]
s_waitcnt lgkmcnt(6)
v_mul_f32 v224, v224, v230
v_mul_f32 v225, v225, v230
v_mfma_f32_16x16x32_bf16 v[140:143], a[220:223], v[204:207], v[140:143]
s_waitcnt lgkmcnt(4)
ds_read_b64_tr_b16 a[192:193], v238 offset:20480
v_mul_f32 v226, v226, v230
v_mfma_f32_16x16x32_bf16 v[140:143], a[224:227], v[220:223], v[140:143]
ds_read_b64_tr_b16 a[194:195], v238 offset:25600
v_mul_f32 v227, v227, v230
v_mfma_f32_16x16x32_bf16 v[136:139], a[224:227], v[216:219], v[136:139]
buffer_load_dwordx4 v244, s[28:31], s3 offen offset:2048 lds
v_mfma_f32_16x16x32_bf16 v[136:139], a[220:223], v[200:203], v[136:139]
ds_read_b64_tr_b16 a[196:197], v238 offset:30720
v_cvt_pk_bf16_f32 v168, v224, v225
v_mfma_f32_16x16x32_bf16 v[132:135], a[220:223], v[196:199], v[132:135]
buffer_load_dwordx4 a[44:47], v250, s[4:7], s90 offen offset:3072 sc1
v_mfma_f32_16x16x32_bf16 v[132:135], a[224:227], v[212:215], v[132:135]
ds_read_b64_tr_b16 a[198:199], v238 offset:35840
v_cvt_pk_bf16_f32 v169, v226, v227
v_mfma_f32_16x16x32_bf16 v[128:131], a[224:227], v[208:211], v[128:131]
buffer_store_dwordx4 v[180:183], v250, s[4:7], s91 offen offset:1024 sc1
v_mfma_f32_16x16x32_bf16 v[128:131], a[220:223], v[192:195], v[128:131]
s_waitcnt lgkmcnt(6)
v_accvgpr_read_b32 v224, a152
v_accvgpr_read_b32 v225, a153
v_mfma_f32_16x16x32_bf16 v[144:147], a[228:231], v[192:195], v[144:147]
s_waitcnt lgkmcnt(4)
buffer_load_dword v254, v253, s[4:7], s71 offen offset:260 sc1
v_mfma_f32_16x16x32_bf16 v[144:147], a[232:235], v[208:211], v[144:147]
ds_read_b64_tr_b16 a[200:201], v239 offset:20512
v_accvgpr_read_b32 v226, a154
v_mfma_f32_16x16x32_bf16 v[148:151], a[232:235], v[212:215], v[148:151]
ds_read_b64_tr_b16 a[202:203], v239 offset:25632
v_accvgpr_read_b32 v227, a155
v_mfma_f32_16x16x32_bf16 v[148:151], a[228:231], v[196:199], v[148:151]
ds_read_b64_tr_b16 a[204:205], v239 offset:30752
v_mul_f32 v224, v224, v230
v_mfma_f32_16x16x32_bf16 v[152:155], a[228:231], v[200:203], v[152:155]
ds_read_b64_tr_b16 a[206:207], v239 offset:35872
v_mul_f32 v225, v225, v230
v_mfma_f32_16x16x32_bf16 v[152:155], a[232:235], v[216:219], v[152:155]
buffer_load_dwordx4 v245, s[28:31], s3 offen offset:3072 lds
v_mfma_f32_16x16x32_bf16 v[156:159], a[232:235], v[220:223], v[156:159]
v_mul_f32 v226, v226, v230
v_mul_f32 v227, v227, v230
v_mfma_f32_16x16x32_bf16 v[156:159], a[228:231], v[204:207], v[156:159]
s_waitcnt vmcnt(17) lgkmcnt(6)
v_cvt_pk_bf16_f32 v170, v224, v225
v_cvt_pk_bf16_f32 v171, v226, v227
v_mfma_f32_16x16x32_bf16 v[12:15], a[192:195], a[12:15], v[12:15]
s_waitcnt vmcnt(11) lgkmcnt(4)
ds_read_b64_tr_b16 a[208:209], v238 offset:20544
v_accvgpr_read_b32 v224, a140
v_mfma_f32_16x16x32_bf16 v[12:15], a[196:199], a[28:31], v[12:15]
ds_read_b64_tr_b16 a[210:211], v238 offset:25664
v_accvgpr_read_b32 v225, a141
v_mfma_f32_16x16x32_bf16 v[8:11], a[196:199], a[24:27], v[8:11]
s_barrier
v_mfma_f32_16x16x32_bf16 v[8:11], a[192:195], a[8:11], v[8:11]
ds_read_b64_tr_b16 a[212:213], v238 offset:30784
v_accvgpr_read_b32 v226, a142
v_mfma_f32_16x16x32_bf16 v[4:7], a[192:195], a[4:7], v[4:7]
s_add_u32 m0, s55, 106496
ds_read_b64_tr_b16 a[214:215], v238 offset:35904
v_accvgpr_read_b32 v227, a143
v_mfma_f32_16x16x32_bf16 v[4:7], a[196:199], a[20:23], v[4:7]
buffer_load_dwordx4 v246, s[28:31], s3 offen lds
v_mfma_f32_16x16x32_bf16 v[0:3], a[196:199], a[16:19], v[0:3]
v_mul_f32 v224, v224, v231
v_mul_f32 v225, v225, v231
v_mfma_f32_16x16x32_bf16 v[0:3], a[192:195], a[0:3], v[0:3]
s_waitcnt lgkmcnt(6)
v_mul_f32 v226, v226, v231
v_mul_f32 v227, v227, v231
v_mfma_f32_16x16x32_bf16 v[16:19], a[200:203], a[0:3], v[16:19]
s_waitcnt lgkmcnt(4)
ds_read_b64_tr_b16 a[216:217], v239 offset:20576
v_cvt_pk_bf16_f32 v172, v224, v225
v_mfma_f32_16x16x32_bf16 v[16:19], a[204:207], a[16:19], v[16:19]
ds_read_b64_tr_b16 a[218:219], v239 offset:25696
v_cvt_pk_bf16_f32 v173, v226, v227
v_mfma_f32_16x16x32_bf16 v[20:23], a[204:207], a[20:23], v[20:23]
ds_read_b64_tr_b16 a[220:221], v239 offset:30816
v_accvgpr_read_b32 v224, a156
v_mfma_f32_16x16x32_bf16 v[20:23], a[200:203], a[4:7], v[20:23]
ds_read_b64_tr_b16 a[222:223], v239 offset:35936
v_accvgpr_read_b32 v225, a157
v_mfma_f32_16x16x32_bf16 v[24:27], a[200:203], a[8:11], v[24:27]
v_accvgpr_read_b32 v226, a158
v_accvgpr_read_b32 v227, a159
v_mfma_f32_16x16x32_bf16 v[24:27], a[204:207], a[24:27], v[24:27]
v_mul_f32 v224, v224, v231
v_mul_f32 v225, v225, v231
v_mfma_f32_16x16x32_bf16 v[28:31], a[204:207], a[28:31], v[28:31]
v_mul_f32 v226, v226, v231
v_mul_f32 v227, v227, v231
v_mfma_f32_16x16x32_bf16 v[28:31], a[200:203], a[12:15], v[28:31]
s_waitcnt lgkmcnt(6)
v_cvt_pk_bf16_f32 v174, v224, v225
v_cvt_pk_bf16_f32 v175, v226, v227
v_mfma_f32_16x16x32_bf16 v[44:47], a[208:211], a[12:15], v[44:47]
s_waitcnt lgkmcnt(4)
ds_read_b64_tr_b16 a[224:225], v238 offset:20608
v_accvgpr_read_b32 v224, a168
v_mfma_f32_16x16x32_bf16 v[44:47], a[212:215], a[28:31], v[44:47]
ds_read_b64_tr_b16 a[226:227], v238 offset:25728
v_accvgpr_read_b32 v225, a169
v_mfma_f32_16x16x32_bf16 v[40:43], a[212:215], a[24:27], v[40:43]
ds_read_b64_tr_b16 a[228:229], v238 offset:30848
v_accvgpr_read_b32 v226, a170
v_mfma_f32_16x16x32_bf16 v[40:43], a[208:211], a[8:11], v[40:43]
ds_read_b64_tr_b16 a[230:231], v238 offset:35968
v_accvgpr_read_b32 v227, a171
v_mfma_f32_16x16x32_bf16 v[36:39], a[208:211], a[4:7], v[36:39]
v_mul_f32 v224, v224, v230
v_mul_f32 v225, v225, v230
v_mfma_f32_16x16x32_bf16 v[36:39], a[212:215], a[20:23], v[36:39]
v_mul_f32 v226, v226, v230
v_mul_f32 v227, v227, v230
v_mfma_f32_16x16x32_bf16 v[32:35], a[212:215], a[16:19], v[32:35]
v_cvt_pk_bf16_f32 v184, v224, v225
v_cvt_pk_bf16_f32 v185, v226, v227
v_mfma_f32_16x16x32_bf16 v[32:35], a[208:211], a[0:3], v[32:35]
s_waitcnt lgkmcnt(6)
v_accvgpr_read_b32 v224, a184
v_accvgpr_read_b32 v225, a185
v_mfma_f32_16x16x32_bf16 v[48:51], a[216:219], a[0:3], v[48:51]
s_waitcnt lgkmcnt(4)
ds_read_b64_tr_b16 a[232:233], v239 offset:20640
v_accvgpr_read_b32 v226, a186
v_mfma_f32_16x16x32_bf16 v[48:51], a[220:223], a[16:19], v[48:51]
ds_read_b64_tr_b16 a[234:235], v239 offset:25760
v_accvgpr_read_b32 v227, a187
v_mfma_f32_16x16x32_bf16 v[52:55], a[220:223], a[20:23], v[52:55]
ds_read_b64_tr_b16 a[192:193], v239 offset:30880
v_mul_f32 v224, v224, v230
v_mfma_f32_16x16x32_bf16 v[52:55], a[216:219], a[4:7], v[52:55]
ds_read_b64_tr_b16 a[194:195], v239 offset:36000
v_mul_f32 v225, v225, v230
v_mfma_f32_16x16x32_bf16 v[56:59], a[216:219], a[8:11], v[56:59]
s_add_u32 m0, s55, 61440
v_mul_f32 v226, v226, v230
v_mul_f32 v227, v227, v230
v_mfma_f32_16x16x32_bf16 v[56:59], a[220:223], a[24:27], v[56:59]
s_add_u32 s3, s75, 122880
v_cvt_pk_bf16_f32 v186, v224, v225
v_cvt_pk_bf16_f32 v187, v226, v227
v_mfma_f32_16x16x32_bf16 v[60:63], a[220:223], a[28:31], v[60:63]
buffer_load_dwordx4 v242, s[28:31], s3 offen lds
v_mfma_f32_16x16x32_bf16 v[60:63], a[216:219], a[12:15], v[60:63]
s_waitcnt lgkmcnt(6)
v_accvgpr_read_b32 v224, a172
v_accvgpr_read_b32 v225, a173
v_mfma_f32_16x16x32_bf16 v[76:79], a[224:227], a[12:15], v[76:79]
s_waitcnt lgkmcnt(4)
ds_read_b64_tr_b16 a[196:197], v238 offset:20672
v_accvgpr_read_b32 v226, a174
v_mfma_f32_16x16x32_bf16 v[76:79], a[228:231], a[28:31], v[76:79]
ds_read_b64_tr_b16 a[198:199], v238 offset:25792
v_accvgpr_read_b32 v227, a175
v_mfma_f32_16x16x32_bf16 v[72:75], a[228:231], a[24:27], v[72:75]
ds_read_b64_tr_b16 a[200:201], v238 offset:30912
v_mul_f32 v224, v224, v231
v_mfma_f32_16x16x32_bf16 v[72:75], a[224:227], a[8:11], v[72:75]
ds_read_b64_tr_b16 a[202:203], v238 offset:36032
v_mul_f32 v225, v225, v231
v_mfma_f32_16x16x32_bf16 v[68:71], a[224:227], a[4:7], v[68:71]
v_mul_f32 v226, v226, v231
v_mul_f32 v227, v227, v231
v_mfma_f32_16x16x32_bf16 v[68:71], a[228:231], a[20:23], v[68:71]
v_cvt_pk_bf16_f32 v188, v224, v225
v_cvt_pk_bf16_f32 v189, v226, v227
v_mfma_f32_16x16x32_bf16 v[64:67], a[228:231], a[16:19], v[64:67]
s_waitcnt vmcnt(3)
buffer_load_dwordx4 v243, s[28:31], s3 offen offset:1024 lds
v_cmp_ne_u32 vcc, v254, v251
v_mfma_f32_16x16x32_bf16 v[64:67], a[224:227], a[0:3], v[64:67]
s_xor_b32 s91, s76, 266240
s_cbranch_vccnz L_spin_2
L_back_2:
v_accvgpr_read_b32 v224, a188
s_waitcnt lgkmcnt(6)
v_mfma_f32_16x16x32_bf16 v[80:83], a[232:235], a[0:3], v[80:83]
s_waitcnt lgkmcnt(4)
buffer_store_dwordx4 v[216:219], v250, s[4:7], s91 offen offset:2048 sc1
v_mfma_f32_16x16x32_bf16 v[80:83], a[192:195], a[16:19], v[80:83]
s_xor_b32 s90, s76, 20480
ds_read_b64_tr_b16 a[204:205], v239 offset:20704
v_accvgpr_read_b32 v225, a189
v_mfma_f32_16x16x32_bf16 v[84:87], a[192:195], a[20:23], v[84:87]
buffer_load_dwordx4 a[48:51], v250, s[4:7], s90 offen sc1
v_mfma_f32_16x16x32_bf16 v[84:87], a[232:235], a[4:7], v[84:87]
ds_read_b64_tr_b16 a[206:207], v239 offset:25824
v_accvgpr_read_b32 v226, a190
v_mfma_f32_16x16x32_bf16 v[88:91], a[232:235], a[8:11], v[88:91]
ds_read_b64_tr_b16 a[208:209], v239 offset:30944
v_accvgpr_read_b32 v227, a191
v_mfma_f32_16x16x32_bf16 v[88:91], a[192:195], a[24:27], v[88:91]
buffer_store_dwordx4 v[250:253], v252, s[4:7], s68 offen offset:384 sc1
v_mfma_f32_16x16x32_bf16 v[92:95], a[192:195], a[28:31], v[92:95]
ds_read_b64_tr_b16 a[210:211], v239 offset:36064
v_mul_f32 v224, v224, v231
v_mfma_f32_16x16x32_bf16 v[92:95], a[232:235], a[12:15], v[92:95]
s_waitcnt lgkmcnt(6)
buffer_load_dwordx4 v244, s[28:31], s3 offen offset:2048 lds
v_mfma_f32_16x16x32_bf16 v[108:111], a[196:199], a[12:15], v[108:111]
s_waitcnt lgkmcnt(4)
ds_read_b64_tr_b16 a[212:213], v238 offset:20736
v_mul_f32 v225, v225, v231
v_mfma_f32_16x16x32_bf16 v[108:111], a[200:203], a[28:31], v[108:111]
buffer_load_dwordx4 a[52:55], v250, s[4:7], s90 offen offset:1024 sc1
v_mfma_f32_16x16x32_bf16 v[104:107], a[200:203], a[24:27], v[104:107]
ds_read_b64_tr_b16 a[214:215], v238 offset:25856
v_mul_f32 v226, v226, v231
v_mfma_f32_16x16x32_bf16 v[104:107], a[196:199], a[8:11], v[104:107]
ds_read_b64_tr_b16 a[216:217], v238 offset:30976
v_mul_f32 v227, v227, v231
v_mfma_f32_16x16x32_bf16 v[100:103], a[196:199], a[4:7], v[100:103]
buffer_load_dwordx4 a[56:59], v250, s[4:7], s90 offen offset:2048 sc1
v_mfma_f32_16x16x32_bf16 v[100:103], a[200:203], a[20:23], v[100:103]
ds_read_b64_tr_b16 a[218:219], v238 offset:36096
v_cvt_pk_bf16_f32 v190, v224, v225
v_mfma_f32_16x16x32_bf16 v[96:99], a[200:203], a[16:19], v[96:99]
buffer_load_dwordx4 v245, s[28:31], s3 offen offset:3072 lds
v_mfma_f32_16x16x32_bf16 v[96:99], a[196:199], a[0:3], v[96:99]
s_waitcnt lgkmcnt(6)
v_cvt_pk_bf16_f32 v191, v226, v227
v_mfma_f32_16x16x32_bf16 v[112:115], a[204:207], a[0:3], v[112:115]
s_waitcnt lgkmcnt(4)
ds_read_b64_tr_b16 a[220:221], v239 offset:20768
v_mfma_f32_16x16x32_bf16 v[112:115], a[208:211], a[16:19], v[112:115]
ds_read_b64_tr_b16 a[222:223], v239 offset:25888
v_mfma_f32_16x16x32_bf16 v[116:119], a[208:211], a[20:23], v[116:119]
buffer_load_dwordx4 a[60:63], v250, s[4:7], s90 offen offset:3072 sc1
v_mfma_f32_16x16x32_bf16 v[116:119], a[204:207], a[4:7], v[116:119]
ds_read_b64_tr_b16 a[224:225], v239 offset:31008
v_mfma_f32_16x16x32_bf16 v[120:123], a[204:207], a[8:11], v[120:123]
buffer_store_dwordx4 v[220:223], v250, s[4:7], s91 offen offset:3072 sc1
v_mfma_f32_16x16x32_bf16 v[120:123], a[208:211], a[24:27], v[120:123]
ds_read_b64_tr_b16 a[226:227], v239 offset:36128
v_mfma_f32_16x16x32_bf16 v[124:127], a[208:211], a[28:31], v[124:127]
s_add_u32 m0, s55, 65536
v_mfma_f32_16x16x32_bf16 v[124:127], a[204:207], a[12:15], v[124:127]
s_waitcnt lgkmcnt(6)
v_mfma_f32_16x16x32_bf16 v[140:143], a[212:215], a[12:15], v[140:143]
s_waitcnt lgkmcnt(4)
buffer_load_dwordx4 v246, s[28:31], s3 offen lds
v_mfma_f32_16x16x32_bf16 v[140:143], a[216:219], a[28:31], v[140:143]
ds_read_b64_tr_b16 a[228:229], v240 offset:0
v_mfma_f32_16x16x32_bf16 v[136:139], a[216:219], a[24:27], v[136:139]
ds_read_b64_tr_b16 a[230:231], v240 offset:5120
v_mfma_f32_16x16x32_bf16 v[136:139], a[212:215], a[8:11], v[136:139]
s_xor_b32 s90, s76, 36864
ds_read_b64_tr_b16 a[232:233], v240 offset:10240
v_mfma_f32_16x16x32_bf16 v[132:135], a[212:215], a[4:7], v[132:135]
buffer_load_dwordx4 a[64:67], v250, s[4:7], s90 offen sc1
v_mfma_f32_16x16x32_bf16 v[132:135], a[216:219], a[20:23], v[132:135]
ds_read_b64_tr_b16 a[234:235], v240 offset:15360
v_mfma_f32_16x16x32_bf16 v[128:131], a[216:219], a[16:19], v[128:131]
v_mfma_f32_16x16x32_bf16 v[128:131], a[212:215], a[0:3], v[128:131]
s_waitcnt lgkmcnt(6)
v_mfma_f32_16x16x32_bf16 v[144:147], a[220:223], a[0:3], v[144:147]
s_waitcnt lgkmcnt(4)
buffer_load_dwordx4 a[68:71], v250, s[4:7], s90 offen offset:1024 sc1
v_mfma_f32_16x16x32_bf16 v[144:147], a[224:227], a[16:19], v[144:147]
ds_read_b64_tr_b16 a[192:193], v241 offset:32
v_mfma_f32_16x16x32_bf16 v[148:151], a[224:227], a[20:23], v[148:151]
ds_read_b64_tr_b16 a[194:195], v241 offset:5152
v_mfma_f32_16x16x32_bf16 v[148:151], a[220:223], a[4:7], v[148:151]
ds_read_b64_tr_b16 a[196:197], v241 offset:10272
v_mfma_f32_16x16x32_bf16 v[152:155], a[220:223], a[8:11], v[152:155]
buffer_load_dwordx4 a[72:75], v250, s[4:7], s90 offen offset:2048 sc1
v_mfma_f32_16x16x32_bf16 v[152:155], a[224:227], a[24:27], v[152:155]
ds_read_b64_tr_b16 a[198:199], v241 offset:15392
v_mfma_f32_16x16x32_bf16 v[156:159], a[224:227], a[28:31], v[156:159]
v_mfma_f32_16x16x32_bf16 v[156:159], a[220:223], a[12:15], v[156:159]
s_waitcnt lgkmcnt(6)
v_mfma_f32_16x16x32_bf16 v[12:15], a[228:231], v[172:175], v[12:15]
s_waitcnt lgkmcnt(4)
ds_read_b64_tr_b16 a[200:201], v240 offset:64
v_mfma_f32_16x16x32_bf16 v[12:15], a[232:235], v[188:191], v[12:15]
ds_read_b64_tr_b16 a[202:203], v240 offset:5184
v_mfma_f32_16x16x32_bf16 v[8:11], a[232:235], v[184:187], v[8:11]
s_barrier
buffer_load_dwordx4 a[76:79], v250, s[4:7], s90 offen offset:3072 sc1
v_mfma_f32_16x16x32_bf16 v[8:11], a[228:231], v[168:171], v[8:11]
ds_read_b64_tr_b16 a[204:205], v240 offset:10304
v_mfma_f32_16x16x32_bf16 v[4:7], a[228:231], v[164:167], v[4:7]
ds_read_b64_tr_b16 a[206:207], v240 offset:15424
v_mfma_f32_16x16x32_bf16 v[4:7], a[232:235], v[180:183], v[4:7]
v_mfma_f32_16x16x32_bf16 v[0:3], a[232:235], v[176:179], v[0:3]
s_xor_b32 s90, s76, 53248
v_mfma_f32_16x16x32_bf16 v[0:3], a[228:231], v[160:163], v[0:3]
s_waitcnt lgkmcnt(6)
v_mfma_f32_16x16x32_bf16 v[16:19], a[192:195], v[160:163], v[16:19]
s_waitcnt lgkmcnt(4)
buffer_load_dwordx4 a[80:83], v250, s[4:7], s90 offen sc1
v_mfma_f32_16x16x32_bf16 v[16:19], a[196:199], v[176:179], v[16:19]
s_xor_b32 s91, s76, 524288
ds_read_b64_tr_b16 a[208:209], v241 offset:96
v_mfma_f32_16x16x32_bf16 v[20:23], a[196:199], v[180:183], v[20:23]
buffer_store_dwordx4 v[168:171], v250, s[4:7], s91 offen offset:2048 sc1
v_mfma_f32_16x16x32_bf16 v[20:23], a[192:195], v[164:167], v[20:23]
s_add_u32 m0, s55, 81920
s_add_u32 s3, s73, 163840
ds_read_b64_tr_b16 a[210:211], v241 offset:5216
v_mfma_f32_16x16x32_bf16 v[24:27], a[192:195], v[168:171], v[24:27]
buffer_load_dwordx4 v242, s[28:31], s3 offen lds
v_mfma_f32_16x16x32_bf16 v[24:27], a[196:199], v[184:187], v[24:27]
ds_read_b64_tr_b16 a[212:213], v241 offset:10336
v_mfma_f32_16x16x32_bf16 v[28:31], a[196:199], v[188:191], v[28:31]
ds_read_b64_tr_b16 a[214:215], v241 offset:15456
v_mfma_f32_16x16x32_bf16 v[28:31], a[192:195], v[172:175], v[28:31]
s_waitcnt lgkmcnt(6)
v_mfma_f32_16x16x32_bf16 v[44:47], a[200:203], v[172:175], v[44:47]
s_waitcnt lgkmcnt(4)
buffer_load_dwordx4 a[84:87], v250, s[4:7], s90 offen offset:1024 sc1
v_mfma_f32_16x16x32_bf16 v[44:47], a[204:207], v[188:191], v[44:47]
ds_read_b64_tr_b16 a[216:217], v240 offset:128
v_mfma_f32_16x16x32_bf16 v[40:43], a[204:207], v[184:187], v[40:43]
ds_read_b64_tr_b16 a[218:219], v240 offset:5248
v_mfma_f32_16x16x32_bf16 v[40:43], a[200:203], v[168:171], v[40:43]
ds_read_b64_tr_b16 a[220:221], v240 offset:10368
v_mfma_f32_16x16x32_bf16 v[36:39], a[200:203], v[164:167], v[36:39]
buffer_load_dwordx4 v243, s[28:31], s3 offen offset:1024 lds
v_mfma_f32_16x16x32_bf16 v[36:39], a[204:207], v[180:183], v[36:39]
ds_read_b64_tr_b16 a[222:223], v240 offset:15488
v_mfma_f32_16x16x32_bf16 v[32:35], a[204:207], v[176:179], v[32:35]
v_mfma_f32_16x16x32_bf16 v[32:35], a[200:203], v[160:163], v[32:35]
s_waitcnt lgkmcnt(6)
v_mfma_f32_16x16x32_bf16 v[48:51], a[208:211], v[160:163], v[48:51]
s_waitcnt lgkmcnt(4)
buffer_load_dwordx4 a[88:91], v250, s[4:7], s90 offen offset:2048 sc1
v_mfma_f32_16x16x32_bf16 v[48:51], a[212:215], v[176:179], v[48:51]
ds_read_b64_tr_b16 a[224:225], v241 offset:160
v_mfma_f32_16x16x32_bf16 v[52:55], a[212:215], v[180:183], v[52:55]
ds_read_b64_tr_b16 a[226:227], v241 offset:5280
v_mfma_f32_16x16x32_bf16 v[52:55], a[208:211], v[164:167], v[52:55]
ds_read_b64_tr_b16 a[228:229], v241 offset:10400
v_mfma_f32_16x16x32_bf16 v[56:59], a[208:211], v[168:171], v[56:59]
buffer_load_dwordx4 v244, s[28:31], s3 offen offset:2048 lds
v_mfma_f32_16x16x32_bf16 v[56:59], a[212:215], v[184:187], v[56:59]
ds_read_b64_tr_b16 a[230:231], v241 offset:15520
v_mfma_f32_16x16x32_bf16 v[60:63], a[212:215], v[188:191], v[60:63]
v_mfma_f32_16x16x32_bf16 v[60:63], a[208:211], v[172:175], v[60:63]
s_waitcnt lgkmcnt(6)
v_mfma_f32_16x16x32_bf16 v[76:79], a[216:219], v[172:175], v[76:79]
s_waitcnt lgkmcnt(4)
buffer_load_dwordx4 a[92:95], v250, s[4:7], s90 offen offset:3072 sc1
v_mfma_f32_16x16x32_bf16 v[76:79], a[220:223], v[188:191], v[76:79]
ds_read_b64_tr_b16 a[232:233], v240 offset:192
v_mfma_f32_16x16x32_bf16 v[72:75], a[220:223], v[184:187], v[72:75]
ds_read_b64_tr_b16 a[234:235], v240 offset:5312
v_mfma_f32_16x16x32_bf16 v[72:75], a[216:219], v[168:171], v[72:75]
ds_read_b64_tr_b16 a[192:193], v240 offset:10432
v_mfma_f32_16x16x32_bf16 v[68:71], a[216:219], v[164:167], v[68:71]
buffer_store_dwordx4 v[172:175], v250, s[4:7], s91 offen offset:3072 sc1
v_mfma_f32_16x16x32_bf16 v[68:71], a[220:223], v[180:183], v[68:71]
ds_read_b64_tr_b16 a[194:195], v240 offset:15552
v_mfma_f32_16x16x32_bf16 v[64:67], a[220:223], v[176:179], v[64:67]
v_mfma_f32_16x16x32_bf16 v[64:67], a[216:219], v[160:163], v[64:67]
s_waitcnt lgkmcnt(6)
v_mfma_f32_16x16x32_bf16 v[80:83], a[224:227], v[160:163], v[80:83]
s_waitcnt lgkmcnt(4)
buffer_load_dwordx4 v245, s[28:31], s3 offen offset:3072 lds
v_mfma_f32_16x16x32_bf16 v[80:83], a[228:231], v[176:179], v[80:83]
ds_read_b64_tr_b16 a[196:197], v241 offset:224
v_mfma_f32_16x16x32_bf16 v[84:87], a[228:231], v[180:183], v[84:87]
ds_read_b64_tr_b16 a[198:199], v241 offset:5344
v_mfma_f32_16x16x32_bf16 v[84:87], a[224:227], v[164:167], v[84:87]
s_add_u32 m0, s55, 86016
ds_read_b64_tr_b16 a[200:201], v241 offset:10464
v_mfma_f32_16x16x32_bf16 v[88:91], a[224:227], v[168:171], v[88:91]
buffer_load_dwordx4 v246, s[28:31], s3 offen lds
v_mfma_f32_16x16x32_bf16 v[88:91], a[228:231], v[184:187], v[88:91]
ds_read_b64_tr_b16 a[202:203], v241 offset:15584
v_mfma_f32_16x16x32_bf16 v[92:95], a[228:231], v[188:191], v[92:95]
v_mfma_f32_16x16x32_bf16 v[92:95], a[224:227], v[172:175], v[92:95]
s_waitcnt lgkmcnt(6)
v_mfma_f32_16x16x32_bf16 v[108:111], a[232:235], v[172:175], v[108:111]
s_waitcnt lgkmcnt(4)
ds_read_b64_tr_b16 a[204:205], v240 offset:256
v_mfma_f32_16x16x32_bf16 v[108:111], a[192:195], v[188:191], v[108:111]
ds_read_b64_tr_b16 a[206:207], v240 offset:5376
v_mfma_f32_16x16x32_bf16 v[104:107], a[192:195], v[184:187], v[104:107]
ds_read_b64_tr_b16 a[208:209], v240 offset:10496
v_mfma_f32_16x16x32_bf16 v[104:107], a[232:235], v[168:171], v[104:107]
ds_read_b64_tr_b16 a[210:211], v240 offset:15616
v_mfma_f32_16x16x32_bf16 v[100:103], a[232:235], v[164:167], v[100:103]
L_walk2_4:
s_cbranch_execz L_ret2
v_mfma_f32_16x16x32_bf16 v[100:103], a[192:195], v[180:183], v[100:103]
v_mfma_f32_16x16x32_bf16 v[96:99], a[192:195], v[176:179], v[96:99]
v_mfma_f32_16x16x32_bf16 v[96:99], a[232:235], v[160:163], v[96:99]
s_waitcnt lgkmcnt(6)
v_mfma_f32_16x16x32_bf16 v[112:115], a[196:199], v[160:163], v[112:115]
s_waitcnt lgkmcnt(4)
ds_read_b64_tr_b16 a[212:213], v241 offset:288
v_mfma_f32_16x16x32_bf16 v[112:115], a[200:203], v[176:179], v[112:115]
ds_read_b64_tr_b16 a[214:215], v241 offset:5408
v_mfma_f32_16x16x32_bf16 v[116:119], a[200:203], v[180:183], v[116:119]
ds_read_b64_tr_b16 a[216:217], v241 offset:10528
v_mfma_f32_16x16x32_bf16 v[116:119], a[196:199], v[164:167], v[116:119]
s_xor_b32 s91, s76, 528384
ds_read_b64_tr_b16 a[218:219], v241 offset:15648
v_mfma_f32_16x16x32_bf16 v[120:123], a[196:199], v[168:171], v[120:123]
buffer_store_dwordx4 v[184:187], v250, s[4:7], s91 offen offset:2048 sc1
v_mfma_f32_16x16x32_bf16 v[120:123], a[200:203], v[184:187], v[120:123]
ds_read_b64_tr_b16 a[220:221], v240 offset:20480
v_mfma_f32_16x16x32_bf16 v[124:127], a[200:203], v[188:191], v[124:127]
buffer_load_dword v254, v253, s[4:7], s71 offen offset:388 sc1
v_mfma_f32_16x16x32_bf16 v[124:127], a[196:199], v[172:175], v[124:127]
s_waitcnt lgkmcnt(7)
ds_read_b64_tr_b16 a[222:223], v240 offset:25600
v_mfma_f32_16x16x32_bf16 v[140:143], a[204:207], v[172:175], v[140:143]
s_waitcnt lgkmcnt(6)
ds_read_b64_tr_b16 a[224:225], v240 offset:30720
v_mfma_f32_16x16x32_bf16 v[140:143], a[208:211], v[188:191], v[140:143]
ds_read_b64_tr_b16 a[226:227], v240 offset:35840
v_mfma_f32_16x16x32_bf16 v[136:139], a[208:211], v[184:187], v[136:139]
ds_read_b64_tr_b16 a[228:229], v236 offset:0
v_mfma_f32_16x16x32_bf16 v[136:139], a[204:207], v[168:171], v[136:139]
ds_read_b64_tr_b16 a[230:231], v236 offset:5120
v_mfma_f32_16x16x32_bf16 v[132:135], a[204:207], v[164:167], v[132:135]
ds_read_b64_tr_b16 a[232:233], v236 offset:10240
v_mfma_f32_16x16x32_bf16 v[132:135], a[208:211], v[180:183], v[132:135]
ds_read_b64_tr_b16 a[234:235], v236 offset:15360
v_mfma_f32_16x16x32_bf16 v[128:131], a[208:211], v[176:179], v[128:131]
v_mfma_f32_16x16x32_bf16 v[128:131], a[204:207], v[160:163], v[128:131]
s_waitcnt lgkmcnt(10)
v_mfma_f32_16x16x32_bf16 v[144:147], a[212:215], v[160:163], v[144:147]
s_waitcnt lgkmcnt(8)
ds_read_b64_tr_b16 a[192:193], v241 offset:20512
v_mfma_f32_16x16x32_bf16 v[144:147], a[216:219], v[176:179], v[144:147]
ds_read_b64_tr_b16 a[194:195], v241 offset:25632
v_mfma_f32_16x16x32_bf16 v[148:151], a[216:219], v[180:183], v[148:151]
ds_read_b64_tr_b16 a[196:197], v241 offset:30752
v_mfma_f32_16x16x32_bf16 v[148:151], a[212:215], v[164:167], v[148:151]
ds_read_b64_tr_b16 a[198:199], v241 offset:35872
v_mfma_f32_16x16x32_bf16 v[152:155], a[212:215], v[168:171], v[152:155]
ds_read_b64_tr_b16 a[200:201], v237 offset:32
v_mfma_f32_16x16x32_bf16 v[152:155], a[216:219], v[184:187], v[152:155]
ds_read_b64_tr_b16 a[202:203], v237 offset:5152
v_mfma_f32_16x16x32_bf16 v[156:159], a[216:219], v[188:191], v[156:159]
ds_read_b64_tr_b16 a[204:205], v237 offset:10272
v_mfma_f32_16x16x32_bf16 v[156:159], a[212:215], v[172:175], v[156:159]
s_waitcnt lgkmcnt(13)
ds_read_b64_tr_b16 a[206:207], v237 offset:15392
v_mfma_f32_16x16x32_bf16 v[12:15], a[220:223], a[44:47], v[12:15]
s_waitcnt vmcnt(19) lgkmcnt(12)
buffer_store_dwordx4 v[188:191], v250, s[4:7], s91 offen offset:3072 sc1
v_mfma_f32_16x16x32_bf16 v[12:15], a[224:227], a[60:63], v[12:15]
s_waitcnt vmcnt(14) lgkmcnt(10)
v_mfma_f32_16x16x32_bf16 v[12:15], a[228:231], a[76:79], v[12:15]
s_waitcnt vmcnt(6) lgkmcnt(8)
s_barrier
v_mfma_f32_16x16x32_bf16 v[12:15], a[232:235], a[92:95], v[12:15]
v_mfma_f32_16x16x32_bf16 v[8:11], a[232:235], a[88:91], v[8:11]
v_mfma_f32_16x16x32_bf16 v[8:11], a[228:231], a[72:75], v[8:11]
v_mfma_f32_16x16x32_bf16 v[8:11], a[224:227], a[56:59], v[8:11]
v_mfma_f32_16x16x32_bf16 v[8:11], a[220:223], a[40:43], v[8:11]
v_mfma_f32_16x16x32_bf16 v[4:7], a[220:223], a[36:39], v[4:7]
s_add_u32 m0, s55, 122880
ds_read_b64_tr_b16 a[208:209], v240 offset:20544
v_mfma_f32_16x16x32_bf16 v[4:7], a[224:227], a[52:55], v[4:7]
s_add_u32 s3, s74, 163840
ds_read_b64_tr_b16 a[210:211], v240 offset:25664
v_mfma_f32_16x16x32_bf16 v[4:7], a[228:231], a[68:71], v[4:7]
buffer_load_dwordx4 v242, s[28:31], s3 offen lds
v_mfma_f32_16x16x32_bf16 v[4:7], a[232:235], a[84:87], v[4:7]
ds_read_b64_tr_b16 a[212:213], v240 offset:30784
v_mfma_f32_16x16x32_bf16 v[0:3], a[232:235], a[80:83], v[0:3]
ds_read_b64_tr_b16 a[214:215], v240 offset:35904
v_mfma_f32_16x16x32_bf16 v[0:3], a[228:231], a[64:67], v[0:3]
ds_read_b64_tr_b16 a[216:217], v236 offset:64
v_mfma_f32_16x16x32_bf16 v[0:3], a[224:227], a[48:51], v[0:3]
ds_read_b64_tr_b16 a[218:219], v236 offset:5184
v_mfma_f32_16x16x32_bf16 v[0:3], a[220:223], a[32:35], v[0:3]
s_waitcnt lgkmcnt(12)
ds_read_b64_tr_b16 a[220:221], v236 offset:10304
v_mfma_f32_16x16x32_bf16 v[16:19], a[192:195], a[32:35], v[16:19]
s_waitcnt lgkmcnt(11)
buffer_load_dwordx4 v243, s[28:31], s3 offen offset:1024 lds
v_mfma_f32_16x16x32_bf16 v[16:19], a[196:199], a[48:51], v[16:19]
s_waitcnt lgkmcnt(9)
ds_read_b64_tr_b16 a[222:223], v236 offset:15424
v_xor_b32 v247, 2048, v247
v_mfma_f32_16x16x32_bf16 v[16:19], a[200:203], a[64:67], v[16:19]
s_waitcnt lgkmcnt(8)
v_mfma_f32_16x16x32_bf16 v[16:19], a[204:207], a[80:83], v[16:19]
v_mfma_f32_16x16x32_bf16 v[20:23], a[204:207], a[84:87], v[20:23]
v_mfma_f32_16x16x32_bf16 v[20:23], a[200:203], a[68:71], v[20:23]
v_mfma_f32_16x16x32_bf16 v[20:23], a[196:199], a[52:55], v[20:23]
buffer_load_dwordx4 v244, s[28:31], s3 offen offset:2048 lds
v_mfma_f32_16x16x32_bf16 v[20:23], a[192:195], a[36:39], v[20:23]
v_mfma_f32_16x16x32_bf16 v[24:27], a[192:195], a[40:43], v[24:27]
ds_read_b64_tr_b16 a[224:225], v241 offset:20576
v_mfma_f32_16x16x32_bf16 v[24:27], a[196:199], a[56:59], v[24:27]
ds_read_b128 v[160:163], v247 offset:40960
v_lshrrev_b32 v232, 8, v250
v_mfma_f32_16x16x32_bf16 v[24:27], a[200:203], a[72:75], v[24:27]
ds_read_b128 v[164:167], v247 offset:45056
v_and_b32 v233, 0xf0, v250
v_mfma_f32_16x16x32_bf16 v[24:27], a[204:207], a[88:91], v[24:27]
ds_read_b128 v[168:171], v247 offset:49152
v_mul_u32_u24 v233, 80, v233
v_mfma_f32_16x16x32_bf16 v[28:31], a[204:207], a[92:95], v[28:31]
ds_read_b128 v[172:175], v247 offset:53248
buffer_load_dwordx4 v245, s[28:31], s3 offen offset:3072 lds
v_mfma_f32_16x16x32_bf16 v[28:31], a[200:203], a[76:79], v[28:31]
s_add_u32 m0, s55, 126976
ds_read_b128 v[176:179], v247 offset:57344
v_lshl_add_u32 v232, v232, 3, v233
v_mfma_f32_16x16x32_bf16 v[28:31], a[196:199], a[60:63], v[28:31]
s_waitcnt vmcnt(5)
ds_read_b64_tr_b16 a[226:227], v241 offset:25696
v_cmp_ne_u32 vcc, v254, v251
v_mfma_f32_16x16x32_bf16 v[28:31], a[192:195], a[44:47], v[28:31]
s_cbranch_vccnz L_spin_3
L_back_3:
ds_read_b64_tr_b16 a[228:229], v241 offset:30816
s_waitcnt lgkmcnt(14)
v_mfma_f32_16x16x32_bf16 v[44:47], a[208:211], a[44:47], v[44:47]
s_waitcnt lgkmcnt(12)
ds_read_b64_tr_b16 a[230:231], v241 offset:35936
v_accvgpr_read_b32 v228, a236
v_mfma_f32_16x16x32_bf16 v[44:47], a[212:215], a[60:63], v[44:47]
s_waitcnt lgkmcnt(7)
ds_read_b64_tr_b16 a[232:233], v237 offset:96
v_add_f32 v160, v160, v228
v_mfma_f32_16x16x32_bf16 v[44:47], a[216:219], a[76:79], v[44:47]
buffer_load_dwordx4 v246, s[28:31], s3 offen lds
v_mfma_f32_16x16x32_bf16 v[44:47], a[220:223], a[92:95], v[44:47]
ds_read_b64_tr_b16 a[234:235], v237 offset:5216
v_mul_f32 v228, 0xbfb8aa3b, v160
v_mfma_f32_16x16x32_bf16 v[40:43], a[220:223], a[88:91], v[40:43]
ds_read_b64_tr_b16 a[192:193], v237 offset:10336
v_accvgpr_read_b32 v229, a237
v_mfma_f32_16x16x32_bf16 v[40:43], a[216:219], a[72:75], v[40:43]
ds_read_b64_tr_b16 a[194:195], v237 offset:15456
v_add_f32 v161, v161, v229
v_mfma_f32_16x16x32_bf16 v[40:43], a[212:215], a[56:59], v[40:43]
s_lshl_b32 s94, s47, 2
v_mul_f32 v229, 0xbfb8aa3b, v161
v_mfma_f32_16x16x32_bf16 v[40:43], a[208:211], a[40:43], v[40:43]
s_xor_b32 s90, s76, 278528
s_xor_b32 s94, s94, 128
v_accvgpr_read_b32 v230, a238
v_mfma_f32_16x16x32_bf16 v[36:39], a[208:211], a[36:39], v[36:39]
buffer_load_dwordx4 a[96:99], v250, s[4:7], s90 offen sc1
v_mfma_f32_16x16x32_bf16 v[36:39], a[212:215], a[52:55], v[36:39]
ds_read_b64_tr_b16 a[196:197], v240 offset:20608
v_add_u32 v211, s94, v232
v_mfma_f32_16x16x32_bf16 v[36:39], a[216:219], a[68:71], v[36:39]
ds_read_b64_tr_b16 a[198:199], v240 offset:25728
v_add_u32 v232, s47, v232
v_mfma_f32_16x16x32_bf16 v[36:39], a[220:223], a[84:87], v[36:39]
ds_read_b64_tr_b16 a[200:201], v240 offset:30848
v_add_f32 v162, v162, v230
v_mfma_f32_16x16x32_bf16 v[32:35], a[220:223], a[80:83], v[32:35]
s_waitcnt lgkmcnt(10)
s_barrier
buffer_load_dwordx4 a[100:103], v250, s[4:7], s90 offen offset:1024 sc1
v_mfma_f32_16x16x32_bf16 v[32:35], a[216:219], a[64:67], v[32:35]
ds_read_b64_tr_b16 a[202:203], v240 offset:35968
v_mul_f32 v230, 0xbfb8aa3b, v162
v_mfma_f32_16x16x32_bf16 v[32:35], a[212:215], a[48:51], v[32:35]
s_xor_b32 s90, s76, 294912
ds_read_b64_tr_b16 a[204:205], v236 offset:128
v_accvgpr_read_b32 v231, a239
v_mfma_f32_16x16x32_bf16 v[32:35], a[208:211], a[32:35], v[32:35]
s_waitcnt lgkmcnt(11)
ds_read_b64_tr_b16 a[206:207], v236 offset:5248
v_add_f32 v163, v163, v231
v_mfma_f32_16x16x32_bf16 v[48:51], a[224:227], a[32:35], v[48:51]
s_waitcnt lgkmcnt(10)
ds_read_b64_tr_b16 a[208:209], v236 offset:10368
v_mul_f32 v231, 0xbfb8aa3b, v163
v_mfma_f32_16x16x32_bf16 v[48:51], a[228:231], a[48:51], v[48:51]
s_waitcnt lgkmcnt(9)
buffer_load_dwordx4 a[104:107], v250, s[4:7], s90 offen sc1
v_mfma_f32_16x16x32_bf16 v[48:51], a[232:235], a[64:67], v[48:51]
s_waitcnt lgkmcnt(7)
s_add_u32 m0, s55, 40960
s_add_u32 s3, s75, 204800
v_exp_f32 v228, v228
v_mfma_f32_16x16x32_bf16 v[48:51], a[192:195], a[80:83], v[48:51]
buffer_load_dwordx4 v242, s[28:31], s3 offen lds
v_mfma_f32_16x16x32_bf16 v[52:55], a[192:195], a[84:87], v[52:55]
ds_read_b64_tr_b16 a[210:211], v236 offset:15488
v_add_f32 v228, 1.0, v228
v_mfma_f32_16x16x32_bf16 v[52:55], a[232:235], a[68:71], v[52:55]
buffer_load_dwordx4 a[108:111], v250, s[4:7], s90 offen offset:1024 sc1
v_mfma_f32_16x16x32_bf16 v[52:55], a[228:231], a[52:55], v[52:55]
v_exp_f32 v229, v229
v_mfma_f32_16x16x32_bf16 v[52:55], a[224:227], a[36:39], v[52:55]
v_exp_f32 v230, v230
v_mfma_f32_16x16x32_bf16 v[56:59], a[224:227], a[40:43], v[56:59]
buffer_load_dwordx4 v243, s[28:31], s3 offen offset:1024 lds
v_mfma_f32_16x16x32_bf16 v[56:59], a[228:231], a[56:59], v[56:59]
s_xor_b32 s90, s76, 311296
ds_read_b64_tr_b16 a[212:213], v241 offset:20640
v_add_f32 v229, 1.0, v229
v_mfma_f32_16x16x32_bf16 v[56:59], a[232:235], a[72:75], v[56:59]
buffer_load_dwordx4 a[112:115], v250, s[4:7], s90 offen sc1
v_mfma_f32_16x16x32_bf16 v[56:59], a[192:195], a[88:91], v[56:59]
ds_read_b64_tr_b16 a[214:215], v241 offset:25760
v_add_f32 v230, 1.0, v230
v_mfma_f32_16x16x32_bf16 v[60:63], a[192:195], a[92:95], v[60:63]
v_exp_f32 v231, v231
v_mfma_f32_16x16x32_bf16 v[60:63], a[232:235], a[76:79], v[60:63]
ds_read_b64_tr_b16 a[216:217], v241 offset:30880
v_add_f32 v231, 1.0, v231
v_mfma_f32_16x16x32_bf16 v[60:63], a[228:231], a[60:63], v[60:63]
buffer_load_dwordx4 v244, s[28:31], s3 offen offset:2048 lds
v_mfma_f32_16x16x32_bf16 v[60:63], a[224:227], a[44:47], v[60:63]
s_waitcnt lgkmcnt(9)
v_rcp_f32 v228, v228
v_mfma_f32_16x16x32_bf16 v[76:79], a[196:199], a[44:47], v[76:79]
s_waitcnt lgkmcnt(7)
buffer_load_dwordx4 a[116:119], v250, s[4:7], s90 offen offset:1024 sc1
v_mfma_f32_16x16x32_bf16 v[76:79], a[200:203], a[60:63], v[76:79]
s_waitcnt lgkmcnt(5)
ds_read_b64_tr_b16 a[218:219], v241 offset:36000
v_mul_f32 v160, v160, v228
v_mfma_f32_16x16x32_bf16 v[76:79], a[204:207], a[76:79], v[76:79]
s_waitcnt vmcnt(14) lgkmcnt(4)
buffer_store_dwordx4 v[250:253], v252, s[4:7], s68 offen offset:512 sc1
v_mfma_f32_16x16x32_bf16 v[76:79], a[208:211], a[92:95], v[76:79]
s_xor_b32 s90, s76, 282624
ds_read_b64_tr_b16 a[220:221], v237 offset:160
v_accvgpr_read_b32 v228, a240
v_mfma_f32_16x16x32_bf16 v[72:75], a[208:211], a[88:91], v[72:75]
buffer_load_dwordx4 a[120:123], v250, s[4:7], s90 offen sc1
v_mfma_f32_16x16x32_bf16 v[72:75], a[204:207], a[72:75], v[72:75]
ds_read_b64_tr_b16 a[222:223], v237 offset:5280
v_add_f32 v164, v164, v228
v_mfma_f32_16x16x32_bf16 v[72:75], a[200:203], a[56:59], v[72:75]
buffer_load_dwordx4 v245, s[28:31], s3 offen offset:3072 lds
v_mfma_f32_16x16x32_bf16 v[72:75], a[196:199], a[40:43], v[72:75]
ds_read_b64_tr_b16 a[224:225], v237 offset:10400
v_mul_f32 v228, 0xbfb8aa3b, v164
v_mfma_f32_16x16x32_bf16 v[68:71], a[196:199], a[36:39], v[68:71]
ds_read_b64_tr_b16 a[226:227], v237 offset:15520
v_mfma_f32_16x16x32_bf16 v[68:71], a[200:203], a[52:55], v[68:71]
v_rcp_f32 v229, v229
v_mfma_f32_16x16x32_bf16 v[68:71], a[204:207], a[68:71], v[68:71]
buffer_load_dwordx4 a[124:127], v250, s[4:7], s90 offen offset:1024 sc1
v_mfma_f32_16x16x32_bf16 v[68:71], a[208:211], a[84:87], v[68:71]
ds_read_b64_tr_b16 a[228:229], v240 offset:20672
v_mul_f32 v161, v161, v229
v_mfma_f32_16x16x32_bf16 v[64:67], a[208:211], a[80:83], v[64:67]
ds_read_b64_tr_b16 a[230:231], v240 offset:25792
v_accvgpr_read_b32 v229, a241
v_mfma_f32_16x16x32_bf16 v[64:67], a[204:207], a[64:67], v[64:67]
s_add_u32 m0, s55, 45056
ds_read_b64_tr_b16 a[232:233], v240 offset:30912
v_add_f32 v165, v165, v229
v_mfma_f32_16x16x32_bf16 v[64:67], a[200:203], a[48:51], v[64:67]
buffer_load_dwordx4 v246, s[28:31], s3 offen lds
v_mfma_f32_16x16x32_bf16 v[64:67], a[196:199], a[32:35], v[64:67]
s_waitcnt lgkmcnt(9)
ds_read_b64_tr_b16 a[234:235], v240 offset:36032
v_mul_f32 v229, 0xbfb8aa3b, v165
v_mfma_f32_16x16x32_bf16 v[80:83], a[212:215], a[32:35], v[80:83]
s_waitcnt lgkmcnt(8)
v_rcp_f32 v230, v230
v_mfma_f32_16x16x32_bf16 v[80:83], a[216:219], a[48:51], v[80:83]
s_waitcnt lgkmcnt(6)
s_xor_b32 s90, s76, 299008
ds_read_b64_tr_b16 a[192:193], v236 offset:192
v_mul_f32 v162, v162, v230
v_mfma_f32_16x16x32_bf16 v[80:83], a[220:223], a[64:67], v[80:83]
s_waitcnt lgkmcnt(5)
buffer_load_dwordx4 a[128:131], v250, s[4:7], s90 offen sc1
v_mfma_f32_16x16x32_bf16 v[80:83], a[224:227], a[80:83], v[80:83]
ds_read_b64_tr_b16 a[194:195], v236 offset:5312
v_accvgpr_read_b32 v230, a242
v_mfma_f32_16x16x32_bf16 v[84:87], a[224:227], a[84:87], v[84:87]
ds_read_b64_tr_b16 a[196:197], v236 offset:10432
v_add_f32 v166, v166, v230
v_mfma_f32_16x16x32_bf16 v[84:87], a[220:223], a[68:71], v[84:87]
ds_read_b64_tr_b16 a[198:199], v236 offset:15552
v_mul_f32 v230, 0xbfb8aa3b, v166
v_mfma_f32_16x16x32_bf16 v[84:87], a[216:219], a[52:55], v[84:87]
buffer_load_dwordx4 a[132:135], v250, s[4:7], s90 offen offset:1024 sc1
v_mfma_f32_16x16x32_bf16 v[84:87], a[212:215], a[36:39], v[84:87]
v_rcp_f32 v231, v231
v_mfma_f32_16x16x32_bf16 v[88:91], a[212:215], a[40:43], v[88:91]
ds_read_b64_tr_b16 a[200:201], v241 offset:20704
v_mul_f32 v163, v163, v231
v_mfma_f32_16x16x32_bf16 v[88:91], a[216:219], a[56:59], v[88:91]
s_xor_b32 s90, s76, 315392
ds_read_b64_tr_b16 a[202:203], v241 offset:25824
v_accvgpr_read_b32 v231, a243
v_mfma_f32_16x16x32_bf16 v[88:91], a[220:223], a[72:75], v[88:91]
buffer_load_dwordx4 a[136:139], v250, s[4:7], s90 offen sc1
v_mfma_f32_16x16x32_bf16 v[88:91], a[224:227], a[88:91], v[88:91]
ds_read_b64_tr_b16 a[204:205], v241 offset:30944
v_add_f32 v167, v167, v231
v_mfma_f32_16x16x32_bf16 v[92:95], a[224:227], a[92:95], v[92:95]
ds_read_b64_tr_b16 a[206:207], v241 offset:36064
v_mul_f32 v231, 0xbfb8aa3b, v167
v_mfma_f32_16x16x32_bf16 v[92:95], a[220:223], a[76:79], v[92:95]
v_exp_f32 v228, v228
v_mfma_f32_16x16x32_bf16 v[92:95], a[216:219], a[60:63], v[92:95]
buffer_load_dwordx4 a[140:143], v250, s[4:7], s90 offen offset:1024 sc1
v_mfma_f32_16x16x32_bf16 v[92:95], a[212:215], a[44:47], v[92:95]
s_waitcnt lgkmcnt(10)
ds_read_b64_tr_b16 a[208:209], v237 offset:224
v_add_f32 v228, 1.0, v228
v_mfma_f32_16x16x32_bf16 v[108:111], a[228:231], a[44:47], v[108:111]
s_waitcnt lgkmcnt(9)
v_exp_f32 v229, v229
v_mfma_f32_16x16x32_bf16 v[108:111], a[232:235], a[60:63], v[108:111]
s_waitcnt lgkmcnt(7)
s_xor_b32 s90, s76, 540672
ds_read_b64_tr_b16 a[210:211], v237 offset:5344
v_add_f32 v229, 1.0, v229
v_mfma_f32_16x16x32_bf16 v[108:111], a[192:195], a[76:79], v[108:111]
s_waitcnt lgkmcnt(6)
buffer_load_dwordx4 a[144:147], v250, s[4:7], s90 offen sc1
v_mfma_f32_16x16x32_bf16 v[108:111], a[196:199], a[92:95], v[108:111]
v_exp_f32 v230, v230
v_mfma_f32_16x16x32_bf16 v[104:107], a[196:199], a[88:91], v[104:107]
ds_read_b64_tr_b16 a[212:213], v237 offset:10464
v_add_f32 v230, 1.0, v230
v_mfma_f32_16x16x32_bf16 v[104:107], a[192:195], a[72:75], v[104:107]
v_exp_f32 v231, v231
v_mfma_f32_16x16x32_bf16 v[104:107], a[232:235], a[56:59], v[104:107]
buffer_load_dwordx4 a[148:151], v250, s[4:7], s90 offen offset:1024 sc1
v_mfma_f32_16x16x32_bf16 v[104:107], a[228:231], a[40:43], v[104:107]
ds_read_b64_tr_b16 a[214:215], v237 offset:15584
v_add_f32 v231, 1.0, v231
v_mfma_f32_16x16x32_bf16 v[100:103], a[228:231], a[36:39], v[100:103]
v_rcp_f32 v228, v228
v_mfma_f32_16x16x32_bf16 v[100:103], a[232:235], a[52:55], v[100:103]
s_xor_b32 s90, s76, 557056
ds_read_b64_tr_b16 a[216:217], v240 offset:20736
v_mul_f32 v164, v164, v228
v_mfma_f32_16x16x32_bf16 v[100:103], a[192:195], a[68:71], v[100:103]
buffer_load_dwordx4 a[152:155], v250, s[4:7], s90 offen sc1
v_mfma_f32_16x16x32_bf16 v[100:103], a[196:199], a[84:87], v[100:103]
ds_read_b64_tr_b16 a[218:219], v240 offset:25856
v_accvgpr_read_b32 v228, a244
v_mfma_f32_16x16x32_bf16 v[96:99], a[196:199], a[80:83], v[96:99]
ds_read_b64_tr_b16 a[220:221], v240 offset:30976
v_add_f32 v168, v168, v228
v_mfma_f32_16x16x32_bf16 v[96:99], a[192:195], a[64:67], v[96:99]
ds_read_b64_tr_b16 a[222:223], v240 offset:36096
v_mul_f32 v228, 0xbfb8aa3b, v168
v_mfma_f32_16x16x32_bf16 v[96:99], a[232:235], a[48:51], v[96:99]
buffer_load_dwordx4 a[156:159], v250, s[4:7], s90 offen offset:1024 sc1
v_mfma_f32_16x16x32_bf16 v[96:99], a[228:231], a[32:35], v[96:99]
s_waitcnt lgkmcnt(10)
v_rcp_f32 v229, v229
v_mfma_f32_16x16x32_bf16 v[112:115], a[200:203], a[32:35], v[112:115]
s_waitcnt lgkmcnt(8)
ds_read_b64_tr_b16 a[224:225], v236 offset:256
v_mul_f32 v165, v165, v229
v_mfma_f32_16x16x32_bf16 v[112:115], a[204:207], a[48:51], v[112:115]
s_waitcnt lgkmcnt(7)
s_xor_b32 s90, s76, 573440
ds_read_b64_tr_b16 a[226:227], v236 offset:5376
v_accvgpr_read_b32 v229, a245
v_mfma_f32_16x16x32_bf16 v[112:115], a[208:211], a[64:67], v[112:115]
s_waitcnt lgkmcnt(6)
buffer_load_dwordx4 a[160:163], v250, s[4:7], s90 offen sc1
v_mfma_f32_16x16x32_bf16 v[112:115], a[212:215], a[80:83], v[112:115]
ds_read_b64_tr_b16 a[228:229], v236 offset:10496
v_add_f32 v169, v169, v229
v_mfma_f32_16x16x32_bf16 v[116:119], a[212:215], a[84:87], v[116:119]
ds_read_b64_tr_b16 a[230:231], v236 offset:15616
v_mul_f32 v229, 0xbfb8aa3b, v169
v_mfma_f32_16x16x32_bf16 v[116:119], a[208:211], a[68:71], v[116:119]
v_rcp_f32 v230, v230
v_mfma_f32_16x16x32_bf16 v[116:119], a[204:207], a[52:55], v[116:119]
buffer_load_dwordx4 a[164:167], v250, s[4:7], s90 offen offset:1024 sc1
v_mfma_f32_16x16x32_bf16 v[116:119], a[200:203], a[36:39], v[116:119]
v_rcp_f32 v231, v231
v_mfma_f32_16x16x32_bf16 v[120:123], a[200:203], a[40:43], v[120:123]
ds_read_b64_tr_b16 a[232:233], v241 offset:20768
v_mul_f32 v166, v166, v230
v_mfma_f32_16x16x32_bf16 v[120:123], a[204:207], a[56:59], v[120:123]
s_xor_b32 s90, s76, 544768
ds_read_b64_tr_b16 a[234:235], v241 offset:25888
v_mul_f32 v167, v167, v231
v_mfma_f32_16x16x32_bf16 v[120:123], a[208:211], a[72:75], v[120:123]
buffer_load_dwordx4 a[168:171], v250, s[4:7], s90 offen sc1
v_mfma_f32_16x16x32_bf16 v[120:123], a[212:215], a[88:91], v[120:123]
ds_read_b64_tr_b16 a[192:193], v241 offset:31008
v_accvgpr_read_b32 v230, a246
v_mfma_f32_16x16x32_bf16 v[124:127], a[212:215], a[92:95], v[124:127]
ds_read_b64_tr_b16 a[194:195], v241 offset:36128
v_add_f32 v170, v170, v230
v_mfma_f32_16x16x32_bf16 v[124:127], a[208:211], a[76:79], v[124:127]
ds_read_b64_tr_b16 a[196:197], v237 offset:288
v_mul_f32 v230, 0xbfb8aa3b, v170
v_mfma_f32_16x16x32_bf16 v[124:127], a[204:207], a[60:63], v[124:127]
ds_read_b64_tr_b16 a[198:199], v237 offset:5408
v_accvgpr_read_b32 v231, a247
v_mfma_f32_16x16x32_bf16 v[124:127], a[200:203], a[44:47], v[124:127]
s_waitcnt lgkmcnt(12)
buffer_load_dwordx4 a[172:175], v250, s[4:7], s90 offen offset:1024 sc1
v_mfma_f32_16x16x32_bf16 v[140:143], a[216:219], a[44:47], v[140:143]
s_waitcnt lgkmcnt(10)
ds_read_b64_tr_b16 a[200:201], v237 offset:10528
v_add_f32 v171, v171, v231
v_mfma_f32_16x16x32_bf16 v[140:143], a[220:223], a[60:63], v[140:143]
s_waitcnt lgkmcnt(9)
ds_read_b64_tr_b16 a[202:203], v237 offset:15648
v_mul_f32 v231, 0xbfb8aa3b, v171
v_mfma_f32_16x16x32_bf16 v[140:143], a[224:227], a[76:79], v[140:143]
s_waitcnt vmcnt(12) lgkmcnt(8)
s_barrier
v_mfma_f32_16x16x32_bf16 v[140:143], a[228:231], a[92:95], v[140:143]
s_xor_b32 s90, s76, 561152
v_exp_f32 v228, v228
v_mfma_f32_16x16x32_bf16 v[136:139], a[228:231], a[88:91], v[136:139]
buffer_load_dwordx4 a[176:179], v250, s[4:7], s90 offen sc1
v_mfma_f32_16x16x32_bf16 v[136:139], a[224:227], a[72:75], v[136:139]
v_exp_f32 v229, v229
v_mfma_f32_16x16x32_bf16 v[136:139], a[220:223], a[56:59], v[136:139]
v_exp_f32 v230, v230
v_mfma_f32_16x16x32_bf16 v[136:139], a[216:219], a[40:43], v[136:139]
v_exp_f32 v231, v231
v_mfma_f32_16x16x32_bf16 v[132:135], a[216:219], a[36:39], v[132:135]
buffer_load_dwordx4 a[180:183], v250, s[4:7], s90 offen offset:1024 sc1
v_mfma_f32_16x16x32_bf16 v[132:135], a[220:223], a[52:55], v[132:135]
ds_read_b64_tr_b16 a[204:205], v236 offset:20480
v_add_f32 v228, 1.0, v228
v_mfma_f32_16x16x32_bf16 v[132:135], a[224:227], a[68:71], v[132:135]
ds_read_b64_tr_b16 a[206:207], v236 offset:25600
v_add_f32 v229, 1.0, v229
v_mfma_f32_16x16x32_bf16 v[132:135], a[228:231], a[84:87], v[132:135]
ds_read_b64_tr_b16 a[208:209], v236 offset:30720
v_add_f32 v230, 1.0, v230
v_mfma_f32_16x16x32_bf16 v[128:131], a[228:231], a[80:83], v[128:131]
s_xor_b32 s90, s76, 577536
ds_read_b64_tr_b16 a[210:211], v236 offset:35840
v_add_f32 v231, 1.0, v231
v_mfma_f32_16x16x32_bf16 v[128:131], a[224:227], a[64:67], v[128:131]
buffer_load_dwordx4 a[184:187], v250, s[4:7], s90 offen sc1
v_mfma_f32_16x16x32_bf16 v[128:131], a[220:223], a[48:51], v[128:131]
ds_read_b64_tr_b16 a[212:213], v238 offset:40960
ds_read_b64_tr_b16 a[214:215], v238 offset:46080
v_mfma_f32_16x16x32_bf16 v[128:131], a[216:219], a[32:35], v[128:131]
s_waitcnt lgkmcnt(12)
v_rcp_f32 v228, v228
v_mfma_f32_16x16x32_bf16 v[144:147], a[232:235], a[32:35], v[144:147]
s_waitcnt lgkmcnt(10)
ds_read_b64_tr_b16 a[216:217], v238 offset:51200
v_mul_f32 v168, v168, v228
v_mfma_f32_16x16x32_bf16 v[144:147], a[192:195], a[48:51], v[144:147]
s_waitcnt lgkmcnt(9)
buffer_load_dwordx4 a[188:191], v250, s[4:7], s90 offen offset:1024 sc1
v_mfma_f32_16x16x32_bf16 v[144:147], a[196:199], a[64:67], v[144:147]
s_waitcnt lgkmcnt(7)
ds_read_b64_tr_b16 a[218:219], v238 offset:56320
v_accvgpr_read_b32 v228, a248
v_mfma_f32_16x16x32_bf16 v[144:147], a[200:203], a[80:83], v[144:147]
ds_read_b64_tr_b16 a[220:221], v237 offset:20512
v_add_f32 v172, v172, v228
v_mfma_f32_16x16x32_bf16 v[148:151], a[200:203], a[84:87], v[148:151]
ds_read_b64_tr_b16 a[222:223], v237 offset:25632
v_mul_f32 v228, 0xbfb8aa3b, v172
v_mfma_f32_16x16x32_bf16 v[148:151], a[196:199], a[68:71], v[148:151]
ds_read_b64_tr_b16 a[224:225], v237 offset:30752
ds_read_b64_tr_b16 a[226:227], v237 offset:35872
v_mfma_f32_16x16x32_bf16 v[148:151], a[192:195], a[52:55], v[148:151]
buffer_load_dword v254, v253, s[4:7], s71 offen offset:516 sc1
v_mfma_f32_16x16x32_bf16 v[148:151], a[232:235], a[36:39], v[148:151]
ds_read_b64_tr_b16 a[228:229], v239 offset:40992
ds_read_b64_tr_b16 a[230:231], v239 offset:46112
v_mfma_f32_16x16x32_bf16 v[152:155], a[232:235], a[40:43], v[152:155]
v_rcp_f32 v229, v229
v_mfma_f32_16x16x32_bf16 v[152:155], a[192:195], a[56:59], v[152:155]
v_rcp_f32 v230, v230
v_mfma_f32_16x16x32_bf16 v[152:155], a[196:199], a[72:75], v[152:155]
buffer_load_dwordx2 v[180:181], v232, s[36:39], s88 offen
v_mfma_f32_16x16x32_bf16 v[152:155], a[200:203], a[88:91], v[152:155]
v_rcp_f32 v231, v231
v_mfma_f32_16x16x32_bf16 v[156:159], a[200:203], a[92:95], v[156:159]
ds_read_b64_tr_b16 a[200:201], v239 offset:41120
v_mul_f32 v169, v169, v229
v_mfma_f32_16x16x32_bf16 v[156:159], a[196:199], a[76:79], v[156:159]
ds_read_b64_tr_b16 a[196:197], v237 offset:30880
v_mul_f32 v170, v170, v230
v_mfma_f32_16x16x32_bf16 v[156:159], a[192:195], a[60:63], v[156:159]
buffer_load_dwordx2 v[184:185], v232, s[36:39], s88 offen offset:32
v_mfma_f32_16x16x32_bf16 v[156:159], a[232:235], a[44:47], v[156:159]
s_waitcnt lgkmcnt(14)
ds_read_b64_tr_b16 a[232:233], v239 offset:51232
v_mul_f32 v171, v171, v231
v_mfma_f32_16x16x32_bf16 v[4:7], a[204:207], a[100:103], v[4:7]
s_waitcnt lgkmcnt(13)
ds_read_b64_tr_b16 a[234:235], v239 offset:56352
v_accvgpr_read_b32 v229, a249
v_mfma_f32_16x16x32_bf16 v[4:7], a[208:211], a[108:111], v[4:7]
s_waitcnt lgkmcnt(12)
ds_read_b64_tr_b16 a[192:193], v237 offset:20640
v_add_f32 v173, v173, v229
v_mfma_f32_16x16x32_bf16 v[4:7], a[212:215], a[116:119], v[4:7]
s_waitcnt lgkmcnt(11)
buffer_load_dwordx2 v[188:189], v232, s[36:39], s88 offen offset:64
v_mfma_f32_16x16x32_bf16 v[4:7], a[216:219], a[124:127], v[4:7]
ds_read_b64_tr_b16 a[194:195], v237 offset:25760
v_mul_f32 v229, 0xbfb8aa3b, v173
v_mfma_f32_16x16x32_bf16 v[0:3], a[216:219], a[120:123], v[0:3]
ds_read_b64_tr_b16 a[198:199], v237 offset:36000
v_accvgpr_read_b32 v230, a250
v_mfma_f32_16x16x32_bf16 v[0:3], a[212:215], a[112:115], v[0:3]
ds_read_b64_tr_b16 a[202:203], v239 offset:46240
v_add_f32 v174, v174, v230
v_mfma_f32_16x16x32_bf16 v[0:3], a[208:211], a[104:107], v[0:3]
ds_read_b64_tr_b16 a[208:209], v236 offset:20672
v_mul_f32 v230, 0xbfb8aa3b, v174
v_mfma_f32_16x16x32_bf16 v[0:3], a[204:207], a[96:99], v[0:3]
s_waitcnt lgkmcnt(13)
buffer_load_dwordx2 v[192:193], v232, s[36:39], s88 offen offset:96
v_mfma_f32_16x16x32_bf16 v[16:19], a[220:223], a[96:99], v[16:19]
s_waitcnt lgkmcnt(11)
ds_read_b64_tr_b16 a[204:205], v239 offset:51360
v_accvgpr_read_b32 v231, a251
v_mfma_f32_16x16x32_bf16 v[16:19], a[224:227], a[104:107], v[16:19]
s_waitcnt lgkmcnt(10)
ds_read_b64_tr_b16 a[206:207], v239 offset:56480
v_add_f32 v175, v175, v231
v_mfma_f32_16x16x32_bf16 v[16:19], a[228:231], a[112:115], v[16:19]
s_waitcnt lgkmcnt(7)
ds_read_b64_tr_b16 a[210:211], v236 offset:25792
v_mul_f32 v231, 0xbfb8aa3b, v175
v_mfma_f32_16x16x32_bf16 v[16:19], a[232:235], a[120:123], v[16:19]
ds_read_b64_tr_b16 a[212:213], v236 offset:30912
ds_read_b64_tr_b16 a[214:215], v236 offset:36032
v_mfma_f32_16x16x32_bf16 v[20:23], a[232:235], a[124:127], v[20:23]
buffer_load_dwordx2 v[196:197], v211, s[36:39], s88 offen
v_mfma_f32_16x16x32_bf16 v[20:23], a[228:231], a[116:119], v[20:23]
ds_read_b64_tr_b16 a[216:217], v238 offset:41152
ds_read_b64_tr_b16 a[218:219], v238 offset:46272
v_mfma_f32_16x16x32_bf16 v[20:23], a[224:227], a[108:111], v[20:23]
v_exp_f32 v228, v228
v_mfma_f32_16x16x32_bf16 v[20:23], a[220:223], a[100:103], v[20:23]
s_waitcnt lgkmcnt(10)
ds_read_b64_tr_b16 a[220:221], v238 offset:51392
v_add_f32 v228, 1.0, v228
v_mfma_f32_16x16x32_bf16 v[84:87], a[192:195], a[100:103], v[84:87]
s_waitcnt lgkmcnt(10)
ds_read_b64_tr_b16 a[222:223], v238 offset:56512
ds_read_b64_tr_b16 a[224:225], v238 offset:0
v_mfma_f32_16x16x32_bf16 v[84:87], a[196:199], a[108:111], v[84:87]
s_waitcnt lgkmcnt(11)
v_exp_f32 v229, v229
v_mfma_f32_16x16x32_bf16 v[84:87], a[200:203], a[116:119], v[84:87]
s_waitcnt lgkmcnt(8)
ds_read_b64_tr_b16 a[226:227], v238 offset:5120
v_add_f32 v229, 1.0, v229
v_mfma_f32_16x16x32_bf16 v[84:87], a[204:207], a[124:127], v[84:87]
ds_read_b64_tr_b16 a[228:229], v238 offset:10240
ds_read_b64_tr_b16 a[230:231], v238 offset:15360
v_mfma_f32_16x16x32_bf16 v[80:83], a[204:207], a[120:123], v[80:83]
ds_read_b64_tr_b16 a[232:233], v238 offset:20480
v_bfe_u32 v212, v250, 8, 1
v_mfma_f32_16x16x32_bf16 v[80:83], a[200:203], a[112:115], v[80:83]
ds_read_b64_tr_b16 a[234:235], v238 offset:25600
v_mul_u32_u24 v212, 24, v212
v_mfma_f32_16x16x32_bf16 v[80:83], a[196:199], a[104:107], v[80:83]
ds_read_b64_tr_b16 a[196:197], v239 offset:32
v_add_u32 v210, v212, v232
v_mfma_f32_16x16x32_bf16 v[80:83], a[192:195], a[96:99], v[80:83]
s_waitcnt lgkmcnt(13)
ds_read_b64_tr_b16 a[192:193], v238 offset:30720
v_and_b32 v214, 16, v250
v_mfma_f32_16x16x32_bf16 v[96:99], a[208:211], a[96:99], v[96:99]
s_waitcnt lgkmcnt(12)
ds_read_b64_tr_b16 a[194:195], v238 offset:35840
v_mov_b32 v212, 0x3f80
v_mfma_f32_16x16x32_bf16 v[96:99], a[212:215], a[104:107], v[96:99]
s_waitcnt lgkmcnt(11)
ds_read_b64_tr_b16 a[198:199], v239 offset:5152
v_lshlrev_b32 v214, v214, v212
v_mfma_f32_16x16x32_bf16 v[96:99], a[216:219], a[112:115], v[96:99]
L_walk2_5:
s_cbranch_execz L_ret2
s_waitcnt lgkmcnt(10)
ds_read_b64_tr_b16 a[200:201], v239 offset:10272
v_bfe_u32 v212, v250, 5, 3
v_mfma_f32_16x16x32_bf16 v[96:99], a[220:223], a[120:123], v[96:99]
ds_read_b64_tr_b16 a[202:203], v239 offset:15392
v_lshrrev_b32 v213, 7, v250
v_mfma_f32_16x16x32_bf16 v[100:103], a[220:223], a[124:127], v[100:103]
ds_read_b64_tr_b16 a[204:205], v239 offset:20512
v_and_b32 v213, 6, v213
v_mfma_f32_16x16x32_bf16 v[100:103], a[216:219], a[116:119], v[100:103]
ds_read_b64_tr_b16 a[206:207], v239 offset:25632
v_sub_u32 v213, v212, v213
v_mfma_f32_16x16x32_bf16 v[100:103], a[212:215], a[108:111], v[100:103]
ds_read_b64_tr_b16 a[212:213], v239 offset:160
v_cmp_eq_u32 s[94:95], 0, v213
v_mfma_f32_16x16x32_bf16 v[100:103], a[208:211], a[100:103], v[100:103]
s_waitcnt vmcnt(20) lgkmcnt(13)
ds_read_b64_tr_b16 a[208:209], v239 offset:30752
v_cndmask_b32 v202, 0, v214, s[94:95]
v_mfma_f32_16x16x32_bf16 v[4:7], a[224:227], a[132:135], v[4:7]
s_waitcnt vmcnt(18) lgkmcnt(12)
ds_read_b64_tr_b16 a[210:211], v239 offset:35872
v_cmp_eq_u32 s[94:95], 1, v213
v_mfma_f32_16x16x32_bf16 v[4:7], a[228:231], a[140:143], v[4:7]
s_waitcnt vmcnt(16) lgkmcnt(11)
ds_read_b64_tr_b16 a[214:215], v239 offset:5280
v_lshrrev_b32 v213, 7, v250
v_mfma_f32_16x16x32_bf16 v[4:7], a[232:235], a[148:151], v[4:7]
s_waitcnt vmcnt(14) lgkmcnt(9)
ds_read_b64_tr_b16 a[216:217], v239 offset:10400
v_and_b32 v213, 2, v213
v_mfma_f32_16x16x32_bf16 v[4:7], a[192:195], a[156:159], v[4:7]
ds_read_b64_tr_b16 a[218:219], v239 offset:15520
v_sub_u32 v213, v212, v213
v_mfma_f32_16x16x32_bf16 v[0:3], a[192:195], a[152:155], v[0:3]
ds_read_b64_tr_b16 a[220:221], v239 offset:20640
v_lshlrev_b32 v212, 7, v250
v_mfma_f32_16x16x32_bf16 v[0:3], a[232:235], a[144:147], v[0:3]
s_xor_b32 s90, s76, 278528
ds_read_b64_tr_b16 a[222:223], v239 offset:25760
v_xnor_b32 v212, s76, v212
v_mfma_f32_16x16x32_bf16 v[0:3], a[228:231], a[136:139], v[0:3]
s_waitcnt vmcnt(5)
ds_read_b64_tr_b16 a[228:229], v238 offset:192
v_cmp_ne_u32 vcc, v254, v251
v_mfma_f32_16x16x32_bf16 v[0:3], a[224:227], a[128:131], v[0:3]
s_cbranch_vccnz L_spin_4
L_back_4:
ds_read_b64_tr_b16 a[224:225], v239 offset:30880
s_waitcnt lgkmcnt(14)
v_mfma_f32_16x16x32_bf16 v[16:19], a[196:199], a[128:131], v[16:19]
s_waitcnt lgkmcnt(12)
ds_read_b64_tr_b16 a[226:227], v239 offset:36000
v_and_b32 v212, 65536, v212
v_mfma_f32_16x16x32_bf16 v[16:19], a[200:203], a[136:139], v[16:19]
s_waitcnt lgkmcnt(11)
ds_read_b64_tr_b16 a[230:231], v238 offset:5312
v_add_u32 v233, v212, v250
v_mfma_f32_16x16x32_bf16 v[16:19], a[204:207], a[144:147], v[16:19]
s_waitcnt lgkmcnt(9)
ds_read_b64_tr_b16 a[232:233], v238 offset:10432
v_cndmask_b32 v203, 0, v214, s[94:95]
v_mfma_f32_16x16x32_bf16 v[16:19], a[208:211], a[152:155], v[16:19]
buffer_load_dwordx4 a[0:3], v250, s[4:7], s90 offen offset:2048 sc1
v_mfma_f32_16x16x32_bf16 v[20:23], a[208:211], a[156:159], v[20:23]
ds_read_b64_tr_b16 a[234:235], v238 offset:15552
v_and_b32 v254, 0x80, v250
v_mfma_f32_16x16x32_bf16 v[20:23], a[204:207], a[148:151], v[20:23]
ds_read_b64_tr_b16 a[192:193], v238 offset:20672
v_lshlrev_b32 v253, 2, v253
v_mfma_f32_16x16x32_bf16 v[20:23], a[200:203], a[140:143], v[20:23]
ds_read_b64_tr_b16 a[194:195], v238 offset:25792
v_lshl_or_b32 v253, v254, 6, v253
v_mfma_f32_16x16x32_bf16 v[20:23], a[196:199], a[132:135], v[20:23]
s_waitcnt lgkmcnt(12)
ds_read_b64_tr_b16 a[196:197], v238 offset:30912
v_cmp_eq_u32 s[94:95], 0, v213
v_mfma_f32_16x16x32_bf16 v[84:87], a[212:215], a[132:135], v[84:87]
s_waitcnt lgkmcnt(11)
ds_read_b64_tr_b16 a[198:199], v238 offset:36032
v_cndmask_b32 v206, 0, v214, s[94:95]
v_mfma_f32_16x16x32_bf16 v[84:87], a[216:219], a[140:143], v[84:87]
s_waitcnt lgkmcnt(10)
ds_read_b64_tr_b16 a[200:201], v240 offset:0
v_cmp_eq_u32 s[94:95], 1, v213
v_mfma_f32_16x16x32_bf16 v[84:87], a[220:223], a[148:151], v[84:87]
s_waitcnt lgkmcnt(8)
buffer_load_dwordx4 a[4:7], v250, s[4:7], s90 offen offset:3072 sc1
v_mfma_f32_16x16x32_bf16 v[84:87], a[224:227], a[156:159], v[84:87]
ds_read_b64_tr_b16 a[202:203], v240 offset:5120
v_cndmask_b32 v207, 0, v214, s[94:95]
v_mfma_f32_16x16x32_bf16 v[80:83], a[224:227], a[152:155], v[80:83]
ds_read_b64_tr_b16 a[204:205], v240 offset:10240
v_cmp_eq_u32 s[94:95], 4, v213
v_mfma_f32_16x16x32_bf16 v[80:83], a[220:223], a[144:147], v[80:83]
ds_read_b64_tr_b16 a[206:207], v240 offset:15360
v_mov_b32 v204, 0
v_mfma_f32_16x16x32_bf16 v[80:83], a[216:219], a[136:139], v[80:83]
s_xor_b32 s90, s76, 294912
ds_read_b64_tr_b16 a[208:209], v236 offset:40960
v_mov_b32 v205, 0
v_mfma_f32_16x16x32_bf16 v[80:83], a[212:215], a[128:131], v[80:83]
s_waitcnt lgkmcnt(11)
ds_read_b64_tr_b16 a[210:211], v236 offset:46080
v_cndmask_b32 v208, 0, v214, s[94:95]
v_mfma_f32_16x16x32_bf16 v[96:99], a[228:231], a[128:131], v[96:99]
s_waitcnt lgkmcnt(10)
ds_read_b64_tr_b16 a[212:213], v236 offset:51200
v_cmp_eq_u32 s[94:95], 5, v213
v_mfma_f32_16x16x32_bf16 v[96:99], a[232:235], a[136:139], v[96:99]
s_waitcnt lgkmcnt(9)
ds_read_b64_tr_b16 a[214:215], v236 offset:56320
v_cndmask_b32 v209, 0, v214, s[94:95]
v_mfma_f32_16x16x32_bf16 v[96:99], a[192:195], a[144:147], v[96:99]
s_waitcnt lgkmcnt(8)
buffer_load_dwordx4 a[8:11], v250, s[4:7], s90 offen offset:2048 sc1
v_mfma_f32_16x16x32_bf16 v[96:99], a[196:199], a[152:155], v[96:99]
ds_read_b64_tr_b16 a[216:217], v241 offset:32
v_lshlrev_b32 v214, 21, v250
v_mfma_f32_16x16x32_bf16 v[100:103], a[196:199], a[156:159], v[100:103]
ds_read_b64_tr_b16 a[218:219], v241 offset:5152
v_and_b32 v214, 1073741824, v214
v_mfma_f32_16x16x32_bf16 v[100:103], a[192:195], a[148:151], v[100:103]
ds_read_b64_tr_b16 a[220:221], v241 offset:10272
v_or_b32 v234, v214, v233
v_mfma_f32_16x16x32_bf16 v[100:103], a[232:235], a[140:143], v[100:103]
ds_read_b64_tr_b16 a[222:223], v241 offset:15392
v_mov_b32 v200, 0
v_mfma_f32_16x16x32_bf16 v[100:103], a[228:231], a[132:135], v[100:103]
s_waitcnt lgkmcnt(10)
ds_read_b64_tr_b16 a[224:225], v237 offset:40992
v_mov_b32 v201, 0
v_mfma_f32_16x16x32_bf16 v[4:7], a[200:203], a[164:167], v[4:7]
s_waitcnt lgkmcnt(9)
ds_read_b64_tr_b16 a[226:227], v237 offset:46112
v_or_b32 v235, v214, v250
v_mfma_f32_16x16x32_bf16 v[4:7], a[204:207], a[172:175], v[4:7]
s_waitcnt lgkmcnt(8)
buffer_load_dwordx4 a[12:15], v250, s[4:7], s90 offen offset:3072 sc1
v_mfma_f32_16x16x32_bf16 v[4:7], a[208:211], a[180:183], v[4:7]
s_waitcnt lgkmcnt(6)
ds_read_b64_tr_b16 a[228:229], v237 offset:51232
ds_read_b64_tr_b16 a[230:231], v237 offset:56352
v_mfma_f32_16x16x32_bf16 v[4:7], a[212:215], a[188:191], v[4:7]
v_exp_f32 v230, v230
v_mfma_f32_16x16x32_bf16 v[0:3], a[212:215], a[184:187], v[0:3]
ds_read_b64_tr_b16 a[232:233], v241 offset:160
v_add_f32 v230, 1.0, v230
v_mfma_f32_16x16x32_bf16 v[0:3], a[208:211], a[176:179], v[0:3]
ds_read_b64_tr_b16 a[234:235], v241 offset:5280
ds_read_b64_tr_b16 a[192:193], v241 offset:10400
v_mfma_f32_16x16x32_bf16 v[0:3], a[204:207], a[168:171], v[0:3]
s_xor_b32 s90, s76, 311296
v_exp_f32 v231, v231
v_mfma_f32_16x16x32_bf16 v[0:3], a[200:203], a[160:163], v[0:3]
s_waitcnt lgkmcnt(9)
buffer_load_dwordx4 a[16:19], v250, s[4:7], s90 offen offset:2048 sc1
v_mfma_f32_16x16x32_bf16 v[16:19], a[216:219], a[160:163], v[16:19]
s_waitcnt lgkmcnt(7)
ds_read_b64_tr_b16 a[194:195], v241 offset:15520
v_cvt_pk_bf16_f32 v4, v4, v5
v_mfma_f32_16x16x32_bf16 v[16:19], a[220:223], a[168:171], v[16:19]
s_waitcnt lgkmcnt(6)
ds_read_b64_tr_b16 a[196:197], v237 offset:41120
v_cvt_pk_bf16_f32 v5, v6, v7
v_mfma_f32_16x16x32_bf16 v[16:19], a[224:227], a[176:179], v[16:19]
s_waitcnt lgkmcnt(5)
ds_read_b64_tr_b16 a[198:199], v237 offset:46240
v_add_f32 v231, 1.0, v231
v_mfma_f32_16x16x32_bf16 v[16:19], a[228:231], a[184:187], v[16:19]
ds_read_b64_tr_b16 a[200:201], v237 offset:51360
v_cvt_pk_bf16_f32 v0, v0, v1
v_mfma_f32_16x16x32_bf16 v[20:23], a[228:231], a[188:191], v[20:23]
ds_read_b64_tr_b16 a[202:203], v237 offset:56480
v_cvt_pk_bf16_f32 v1, v2, v3
v_mfma_f32_16x16x32_bf16 v[20:23], a[224:227], a[180:183], v[20:23]
s_waitcnt vmcnt(9)
ds_read_b64_tr_b16 a[204:205], v240 offset:192
v_and_b32 v183, 0xffff0000, v181
v_mfma_f32_16x16x32_bf16 v[20:23], a[220:223], a[172:175], v[20:23]
buffer_load_dwordx4 a[20:23], v250, s[4:7], s90 offen offset:3072 sc1
v_mfma_f32_16x16x32_bf16 v[20:23], a[216:219], a[164:167], v[20:23]
s_waitcnt lgkmcnt(7)
ds_read_b64_tr_b16 a[206:207], v240 offset:5312
v_cvt_pk_bf16_f32 v2, v16, v17
v_mfma_f32_16x16x32_bf16 v[84:87], a[232:235], a[164:167], v[84:87]
s_waitcnt lgkmcnt(6)
ds_read_b64_tr_b16 a[208:209], v240 offset:10432
v_cvt_pk_bf16_f32 v3, v18, v19
v_mfma_f32_16x16x32_bf16 v[84:87], a[192:195], a[172:175], v[84:87]
s_waitcnt lgkmcnt(5)
s_xor_b32 s91, s76, 998400
ds_read_b64_tr_b16 a[210:211], v240 offset:15552
v_lshlrev_b32 v182, 16, v181
v_mfma_f32_16x16x32_bf16 v[84:87], a[196:199], a[180:183], v[84:87]
s_waitcnt lgkmcnt(4)
buffer_store_dwordx4 v[0:3], v250, s[4:7], s91 offen sc1
v_mfma_f32_16x16x32_bf16 v[84:87], a[200:203], a[188:191], v[84:87]
ds_read_b64_tr_b16 a[212:213], v236 offset:41152
v_cvt_pk_bf16_f32 v6, v20, v21
v_mfma_f32_16x16x32_bf16 v[80:83], a[200:203], a[184:187], v[80:83]
ds_read_b64_tr_b16 a[214:215], v236 offset:46272
v_cvt_pk_bf16_f32 v7, v22, v23
v_mfma_f32_16x16x32_bf16 v[80:83], a[196:199], a[176:179], v[80:83]
s_xor_b32 s90, s76, 282624
ds_read_b64_tr_b16 a[216:217], v236 offset:51392
ds_read_b64_tr_b16 a[218:219], v236 offset:56512
v_mfma_f32_16x16x32_bf16 v[80:83], a[192:195], a[168:171], v[80:83]
buffer_load_dwordx4 a[24:27], v250, s[4:7], s90 offen offset:2048 sc1
v_mfma_f32_16x16x32_bf16 v[80:83], a[232:235], a[160:163], v[80:83]
s_waitcnt lgkmcnt(6)
ds_read_b64_tr_b16 a[220:221], v236 offset:20544
v_cvt_pk_bf16_f32 v84, v84, v85
v_mfma_f32_16x16x32_bf16 v[96:99], a[204:207], a[160:163], v[96:99]
s_waitcnt lgkmcnt(5)
ds_read_b64_tr_b16 a[222:223], v236 offset:25664
v_cvt_pk_bf16_f32 v85, v86, v87
v_mfma_f32_16x16x32_bf16 v[96:99], a[208:211], a[168:171], v[96:99]
s_waitcnt lgkmcnt(4)
ds_read_b64_tr_b16 a[224:225], v236 offset:30784
v_and_b32 v181, 0xffff0000, v180
v_mfma_f32_16x16x32_bf16 v[96:99], a[212:215], a[176:179], v[96:99]
s_waitcnt lgkmcnt(3)
s_xor_b32 s91, s76, 930816
ds_read_b64_tr_b16 a[226:227], v236 offset:35904
v_lshlrev_b32 v180, 16, v180
v_mfma_f32_16x16x32_bf16 v[96:99], a[216:219], a[184:187], v[96:99]
buffer_store_dwordx4 v[4:7], v250, s[4:7], s91 offen sc1
v_mfma_f32_16x16x32_bf16 v[100:103], a[216:219], a[188:191], v[100:103]
ds_read_b64_tr_b16 a[228:229], v238 offset:41024
ds_read_b64_tr_b16 a[230:231], v238 offset:46144
v_mfma_f32_16x16x32_bf16 v[100:103], a[212:215], a[180:183], v[100:103]
ds_read_b64_tr_b16 a[232:233], v238 offset:51264
v_cvt_pk_bf16_f32 v80, v80, v81
v_mfma_f32_16x16x32_bf16 v[100:103], a[208:211], a[172:175], v[100:103]
buffer_load_dwordx4 a[28:31], v250, s[4:7], s90 offen offset:3072 sc1
ds_read_b64_tr_b16 a[234:235], v238 offset:56384
v_mfma_f32_16x16x32_bf16 v[100:103], a[204:207], a[164:167], v[100:103]
s_waitcnt lgkmcnt(6)
ds_read_b64_tr_b16 a[192:193], v238 offset:64
ds_read_b64_tr_b16 a[194:195], v238 offset:5184
v_mfma_f32_16x16x32_bf16 v[32:35], a[220:223], a[96:99], v[32:35]
s_waitcnt lgkmcnt(6)
ds_read_b64_tr_b16 a[196:197], v238 offset:10304
ds_read_b64_tr_b16 a[198:199], v238 offset:15424
v_mfma_f32_16x16x32_bf16 v[32:35], a[224:227], a[104:107], v[32:35]
s_waitcnt lgkmcnt(6)
ds_read_b64_tr_b16 a[200:201], v238 offset:20544
v_cvt_pk_bf16_f32 v81, v82, v83
v_mfma_f32_16x16x32_bf16 v[32:35], a[228:231], a[112:115], v[32:35]
s_waitcnt lgkmcnt(5)
s_xor_b32 s90, s76, 299008
ds_read_b64_tr_b16 a[202:203], v238 offset:25664
v_cvt_pk_bf16_f32 v82, v96, v97
v_mfma_f32_16x16x32_bf16 v[32:35], a[232:235], a[120:123], v[32:35]
s_waitcnt lgkmcnt(4)
buffer_load_dwordx4 a[32:35], v250, s[4:7], s90 offen offset:2048 sc1
v_mfma_f32_16x16x32_bf16 v[32:35], a[192:195], a[128:131], v[32:35]
s_waitcnt lgkmcnt(2)
ds_read_b64_tr_b16 a[204:205], v238 offset:30784
v_cvt_pk_bf16_f32 v83, v98, v99
v_mfma_f32_16x16x32_bf16 v[32:35], a[196:199], a[136:139], v[32:35]
s_xor_b32 s91, s76, 989184
ds_read_b64_tr_b16 a[206:207], v238 offset:35904
v_cvt_pk_bf16_f32 v86, v100, v101
v_mfma_f32_16x16x32_bf16 v[36:39], a[196:199], a[140:143], v[36:39]
buffer_store_dwordx4 v[80:83], v250, s[4:7], s91 offen sc1
v_mfma_f32_16x16x32_bf16 v[36:39], a[192:195], a[132:135], v[36:39]
ds_read_b64_tr_b16 a[208:209], v240 offset:64
v_cvt_pk_bf16_f32 v87, v102, v103
v_mfma_f32_16x16x32_bf16 v[36:39], a[232:235], a[124:127], v[36:39]
s_waitcnt vmcnt(15)
ds_read_b64_tr_b16 a[210:211], v240 offset:5184
v_and_b32 v187, 0xffff0000, v185
v_mfma_f32_16x16x32_bf16 v[36:39], a[228:231], a[116:119], v[36:39]
ds_read_b64_tr_b16 a[212:213], v240 offset:10304
ds_read_b64_tr_b16 a[214:215], v240 offset:15424
v_mfma_f32_16x16x32_bf16 v[36:39], a[224:227], a[108:111], v[36:39]
buffer_load_dwordx4 a[36:39], v250, s[4:7], s90 offen offset:3072 sc1
v_mfma_f32_16x16x32_bf16 v[36:39], a[220:223], a[100:103], v[36:39]
s_waitcnt lgkmcnt(6)
ds_read_b64_tr_b16 a[216:217], v236 offset:41024
ds_read_b64_tr_b16 a[218:219], v236 offset:46144
v_mfma_f32_16x16x32_bf16 v[32:35], a[200:203], a[144:147], v[32:35]
s_waitcnt lgkmcnt(6)
ds_read_b64_tr_b16 a[220:221], v236 offset:51264
ds_read_b64_tr_b16 a[222:223], v236 offset:56384
v_mfma_f32_16x16x32_bf16 v[32:35], a[204:207], a[152:155], v[32:35]
s_waitcnt lgkmcnt(6)
s_xor_b32 s91, s76, 921600
ds_read_b64_tr_b16 a[224:225], v237 offset:20576
v_lshlrev_b32 v186, 16, v185
v_mfma_f32_16x16x32_bf16 v[32:35], a[208:211], a[160:163], v[32:35]
s_waitcnt lgkmcnt(5)
buffer_store_dwordx4 v[84:87], v250, s[4:7], s91 offen sc1
v_mfma_f32_16x16x32_bf16 v[32:35], a[212:215], a[168:171], v[32:35]
s_waitcnt lgkmcnt(3)
ds_read_b64_tr_b16 a[226:227], v237 offset:25696
v_and_b32 v185, 0xffff0000, v184
v_mfma_f32_16x16x32_bf16 v[32:35], a[216:219], a[176:179], v[32:35]
s_waitcnt lgkmcnt(2)
ds_read_b64_tr_b16 a[228:229], v237 offset:30816
v_lshlrev_b32 v184, 16, v184
v_mfma_f32_16x16x32_bf16 v[32:35], a[220:223], a[184:187], v[32:35]
s_waitcnt vmcnt(16)
ds_read_b64_tr_b16 a[230:231], v237 offset:35936
v_and_b32 v191, 0xffff0000, v189
v_mfma_f32_16x16x32_bf16 v[36:39], a[220:223], a[188:191], v[36:39]
ds_read_b64_tr_b16 a[232:233], v239 offset:41056
v_lshlrev_b32 v190, 16, v189
v_mfma_f32_16x16x32_bf16 v[36:39], a[216:219], a[180:183], v[36:39]
ds_read_b64_tr_b16 a[234:235], v239 offset:46176
v_and_b32 v189, 0xffff0000, v188
v_mfma_f32_16x16x32_bf16 v[36:39], a[212:215], a[172:175], v[36:39]
ds_read_b64_tr_b16 a[192:193], v239 offset:51296
v_lshlrev_b32 v188, 16, v188
v_mfma_f32_16x16x32_bf16 v[36:39], a[208:211], a[164:167], v[36:39]
s_xor_b32 s90, s76, 315392
ds_read_b64_tr_b16 a[194:195], v239 offset:56416
v_cvt_pk_bf16_f32 v32, v32, v33
v_mfma_f32_16x16x32_bf16 v[36:39], a[204:207], a[156:159], v[36:39]
buffer_load_dwordx4 a[40:43], v250, s[4:7], s90 offen offset:2048 sc1
v_mfma_f32_16x16x32_bf16 v[36:39], a[200:203], a[148:151], v[36:39]
s_waitcnt lgkmcnt(6)
ds_read_b64_tr_b16 a[196:197], v239 offset:96
ds_read_b64_tr_b16 a[198:199], v239 offset:5216
v_mfma_f32_16x16x32_bf16 v[48:51], a[224:227], a[96:99], v[48:51]
s_waitcnt lgkmcnt(6)
ds_read_b64_tr_b16 a[200:201], v239 offset:10336
ds_read_b64_tr_b16 a[202:203], v239 offset:15456
v_mfma_f32_16x16x32_bf16 v[48:51], a[228:231], a[104:107], v[48:51]
s_waitcnt lgkmcnt(6)
ds_read_b64_tr_b16 a[204:205], v239 offset:20576
v_cvt_pk_bf16_f32 v33, v34, v35
v_mfma_f32_16x16x32_bf16 v[48:51], a[232:235], a[112:115], v[48:51]
s_waitcnt lgkmcnt(5)
buffer_load_dwordx4 a[44:47], v250, s[4:7], s90 offen offset:3072 sc1
v_mfma_f32_16x16x32_bf16 v[48:51], a[192:195], a[120:123], v[48:51]
s_waitcnt lgkmcnt(3)
ds_read_b64_tr_b16 a[206:207], v239 offset:25696
v_cvt_pk_bf16_f32 v36, v36, v37
v_mfma_f32_16x16x32_bf16 v[48:51], a[196:199], a[128:131], v[48:51]
s_waitcnt lgkmcnt(2)
ds_read_b64_tr_b16 a[208:209], v239 offset:30816
v_cvt_pk_bf16_f32 v37, v38, v39
v_mfma_f32_16x16x32_bf16 v[48:51], a[200:203], a[136:139], v[48:51]
s_waitcnt vmcnt(17)
ds_read_b64_tr_b16 a[210:211], v239 offset:35936
v_and_b32 v195, 0xffff0000, v193
v_mfma_f32_16x16x32_bf16 v[52:55], a[200:203], a[140:143], v[52:55]
ds_read_b64_tr_b16 a[212:213], v241 offset:96
v_lshlrev_b32 v194, 16, v193
v_mfma_f32_16x16x32_bf16 v[52:55], a[196:199], a[132:135], v[52:55]
ds_read_b64_tr_b16 a[214:215], v241 offset:5216
v_and_b32 v193, 0xffff0000, v192
v_mfma_f32_16x16x32_bf16 v[52:55], a[192:195], a[124:127], v[52:55]
ds_read_b64_tr_b16 a[216:217], v241 offset:10336
v_lshlrev_b32 v192, 16, v192
v_mfma_f32_16x16x32_bf16 v[52:55], a[232:235], a[116:119], v[52:55]
s_waitcnt vmcnt(16)
ds_read_b64_tr_b16 a[218:219], v241 offset:15456
v_and_b32 v199, 0xffff0000, v197
v_mfma_f32_16x16x32_bf16 v[52:55], a[228:231], a[108:111], v[52:55]
s_xor_b32 s90, s76, 540672
ds_read_b64_tr_b16 a[220:221], v237 offset:41056
ds_read_b64_tr_b16 a[222:223], v237 offset:46176
v_mfma_f32_16x16x32_bf16 v[52:55], a[224:227], a[100:103], v[52:55]
s_waitcnt lgkmcnt(8)
ds_read_b64_tr_b16 a[224:225], v237 offset:51296
v_lshlrev_b32 v198, 16, v197
v_mfma_f32_16x16x32_bf16 v[48:51], a[204:207], a[144:147], v[48:51]
s_waitcnt lgkmcnt(7)
ds_read_b64_tr_b16 a[226:227], v237 offset:56416
v_and_b32 v197, 0xffff0000, v196
v_mfma_f32_16x16x32_bf16 v[48:51], a[208:211], a[152:155], v[48:51]
s_waitcnt lgkmcnt(6)
buffer_load_dwordx4 a[48:51], v250, s[4:7], s90 offen offset:2048 sc1
v_mfma_f32_16x16x32_bf16 v[48:51], a[212:215], a[160:163], v[48:51]
s_waitcnt lgkmcnt(4)
ds_read_b64_tr_b16 a[228:229], v237 offset:20704
v_lshlrev_b32 v196, 16, v196
v_mfma_f32_16x16x32_bf16 v[48:51], a[216:219], a[168:171], v[48:51]
s_waitcnt lgkmcnt(3)
ds_read_b64_tr_b16 a[230:231], v237 offset:25824
ds_read_b64_tr_b16 a[232:233], v237 offset:30944
v_mfma_f32_16x16x32_bf16 v[48:51], a[220:223], a[176:179], v[48:51]
s_waitcnt lgkmcnt(3)
v_rcp_f32 v228, v228
v_mfma_f32_16x16x32_bf16 v[48:51], a[224:227], a[184:187], v[48:51]
buffer_load_dwordx4 a[52:55], v250, s[4:7], s90 offen offset:3072 sc1
v_mfma_f32_16x16x32_bf16 v[52:55], a[224:227], a[188:191], v[52:55]
ds_read_b64_tr_b16 a[234:235], v237 offset:36064
v_mul_f32 v172, v172, v228
v_mfma_f32_16x16x32_bf16 v[52:55], a[220:223], a[180:183], v[52:55]
ds_read_b64_tr_b16 a[192:193], v239 offset:41184
v_accvgpr_read_b32 v228, a252
v_mfma_f32_16x16x32_bf16 v[52:55], a[216:219], a[172:175], v[52:55]
s_xor_b32 s90, s76, 557056
ds_read_b64_tr_b16 a[194:195], v239 offset:46304
v_add_f32 v176, v176, v228
v_mfma_f32_16x16x32_bf16 v[52:55], a[212:215], a[164:167], v[52:55]
buffer_load_dwordx4 a[56:59], v250, s[4:7], s90 offen offset:2048 sc1
v_mfma_f32_16x16x32_bf16 v[52:55], a[208:211], a[156:159], v[52:55]
s_xor_b32 s91, s76, 1260544
ds_read_b64_tr_b16 a[196:197], v239 offset:51424
ds_read_b64_tr_b16 a[198:199], v239 offset:56544
v_mfma_f32_16x16x32_bf16 v[52:55], a[204:207], a[148:151], v[52:55]
s_waitcnt lgkmcnt(6)
ds_read_b64_tr_b16 a[200:201], v239 offset:224
ds_read_b64_tr_b16 a[202:203], v239 offset:5344
v_mfma_f32_16x16x32_bf16 v[112:115], a[228:231], a[96:99], v[112:115]
s_waitcnt lgkmcnt(6)
ds_read_b64_tr_b16 a[204:205], v239 offset:10464
ds_read_b64_tr_b16 a[206:207], v239 offset:15584
v_mfma_f32_16x16x32_bf16 v[112:115], a[232:235], a[104:107], v[112:115]
s_waitcnt lgkmcnt(6)
v_cvt_pk_bf16_f32 v34, v48, v49
v_cvt_pk_bf16_f32 v35, v50, v51
v_mfma_f32_16x16x32_bf16 v[112:115], a[192:195], a[112:115], v[112:115]
s_waitcnt lgkmcnt(4)
buffer_store_dwordx4 v[32:35], v250, s[4:7], s91 offen sc1
v_mfma_f32_16x16x32_bf16 v[112:115], a[196:199], a[120:123], v[112:115]
s_waitcnt lgkmcnt(2)
ds_read_b64_tr_b16 a[208:209], v239 offset:20704
v_cvt_pk_bf16_f32 v38, v52, v53
v_mfma_f32_16x16x32_bf16 v[112:115], a[200:203], a[128:131], v[112:115]
s_waitcnt lgkmcnt(1)
ds_read_b64_tr_b16 a[210:211], v239 offset:25824
v_cvt_pk_bf16_f32 v39, v54, v55
v_mfma_f32_16x16x32_bf16 v[112:115], a[204:207], a[136:139], v[112:115]
ds_read_b64_tr_b16 a[212:213], v239 offset:30944
v_mul_f32 v228, 0xbfb8aa3b, v176
v_mfma_f32_16x16x32_bf16 v[116:119], a[204:207], a[140:143], v[116:119]
buffer_load_dwordx4 a[60:63], v250, s[4:7], s90 offen offset:3072 sc1
v_mfma_f32_16x16x32_bf16 v[116:119], a[200:203], a[132:135], v[116:119]
ds_read_b64_tr_b16 a[214:215], v239 offset:36064
ds_read_b64_tr_b16 a[216:217], v241 offset:224
v_mfma_f32_16x16x32_bf16 v[116:119], a[196:199], a[124:127], v[116:119]
ds_read_b64_tr_b16 a[218:219], v241 offset:5344
v_mfma_f32_16x16x32_bf16 v[116:119], a[192:195], a[116:119], v[116:119]
s_xor_b32 s91, s76, 1192960
ds_read_b64_tr_b16 a[220:221], v241 offset:10464
ds_read_b64_tr_b16 a[222:223], v241 offset:15584
v_mfma_f32_16x16x32_bf16 v[116:119], a[232:235], a[108:111], v[116:119]
buffer_store_dwordx4 v[36:39], v250, s[4:7], s91 offen sc1
v_mfma_f32_16x16x32_bf16 v[116:119], a[228:231], a[100:103], v[116:119]
s_waitcnt lgkmcnt(6)
ds_read_b64_tr_b16 a[224:225], v237 offset:41184
ds_read_b64_tr_b16 a[226:227], v237 offset:46304
v_mfma_f32_16x16x32_bf16 v[112:115], a[208:211], a[144:147], v[112:115]
s_waitcnt lgkmcnt(6)
ds_read_b64_tr_b16 a[228:229], v237 offset:51424
ds_read_b64_tr_b16 a[230:231], v237 offset:56544
v_mfma_f32_16x16x32_bf16 v[112:115], a[212:215], a[152:155], v[112:115]
s_waitcnt lgkmcnt(6)
s_xor_b32 s90, s76, 573440
ds_read_b64_tr_b16 a[232:233], v236 offset:20736
ds_read_b64_tr_b16 a[234:235], v236 offset:25856
v_mfma_f32_16x16x32_bf16 v[112:115], a[216:219], a[160:163], v[112:115]
s_waitcnt lgkmcnt(6)
buffer_load_dwordx4 a[64:67], v250, s[4:7], s90 offen offset:2048 sc1
v_mfma_f32_16x16x32_bf16 v[112:115], a[220:223], a[168:171], v[112:115]
s_waitcnt lgkmcnt(4)
ds_read_b64_tr_b16 a[192:193], v236 offset:30976
ds_read_b64_tr_b16 a[194:195], v236 offset:36096
v_mfma_f32_16x16x32_bf16 v[112:115], a[224:227], a[176:179], v[112:115]
s_waitcnt lgkmcnt(4)
v_rcp_f32 v229, v229
v_mfma_f32_16x16x32_bf16 v[112:115], a[228:231], a[184:187], v[112:115]
ds_read_b64_tr_b16 a[196:197], v238 offset:41216
v_mul_f32 v173, v173, v229
v_mfma_f32_16x16x32_bf16 v[116:119], a[228:231], a[188:191], v[116:119]
ds_read_b64_tr_b16 a[198:199], v238 offset:46336
v_accvgpr_read_b32 v229, a253
v_mfma_f32_16x16x32_bf16 v[116:119], a[224:227], a[180:183], v[116:119]
ds_read_b64_tr_b16 a[200:201], v238 offset:51456
v_add_f32 v177, v177, v229
v_mfma_f32_16x16x32_bf16 v[116:119], a[220:223], a[172:175], v[116:119]
ds_read_b64_tr_b16 a[202:203], v238 offset:56576
v_mul_f32 v229, 0xbfb8aa3b, v177
v_mfma_f32_16x16x32_bf16 v[116:119], a[216:219], a[164:167], v[116:119]
buffer_load_dwordx4 a[68:71], v250, s[4:7], s90 offen offset:3072 sc1
v_mfma_f32_16x16x32_bf16 v[116:119], a[212:215], a[156:159], v[116:119]
s_xor_b32 s90, s76, 544768
ds_read_b64_tr_b16 a[204:205], v238 offset:256
ds_read_b64_tr_b16 a[206:207], v238 offset:5376
v_mfma_f32_16x16x32_bf16 v[116:119], a[208:211], a[148:151], v[116:119]
s_waitcnt lgkmcnt(8)
ds_read_b64_tr_b16 a[208:209], v238 offset:10496
v_cvt_pk_bf16_f32 v112, v112, v113
v_mfma_f32_16x16x32_bf16 v[128:131], a[232:235], a[96:99], v[128:131]
s_waitcnt lgkmcnt(7)
ds_read_b64_tr_b16 a[210:211], v238 offset:15616
v_cvt_pk_bf16_f32 v113, v114, v115
v_mfma_f32_16x16x32_bf16 v[128:131], a[192:195], a[104:107], v[128:131]
s_waitcnt lgkmcnt(6)
buffer_load_dwordx4 a[72:75], v250, s[4:7], s90 offen offset:2048 sc1
v_mfma_f32_16x16x32_bf16 v[128:131], a[196:199], a[112:115], v[128:131]
s_waitcnt lgkmcnt(4)
ds_read_b64_tr_b16 a[212:213], v238 offset:20736
ds_read_b64_tr_b16 a[214:215], v238 offset:25856
v_mfma_f32_16x16x32_bf16 v[128:131], a[200:203], a[120:123], v[128:131]
s_waitcnt lgkmcnt(4)
ds_read_b64_tr_b16 a[216:217], v238 offset:30976
v_cvt_pk_bf16_f32 v116, v116, v117
v_mfma_f32_16x16x32_bf16 v[128:131], a[204:207], a[128:131], v[128:131]
s_waitcnt lgkmcnt(3)
ds_read_b64_tr_b16 a[218:219], v238 offset:36096
v_cvt_pk_bf16_f32 v117, v118, v119
v_mfma_f32_16x16x32_bf16 v[128:131], a[208:211], a[136:139], v[128:131]
ds_read_b64_tr_b16 a[220:221], v240 offset:256
ds_read_b64_tr_b16 a[222:223], v240 offset:5376
v_mfma_f32_16x16x32_bf16 v[132:135], a[208:211], a[140:143], v[132:135]
v_rcp_f32 v230, v230
v_mfma_f32_16x16x32_bf16 v[132:135], a[204:207], a[132:135], v[132:135]
s_waitcnt vmcnt(11)
buffer_store_dwordx4 v[250:253], v252, s[4:7], s68 offen offset:640 sc1
v_mfma_f32_16x16x32_bf16 v[132:135], a[200:203], a[124:127], v[132:135]
ds_read_b64_tr_b16 a[224:225], v240 offset:10496
v_mul_f32 v174, v174, v230
v_mfma_f32_16x16x32_bf16 v[132:135], a[196:199], a[116:119], v[132:135]
ds_read_b64_tr_b16 a[226:227], v240 offset:15616
v_accvgpr_read_b32 v230, a254
v_mfma_f32_16x16x32_bf16 v[132:135], a[192:195], a[108:111], v[132:135]
ds_read_b64_tr_b16 a[228:229], v236 offset:41216
ds_read_b64_tr_b16 a[230:231], v236 offset:46336
v_mfma_f32_16x16x32_bf16 v[132:135], a[232:235], a[100:103], v[132:135]
s_waitcnt lgkmcnt(8)
ds_read_b64_tr_b16 a[232:233], v236 offset:51456
v_add_f32 v178, v178, v230
v_mfma_f32_16x16x32_bf16 v[128:131], a[212:215], a[144:147], v[128:131]
s_waitcnt lgkmcnt(7)
ds_read_b64_tr_b16 a[234:235], v236 offset:56576
v_mul_f32 v230, 0xbfb8aa3b, v178
v_mfma_f32_16x16x32_bf16 v[128:131], a[216:219], a[152:155], v[128:131]
s_waitcnt lgkmcnt(6)
buffer_load_dwordx4 a[76:79], v250, s[4:7], s90 offen offset:3072 sc1
v_mfma_f32_16x16x32_bf16 v[128:131], a[220:223], a[160:163], v[128:131]
s_waitcnt lgkmcnt(4)
ds_read_b64_tr_b16 a[192:193], v236 offset:20608
ds_read_b64_tr_b16 a[194:195], v236 offset:25728
v_mfma_f32_16x16x32_bf16 v[128:131], a[224:227], a[168:171], v[128:131]
s_waitcnt lgkmcnt(4)
v_rcp_f32 v231, v231
v_mfma_f32_16x16x32_bf16 v[128:131], a[228:231], a[176:179], v[128:131]
s_waitcnt lgkmcnt(2)
s_xor_b32 s90, s76, 561152
ds_read_b64_tr_b16 a[196:197], v236 offset:30848
v_mul_f32 v175, v175, v231
v_mfma_f32_16x16x32_bf16 v[128:131], a[232:235], a[184:187], v[128:131]
buffer_load_dwordx4 a[80:83], v250, s[4:7], s90 offen offset:2048 sc1
v_mfma_f32_16x16x32_bf16 v[132:135], a[232:235], a[188:191], v[132:135]
ds_read_b64_tr_b16 a[198:199], v236 offset:35968
v_accvgpr_read_b32 v231, a255
v_mfma_f32_16x16x32_bf16 v[132:135], a[228:231], a[180:183], v[132:135]
ds_read_b64_tr_b16 a[200:201], v238 offset:41088
v_add_f32 v179, v179, v231
v_mfma_f32_16x16x32_bf16 v[132:135], a[224:227], a[172:175], v[132:135]
ds_read_b64_tr_b16 a[202:203], v238 offset:46208
v_mul_f32 v231, 0xbfb8aa3b, v179
v_mfma_f32_16x16x32_bf16 v[132:135], a[220:223], a[164:167], v[132:135]
ds_read_b64_tr_b16 a[204:205], v238 offset:51328
ds_read_b64_tr_b16 a[206:207], v238 offset:56448
v_mfma_f32_16x16x32_bf16 v[132:135], a[216:219], a[156:159], v[132:135]
buffer_load_dwordx4 a[84:87], v250, s[4:7], s90 offen offset:3072 sc1
v_mfma_f32_16x16x32_bf16 v[132:135], a[212:215], a[148:151], v[132:135]
s_waitcnt lgkmcnt(6)
ds_read_b64_tr_b16 a[208:209], v238 offset:128
ds_read_b64_tr_b16 a[210:211], v238 offset:5248
v_mfma_f32_16x16x32_bf16 v[64:67], a[192:195], a[96:99], v[64:67]
s_waitcnt lgkmcnt(6)
ds_read_b64_tr_b16 a[212:213], v238 offset:10368
ds_read_b64_tr_b16 a[214:215], v238 offset:15488
v_mfma_f32_16x16x32_bf16 v[64:67], a[196:199], a[104:107], v[64:67]
s_waitcnt lgkmcnt(6)
s_xor_b32 s91, s76, 1251328
v_cvt_pk_bf16_f32 v114, v128, v129
v_cvt_pk_bf16_f32 v115, v130, v131
v_mfma_f32_16x16x32_bf16 v[64:67], a[200:203], a[112:115], v[64:67]
s_waitcnt lgkmcnt(4)
buffer_store_dwordx4 v[112:115], v250, s[4:7], s91 offen sc1
L_walk2_6:
s_cbranch_execz L_ret2
v_mfma_f32_16x16x32_bf16 v[64:67], a[204:207], a[120:123], v[64:67]
s_waitcnt lgkmcnt(2)
ds_read_b64_tr_b16 a[216:217], v238 offset:20608
v_cvt_pk_bf16_f32 v118, v132, v133
v_mfma_f32_16x16x32_bf16 v[64:67], a[208:211], a[128:131], v[64:67]
s_waitcnt lgkmcnt(1)
ds_read_b64_tr_b16 a[218:219], v238 offset:25728
v_cvt_pk_bf16_f32 v119, v134, v135
v_mfma_f32_16x16x32_bf16 v[64:67], a[212:215], a[136:139], v[64:67]
s_xor_b32 s90, s76, 577536
ds_read_b64_tr_b16 a[220:221], v238 offset:30848
ds_read_b64_tr_b16 a[222:223], v238 offset:35968
v_mfma_f32_16x16x32_bf16 v[68:71], a[212:215], a[140:143], v[68:71]
buffer_load_dwordx4 a[88:91], v250, s[4:7], s90 offen offset:2048 sc1
v_mfma_f32_16x16x32_bf16 v[68:71], a[208:211], a[132:135], v[68:71]
ds_read_b64_tr_b16 a[224:225], v240 offset:128
ds_read_b64_tr_b16 a[226:227], v240 offset:5248
v_mfma_f32_16x16x32_bf16 v[68:71], a[204:207], a[124:127], v[68:71]
v_exp_f32 v228, v228
v_mfma_f32_16x16x32_bf16 v[68:71], a[200:203], a[116:119], v[68:71]
s_xor_b32 s91, s76, 1183744
ds_read_b64_tr_b16 a[228:229], v240 offset:10368
ds_read_b64_tr_b16 a[230:231], v240 offset:15488
v_mfma_f32_16x16x32_bf16 v[68:71], a[196:199], a[108:111], v[68:71]
buffer_store_dwordx4 v[116:119], v250, s[4:7], s91 offen sc1
v_mfma_f32_16x16x32_bf16 v[68:71], a[192:195], a[100:103], v[68:71]
s_waitcnt lgkmcnt(6)
ds_read_b64_tr_b16 a[232:233], v236 offset:41088
ds_read_b64_tr_b16 a[234:235], v236 offset:46208
v_mfma_f32_16x16x32_bf16 v[64:67], a[216:219], a[144:147], v[64:67]
s_waitcnt lgkmcnt(6)
ds_read_b64_tr_b16 a[192:193], v236 offset:51328
ds_read_b64_tr_b16 a[194:195], v236 offset:56448
v_mfma_f32_16x16x32_bf16 v[64:67], a[220:223], a[152:155], v[64:67]
s_waitcnt lgkmcnt(6)
ds_read_b64_tr_b16 a[196:197], v237 offset:20768
v_add_f32 v228, 1.0, v228
v_mfma_f32_16x16x32_bf16 v[64:67], a[224:227], a[160:163], v[64:67]
s_waitcnt lgkmcnt(5)
buffer_load_dwordx4 a[92:95], v250, s[4:7], s90 offen offset:3072 sc1
v_mfma_f32_16x16x32_bf16 v[64:67], a[228:231], a[168:171], v[64:67]
s_waitcnt lgkmcnt(3)
ds_read_b64_tr_b16 a[198:199], v237 offset:25888
ds_read_b64_tr_b16 a[200:201], v237 offset:31008
v_mfma_f32_16x16x32_bf16 v[64:67], a[232:235], a[176:179], v[64:67]
s_waitcnt lgkmcnt(3)
v_exp_f32 v229, v229
v_mfma_f32_16x16x32_bf16 v[64:67], a[192:195], a[184:187], v[64:67]
ds_read_b64_tr_b16 a[202:203], v237 offset:36128
v_add_f32 v229, 1.0, v229
v_mfma_f32_16x16x32_bf16 v[68:71], a[192:195], a[188:191], v[68:71]
ds_read_b64_tr_b16 a[204:205], v239 offset:41248
ds_read_b64_tr_b16 a[206:207], v239 offset:46368
v_mfma_f32_16x16x32_bf16 v[68:71], a[232:235], a[180:183], v[68:71]
v_exp_f32 v230, v230
v_mfma_f32_16x16x32_bf16 v[68:71], a[228:231], a[172:175], v[68:71]
ds_read_b64_tr_b16 a[208:209], v239 offset:51488
v_add_f32 v230, 1.0, v230
v_mfma_f32_16x16x32_bf16 v[68:71], a[224:227], a[164:167], v[68:71]
ds_read_b64_tr_b16 a[210:211], v239 offset:56608
v_cvt_pk_bf16_f32 v64, v64, v65
v_mfma_f32_16x16x32_bf16 v[68:71], a[220:223], a[156:159], v[68:71]
ds_read_b64_tr_b16 a[212:213], v239 offset:288
ds_read_b64_tr_b16 a[214:215], v239 offset:5408
v_mfma_f32_16x16x32_bf16 v[68:71], a[216:219], a[148:151], v[68:71]
s_waitcnt lgkmcnt(8)
ds_read_b64_tr_b16 a[216:217], v239 offset:10528
v_cvt_pk_bf16_f32 v65, v66, v67
v_mfma_f32_16x16x32_bf16 v[144:147], a[196:199], a[96:99], v[144:147]
s_waitcnt lgkmcnt(7)
ds_read_b64_tr_b16 a[218:219], v239 offset:15648
ds_read_b64_tr_b16 a[220:221], v239 offset:20768
v_mfma_f32_16x16x32_bf16 v[144:147], a[200:203], a[104:107], v[144:147]
s_waitcnt lgkmcnt(7)
v_exp_f32 v231, v231
v_mfma_f32_16x16x32_bf16 v[144:147], a[204:207], a[112:115], v[144:147]
s_waitcnt lgkmcnt(5)
ds_read_b64_tr_b16 a[222:223], v239 offset:25888
v_add_f32 v231, 1.0, v231
v_mfma_f32_16x16x32_bf16 v[144:147], a[208:211], a[120:123], v[144:147]
s_waitcnt lgkmcnt(4)
ds_read_b64_tr_b16 a[224:225], v239 offset:31008
v_cvt_pk_bf16_f32 v66, v68, v69
v_mfma_f32_16x16x32_bf16 v[144:147], a[212:215], a[128:131], v[144:147]
s_waitcnt lgkmcnt(3)
ds_read_b64_tr_b16 a[226:227], v239 offset:36128
v_cvt_pk_bf16_f32 v67, v70, v71
v_mfma_f32_16x16x32_bf16 v[144:147], a[216:219], a[136:139], v[144:147]
ds_read_b64_tr_b16 a[228:229], v241 offset:288
v_permlane32_swap_b32 v64, v66
v_mfma_f32_16x16x32_bf16 v[148:151], a[216:219], a[140:143], v[148:151]
s_xor_b32 s91, s77, 1449984
ds_read_b64_tr_b16 a[230:231], v241 offset:5408
v_permlane32_swap_b32 v65, v67
v_mfma_f32_16x16x32_bf16 v[148:151], a[212:215], a[132:135], v[148:151]
buffer_store_dwordx4 v[64:67], v233, s[4:7], s91 offen sc1
v_mfma_f32_16x16x32_bf16 v[148:151], a[208:211], a[124:127], v[148:151]
ds_read_b64_tr_b16 a[232:233], v241 offset:10528
ds_read_b64_tr_b16 a[234:235], v241 offset:15648
v_mfma_f32_16x16x32_bf16 v[148:151], a[204:207], a[116:119], v[148:151]
v_rcp_f32 v228, v228
v_mfma_f32_16x16x32_bf16 v[148:151], a[200:203], a[108:111], v[148:151]
ds_read_b64_tr_b16 a[192:193], v237 offset:41248
ds_read_b64_tr_b16 a[194:195], v237 offset:46368
v_mfma_f32_16x16x32_bf16 v[148:151], a[196:199], a[100:103], v[148:151]
s_waitcnt lgkmcnt(8)
ds_read_b64_tr_b16 a[196:197], v237 offset:51488
v_mul_f32 v176, v176, v228
v_mfma_f32_16x16x32_bf16 v[144:147], a[220:223], a[144:147], v[144:147]
s_waitcnt lgkmcnt(7)
ds_read_b64_tr_b16 a[198:199], v237 offset:56608
ds_read_b64_tr_b16 a[200:201], v236 offset:20480
v_mfma_f32_16x16x32_bf16 v[144:147], a[224:227], a[152:155], v[144:147]
s_waitcnt lgkmcnt(7)
v_rcp_f32 v229, v229
v_mfma_f32_16x16x32_bf16 v[144:147], a[228:231], a[160:163], v[144:147]
s_waitcnt lgkmcnt(5)
ds_read_b64_tr_b16 a[202:203], v236 offset:25600
v_mul_f32 v177, v177, v229
v_mfma_f32_16x16x32_bf16 v[144:147], a[232:235], a[168:171], v[144:147]
s_waitcnt lgkmcnt(4)
ds_read_b64_tr_b16 a[204:205], v236 offset:30720
ds_read_b64_tr_b16 a[206:207], v236 offset:35840
v_mfma_f32_16x16x32_bf16 v[144:147], a[192:195], a[176:179], v[144:147]
s_waitcnt lgkmcnt(4)
v_rcp_f32 v230, v230
v_mfma_f32_16x16x32_bf16 v[144:147], a[196:199], a[184:187], v[144:147]
ds_read_b64_tr_b16 a[208:209], v238 offset:40960
v_mul_f32 v178, v178, v230
v_mfma_f32_16x16x32_bf16 v[148:151], a[196:199], a[188:191], v[148:151]
ds_read_b64_tr_b16 a[210:211], v238 offset:46080
ds_read_b64_tr_b16 a[212:213], v238 offset:51200
v_mfma_f32_16x16x32_bf16 v[148:151], a[192:195], a[180:183], v[148:151]
v_rcp_f32 v231, v231
v_mfma_f32_16x16x32_bf16 v[148:151], a[232:235], a[172:175], v[148:151]
ds_read_b64_tr_b16 a[214:215], v238 offset:56320
v_mul_f32 v179, v179, v231
v_mfma_f32_16x16x32_bf16 v[148:151], a[228:231], a[164:167], v[148:151]
ds_read_b64_tr_b16 a[216:217], v238 offset:0
v_cvt_pk_bf16_f32 v144, v144, v145
v_mfma_f32_16x16x32_bf16 v[148:151], a[224:227], a[156:159], v[148:151]
ds_read_b64_tr_b16 a[218:219], v238 offset:5120
v_cvt_pk_bf16_f32 v145, v146, v147
v_mfma_f32_16x16x32_bf16 v[148:151], a[220:223], a[148:151], v[148:151]
s_waitcnt lgkmcnt(8)
ds_read_b64_tr_b16 a[220:221], v238 offset:10240
ds_read_b64_tr_b16 a[222:223], v238 offset:15360
v_mfma_f32_16x16x32_bf16 v[8:11], a[200:203], a[0:3], v[8:11]
s_waitcnt lgkmcnt(8)
ds_read_b64_tr_b16 a[224:225], v238 offset:20480
v_mfma_f32_16x16x32_bf16 v[8:11], a[204:207], a[8:11], v[8:11]
s_waitcnt lgkmcnt(7)
ds_read_b64_tr_b16 a[226:227], v238 offset:25600
ds_read_b64_tr_b16 a[228:229], v238 offset:30720
v_mfma_f32_16x16x32_bf16 v[8:11], a[208:211], a[16:19], v[8:11]
s_waitcnt lgkmcnt(7)
ds_read_b64_tr_b16 a[230:231], v238 offset:35840
v_mfma_f32_16x16x32_bf16 v[8:11], a[212:215], a[24:27], v[8:11]
s_waitcnt lgkmcnt(6)
ds_read_b64_tr_b16 a[232:233], v240 offset:0
v_cvt_pk_bf16_f32 v146, v148, v149
v_mfma_f32_16x16x32_bf16 v[8:11], a[216:219], a[32:35], v[8:11]
s_waitcnt vmcnt(19) lgkmcnt(5)
ds_read_b64_tr_b16 a[234:235], v240 offset:5120
v_cvt_pk_bf16_f32 v147, v150, v151
v_mfma_f32_16x16x32_bf16 v[8:11], a[220:223], a[40:43], v[8:11]
s_waitcnt vmcnt(18)
buffer_load_dword v254, v253, s[4:7], s70 offen offset:644 sc1
v_mfma_f32_16x16x32_bf16 v[12:15], a[220:223], a[44:47], v[12:15]
v_permlane32_swap_b32 v144, v146
v_permlane32_swap_b32 v145, v147
v_mfma_f32_16x16x32_bf16 v[12:15], a[216:219], a[36:39], v[12:15]
s_xor_b32 s91, s77, 1441792
ds_read_b64_tr_b16 a[192:193], v240 offset:10240
ds_read_b64_tr_b16 a[194:195], v240 offset:15360
v_mfma_f32_16x16x32_bf16 v[12:15], a[212:215], a[28:31], v[12:15]
buffer_store_dwordx4 v[144:147], v233, s[4:7], s91 offen offset:2048 sc1
v_mfma_f32_16x16x32_bf16 v[12:15], a[208:211], a[20:23], v[12:15]
ds_read_b64_tr_b16 a[196:197], v236 offset:40960
ds_read_b64_tr_b16 a[198:199], v236 offset:46080
v_mfma_f32_16x16x32_bf16 v[12:15], a[204:207], a[12:15], v[12:15]
ds_read_b64_tr_b16 a[204:205], v237 offset:20640
v_mfma_f32_16x16x32_bf16 v[12:15], a[200:203], a[4:7], v[12:15]
s_waitcnt vmcnt(19) lgkmcnt(9)
ds_read_b64_tr_b16 a[200:201], v236 offset:51200
ds_read_b64_tr_b16 a[202:203], v236 offset:56320
v_mfma_f32_16x16x32_bf16 v[8:11], a[224:227], a[48:51], v[8:11]
s_waitcnt vmcnt(17) lgkmcnt(9)
ds_read_b64_tr_b16 a[206:207], v237 offset:25760
v_mfma_f32_16x16x32_bf16 v[8:11], a[228:231], a[56:59], v[8:11]
s_waitcnt vmcnt(13) lgkmcnt(8)
ds_read_b64_tr_b16 a[208:209], v237 offset:30880
ds_read_b64_tr_b16 a[210:211], v237 offset:36000
v_mfma_f32_16x16x32_bf16 v[8:11], a[232:235], a[64:67], v[8:11]
s_waitcnt vmcnt(11) lgkmcnt(8)
ds_read_b64_tr_b16 a[212:213], v239 offset:41120
v_mfma_f32_16x16x32_bf16 v[8:11], a[192:195], a[72:75], v[8:11]
s_waitcnt vmcnt(8) lgkmcnt(7)
ds_read_b64_tr_b16 a[214:215], v239 offset:46240
ds_read_b64_tr_b16 a[216:217], v239 offset:51360
v_mfma_f32_16x16x32_bf16 v[8:11], a[196:199], a[80:83], v[8:11]
s_waitcnt vmcnt(5) lgkmcnt(6)
ds_read_b64_tr_b16 a[218:219], v239 offset:56480
v_mfma_f32_16x16x32_bf16 v[8:11], a[200:203], a[88:91], v[8:11]
s_waitcnt vmcnt(3)
ds_read_b64_tr_b16 a[220:221], v239 offset:160
ds_read_b64_tr_b16 a[222:223], v239 offset:5280
v_mfma_f32_16x16x32_bf16 v[12:15], a[200:203], a[92:95], v[12:15]
ds_read_b64_tr_b16 a[200:201], v237 offset:41120
v_mfma_f32_16x16x32_bf16 v[12:15], a[196:199], a[84:87], v[12:15]
ds_read_b64_tr_b16 a[196:197], v241 offset:10400
ds_read_b64_tr_b16 a[198:199], v241 offset:15520
v_mfma_f32_16x16x32_bf16 v[12:15], a[192:195], a[76:79], v[12:15]
ds_read_b64_tr_b16 a[192:193], v241 offset:160
v_mfma_f32_16x16x32_bf16 v[12:15], a[232:235], a[68:71], v[12:15]
ds_read_b64_tr_b16 a[232:233], v239 offset:30880
v_cvt_pk_bf16_f32 v8, v8, v9
v_mfma_f32_16x16x32_bf16 v[12:15], a[228:231], a[60:63], v[12:15]
ds_read_b64_tr_b16 a[228:229], v239 offset:20640
v_cvt_pk_bf16_f32 v9, v10, v11
v_mfma_f32_16x16x32_bf16 v[12:15], a[224:227], a[52:55], v[12:15]
s_waitcnt lgkmcnt(14)
ds_read_b64_tr_b16 a[224:225], v239 offset:10400
ds_read_b64_tr_b16 a[226:227], v239 offset:15520
v_mfma_f32_16x16x32_bf16 v[88:91], a[204:207], a[0:3], v[88:91]
s_waitcnt lgkmcnt(14)
ds_read_b64_tr_b16 a[230:231], v239 offset:25760
v_mfma_f32_16x16x32_bf16 v[88:91], a[208:211], a[8:11], v[88:91]
s_waitcnt lgkmcnt(13)
ds_read_b64_tr_b16 a[234:235], v239 offset:36000
ds_read_b64_tr_b16 a[194:195], v241 offset:5280
v_mfma_f32_16x16x32_bf16 v[88:91], a[212:215], a[16:19], v[88:91]
s_waitcnt lgkmcnt(13)
ds_read_b64_tr_b16 a[202:203], v237 offset:46240
v_mfma_f32_16x16x32_bf16 v[88:91], a[216:219], a[24:27], v[88:91]
s_waitcnt lgkmcnt(12)
ds_read_b64_tr_b16 a[204:205], v237 offset:51360
v_cvt_pk_bf16_f32 v12, v12, v13
v_mfma_f32_16x16x32_bf16 v[88:91], a[220:223], a[32:35], v[88:91]
s_waitcnt lgkmcnt(5)
ds_read_b64_tr_b16 a[206:207], v237 offset:56480
v_cvt_pk_bf16_f32 v13, v14, v15
v_mfma_f32_16x16x32_bf16 v[88:91], a[224:227], a[40:43], v[88:91]
s_waitcnt lgkmcnt(5)
ds_read_b64_tr_b16 a[208:209], v237 offset:20512
ds_read_b64_tr_b16 a[210:211], v237 offset:25632
v_mfma_f32_16x16x32_bf16 v[88:91], a[228:231], a[48:51], v[88:91]
s_waitcnt lgkmcnt(6)
ds_read_b64_tr_b16 a[212:213], v237 offset:30752
v_mfma_f32_16x16x32_bf16 v[88:91], a[232:235], a[56:59], v[88:91]
s_waitcnt lgkmcnt(6)
ds_read_b64_tr_b16 a[214:215], v237 offset:35872
ds_read_b64_tr_b16 a[216:217], v239 offset:40992
v_mfma_f32_16x16x32_bf16 v[88:91], a[192:195], a[64:67], v[88:91]
ds_read_b64_tr_b16 a[218:219], v239 offset:46112
v_mfma_f32_16x16x32_bf16 v[88:91], a[196:199], a[72:75], v[88:91]
s_waitcnt lgkmcnt(8)
ds_read_b64_tr_b16 a[220:221], v239 offset:51232
ds_read_b64_tr_b16 a[222:223], v239 offset:56352
v_mfma_f32_16x16x32_bf16 v[88:91], a[200:203], a[80:83], v[88:91]
s_waitcnt lgkmcnt(8)
ds_read_b64_tr_b16 a[224:225], v239 offset:32
v_mfma_f32_16x16x32_bf16 v[88:91], a[204:207], a[88:91], v[88:91]
s_waitcnt lgkmcnt(7)
ds_read_b64_tr_b16 a[226:227], v239 offset:5152
ds_read_b64_tr_b16 a[228:229], v239 offset:10272
v_mfma_f32_16x16x32_bf16 v[24:27], a[208:211], a[0:3], v[24:27]
s_waitcnt lgkmcnt(7)
ds_read_b64_tr_b16 a[230:231], v239 offset:15392
v_mfma_f32_16x16x32_bf16 v[24:27], a[212:215], a[8:11], v[24:27]
s_waitcnt lgkmcnt(6)
ds_read_b64_tr_b16 a[232:233], v239 offset:20512
ds_read_b64_tr_b16 a[234:235], v239 offset:25632
v_mfma_f32_16x16x32_bf16 v[24:27], a[216:219], a[16:19], v[24:27]
s_waitcnt lgkmcnt(6)
ds_read_b64_tr_b16 a[192:193], v239 offset:30752
v_mfma_f32_16x16x32_bf16 v[24:27], a[220:223], a[24:27], v[24:27]
s_waitcnt lgkmcnt(5)
ds_read_b64_tr_b16 a[194:195], v239 offset:35872
v_cvt_pk_bf16_f32 v88, v88, v89
v_mfma_f32_16x16x32_bf16 v[24:27], a[224:227], a[32:35], v[24:27]
s_waitcnt lgkmcnt(4)
ds_read_b64_tr_b16 a[196:197], v241 offset:32
v_cvt_pk_bf16_f32 v89, v90, v91
v_mfma_f32_16x16x32_bf16 v[24:27], a[228:231], a[40:43], v[24:27]
ds_read_b64_tr_b16 a[198:199], v241 offset:5152
ds_read_b64_tr_b16 a[200:201], v241 offset:10272
v_mfma_f32_16x16x32_bf16 v[28:31], a[228:231], a[44:47], v[28:31]
ds_read_b64_tr_b16 a[202:203], v241 offset:15392
v_mfma_f32_16x16x32_bf16 v[28:31], a[224:227], a[36:39], v[28:31]
ds_read_b64_tr_b16 a[204:205], v237 offset:40992
ds_read_b64_tr_b16 a[206:207], v237 offset:46112
v_mfma_f32_16x16x32_bf16 v[28:31], a[220:223], a[28:31], v[28:31]
ds_read_b64_tr_b16 a[220:221], v238 offset:41152
v_mfma_f32_16x16x32_bf16 v[28:31], a[216:219], a[20:23], v[28:31]
ds_read_b64_tr_b16 a[216:217], v236 offset:30912
ds_read_b64_tr_b16 a[218:219], v236 offset:36032
v_mfma_f32_16x16x32_bf16 v[28:31], a[212:215], a[12:15], v[28:31]
ds_read_b64_tr_b16 a[212:213], v236 offset:20672
v_mfma_f32_16x16x32_bf16 v[28:31], a[208:211], a[4:7], v[28:31]
s_waitcnt lgkmcnt(12)
ds_read_b64_tr_b16 a[208:209], v237 offset:51232
ds_read_b64_tr_b16 a[210:211], v237 offset:56352
v_mfma_f32_16x16x32_bf16 v[24:27], a[232:235], a[48:51], v[24:27]
s_waitcnt lgkmcnt(12)
ds_read_b64_tr_b16 a[214:215], v236 offset:25792
v_mfma_f32_16x16x32_bf16 v[24:27], a[192:195], a[56:59], v[24:27]
s_waitcnt lgkmcnt(11)
ds_read_b64_tr_b16 a[222:223], v238 offset:46272
ds_read_b64_tr_b16 a[224:225], v238 offset:51392
v_mfma_f32_16x16x32_bf16 v[24:27], a[196:199], a[64:67], v[24:27]
s_waitcnt lgkmcnt(11)
ds_read_b64_tr_b16 a[226:227], v238 offset:56512
v_mfma_f32_16x16x32_bf16 v[24:27], a[200:203], a[72:75], v[24:27]
s_waitcnt lgkmcnt(10)
ds_read_b64_tr_b16 a[228:229], v238 offset:192
ds_read_b64_tr_b16 a[230:231], v238 offset:5312
v_mfma_f32_16x16x32_bf16 v[24:27], a[204:207], a[80:83], v[24:27]
s_waitcnt lgkmcnt(6)
ds_read_b64_tr_b16 a[96:97], v236 offset:20736
v_mfma_f32_16x16x32_bf16 v[24:27], a[208:211], a[88:91], v[24:27]
s_waitcnt vmcnt(1)
ds_read_b64_tr_b16 a[98:99], v236 offset:25856
v_cmp_ne_u32 vcc, v254, v251
v_mfma_f32_16x16x32_bf16 v[28:31], a[208:211], a[92:95], v[28:31]
s_cbranch_vccnz L_spin_5
L_back_5:
ds_read_b64_tr_b16 a[208:209], v236 offset:41152
v_mfma_f32_16x16x32_bf16 v[28:31], a[204:207], a[84:87], v[28:31]
ds_read_b64_tr_b16 a[204:205], v240 offset:10432
ds_read_b64_tr_b16 a[206:207], v240 offset:15552
v_mfma_f32_16x16x32_bf16 v[28:31], a[200:203], a[76:79], v[28:31]
s_xor_b32 s90, s76, 790528
ds_read_b64_tr_b16 a[200:201], v240 offset:192
v_mfma_f32_16x16x32_bf16 v[28:31], a[196:199], a[68:71], v[28:31]
buffer_load_dwordx4 v[16:19], v250, s[4:7], s90 offen offset:3072 sc1
v_cvt_pk_bf16_f32 v10, v24, v25
v_cvt_pk_bf16_f32 v11, v26, v27
v_mfma_f32_16x16x32_bf16 v[28:31], a[192:195], a[60:63], v[28:31]
s_xor_b32 s91, s76, 863232
ds_read_b64_tr_b16 a[192:193], v238 offset:20672
ds_read_b64_tr_b16 a[194:195], v238 offset:25792
v_mfma_f32_16x16x32_bf16 v[28:31], a[232:235], a[52:55], v[28:31]
s_waitcnt lgkmcnt(13)
ds_read_b64_tr_b16 a[232:233], v238 offset:10432
v_mfma_f32_16x16x32_bf16 v[104:107], a[212:215], a[0:3], v[104:107]
ds_read_b64_tr_b16 a[234:235], v238 offset:15552
buffer_store_dwordx4 v[8:11], v250, s[4:7], s91 offen sc1
v_mfma_f32_16x16x32_bf16 v[104:107], a[216:219], a[8:11], v[104:107]
s_waitcnt lgkmcnt(14)
ds_read_b64_tr_b16 a[196:197], v238 offset:30912
ds_read_b64_tr_b16 a[198:199], v238 offset:36032
v_mfma_f32_16x16x32_bf16 v[104:107], a[220:223], a[16:19], v[104:107]
s_waitcnt lgkmcnt(14)
ds_read_b64_tr_b16 a[202:203], v240 offset:5312
v_mfma_f32_16x16x32_bf16 v[104:107], a[224:227], a[24:27], v[104:107]
s_waitcnt lgkmcnt(13)
ds_read_b64_tr_b16 a[210:211], v236 offset:46272
v_cvt_pk_bf16_f32 v14, v28, v29
v_mfma_f32_16x16x32_bf16 v[104:107], a[228:231], a[32:35], v[104:107]
s_waitcnt lgkmcnt(4)
ds_read_b64_tr_b16 a[212:213], v236 offset:51392
v_cvt_pk_bf16_f32 v15, v30, v31
v_mfma_f32_16x16x32_bf16 v[104:107], a[232:235], a[40:43], v[104:107]
buffer_load_dwordx4 v[20:23], v250, s[4:7], s90 offen offset:1024 sc1
v_mfma_f32_16x16x32_bf16 v[104:107], a[192:195], a[48:51], v[104:107]
s_waitcnt lgkmcnt(3)
ds_read_b64_tr_b16 a[214:215], v236 offset:56512
ds_read_b64_tr_b16 a[216:217], v236 offset:20544
v_mfma_f32_16x16x32_bf16 v[104:107], a[196:199], a[56:59], v[104:107]
s_waitcnt vmcnt(3) lgkmcnt(4)
buffer_store_dwordx4 v[250:253], v252, s[4:7], s68 offen offset:768 sc1
ds_read_b64_tr_b16 a[218:219], v236 offset:25664
v_mfma_f32_16x16x32_bf16 v[104:107], a[200:203], a[64:67], v[104:107]
s_xor_b32 s91, s76, 795648
ds_read_b64_tr_b16 a[220:221], v236 offset:30784
ds_read_b64_tr_b16 a[222:223], v236 offset:35904
v_mfma_f32_16x16x32_bf16 v[104:107], a[204:207], a[72:75], v[104:107]
s_waitcnt lgkmcnt(6)
ds_read_b64_tr_b16 a[224:225], v238 offset:41024
ds_read_b64_tr_b16 a[226:227], v238 offset:46144
v_mfma_f32_16x16x32_bf16 v[104:107], a[208:211], a[80:83], v[104:107]
s_waitcnt lgkmcnt(6)
ds_read_b64_tr_b16 a[228:229], v238 offset:51264
ds_read_b64_tr_b16 a[230:231], v238 offset:56384
v_mfma_f32_16x16x32_bf16 v[104:107], a[212:215], a[88:91], v[104:107]
s_waitcnt lgkmcnt(6)
buffer_store_dwordx4 v[12:15], v250, s[4:7], s91 offen sc1
ds_read_b64_tr_b16 a[232:233], v238 offset:64
ds_read_b64_tr_b16 a[234:235], v238 offset:5184
v_mfma_f32_16x16x32_bf16 v[40:43], a[216:219], a[0:3], v[40:43]
s_waitcnt lgkmcnt(6)
ds_read_b64_tr_b16 a[192:193], v238 offset:10304
ds_read_b64_tr_b16 a[194:195], v238 offset:15424
v_mfma_f32_16x16x32_bf16 v[40:43], a[220:223], a[8:11], v[40:43]
s_waitcnt lgkmcnt(6)
ds_read_b64_tr_b16 a[196:197], v238 offset:20544
ds_read_b64_tr_b16 a[198:199], v238 offset:25664
v_mfma_f32_16x16x32_bf16 v[40:43], a[224:227], a[16:19], v[40:43]
s_waitcnt lgkmcnt(6)
ds_read_b64_tr_b16 a[200:201], v238 offset:30784
v_mfma_f32_16x16x32_bf16 v[40:43], a[228:231], a[24:27], v[40:43]
s_waitcnt lgkmcnt(5)
buffer_load_dwordx4 v[0:3], v250, s[4:7], s90 offen offset:2048 sc1
v_mfma_f32_16x16x32_bf16 v[40:43], a[232:235], a[32:35], v[40:43]
s_waitcnt lgkmcnt(3)
ds_read_b64_tr_b16 a[202:203], v238 offset:35904
v_cvt_pk_bf16_f32 v90, v104, v105
v_mfma_f32_16x16x32_bf16 v[40:43], a[192:195], a[40:43], v[40:43]
ds_read_b64_tr_b16 a[204:205], v240 offset:64
v_cvt_pk_bf16_f32 v91, v106, v107
v_mfma_f32_16x16x32_bf16 v[44:47], a[192:195], a[44:47], v[44:47]
s_xor_b32 s91, s76, 854016
ds_read_b64_tr_b16 a[206:207], v240 offset:5184
ds_read_b64_tr_b16 a[208:209], v240 offset:10304
v_mfma_f32_16x16x32_bf16 v[44:47], a[232:235], a[36:39], v[44:47]
buffer_store_dwordx4 v[88:91], v250, s[4:7], s91 offen sc1
v_mfma_f32_16x16x32_bf16 v[44:47], a[228:231], a[28:31], v[44:47]
ds_read_b64_tr_b16 a[210:211], v240 offset:15424
ds_read_b64_tr_b16 a[212:213], v236 offset:41024
v_mfma_f32_16x16x32_bf16 v[44:47], a[224:227], a[20:23], v[44:47]
ds_read_b64_tr_b16 a[214:215], v236 offset:46144
v_mfma_f32_16x16x32_bf16 v[44:47], a[220:223], a[12:15], v[44:47]
ds_read_b64_tr_b16 a[220:221], v237 offset:20704
ds_read_b64_tr_b16 a[222:223], v237 offset:25824
v_mfma_f32_16x16x32_bf16 v[44:47], a[216:219], a[4:7], v[44:47]
s_waitcnt lgkmcnt(10)
ds_read_b64_tr_b16 a[216:217], v236 offset:51264
v_mfma_f32_16x16x32_bf16 v[40:43], a[196:199], a[48:51], v[40:43]
s_waitcnt lgkmcnt(9)
ds_read_b64_tr_b16 a[218:219], v236 offset:56384
ds_read_b64_tr_b16 a[224:225], v237 offset:30944
v_mfma_f32_16x16x32_bf16 v[40:43], a[200:203], a[56:59], v[40:43]
s_waitcnt lgkmcnt(9)
buffer_load_dwordx4 v[96:99], v250, s[4:7], s90 offen sc1
v_mfma_f32_16x16x32_bf16 v[40:43], a[204:207], a[64:67], v[40:43]
s_waitcnt lgkmcnt(7)
ds_read_b64_tr_b16 a[226:227], v237 offset:36064
ds_read_b64_tr_b16 a[228:229], v239 offset:41184
v_mfma_f32_16x16x32_bf16 v[40:43], a[208:211], a[72:75], v[40:43]
s_waitcnt lgkmcnt(7)
ds_read_b64_tr_b16 a[230:231], v239 offset:46304
v_mfma_f32_16x16x32_bf16 v[40:43], a[212:215], a[80:83], v[40:43]
s_waitcnt lgkmcnt(4)
ds_read_b64_tr_b16 a[232:233], v239 offset:51424
ds_read_b64_tr_b16 a[234:235], v239 offset:56544
v_mfma_f32_16x16x32_bf16 v[40:43], a[216:219], a[88:91], v[40:43]
ds_read_b64_tr_b16 a[192:193], v239 offset:224
v_mfma_f32_16x16x32_bf16 v[44:47], a[216:219], a[92:95], v[44:47]
ds_read_b64_tr_b16 a[194:195], v239 offset:5344
ds_read_b64_tr_b16 a[216:217], v237 offset:41184
v_mfma_f32_16x16x32_bf16 v[44:47], a[212:215], a[84:87], v[44:47]
ds_read_b64_tr_b16 a[212:213], v241 offset:10464
v_mfma_f32_16x16x32_bf16 v[44:47], a[208:211], a[76:79], v[44:47]
ds_read_b64_tr_b16 a[208:209], v241 offset:224
ds_read_b64_tr_b16 a[210:211], v241 offset:5344
v_mfma_f32_16x16x32_bf16 v[44:47], a[204:207], a[68:71], v[44:47]
ds_read_b64_tr_b16 a[204:205], v239 offset:30944
v_cvt_pk_bf16_f32 v40, v40, v41
v_mfma_f32_16x16x32_bf16 v[44:47], a[200:203], a[60:63], v[44:47]
ds_read_b64_tr_b16 a[200:201], v239 offset:20704
v_cvt_pk_bf16_f32 v41, v42, v43
v_mfma_f32_16x16x32_bf16 v[44:47], a[196:199], a[52:55], v[44:47]
ds_read_b64_tr_b16 a[196:197], v239 offset:10464
ds_read_b64_tr_b16 a[198:199], v239 offset:15584
v_mfma_f32_16x16x32_bf16 v[120:123], a[220:223], a[0:3], v[120:123]
s_waitcnt lgkmcnt(14)
ds_read_b64_tr_b16 a[202:203], v239 offset:25824
v_mfma_f32_16x16x32_bf16 v[120:123], a[224:227], a[8:11], v[120:123]
s_waitcnt lgkmcnt(13)
ds_read_b64_tr_b16 a[206:207], v239 offset:36064
ds_read_b64_tr_b16 a[214:215], v241 offset:15584
v_mfma_f32_16x16x32_bf16 v[120:123], a[228:231], a[16:19], v[120:123]
s_waitcnt lgkmcnt(13)
ds_read_b64_tr_b16 a[218:219], v237 offset:46304
v_mfma_f32_16x16x32_bf16 v[120:123], a[232:235], a[24:27], v[120:123]
s_waitcnt lgkmcnt(12)
ds_read_b64_tr_b16 a[220:221], v237 offset:51424
v_cvt_pk_bf16_f32 v44, v44, v45
v_mfma_f32_16x16x32_bf16 v[120:123], a[192:195], a[32:35], v[120:123]
s_waitcnt lgkmcnt(5)
ds_read_b64_tr_b16 a[222:223], v237 offset:56544
v_cvt_pk_bf16_f32 v45, v46, v47
v_mfma_f32_16x16x32_bf16 v[120:123], a[196:199], a[40:43], v[120:123]
s_waitcnt lgkmcnt(5)
ds_read_b64_tr_b16 a[224:225], v237 offset:20576
ds_read_b64_tr_b16 a[226:227], v237 offset:25696
v_mfma_f32_16x16x32_bf16 v[120:123], a[200:203], a[48:51], v[120:123]
s_waitcnt lgkmcnt(6)
ds_read_b64_tr_b16 a[228:229], v237 offset:30816
v_mfma_f32_16x16x32_bf16 v[120:123], a[204:207], a[56:59], v[120:123]
ds_read_b64_tr_b16 a[230:231], v237 offset:35936
ds_read_b64_tr_b16 a[232:233], v239 offset:41056
v_mfma_f32_16x16x32_bf16 v[120:123], a[208:211], a[64:67], v[120:123]
s_waitcnt lgkmcnt(8)
ds_read_b64_tr_b16 a[234:235], v239 offset:46176
v_mfma_f32_16x16x32_bf16 v[120:123], a[212:215], a[72:75], v[120:123]
s_waitcnt lgkmcnt(8)
ds_read_b64_tr_b16 a[192:193], v239 offset:51296
ds_read_b64_tr_b16 a[194:195], v239 offset:56416
v_mfma_f32_16x16x32_bf16 v[120:123], a[216:219], a[80:83], v[120:123]
s_waitcnt lgkmcnt(8)
ds_read_b64_tr_b16 a[196:197], v239 offset:96
v_mfma_f32_16x16x32_bf16 v[120:123], a[220:223], a[88:91], v[120:123]
s_waitcnt lgkmcnt(7)
ds_read_b64_tr_b16 a[198:199], v239 offset:5216
ds_read_b64_tr_b16 a[200:201], v239 offset:10336
v_mfma_f32_16x16x32_bf16 v[56:59], a[224:227], a[0:3], v[56:59]
s_waitcnt lgkmcnt(7)
ds_read_b64_tr_b16 a[202:203], v239 offset:15456
v_mfma_f32_16x16x32_bf16 v[56:59], a[228:231], a[8:11], v[56:59]
s_waitcnt lgkmcnt(6)
ds_read_b64_tr_b16 a[204:205], v239 offset:20576
ds_read_b64_tr_b16 a[206:207], v239 offset:25696
v_mfma_f32_16x16x32_bf16 v[56:59], a[232:235], a[16:19], v[56:59]
s_waitcnt lgkmcnt(6)
ds_read_b64_tr_b16 a[208:209], v239 offset:30816
v_mfma_f32_16x16x32_bf16 v[56:59], a[192:195], a[24:27], v[56:59]
s_waitcnt lgkmcnt(5)
ds_read_b64_tr_b16 a[210:211], v239 offset:35936
v_cvt_pk_bf16_f32 v120, v120, v121
v_mfma_f32_16x16x32_bf16 v[56:59], a[196:199], a[32:35], v[56:59]
s_waitcnt lgkmcnt(4)
ds_read_b64_tr_b16 a[212:213], v241 offset:96
v_cvt_pk_bf16_f32 v121, v122, v123
v_mfma_f32_16x16x32_bf16 v[56:59], a[200:203], a[40:43], v[56:59]
ds_read_b64_tr_b16 a[214:215], v241 offset:5216
ds_read_b64_tr_b16 a[216:217], v241 offset:10336
v_mfma_f32_16x16x32_bf16 v[60:63], a[200:203], a[44:47], v[60:63]
ds_read_b64_tr_b16 a[218:219], v241 offset:15456
v_mfma_f32_16x16x32_bf16 v[60:63], a[196:199], a[36:39], v[60:63]
ds_read_b64_tr_b16 a[220:221], v237 offset:41056
ds_read_b64_tr_b16 a[222:223], v237 offset:46176
v_mfma_f32_16x16x32_bf16 v[60:63], a[192:195], a[28:31], v[60:63]
ds_read_b64_tr_b16 a[100:101], v236 offset:30976
v_mfma_f32_16x16x32_bf16 v[60:63], a[232:235], a[20:23], v[60:63]
ds_read_b64_tr_b16 a[102:103], v236 offset:36096
ds_read_b64_tr_b16 a[104:105], v238 offset:41216
v_mfma_f32_16x16x32_bf16 v[60:63], a[228:231], a[12:15], v[60:63]
ds_read_b64_tr_b16 a[106:107], v238 offset:46336
v_mfma_f32_16x16x32_bf16 v[60:63], a[224:227], a[4:7], v[60:63]
s_waitcnt lgkmcnt(12)
ds_read_b64_tr_b16 a[224:225], v237 offset:51296
ds_read_b64_tr_b16 a[226:227], v237 offset:56416
v_mfma_f32_16x16x32_bf16 v[56:59], a[204:207], a[48:51], v[56:59]
s_waitcnt lgkmcnt(12)
ds_read_b64_tr_b16 a[108:109], v238 offset:51456
v_mfma_f32_16x16x32_bf16 v[56:59], a[208:211], a[56:59], v[56:59]
s_waitcnt lgkmcnt(11)
ds_read_b64_tr_b16 a[110:111], v238 offset:56576
ds_read_b64_tr_b16 a[112:113], v238 offset:256
v_mfma_f32_16x16x32_bf16 v[56:59], a[212:215], a[64:67], v[56:59]
s_waitcnt lgkmcnt(11)
ds_read_b64_tr_b16 a[114:115], v238 offset:5376
v_mfma_f32_16x16x32_bf16 v[56:59], a[216:219], a[72:75], v[56:59]
s_waitcnt lgkmcnt(10)
ds_read_b64_tr_b16 a[116:117], v238 offset:10496
ds_read_b64_tr_b16 a[118:119], v238 offset:15616
v_mfma_f32_16x16x32_bf16 v[56:59], a[220:223], a[80:83], v[56:59]
s_waitcnt lgkmcnt(6)
ds_read_b64_tr_b16 a[120:121], v238 offset:20736
v_mfma_f32_16x16x32_bf16 v[56:59], a[224:227], a[88:91], v[56:59]
ds_read_b64_tr_b16 a[122:123], v238 offset:25856
ds_read_b64_tr_b16 a[124:125], v238 offset:30976
v_mfma_f32_16x16x32_bf16 v[60:63], a[224:227], a[92:95], v[60:63]
ds_read_b64_tr_b16 a[126:127], v238 offset:36096
v_mfma_f32_16x16x32_bf16 v[60:63], a[220:223], a[84:87], v[60:63]
ds_read_b64_tr_b16 a[128:129], v240 offset:256
ds_read_b64_tr_b16 a[130:131], v240 offset:5376
v_mfma_f32_16x16x32_bf16 v[60:63], a[216:219], a[76:79], v[60:63]
L_walk2_7:
s_cbranch_execz L_ret2
ds_read_b64_tr_b16 a[132:133], v240 offset:10496
v_mfma_f32_16x16x32_bf16 v[60:63], a[212:215], a[68:71], v[60:63]
ds_read_b64_tr_b16 a[134:135], v240 offset:15616
v_cvt_pk_bf16_f32 v42, v56, v57
v_mfma_f32_16x16x32_bf16 v[60:63], a[208:211], a[60:63], v[60:63]
ds_read_b64_tr_b16 a[136:137], v236 offset:41216
v_cvt_pk_bf16_f32 v43, v58, v59
v_mfma_f32_16x16x32_bf16 v[60:63], a[204:207], a[52:55], v[60:63]
s_xor_b32 s91, s76, 1125376
ds_read_b64_tr_b16 a[138:139], v236 offset:46336
ds_read_b64_tr_b16 a[140:141], v236 offset:51456
v_mfma_f32_16x16x32_bf16 v[136:139], a[96:99], a[0:3], v[136:139]
buffer_store_dwordx4 v[40:43], v250, s[4:7], s91 offen sc1
v_mfma_f32_16x16x32_bf16 v[136:139], a[100:103], a[8:11], v[136:139]
ds_read_b64_tr_b16 a[142:143], v236 offset:56576
ds_read_b64_tr_b16 a[228:229], v236 offset:20608
v_mfma_f32_16x16x32_bf16 v[136:139], a[104:107], a[16:19], v[136:139]
s_waitcnt lgkmcnt(14)
ds_read_b64_tr_b16 a[230:231], v236 offset:25728
v_mfma_f32_16x16x32_bf16 v[136:139], a[108:111], a[24:27], v[136:139]
s_waitcnt lgkmcnt(14)
ds_read_b64_tr_b16 a[232:233], v236 offset:30848
v_cvt_pk_bf16_f32 v46, v60, v61
v_mfma_f32_16x16x32_bf16 v[136:139], a[112:115], a[32:35], v[136:139]
s_waitcnt lgkmcnt(14)
ds_read_b64_tr_b16 a[234:235], v236 offset:35968
v_cvt_pk_bf16_f32 v47, v62, v63
v_mfma_f32_16x16x32_bf16 v[136:139], a[116:119], a[40:43], v[136:139]
s_waitcnt lgkmcnt(14)
ds_read_b64_tr_b16 a[192:193], v238 offset:41088
ds_read_b64_tr_b16 a[194:195], v238 offset:46208
v_mfma_f32_16x16x32_bf16 v[136:139], a[120:123], a[48:51], v[136:139]
s_waitcnt lgkmcnt(14)
buffer_load_dword v254, v253, s[4:7], s70 offen offset:772 sc1
v_mfma_f32_16x16x32_bf16 v[136:139], a[124:127], a[56:59], v[136:139]
s_waitcnt lgkmcnt(12)
ds_read_b64_tr_b16 a[196:197], v238 offset:51328
ds_read_b64_tr_b16 a[198:199], v238 offset:56448
v_mfma_f32_16x16x32_bf16 v[136:139], a[128:131], a[64:67], v[136:139]
s_waitcnt lgkmcnt(12)
s_xor_b32 s91, s76, 1057792
ds_read_b64_tr_b16 a[200:201], v238 offset:128
v_mfma_f32_16x16x32_bf16 v[136:139], a[132:135], a[72:75], v[136:139]
s_waitcnt lgkmcnt(11)
ds_read_b64_tr_b16 a[202:203], v238 offset:5248
ds_read_b64_tr_b16 a[204:205], v238 offset:10368
v_mfma_f32_16x16x32_bf16 v[136:139], a[136:139], a[80:83], v[136:139]
s_waitcnt lgkmcnt(11)
buffer_store_dwordx4 v[44:47], v250, s[4:7], s91 offen sc1
v_mfma_f32_16x16x32_bf16 v[136:139], a[140:143], a[88:91], v[136:139]
s_waitcnt lgkmcnt(9)
ds_read_b64_tr_b16 a[206:207], v238 offset:15488
ds_read_b64_tr_b16 a[208:209], v238 offset:20608
v_mfma_f32_16x16x32_bf16 v[72:75], a[228:231], a[0:3], v[72:75]
s_waitcnt lgkmcnt(9)
ds_read_b64_tr_b16 a[210:211], v238 offset:25728
v_mfma_f32_16x16x32_bf16 v[72:75], a[232:235], a[8:11], v[72:75]
s_waitcnt lgkmcnt(8)
ds_read_b64_tr_b16 a[212:213], v238 offset:30848
ds_read_b64_tr_b16 a[214:215], v238 offset:35968
v_mfma_f32_16x16x32_bf16 v[72:75], a[192:195], a[16:19], v[72:75]
s_waitcnt lgkmcnt(8)
ds_read_b64_tr_b16 a[216:217], v240 offset:128
v_mfma_f32_16x16x32_bf16 v[72:75], a[196:199], a[24:27], v[72:75]
s_waitcnt lgkmcnt(7)
ds_read_b64_tr_b16 a[218:219], v240 offset:5248
v_cvt_pk_bf16_f32 v122, v136, v137
v_mfma_f32_16x16x32_bf16 v[72:75], a[200:203], a[32:35], v[72:75]
s_waitcnt lgkmcnt(6)
ds_read_b64_tr_b16 a[220:221], v240 offset:10368
v_cvt_pk_bf16_f32 v123, v138, v139
v_mfma_f32_16x16x32_bf16 v[72:75], a[204:207], a[40:43], v[72:75]
s_xor_b32 s91, s76, 1116160
ds_read_b64_tr_b16 a[222:223], v240 offset:15488
ds_read_b64_tr_b16 a[224:225], v236 offset:41088
v_mfma_f32_16x16x32_bf16 v[76:79], a[204:207], a[44:47], v[76:79]
buffer_store_dwordx4 v[120:123], v250, s[4:7], s91 offen sc1
v_mfma_f32_16x16x32_bf16 v[76:79], a[200:203], a[36:39], v[76:79]
ds_read_b64_tr_b16 a[226:227], v236 offset:46208
ds_read_b64_tr_b16 a[144:145], v237 offset:20768
v_mfma_f32_16x16x32_bf16 v[76:79], a[196:199], a[28:31], v[76:79]
ds_read_b64_tr_b16 a[146:147], v237 offset:25888
v_mfma_f32_16x16x32_bf16 v[76:79], a[192:195], a[20:23], v[76:79]
ds_read_b64_tr_b16 a[148:149], v237 offset:31008
ds_read_b64_tr_b16 a[150:151], v237 offset:36128
v_mfma_f32_16x16x32_bf16 v[76:79], a[232:235], a[12:15], v[76:79]
ds_read_b64_tr_b16 a[152:153], v239 offset:41248
v_mfma_f32_16x16x32_bf16 v[76:79], a[228:231], a[4:7], v[76:79]
s_waitcnt lgkmcnt(13)
ds_read_b64_tr_b16 a[228:229], v236 offset:51328
ds_read_b64_tr_b16 a[230:231], v236 offset:56448
v_mfma_f32_16x16x32_bf16 v[72:75], a[208:211], a[48:51], v[72:75]
s_waitcnt lgkmcnt(13)
ds_read_b64_tr_b16 a[154:155], v239 offset:46368
v_mfma_f32_16x16x32_bf16 v[72:75], a[212:215], a[56:59], v[72:75]
s_waitcnt lgkmcnt(12)
ds_read_b64_tr_b16 a[156:157], v239 offset:51488
ds_read_b64_tr_b16 a[158:159], v239 offset:56608
v_mfma_f32_16x16x32_bf16 v[72:75], a[216:219], a[64:67], v[72:75]
s_waitcnt lgkmcnt(12)
ds_read_b64_tr_b16 a[160:161], v239 offset:288
v_mfma_f32_16x16x32_bf16 v[72:75], a[220:223], a[72:75], v[72:75]
s_waitcnt lgkmcnt(11)
ds_read_b64_tr_b16 a[162:163], v239 offset:5408
ds_read_b64_tr_b16 a[164:165], v239 offset:10528
v_mfma_f32_16x16x32_bf16 v[72:75], a[224:227], a[80:83], v[72:75]
s_waitcnt lgkmcnt(6)
ds_read_b64_tr_b16 a[166:167], v239 offset:15648
v_mfma_f32_16x16x32_bf16 v[72:75], a[228:231], a[88:91], v[72:75]
ds_read_b64_tr_b16 a[168:169], v239 offset:20768
ds_read_b64_tr_b16 a[170:171], v239 offset:25888
v_mfma_f32_16x16x32_bf16 v[76:79], a[228:231], a[92:95], v[76:79]
ds_read_b64_tr_b16 a[172:173], v239 offset:31008
v_mfma_f32_16x16x32_bf16 v[76:79], a[224:227], a[84:87], v[76:79]
s_xor_b32 s90, s76, 786432
ds_read_b64_tr_b16 a[174:175], v239 offset:36128
ds_read_b64_tr_b16 a[176:177], v241 offset:288
v_mfma_f32_16x16x32_bf16 v[76:79], a[220:223], a[76:79], v[76:79]
buffer_load_dwordx4 v[4:7], v250, s[4:7], s90 offen offset:3072 sc1
v_mfma_f32_16x16x32_bf16 v[76:79], a[216:219], a[68:71], v[76:79]
ds_read_b64_tr_b16 a[178:179], v241 offset:5408
v_cvt_pk_bf16_f32 v72, v72, v73
v_mfma_f32_16x16x32_bf16 v[76:79], a[212:215], a[60:63], v[76:79]
ds_read_b64_tr_b16 a[180:181], v241 offset:10528
v_cvt_pk_bf16_f32 v73, v74, v75
v_mfma_f32_16x16x32_bf16 v[76:79], a[208:211], a[52:55], v[76:79]
ds_read_b64_tr_b16 a[182:183], v241 offset:15648
ds_read_b64_tr_b16 a[184:185], v237 offset:41248
v_mfma_f32_16x16x32_bf16 v[152:155], a[144:147], a[0:3], v[152:155]
ds_read_b64_tr_b16 a[186:187], v237 offset:46368
v_mfma_f32_16x16x32_bf16 v[152:155], a[148:151], a[8:11], v[152:155]
s_waitcnt lgkmcnt(14)
buffer_load_dwordx4 v[100:103], v250, s[4:7], s90 offen offset:1024 sc1
v_mfma_f32_16x16x32_bf16 v[152:155], a[152:155], a[16:19], v[152:155]
s_waitcnt lgkmcnt(14)
ds_read_b64_tr_b16 a[188:189], v237 offset:51488
ds_read_b64_tr_b16 a[190:191], v237 offset:56608
v_mfma_f32_16x16x32_bf16 v[152:155], a[156:159], a[24:27], v[152:155]
s_waitcnt lgkmcnt(14)
ds_read_b64_tr_b16 a[232:233], v237 offset:20640
v_cvt_pk_bf16_f32 v74, v76, v77
v_mfma_f32_16x16x32_bf16 v[152:155], a[160:163], a[32:35], v[152:155]
s_waitcnt lgkmcnt(13)
ds_read_b64_tr_b16 a[234:235], v237 offset:25760
v_cvt_pk_bf16_f32 v75, v78, v79
v_mfma_f32_16x16x32_bf16 v[152:155], a[164:167], a[40:43], v[152:155]
s_waitcnt lgkmcnt(12)
v_permlane32_swap_b32 v72, v74
v_permlane32_swap_b32 v73, v75
v_mfma_f32_16x16x32_bf16 v[152:155], a[168:171], a[48:51], v[152:155]
s_waitcnt lgkmcnt(10)
buffer_load_dwordx4 v[80:83], v250, s[4:7], s90 offen offset:2048 sc1
v_mfma_f32_16x16x32_bf16 v[152:155], a[172:175], a[56:59], v[152:155]
s_waitcnt lgkmcnt(8)
s_xor_b32 s91, s77, 1318912
ds_read_b64_tr_b16 a[192:193], v237 offset:30880
ds_read_b64_tr_b16 a[194:195], v237 offset:36000
v_mfma_f32_16x16x32_bf16 v[152:155], a[176:179], a[64:67], v[152:155]
s_waitcnt lgkmcnt(8)
buffer_store_dwordx4 v[72:75], v233, s[4:7], s91 offen offset:1024 sc1
v_mfma_f32_16x16x32_bf16 v[152:155], a[180:183], a[72:75], v[152:155]
s_waitcnt vmcnt(6) lgkmcnt(6)
ds_read_b64_tr_b16 a[196:197], v239 offset:41120
ds_read_b64_tr_b16 a[198:199], v239 offset:46240
v_cmp_ne_u32 vcc, v254, v251
v_mfma_f32_16x16x32_bf16 v[152:155], a[184:187], a[80:83], v[152:155]
s_cbranch_vccnz L_spin_6
L_back_6:
ds_read_b64_tr_b16 a[200:201], v239 offset:51360
ds_read_b64_tr_b16 a[202:203], v239 offset:56480
s_waitcnt lgkmcnt(8)
v_mfma_f32_16x16x32_bf16 v[152:155], a[188:191], a[88:91], v[152:155]
s_waitcnt lgkmcnt(6)
s_xor_b32 s90, s76, 1052672
ds_read_b64_tr_b16 a[204:205], v239 offset:160
ds_read_b64_tr_b16 a[206:207], v239 offset:5280
v_mfma_f32_16x16x32_bf16 v[92:95], a[232:235], a[4:7], v[92:95]
s_waitcnt lgkmcnt(6)
ds_read_b64_tr_b16 a[208:209], v239 offset:10400
ds_read_b64_tr_b16 a[210:211], v239 offset:15520
buffer_load_dwordx4 v[84:87], v250, s[4:7], s90 offen offset:3072 sc1
v_mfma_f32_16x16x32_bf16 v[92:95], a[192:195], a[12:15], v[92:95]
s_waitcnt lgkmcnt(6)
ds_read_b64_tr_b16 a[212:213], v239 offset:20640
ds_read_b64_tr_b16 a[214:215], v239 offset:25760
v_mfma_f32_16x16x32_bf16 v[92:95], a[196:199], a[20:23], v[92:95]
s_waitcnt lgkmcnt(6)
ds_read_b64_tr_b16 a[216:217], v239 offset:30880
v_mfma_f32_16x16x32_bf16 v[92:95], a[200:203], a[28:31], v[92:95]
s_waitcnt lgkmcnt(5)
ds_read_b64_tr_b16 a[218:219], v239 offset:36000
v_cvt_pk_bf16_f32 v152, v152, v153
v_mfma_f32_16x16x32_bf16 v[92:95], a[204:207], a[36:39], v[92:95]
s_waitcnt lgkmcnt(4)
buffer_load_dwordx4 v[48:51], v250, s[4:7], s90 offen offset:1024 sc1
v_mfma_f32_16x16x32_bf16 v[92:95], a[208:211], a[44:47], v[92:95]
v_cvt_pk_bf16_f32 v153, v154, v155
v_permlane32_swap_b32 v152, v154
v_mfma_f32_16x16x32_bf16 v[92:95], v[202:205], v[16:19], v[92:95]
s_xor_b32 s91, s77, 1310720
ds_read_b64_tr_b16 a[220:221], v241 offset:160
v_permlane32_swap_b32 v153, v155
v_mfma_f32_16x16x32_bf16 v[92:95], v[202:205], v[20:23], v[92:95]
buffer_store_dwordx4 v[152:155], v234, s[4:7], s91 offen offset:3072 sc1
v_mfma_f32_16x16x32_bf16 v[92:95], v[202:205], v[0:3], v[92:95]
ds_read_b64_tr_b16 a[222:223], v241 offset:5280
ds_read_b64_tr_b16 a[224:225], v241 offset:10400
v_mfma_f32_16x16x32_bf16 v[92:95], v[202:205], v[96:99], v[92:95]
ds_read_b64_tr_b16 a[226:227], v241 offset:15520
v_mfma_f32_16x16x32_bf16 v[108:111], v[200:203], v[16:19], v[108:111]
ds_read_b64_tr_b16 a[228:229], v237 offset:41120
ds_read_b64_tr_b16 a[230:231], v237 offset:46240
v_mfma_f32_16x16x32_bf16 v[108:111], v[200:203], v[20:23], v[108:111]
buffer_load_dwordx4 v[52:55], v250, s[4:7], s90 offen offset:2048 sc1
v_mfma_f32_16x16x32_bf16 v[108:111], v[200:203], v[0:3], v[108:111]
ds_read_b64_tr_b16 a[232:233], v237 offset:51360
ds_read_b64_tr_b16 a[234:235], v237 offset:56480
v_mfma_f32_16x16x32_bf16 v[108:111], v[200:203], v[96:99], v[108:111]
s_waitcnt lgkmcnt(10)
ds_read_b64_tr_b16 a[192:193], v236 offset:20672
v_mfma_f32_16x16x32_bf16 v[92:95], a[212:215], a[52:55], v[92:95]
s_waitcnt lgkmcnt(9)
ds_read_b64_tr_b16 a[194:195], v236 offset:25792
ds_read_b64_tr_b16 a[196:197], v236 offset:30912
v_mfma_f32_16x16x32_bf16 v[92:95], a[216:219], a[60:63], v[92:95]
s_waitcnt lgkmcnt(9)
buffer_load_dwordx4 v[32:35], v250, s[4:7], s90 offen sc1
v_mfma_f32_16x16x32_bf16 v[92:95], a[220:223], a[68:71], v[92:95]
s_waitcnt lgkmcnt(7)
ds_read_b64_tr_b16 a[198:199], v236 offset:36032
ds_read_b64_tr_b16 a[200:201], v238 offset:41152
v_mfma_f32_16x16x32_bf16 v[92:95], a[224:227], a[76:79], v[92:95]
s_waitcnt lgkmcnt(7)
s_xor_b32 s90, s76, 1310720
ds_read_b64_tr_b16 a[202:203], v238 offset:46272
v_mfma_f32_16x16x32_bf16 v[92:95], a[228:231], a[84:87], v[92:95]
s_waitcnt lgkmcnt(6)
ds_read_b64_tr_b16 a[204:205], v238 offset:51392
ds_read_b64_tr_b16 a[206:207], v238 offset:56512
v_mfma_f32_16x16x32_bf16 v[92:95], a[232:235], a[92:95], v[92:95]
s_waitcnt lgkmcnt(6)
buffer_load_dwordx4 v[36:39], v250, s[4:7], s90 offen sc1
ds_read_b64_tr_b16 a[208:209], v238 offset:192
ds_read_b64_tr_b16 a[210:211], v238 offset:5312
v_mfma_f32_16x16x32_bf16 v[108:111], a[192:195], a[4:7], v[108:111]
s_waitcnt lgkmcnt(6)
ds_read_b64_tr_b16 a[212:213], v238 offset:10432
ds_read_b64_tr_b16 a[214:215], v238 offset:15552
v_mfma_f32_16x16x32_bf16 v[108:111], a[196:199], a[12:15], v[108:111]
s_waitcnt lgkmcnt(6)
ds_read_b64_tr_b16 a[216:217], v238 offset:20672
ds_read_b64_tr_b16 a[218:219], v238 offset:25792
v_mfma_f32_16x16x32_bf16 v[108:111], a[200:203], a[20:23], v[108:111]
s_waitcnt lgkmcnt(6)
ds_read_b64_tr_b16 a[220:221], v238 offset:30912
ds_read_b64_tr_b16 a[222:223], v238 offset:36032
v_mfma_f32_16x16x32_bf16 v[108:111], a[204:207], a[28:31], v[108:111]
s_waitcnt lgkmcnt(6)
buffer_load_dwordx4 v[128:131], v250, s[4:7], s90 offen offset:2048 sc1
ds_read_b64_tr_b16 a[224:225], v240 offset:192
ds_read_b64_tr_b16 a[226:227], v240 offset:5312
v_mfma_f32_16x16x32_bf16 v[108:111], a[208:211], a[36:39], v[108:111]
s_waitcnt lgkmcnt(6)
ds_read_b64_tr_b16 a[228:229], v240 offset:10432
ds_read_b64_tr_b16 a[230:231], v240 offset:15552
v_mfma_f32_16x16x32_bf16 v[108:111], a[212:215], a[44:47], v[108:111]
s_waitcnt lgkmcnt(6)
ds_read_b64_tr_b16 a[232:233], v236 offset:41152
ds_read_b64_tr_b16 a[234:235], v236 offset:46272
v_mfma_f32_16x16x32_bf16 v[108:111], a[216:219], a[52:55], v[108:111]
s_waitcnt lgkmcnt(6)
ds_read_b64_tr_b16 a[192:193], v236 offset:51392
ds_read_b64_tr_b16 a[194:195], v236 offset:56512
v_mfma_f32_16x16x32_bf16 v[108:111], a[220:223], a[60:63], v[108:111]
s_waitcnt lgkmcnt(6)
ds_read_b64_tr_b16 a[196:197], v237 offset:20704
ds_read_b64_tr_b16 a[198:199], v237 offset:25824
v_mfma_f32_16x16x32_bf16 v[108:111], a[224:227], a[68:71], v[108:111]
s_waitcnt lgkmcnt(6)
ds_read_b64_tr_b16 a[200:201], v237 offset:30944
v_mfma_f32_16x16x32_bf16 v[108:111], a[228:231], a[76:79], v[108:111]
s_waitcnt lgkmcnt(5)
ds_read_b64_tr_b16 a[202:203], v237 offset:36064
ds_read_b64_tr_b16 a[204:205], v239 offset:41184
v_mfma_f32_16x16x32_bf16 v[108:111], a[232:235], a[84:87], v[108:111]
s_waitcnt lgkmcnt(5)
ds_read_b64_tr_b16 a[206:207], v239 offset:46304
v_mfma_f32_16x16x32_bf16 v[108:111], a[192:195], a[92:95], v[108:111]
s_waitcnt vmcnt(8)
v_max3_u32 v254, v5, v101, v81
v_cmp_ge_u32 vcc, v254, v251
s_cbranch_vccnz L_spin_k2
L_back_k2:
v_mfma_f32_16x16x32_bf16 v[92:95], v[202:205], v[4:7], v[92:95]
ds_read_b64_tr_b16 a[208:209], v239 offset:51424
ds_read_b64_tr_b16 a[210:211], v239 offset:56544
v_mfma_f32_16x16x32_bf16 v[92:95], v[202:205], v[100:103], v[92:95]
ds_read_b64_tr_b16 a[212:213], v239 offset:224
v_mfma_f32_16x16x32_bf16 v[92:95], v[202:205], v[80:83], v[92:95]
s_xor_b32 s90, s76, 1048576
ds_read_b64_tr_b16 a[214:215], v239 offset:5344
ds_read_b64_tr_b16 a[216:217], v239 offset:10464
v_mfma_f32_16x16x32_bf16 v[108:111], v[200:203], v[4:7], v[108:111]
buffer_load_dwordx4 v[132:135], v250, s[4:7], s90 offen offset:3072 sc1
v_mfma_f32_16x16x32_bf16 v[108:111], v[200:203], v[100:103], v[108:111]
ds_read_b64_tr_b16 a[218:219], v239 offset:15584
ds_read_b64_tr_b16 a[220:221], v239 offset:20704
v_mfma_f32_16x16x32_bf16 v[108:111], v[200:203], v[80:83], v[108:111]
ds_read_b64_tr_b16 a[222:223], v239 offset:25824
v_mfma_f32_16x16x32_bf16 v[140:143], a[96:99], a[4:7], v[140:143]
ds_read_b64_tr_b16 a[224:225], v239 offset:30944
v_fma_f32 v92, v92, v160, v180
v_mfma_f32_16x16x32_bf16 v[140:143], a[100:103], a[12:15], v[140:143]
ds_read_b64_tr_b16 a[226:227], v239 offset:36064
v_fma_f32 v93, v93, v161, v181
v_mfma_f32_16x16x32_bf16 v[140:143], a[104:107], a[20:23], v[140:143]
buffer_load_dwordx4 v[112:115], v250, s[4:7], s90 offen offset:1024 sc1
v_mfma_f32_16x16x32_bf16 v[140:143], a[108:111], a[28:31], v[140:143]
ds_read_b64_tr_b16 a[228:229], v241 offset:224
v_fma_f32 v94, v94, v162, v182
v_mfma_f32_16x16x32_bf16 v[140:143], a[112:115], a[36:39], v[140:143]
ds_read_b64_tr_b16 a[230:231], v241 offset:5344
v_fma_f32 v95, v95, v163, v183
v_mfma_f32_16x16x32_bf16 v[140:143], a[116:119], a[44:47], v[140:143]
s_waitcnt lgkmcnt(14)
ds_read_b64_tr_b16 a[232:233], v241 offset:10464
v_cvt_pk_bf16_f32 v92, v92, v93
v_mfma_f32_16x16x32_bf16 v[124:127], a[196:199], a[4:7], v[124:127]
s_waitcnt lgkmcnt(14)
ds_read_b64_tr_b16 a[234:235], v241 offset:15584
v_cvt_pk_bf16_f32 v93, v94, v95
v_mfma_f32_16x16x32_bf16 v[124:127], a[200:203], a[12:15], v[124:127]
s_waitcnt lgkmcnt(14)
buffer_load_dwordx4 v[116:119], v250, s[4:7], s90 offen offset:2048 sc1
v_mfma_f32_16x16x32_bf16 v[124:127], a[204:207], a[20:23], v[124:127]
s_waitcnt lgkmcnt(12)
ds_read_b64_tr_b16 a[192:193], v237 offset:41184
v_fma_f32 v108, v108, v164, v184
v_mfma_f32_16x16x32_bf16 v[124:127], a[208:211], a[28:31], v[124:127]
s_waitcnt lgkmcnt(11)
ds_read_b64_tr_b16 a[194:195], v237 offset:46304
v_fma_f32 v109, v109, v165, v185
v_mfma_f32_16x16x32_bf16 v[124:127], a[212:215], a[36:39], v[124:127]
s_waitcnt lgkmcnt(10)
ds_read_b64_tr_b16 a[196:197], v237 offset:51424
v_fma_f32 v110, v110, v166, v186
v_mfma_f32_16x16x32_bf16 v[124:127], a[216:219], a[44:47], v[124:127]
ds_read_b64_tr_b16 a[198:199], v237 offset:56544
v_fma_f32 v111, v111, v167, v187
v_mfma_f32_16x16x32_bf16 v[140:143], a[120:123], a[52:55], v[140:143]
v_cvt_pk_bf16_f32 v94, v108, v109
v_cvt_pk_bf16_f32 v95, v110, v111
v_mfma_f32_16x16x32_bf16 v[140:143], a[124:127], a[60:63], v[140:143]
v_permlane16_swap_b32 v92, v94
v_permlane16_swap_b32 v93, v95
v_mfma_f32_16x16x32_bf16 v[140:143], a[128:131], a[68:71], v[140:143]
v_mfma_f32_16x16x32_bf16 v[140:143], a[132:135], a[76:79], v[140:143]
v_mfma_f32_16x16x32_bf16 v[140:143], a[136:139], a[84:87], v[140:143]
s_xor_b32 s90, s76, 1310720
v_mfma_f32_16x16x32_bf16 v[140:143], a[140:143], a[92:95], v[140:143]
s_waitcnt lgkmcnt(10)
buffer_load_dwordx4 v[68:71], v250, s[4:7], s90 offen offset:1024 sc1
v_mfma_f32_16x16x32_bf16 v[124:127], a[220:223], a[52:55], v[124:127]
s_waitcnt lgkmcnt(8)
v_mfma_f32_16x16x32_bf16 v[124:127], a[224:227], a[60:63], v[124:127]
s_waitcnt lgkmcnt(6)
v_mfma_f32_16x16x32_bf16 v[124:127], a[228:231], a[68:71], v[124:127]
s_waitcnt lgkmcnt(4)
v_mfma_f32_16x16x32_bf16 v[124:127], a[232:235], a[76:79], v[124:127]
s_waitcnt lgkmcnt(2)
buffer_load_dwordx4 v[64:67], v235, s[4:7], s90 offen offset:3072 sc1
v_mfma_f32_16x16x32_bf16 v[124:127], a[192:195], a[84:87], v[124:127]
s_waitcnt lgkmcnt(0)
v_mfma_f32_16x16x32_bf16 v[124:127], a[196:199], a[92:95], v[124:127]
s_waitcnt vmcnt(11)
v_mfma_f32_16x16x32_bf16 v[124:127], v[202:205], v[84:87], v[124:127]
s_waitcnt vmcnt(10)
v_mfma_f32_16x16x32_bf16 v[124:127], v[202:205], v[48:51], v[124:127]
s_waitcnt vmcnt(8)
buffer_store_dwordx4 v[92:95], v210, s[40:43], s88 offen sc1 nt
v_mfma_f32_16x16x32_bf16 v[124:127], v[202:205], v[52:55], v[124:127]
s_waitcnt vmcnt(8)
v_mfma_f32_16x16x32_bf16 v[124:127], v[202:205], v[32:35], v[124:127]
v_mfma_f32_16x16x32_bf16 v[140:143], v[200:203], v[84:87], v[140:143]
v_mfma_f32_16x16x32_bf16 v[140:143], v[200:203], v[48:51], v[140:143]
v_mfma_f32_16x16x32_bf16 v[140:143], v[200:203], v[52:55], v[140:143]
v_mfma_f32_16x16x32_bf16 v[140:143], v[200:203], v[32:35], v[140:143]
s_waitcnt vmcnt(7)
v_mfma_f32_16x16x32_bf16 v[156:159], v[206:209], v[36:39], v[156:159]
s_waitcnt vmcnt(6)
v_mfma_f32_16x16x32_bf16 v[156:159], v[206:209], v[128:131], v[156:159]
v_mfma_f32_16x16x32_bf16 v[156:159], a[144:147], a[4:7], v[156:159]
v_mfma_f32_16x16x32_bf16 v[156:159], a[148:151], a[12:15], v[156:159]
v_mfma_f32_16x16x32_bf16 v[156:159], a[152:155], a[20:23], v[156:159]
v_mfma_f32_16x16x32_bf16 v[156:159], a[156:159], a[28:31], v[156:159]
v_mfma_f32_16x16x32_bf16 v[156:159], a[160:163], a[36:39], v[156:159]
v_mfma_f32_16x16x32_bf16 v[156:159], a[164:167], a[44:47], v[156:159]
s_waitcnt vmcnt(3)
v_max3_u32 v254, v133, v113, v117
v_cmp_ge_u32 vcc, v254, v251
s_cbranch_vccnz L_spin_k3
L_back_k3:
v_mfma_f32_16x16x32_bf16 v[124:127], v[202:205], v[132:135], v[124:127]
v_mfma_f32_16x16x32_bf16 v[124:127], v[202:205], v[112:115], v[124:127]
v_mfma_f32_16x16x32_bf16 v[124:127], v[202:205], v[116:119], v[124:127]
v_mfma_f32_16x16x32_bf16 v[140:143], v[200:203], v[132:135], v[140:143]
v_mfma_f32_16x16x32_bf16 v[140:143], v[200:203], v[112:115], v[140:143]
v_mfma_f32_16x16x32_bf16 v[140:143], v[200:203], v[116:119], v[140:143]
v_mfma_f32_16x16x32_bf16 v[156:159], a[168:171], a[52:55], v[156:159]
s_nop 3
v_fma_f32 v124, v124, v168, v188
v_fma_f32 v125, v125, v169, v189
v_mfma_f32_16x16x32_bf16 v[156:159], a[172:175], a[60:63], v[156:159]
v_fma_f32 v126, v126, v170, v190
v_fma_f32 v127, v127, v171, v191
v_mfma_f32_16x16x32_bf16 v[156:159], a[176:179], a[68:71], v[156:159]
v_cvt_pk_bf16_f32 v124, v124, v125
v_cvt_pk_bf16_f32 v125, v126, v127
v_mfma_f32_16x16x32_bf16 v[156:159], a[180:183], a[76:79], v[156:159]
v_fma_f32 v140, v140, v172, v192
v_fma_f32 v141, v141, v173, v193
v_mfma_f32_16x16x32_bf16 v[156:159], a[184:187], a[84:87], v[156:159]
v_fma_f32 v142, v142, v174, v194
v_fma_f32 v143, v143, v175, v195
v_cvt_pk_bf16_f32 v126, v140, v141
v_cvt_pk_bf16_f32 v127, v142, v143
v_mfma_f32_16x16x32_bf16 v[156:159], a[188:191], a[92:95], v[156:159]
v_permlane16_swap_b32 v124, v126
v_permlane16_swap_b32 v125, v127
s_waitcnt vmcnt(1)
v_max3_u32 v254, v69, v65, v65
v_cmp_ge_u32 vcc, v254, v251
s_cbranch_vccnz L_spin_k4
L_back_k4:
buffer_store_dwordx4 v[124:127], v210, s[40:43], s88 offen offset:64 sc1 nt
v_mfma_f32_16x16x32_bf16 v[156:159], v[206:209], v[68:71], v[156:159]
v_mfma_f32_16x16x32_bf16 v[156:159], v[206:209], v[64:67], v[156:159]
s_nop 7
v_fma_f32 v156, v156, v176, v196
v_fma_f32 v157, v157, v177, v197
v_fma_f32 v158, v158, v178, v198
v_fma_f32 v159, v159, v179, v199
v_cvt_pk_bf16_f32 v156, v156, v157
v_cvt_pk_bf16_f32 v157, v158, v159
buffer_store_dwordx2 v[156:157], v211, s[40:43], s88 offen sc1 nt
s_endpgm
L_codeend:
L_fallback:
s_waitcnt vmcnt(0) lgkmcnt(0)
s_nop 15
v_lshrrev_b32 v182, 4, v250
v_and_b32 v183, 15, v182
v_lshrrev_b32 v182, 4, v182
v_mul_u32_u24 v180, 384, v183
v_lshl_add_u32 v180, v182, 4, v180
v_mul_u32_u24 v181, 1536, v182
v_lshl_add_u32 v181, v183, 1, v181
v_mov_b32 v160, 0xff800000
v_mov_b32 v161, 0xff800000
v_mov_b32 v162, 0xff800000
v_mov_b32 v163, 0xff800000
s_mov_b32 s94, 0
L_fb1:
s_add_u32 s95, s94, 6144
buffer_load_dwordx4 a[192:195], v180, s[20:23], s94 offen
buffer_load_dwordx4 a[196:199], v180, s[20:23], s94 offen offset:64
buffer_load_dwordx4 a[200:203], v180, s[20:23], s94 offen offset:128
buffer_load_dwordx4 a[204:207], v180, s[20:23], s94 offen offset:192
buffer_load_dwordx4 a[208:211], v180, s[20:23], s94 offen offset:256
buffer_load_dwordx4 a[212:215], v180, s[20:23], s94 offen offset:320
buffer_load_dwordx4 a[216:219], v180, s[20:23], s95 offen
buffer_load_dwordx4 a[220:223], v180, s[20:23], s95 offen offset:64
buffer_load_dwordx4 a[224:227], v180, s[20:23], s95 offen offset:128
buffer_load_dwordx4 a[228:231], v180, s[20:23], s95 offen offset:192
buffer_load_dwordx4 a[232:235], v180, s[20:23], s95 offen offset:256
buffer_load_dwordx4 v[224:227], v180, s[20:23], s95 offen offset:320
s_waitcnt vmcnt(0)
v_mfma_f32_16x16x32_bf16 v[96:99], a[192:195], v[0:3], 0
v_mfma_f32_16x16x32_bf16 v[96:99], a[196:199], v[16:19], v[96:99]
v_mfma_f32_16x16x32_bf16 v[96:99], a[200:203], v[32:35], v[96:99]
v_mfma_f32_16x16x32_bf16 v[96:99], a[204:207], v[48:51], v[96:99]
v_mfma_f32_16x16x32_bf16 v[96:99], a[208:211], v[64:67], v[96:99]
v_mfma_f32_16x16x32_bf16 v[96:99], a[212:215], v[80:83], v[96:99]
v_mfma_f32_16x16x32_bf16 v[100:103], a[216:219], v[0:3], 0
v_mfma_f32_16x16x32_bf16 v[100:103], a[220:223], v[16:19], v[100:103]
v_mfma_f32_16x16x32_bf16 v[100:103], a[224:227], v[32:35], v[100:103]
v_mfma_f32_16x16x32_bf16 v[100:103], a[228:231], v[48:51], v[100:103]
v_mfma_f32_16x16x32_bf16 v[100:103], a[232:235], v[64:67], v[100:103]
v_mfma_f32_16x16x32_bf16 v[100:103], v[224:227], v[80:83], v[100:103]
v_mfma_f32_16x16x32_bf16 v[104:107], a[192:195], v[4:7], 0
v_mfma_f32_16x16x32_bf16 v[104:107], a[196:199], v[20:23], v[104:107]
v_mfma_f32_16x16x32_bf16 v[104:107], a[200:203], v[36:39], v[104:107]
v_mfma_f32_16x16x32_bf16 v[104:107], a[204:207], v[52:55], v[104:107]
v_mfma_f32_16x16x32_bf16 v[104:107], a[208:211], v[68:71], v[104:107]
v_mfma_f32_16x16x32_bf16 v[104:107], a[212:215], v[84:87], v[104:107]
v_mfma_f32_16x16x32_bf16 v[108:111], a[216:219], v[4:7], 0
v_mfma_f32_16x16x32_bf16 v[108:111], a[220:223], v[20:23], v[108:111]
v_mfma_f32_16x16x32_bf16 v[108:111], a[224:227], v[36:39], v[108:111]
v_mfma_f32_16x16x32_bf16 v[108:111], a[228:231], v[52:55], v[108:111]
v_mfma_f32_16x16x32_bf16 v[108:111], a[232:235], v[68:71], v[108:111]
v_mfma_f32_16x16x32_bf16 v[108:111], v[224:227], v[84:87], v[108:111]
v_mfma_f32_16x16x32_bf16 v[112:115], a[192:195], v[8:11], 0
v_mfma_f32_16x16x32_bf16 v[112:115], a[196:199], v[24:27], v[112:115]
v_mfma_f32_16x16x32_bf16 v[112:115], a[200:203], v[40:43], v[112:115]
v_mfma_f32_16x16x32_bf16 v[112:115], a[204:207], v[56:59], v[112:115]
v_mfma_f32_16x16x32_bf16 v[112:115], a[208:211], v[72:75], v[112:115]
v_mfma_f32_16x16x32_bf16 v[112:115], a[212:215], v[88:91], v[112:115]
v_mfma_f32_16x16x32_bf16 v[116:119], a[216:219], v[8:11], 0
v_mfma_f32_16x16x32_bf16 v[116:119], a[220:223], v[24:27], v[116:119]
v_mfma_f32_16x16x32_bf16 v[116:119], a[224:227], v[40:43], v[116:119]
v_mfma_f32_16x16x32_bf16 v[116:119], a[228:231], v[56:59], v[116:119]
v_mfma_f32_16x16x32_bf16 v[116:119], a[232:235], v[72:75], v[116:119]
v_mfma_f32_16x16x32_bf16 v[116:119], v[224:227], v[88:91], v[116:119]
v_mfma_f32_16x16x32_bf16 v[120:123], a[192:195], v[12:15], 0
v_mfma_f32_16x16x32_bf16 v[120:123], a[196:199], v[28:31], v[120:123]
v_mfma_f32_16x16x32_bf16 v[120:123], a[200:203], v[44:47], v[120:123]
v_mfma_f32_16x16x32_bf16 v[120:123], a[204:207], v[60:63], v[120:123]
v_mfma_f32_16x16x32_bf16 v[120:123], a[208:211], v[76:79], v[120:123]
v_mfma_f32_16x16x32_bf16 v[120:123], a[212:215], v[92:95], v[120:123]
v_mfma_f32_16x16x32_bf16 v[124:127], a[216:219], v[12:15], 0
v_mfma_f32_16x16x32_bf16 v[124:127], a[220:223], v[28:31], v[124:127]
v_mfma_f32_16x16x32_bf16 v[124:127], a[224:227], v[44:47], v[124:127]
v_mfma_f32_16x16x32_bf16 v[124:127], a[228:231], v[60:63], v[124:127]
v_mfma_f32_16x16x32_bf16 v[124:127], a[232:235], v[76:79], v[124:127]
v_mfma_f32_16x16x32_bf16 v[124:127], v[224:227], v[92:95], v[124:127]
s_nop 15
v_max3_f32 v160, v160, v96, v97
v_max3_f32 v160, v160, v98, v99
v_max3_f32 v160, v160, v100, v101
v_max3_f32 v160, v160, v102, v103
v_max3_f32 v161, v161, v104, v105
v_max3_f32 v161, v161, v106, v107
v_max3_f32 v161, v161, v108, v109
v_max3_f32 v161, v161, v110, v111
v_max3_f32 v162, v162, v112, v113
v_max3_f32 v162, v162, v114, v115
v_max3_f32 v162, v162, v116, v117
v_max3_f32 v162, v162, v118, v119
v_max3_f32 v163, v163, v120, v121
v_max3_f32 v163, v163, v122, v123
v_max3_f32 v163, v163, v124, v125
v_max3_f32 v163, v163, v126, v127
s_add_u32 s94, s94, 12288
s_cmp_lt_u32 s94, 196608
s_cbranch_scc1 L_fb1
v_mov_b32 v182, v160
s_nop 1
v_permlane16_swap_b32 v182, v160
v_max_f32 v160, v182, v160
v_mov_b32 v182, v160
s_nop 1
v_permlane32_swap_b32 v182, v160
v_max_f32 v160, v182, v160
v_sub_f32 v164, 0, v160
v_sub_f32 v165, 0, v160
v_sub_f32 v166, 0, v160
v_sub_f32 v167, 0, v160
v_mov_b32 v228, 0
v_mov_b32 v182, v161
s_nop 1
v_permlane16_swap_b32 v182, v161
v_max_f32 v161, v182, v161
v_mov_b32 v182, v161
s_nop 1
v_permlane32_swap_b32 v182, v161
v_max_f32 v161, v182, v161
v_sub_f32 v168, 0, v161
v_sub_f32 v169, 0, v161
v_sub_f32 v170, 0, v161
v_sub_f32 v171, 0, v161
v_mov_b32 v229, 0
v_mov_b32 v182, v162
s_nop 1
v_permlane16_swap_b32 v182, v162
v_max_f32 v162, v182, v162
v_mov_b32 v182, v162
s_nop 1
v_permlane32_swap_b32 v182, v162
v_max_f32 v162, v182, v162
v_sub_f32 v172, 0, v162
v_sub_f32 v173, 0, v162
v_sub_f32 v174, 0, v162
v_sub_f32 v175, 0, v162
v_mov_b32 v230, 0
v_mov_b32 v182, v163
s_nop 1
v_permlane16_swap_b32 v182, v163
v_max_f32 v163, v182, v163
v_mov_b32 v182, v163
s_nop 1
v_permlane32_swap_b32 v182, v163
v_max_f32 v163, v182, v163
v_sub_f32 v176, 0, v163
v_sub_f32 v177, 0, v163
v_sub_f32 v178, 0, v163
v_sub_f32 v179, 0, v163
v_mov_b32 v231, 0
v_accvgpr_write_b32 a0, 0
v_accvgpr_write_b32 a1, 0
v_accvgpr_write_b32 a2, 0
v_accvgpr_write_b32 a3, 0
v_accvgpr_write_b32 a4, 0
v_accvgpr_write_b32 a5, 0
v_accvgpr_write_b32 a6, 0
v_accvgpr_write_b32 a7, 0
v_accvgpr_write_b32 a8, 0
v_accvgpr_write_b32 a9, 0
v_accvgpr_write_b32 a10, 0
v_accvgpr_write_b32 a11, 0
v_accvgpr_write_b32 a12, 0
v_accvgpr_write_b32 a13, 0
v_accvgpr_write_b32 a14, 0
v_accvgpr_write_b32 a15, 0
v_accvgpr_write_b32 a16, 0
v_accvgpr_write_b32 a17, 0
v_accvgpr_write_b32 a18, 0
v_accvgpr_write_b32 a19, 0
v_accvgpr_write_b32 a20, 0
v_accvgpr_write_b32 a21, 0
v_accvgpr_write_b32 a22, 0
v_accvgpr_write_b32 a23, 0
v_accvgpr_write_b32 a24, 0
v_accvgpr_write_b32 a25, 0
v_accvgpr_write_b32 a26, 0
v_accvgpr_write_b32 a27, 0
v_accvgpr_write_b32 a28, 0
v_accvgpr_write_b32 a29, 0
v_accvgpr_write_b32 a30, 0
v_accvgpr_write_b32 a31, 0
v_accvgpr_write_b32 a32, 0
v_accvgpr_write_b32 a33, 0
v_accvgpr_write_b32 a34, 0
v_accvgpr_write_b32 a35, 0
v_accvgpr_write_b32 a36, 0
v_accvgpr_write_b32 a37, 0
v_accvgpr_write_b32 a38, 0
v_accvgpr_write_b32 a39, 0
v_accvgpr_write_b32 a40, 0
v_accvgpr_write_b32 a41, 0
v_accvgpr_write_b32 a42, 0
v_accvgpr_write_b32 a43, 0
v_accvgpr_write_b32 a44, 0
v_accvgpr_write_b32 a45, 0
v_accvgpr_write_b32 a46, 0
v_accvgpr_write_b32 a47, 0
v_accvgpr_write_b32 a48, 0
v_accvgpr_write_b32 a49, 0
v_accvgpr_write_b32 a50, 0
v_accvgpr_write_b32 a51, 0
v_accvgpr_write_b32 a52, 0
v_accvgpr_write_b32 a53, 0
v_accvgpr_write_b32 a54, 0
v_accvgpr_write_b32 a55, 0
v_accvgpr_write_b32 a56, 0
v_accvgpr_write_b32 a57, 0
v_accvgpr_write_b32 a58, 0
v_accvgpr_write_b32 a59, 0
v_accvgpr_write_b32 a60, 0
v_accvgpr_write_b32 a61, 0
v_accvgpr_write_b32 a62, 0
v_accvgpr_write_b32 a63, 0
v_accvgpr_write_b32 a64, 0
v_accvgpr_write_b32 a65, 0
v_accvgpr_write_b32 a66, 0
v_accvgpr_write_b32 a67, 0
v_accvgpr_write_b32 a68, 0
v_accvgpr_write_b32 a69, 0
v_accvgpr_write_b32 a70, 0
v_accvgpr_write_b32 a71, 0
v_accvgpr_write_b32 a72, 0
v_accvgpr_write_b32 a73, 0
v_accvgpr_write_b32 a74, 0
v_accvgpr_write_b32 a75, 0
v_accvgpr_write_b32 a76, 0
v_accvgpr_write_b32 a77, 0
v_accvgpr_write_b32 a78, 0
v_accvgpr_write_b32 a79, 0
v_accvgpr_write_b32 a80, 0
v_accvgpr_write_b32 a81, 0
v_accvgpr_write_b32 a82, 0
v_accvgpr_write_b32 a83, 0
v_accvgpr_write_b32 a84, 0
v_accvgpr_write_b32 a85, 0
v_accvgpr_write_b32 a86, 0
v_accvgpr_write_b32 a87, 0
v_accvgpr_write_b32 a88, 0
v_accvgpr_write_b32 a89, 0
v_accvgpr_write_b32 a90, 0
v_accvgpr_write_b32 a91, 0
v_accvgpr_write_b32 a92, 0
v_accvgpr_write_b32 a93, 0
v_accvgpr_write_b32 a94, 0
v_accvgpr_write_b32 a95, 0
v_accvgpr_write_b32 a96, 0
v_accvgpr_write_b32 a97, 0
v_accvgpr_write_b32 a98, 0
v_accvgpr_write_b32 a99, 0
v_accvgpr_write_b32 a100, 0
v_accvgpr_write_b32 a101, 0
v_accvgpr_write_b32 a102, 0
v_accvgpr_write_b32 a103, 0
v_accvgpr_write_b32 a104, 0
v_accvgpr_write_b32 a105, 0
v_accvgpr_write_b32 a106, 0
v_accvgpr_write_b32 a107, 0
v_accvgpr_write_b32 a108, 0
v_accvgpr_write_b32 a109, 0
v_accvgpr_write_b32 a110, 0
v_accvgpr_write_b32 a111, 0
v_accvgpr_write_b32 a112, 0
v_accvgpr_write_b32 a113, 0
v_accvgpr_write_b32 a114, 0
v_accvgpr_write_b32 a115, 0
v_accvgpr_write_b32 a116, 0
v_accvgpr_write_b32 a117, 0
v_accvgpr_write_b32 a118, 0
v_accvgpr_write_b32 a119, 0
v_accvgpr_write_b32 a120, 0
v_accvgpr_write_b32 a121, 0
v_accvgpr_write_b32 a122, 0
v_accvgpr_write_b32 a123, 0
v_accvgpr_write_b32 a124, 0
v_accvgpr_write_b32 a125, 0
v_accvgpr_write_b32 a126, 0
v_accvgpr_write_b32 a127, 0
v_accvgpr_write_b32 a128, 0
v_accvgpr_write_b32 a129, 0
v_accvgpr_write_b32 a130, 0
v_accvgpr_write_b32 a131, 0
v_accvgpr_write_b32 a132, 0
v_accvgpr_write_b32 a133, 0
v_accvgpr_write_b32 a134, 0
v_accvgpr_write_b32 a135, 0
v_accvgpr_write_b32 a136, 0
v_accvgpr_write_b32 a137, 0
v_accvgpr_write_b32 a138, 0
v_accvgpr_write_b32 a139, 0
v_accvgpr_write_b32 a140, 0
v_accvgpr_write_b32 a141, 0
v_accvgpr_write_b32 a142, 0
v_accvgpr_write_b32 a143, 0
v_accvgpr_write_b32 a144, 0
v_accvgpr_write_b32 a145, 0
v_accvgpr_write_b32 a146, 0
v_accvgpr_write_b32 a147, 0
v_accvgpr_write_b32 a148, 0
v_accvgpr_write_b32 a149, 0
v_accvgpr_write_b32 a150, 0
v_accvgpr_write_b32 a151, 0
v_accvgpr_write_b32 a152, 0
v_accvgpr_write_b32 a153, 0
v_accvgpr_write_b32 a154, 0
v_accvgpr_write_b32 a155, 0
v_accvgpr_write_b32 a156, 0
v_accvgpr_write_b32 a157, 0
v_accvgpr_write_b32 a158, 0
v_accvgpr_write_b32 a159, 0
v_accvgpr_write_b32 a160, 0
v_accvgpr_write_b32 a161, 0
v_accvgpr_write_b32 a162, 0
v_accvgpr_write_b32 a163, 0
v_accvgpr_write_b32 a164, 0
v_accvgpr_write_b32 a165, 0
v_accvgpr_write_b32 a166, 0
v_accvgpr_write_b32 a167, 0
v_accvgpr_write_b32 a168, 0
v_accvgpr_write_b32 a169, 0
v_accvgpr_write_b32 a170, 0
v_accvgpr_write_b32 a171, 0
v_accvgpr_write_b32 a172, 0
v_accvgpr_write_b32 a173, 0
v_accvgpr_write_b32 a174, 0
v_accvgpr_write_b32 a175, 0
v_accvgpr_write_b32 a176, 0
v_accvgpr_write_b32 a177, 0
v_accvgpr_write_b32 a178, 0
v_accvgpr_write_b32 a179, 0
v_accvgpr_write_b32 a180, 0
v_accvgpr_write_b32 a181, 0
v_accvgpr_write_b32 a182, 0
v_accvgpr_write_b32 a183, 0
v_accvgpr_write_b32 a184, 0
v_accvgpr_write_b32 a185, 0
v_accvgpr_write_b32 a186, 0
v_accvgpr_write_b32 a187, 0
v_accvgpr_write_b32 a188, 0
v_accvgpr_write_b32 a189, 0
v_accvgpr_write_b32 a190, 0
v_accvgpr_write_b32 a191, 0
s_mov_b32 s94, 0
L_fb3:
s_add_u32 s95, s94, 6144
buffer_load_dwordx4 a[192:195], v180, s[20:23], s94 offen
buffer_load_dwordx4 a[196:199], v180, s[20:23], s94 offen offset:64
buffer_load_dwordx4 a[200:203], v180, s[20:23], s94 offen offset:128
buffer_load_dwordx4 a[204:207], v180, s[20:23], s94 offen offset:192
buffer_load_dwordx4 a[208:211], v180, s[20:23], s94 offen offset:256
buffer_load_dwordx4 a[212:215], v180, s[20:23], s94 offen offset:320
buffer_load_dwordx4 a[216:219], v180, s[20:23], s95 offen
buffer_load_dwordx4 a[220:223], v180, s[20:23], s95 offen offset:64
buffer_load_dwordx4 a[224:227], v180, s[20:23], s95 offen offset:128
buffer_load_dwordx4 a[228:231], v180, s[20:23], s95 offen offset:192
buffer_load_dwordx4 a[232:235], v180, s[20:23], s95 offen offset:256
buffer_load_dwordx4 v[224:227], v180, s[20:23], s95 offen offset:320
s_waitcnt vmcnt(0)
v_mfma_f32_16x16x32_bf16 v[96:99], a[192:195], v[0:3], v[164:167]
v_mfma_f32_16x16x32_bf16 v[96:99], a[196:199], v[16:19], v[96:99]
v_mfma_f32_16x16x32_bf16 v[96:99], a[200:203], v[32:35], v[96:99]
v_mfma_f32_16x16x32_bf16 v[96:99], a[204:207], v[48:51], v[96:99]
v_mfma_f32_16x16x32_bf16 v[96:99], a[208:211], v[64:67], v[96:99]
v_mfma_f32_16x16x32_bf16 v[96:99], a[212:215], v[80:83], v[96:99]
v_mfma_f32_16x16x32_bf16 v[100:103], a[216:219], v[0:3], v[164:167]
v_mfma_f32_16x16x32_bf16 v[100:103], a[220:223], v[16:19], v[100:103]
v_mfma_f32_16x16x32_bf16 v[100:103], a[224:227], v[32:35], v[100:103]
v_mfma_f32_16x16x32_bf16 v[100:103], a[228:231], v[48:51], v[100:103]
v_mfma_f32_16x16x32_bf16 v[100:103], a[232:235], v[64:67], v[100:103]
v_mfma_f32_16x16x32_bf16 v[100:103], v[224:227], v[80:83], v[100:103]
v_mfma_f32_16x16x32_bf16 v[104:107], a[192:195], v[4:7], v[168:171]
v_mfma_f32_16x16x32_bf16 v[104:107], a[196:199], v[20:23], v[104:107]
v_mfma_f32_16x16x32_bf16 v[104:107], a[200:203], v[36:39], v[104:107]
v_mfma_f32_16x16x32_bf16 v[104:107], a[204:207], v[52:55], v[104:107]
v_mfma_f32_16x16x32_bf16 v[104:107], a[208:211], v[68:71], v[104:107]
v_mfma_f32_16x16x32_bf16 v[104:107], a[212:215], v[84:87], v[104:107]
v_mfma_f32_16x16x32_bf16 v[108:111], a[216:219], v[4:7], v[168:171]
v_mfma_f32_16x16x32_bf16 v[108:111], a[220:223], v[20:23], v[108:111]
v_mfma_f32_16x16x32_bf16 v[108:111], a[224:227], v[36:39], v[108:111]
v_mfma_f32_16x16x32_bf16 v[108:111], a[228:231], v[52:55], v[108:111]
v_mfma_f32_16x16x32_bf16 v[108:111], a[232:235], v[68:71], v[108:111]
v_mfma_f32_16x16x32_bf16 v[108:111], v[224:227], v[84:87], v[108:111]
v_mfma_f32_16x16x32_bf16 v[112:115], a[192:195], v[8:11], v[172:175]
v_mfma_f32_16x16x32_bf16 v[112:115], a[196:199], v[24:27], v[112:115]
v_mfma_f32_16x16x32_bf16 v[112:115], a[200:203], v[40:43], v[112:115]
v_mfma_f32_16x16x32_bf16 v[112:115], a[204:207], v[56:59], v[112:115]
v_mfma_f32_16x16x32_bf16 v[112:115], a[208:211], v[72:75], v[112:115]
v_mfma_f32_16x16x32_bf16 v[112:115], a[212:215], v[88:91], v[112:115]
v_mfma_f32_16x16x32_bf16 v[116:119], a[216:219], v[8:11], v[172:175]
v_mfma_f32_16x16x32_bf16 v[116:119], a[220:223], v[24:27], v[116:119]
v_mfma_f32_16x16x32_bf16 v[116:119], a[224:227], v[40:43], v[116:119]
v_mfma_f32_16x16x32_bf16 v[116:119], a[228:231], v[56:59], v[116:119]
v_mfma_f32_16x16x32_bf16 v[116:119], a[232:235], v[72:75], v[116:119]
v_mfma_f32_16x16x32_bf16 v[116:119], v[224:227], v[88:91], v[116:119]
v_mfma_f32_16x16x32_bf16 v[120:123], a[192:195], v[12:15], v[176:179]
v_mfma_f32_16x16x32_bf16 v[120:123], a[196:199], v[28:31], v[120:123]
v_mfma_f32_16x16x32_bf16 v[120:123], a[200:203], v[44:47], v[120:123]
v_mfma_f32_16x16x32_bf16 v[120:123], a[204:207], v[60:63], v[120:123]
v_mfma_f32_16x16x32_bf16 v[120:123], a[208:211], v[76:79], v[120:123]
v_mfma_f32_16x16x32_bf16 v[120:123], a[212:215], v[92:95], v[120:123]
v_mfma_f32_16x16x32_bf16 v[124:127], a[216:219], v[12:15], v[176:179]
v_mfma_f32_16x16x32_bf16 v[124:127], a[220:223], v[28:31], v[124:127]
v_mfma_f32_16x16x32_bf16 v[124:127], a[224:227], v[44:47], v[124:127]
v_mfma_f32_16x16x32_bf16 v[124:127], a[228:231], v[60:63], v[124:127]
v_mfma_f32_16x16x32_bf16 v[124:127], a[232:235], v[76:79], v[124:127]
v_mfma_f32_16x16x32_bf16 v[124:127], v[224:227], v[92:95], v[124:127]
s_nop 15
v_exp_f32 v96, v96
v_exp_f32 v97, v97
v_exp_f32 v98, v98
v_exp_f32 v99, v99
v_add_f32 v228, v228, v96
v_add_f32 v228, v228, v97
v_add_f32 v228, v228, v98
v_add_f32 v228, v228, v99
v_cvt_pk_bf16_f32 v144, v96, v97
v_cvt_pk_bf16_f32 v145, v98, v99
v_exp_f32 v100, v100
v_exp_f32 v101, v101
v_exp_f32 v102, v102
v_exp_f32 v103, v103
v_add_f32 v228, v228, v100
v_add_f32 v228, v228, v101
v_add_f32 v228, v228, v102
v_add_f32 v228, v228, v103
v_cvt_pk_bf16_f32 v146, v100, v101
v_cvt_pk_bf16_f32 v147, v102, v103
v_exp_f32 v104, v104
v_exp_f32 v105, v105
v_exp_f32 v106, v106
v_exp_f32 v107, v107
v_add_f32 v229, v229, v104
v_add_f32 v229, v229, v105
v_add_f32 v229, v229, v106
v_add_f32 v229, v229, v107
v_cvt_pk_bf16_f32 v148, v104, v105
v_cvt_pk_bf16_f32 v149, v106, v107
v_exp_f32 v108, v108
v_exp_f32 v109, v109
v_exp_f32 v110, v110
v_exp_f32 v111, v111
v_add_f32 v229, v229, v108
v_add_f32 v229, v229, v109
v_add_f32 v229, v229, v110
v_add_f32 v229, v229, v111
v_cvt_pk_bf16_f32 v150, v108, v109
v_cvt_pk_bf16_f32 v151, v110, v111
v_exp_f32 v112, v112
v_exp_f32 v113, v113
v_exp_f32 v114, v114
v_exp_f32 v115, v115
v_add_f32 v230, v230, v112
v_add_f32 v230, v230, v113
v_add_f32 v230, v230, v114
v_add_f32 v230, v230, v115
v_cvt_pk_bf16_f32 v152, v112, v113
v_cvt_pk_bf16_f32 v153, v114, v115
v_exp_f32 v116, v116
v_exp_f32 v117, v117
v_exp_f32 v118, v118
v_exp_f32 v119, v119
v_add_f32 v230, v230, v116
v_add_f32 v230, v230, v117
v_add_f32 v230, v230, v118
v_add_f32 v230, v230, v119
v_cvt_pk_bf16_f32 v154, v116, v117
v_cvt_pk_bf16_f32 v155, v118, v119
v_exp_f32 v120, v120
v_exp_f32 v121, v121
v_exp_f32 v122, v122
v_exp_f32 v123, v123
v_add_f32 v231, v231, v120
v_add_f32 v231, v231, v121
v_add_f32 v231, v231, v122
v_add_f32 v231, v231, v123
v_cvt_pk_bf16_f32 v156, v120, v121
v_cvt_pk_bf16_f32 v157, v122, v123
v_exp_f32 v124, v124
v_exp_f32 v125, v125
v_exp_f32 v126, v126
v_exp_f32 v127, v127
v_add_f32 v231, v231, v124
v_add_f32 v231, v231, v125
v_add_f32 v231, v231, v126
v_add_f32 v231, v231, v127
v_cvt_pk_bf16_f32 v158, v124, v125
v_cvt_pk_bf16_f32 v159, v126, v127
buffer_load_ushort v96, v181, s[24:27], s94 offen
buffer_load_ushort v97, v181, s[24:27], s94 offen offset:384
buffer_load_ushort v98, v181, s[24:27], s94 offen offset:768
buffer_load_ushort v99, v181, s[24:27], s94 offen offset:1152
buffer_load_ushort v100, v181, s[24:27], s95 offen
buffer_load_ushort v101, v181, s[24:27], s95 offen offset:384
buffer_load_ushort v102, v181, s[24:27], s95 offen offset:768
buffer_load_ushort v103, v181, s[24:27], s95 offen offset:1152
buffer_load_ushort v104, v181, s[24:27], s94 offen offset:32
buffer_load_ushort v105, v181, s[24:27], s94 offen offset:416
buffer_load_ushort v106, v181, s[24:27], s94 offen offset:800
buffer_load_ushort v107, v181, s[24:27], s94 offen offset:1184
buffer_load_ushort v108, v181, s[24:27], s95 offen offset:32
buffer_load_ushort v109, v181, s[24:27], s95 offen offset:416
buffer_load_ushort v110, v181, s[24:27], s95 offen offset:800
buffer_load_ushort v111, v181, s[24:27], s95 offen offset:1184
buffer_load_ushort v112, v181, s[24:27], s94 offen offset:64
buffer_load_ushort v113, v181, s[24:27], s94 offen offset:448
buffer_load_ushort v114, v181, s[24:27], s94 offen offset:832
buffer_load_ushort v115, v181, s[24:27], s94 offen offset:1216
buffer_load_ushort v116, v181, s[24:27], s95 offen offset:64
buffer_load_ushort v117, v181, s[24:27], s95 offen offset:448
buffer_load_ushort v118, v181, s[24:27], s95 offen offset:832
buffer_load_ushort v119, v181, s[24:27], s95 offen offset:1216
buffer_load_ushort v120, v181, s[24:27], s94 offen offset:96
buffer_load_ushort v121, v181, s[24:27], s94 offen offset:480
buffer_load_ushort v122, v181, s[24:27], s94 offen offset:864
buffer_load_ushort v123, v181, s[24:27], s94 offen offset:1248
buffer_load_ushort v124, v181, s[24:27], s95 offen offset:96
buffer_load_ushort v125, v181, s[24:27], s95 offen offset:480
buffer_load_ushort v126, v181, s[24:27], s95 offen offset:864
buffer_load_ushort v127, v181, s[24:27], s95 offen offset:1248
buffer_load_ushort v128, v181, s[24:27], s94 offen offset:128
buffer_load_ushort v129, v181, s[24:27], s94 offen offset:512
buffer_load_ushort v130, v181, s[24:27], s94 offen offset:896
buffer_load_ushort v131, v181, s[24:27], s94 offen offset:1280
buffer_load_ushort v132, v181, s[24:27], s95 offen offset:128
buffer_load_ushort v133, v181, s[24:27], s95 offen offset:512
buffer_load_ushort v134, v181, s[24:27], s95 offen offset:896
buffer_load_ushort v135, v181, s[24:27], s95 offen offset:1280
buffer_load_ushort v136, v181, s[24:27], s94 offen offset:160
buffer_load_ushort v137, v181, s[24:27], s94 offen offset:544
buffer_load_ushort v138, v181, s[24:27], s94 offen offset:928
buffer_load_ushort v139, v181, s[24:27], s94 offen offset:1312
buffer_load_ushort v140, v181, s[24:27], s95 offen offset:160
buffer_load_ushort v141, v181, s[24:27], s95 offen offset:544
buffer_load_ushort v142, v181, s[24:27], s95 offen offset:928
buffer_load_ushort v143, v181, s[24:27], s95 offen offset:1312
s_waitcnt vmcnt(0)
v_lshl_or_b32 v96, v97, 16, v96
v_lshl_or_b32 v97, v99, 16, v98
v_lshl_or_b32 v98, v101, 16, v100
v_lshl_or_b32 v99, v103, 16, v102
v_lshl_or_b32 v104, v105, 16, v104
v_lshl_or_b32 v105, v107, 16, v106
v_lshl_or_b32 v106, v109, 16, v108
v_lshl_or_b32 v107, v111, 16, v110
v_lshl_or_b32 v112, v113, 16, v112
v_lshl_or_b32 v113, v115, 16, v114
v_lshl_or_b32 v114, v117, 16, v116
v_lshl_or_b32 v115, v119, 16, v118
v_lshl_or_b32 v120, v121, 16, v120
v_lshl_or_b32 v121, v123, 16, v122
v_lshl_or_b32 v122, v125, 16, v124
v_lshl_or_b32 v123, v127, 16, v126
v_lshl_or_b32 v128, v129, 16, v128
v_lshl_or_b32 v129, v131, 16, v130
v_lshl_or_b32 v130, v133, 16, v132
v_lshl_or_b32 v131, v135, 16, v134
v_lshl_or_b32 v136, v137, 16, v136
v_lshl_or_b32 v137, v139, 16, v138
v_lshl_or_b32 v138, v141, 16, v140
v_lshl_or_b32 v139, v143, 16, v142
v_mfma_f32_16x16x32_bf16 a[0:3], v[96:99], v[144:147], a[0:3]
v_mfma_f32_16x16x32_bf16 a[4:7], v[96:99], v[148:151], a[4:7]
v_mfma_f32_16x16x32_bf16 a[8:11], v[96:99], v[152:155], a[8:11]
v_mfma_f32_16x16x32_bf16 a[12:15], v[96:99], v[156:159], a[12:15]
v_mfma_f32_16x16x32_bf16 a[16:19], v[104:107], v[144:147], a[16:19]
v_mfma_f32_16x16x32_bf16 a[20:23], v[104:107], v[148:151], a[20:23]
v_mfma_f32_16x16x32_bf16 a[24:27], v[104:107], v[152:155], a[24:27]
v_mfma_f32_16x16x32_bf16 a[28:31], v[104:107], v[156:159], a[28:31]
v_mfma_f32_16x16x32_bf16 a[32:35], v[112:115], v[144:147], a[32:35]
v_mfma_f32_16x16x32_bf16 a[36:39], v[112:115], v[148:151], a[36:39]
v_mfma_f32_16x16x32_bf16 a[40:43], v[112:115], v[152:155], a[40:43]
v_mfma_f32_16x16x32_bf16 a[44:47], v[112:115], v[156:159], a[44:47]
v_mfma_f32_16x16x32_bf16 a[48:51], v[120:123], v[144:147], a[48:51]
v_mfma_f32_16x16x32_bf16 a[52:55], v[120:123], v[148:151], a[52:55]
v_mfma_f32_16x16x32_bf16 a[56:59], v[120:123], v[152:155], a[56:59]
v_mfma_f32_16x16x32_bf16 a[60:63], v[120:123], v[156:159], a[60:63]
v_mfma_f32_16x16x32_bf16 a[64:67], v[128:131], v[144:147], a[64:67]
v_mfma_f32_16x16x32_bf16 a[68:71], v[128:131], v[148:151], a[68:71]
v_mfma_f32_16x16x32_bf16 a[72:75], v[128:131], v[152:155], a[72:75]
v_mfma_f32_16x16x32_bf16 a[76:79], v[128:131], v[156:159], a[76:79]
v_mfma_f32_16x16x32_bf16 a[80:83], v[136:139], v[144:147], a[80:83]
v_mfma_f32_16x16x32_bf16 a[84:87], v[136:139], v[148:151], a[84:87]
v_mfma_f32_16x16x32_bf16 a[88:91], v[136:139], v[152:155], a[88:91]
v_mfma_f32_16x16x32_bf16 a[92:95], v[136:139], v[156:159], a[92:95]
s_nop 15
buffer_load_ushort v96, v181, s[24:27], s94 offen offset:192
buffer_load_ushort v97, v181, s[24:27], s94 offen offset:576
buffer_load_ushort v98, v181, s[24:27], s94 offen offset:960
buffer_load_ushort v99, v181, s[24:27], s94 offen offset:1344
buffer_load_ushort v100, v181, s[24:27], s95 offen offset:192
buffer_load_ushort v101, v181, s[24:27], s95 offen offset:576
buffer_load_ushort v102, v181, s[24:27], s95 offen offset:960
buffer_load_ushort v103, v181, s[24:27], s95 offen offset:1344
buffer_load_ushort v104, v181, s[24:27], s94 offen offset:224
buffer_load_ushort v105, v181, s[24:27], s94 offen offset:608
buffer_load_ushort v106, v181, s[24:27], s94 offen offset:992
buffer_load_ushort v107, v181, s[24:27], s94 offen offset:1376
buffer_load_ushort v108, v181, s[24:27], s95 offen offset:224
buffer_load_ushort v109, v181, s[24:27], s95 offen offset:608
buffer_load_ushort v110, v181, s[24:27], s95 offen offset:992
buffer_load_ushort v111, v181, s[24:27], s95 offen offset:1376
buffer_load_ushort v112, v181, s[24:27], s94 offen offset:256
buffer_load_ushort v113, v181, s[24:27], s94 offen offset:640
buffer_load_ushort v114, v181, s[24:27], s94 offen offset:1024
buffer_load_ushort v115, v181, s[24:27], s94 offen offset:1408
buffer_load_ushort v116, v181, s[24:27], s95 offen offset:256
buffer_load_ushort v117, v181, s[24:27], s95 offen offset:640
buffer_load_ushort v118, v181, s[24:27], s95 offen offset:1024
buffer_load_ushort v119, v181, s[24:27], s95 offen offset:1408
buffer_load_ushort v120, v181, s[24:27], s94 offen offset:288
buffer_load_ushort v121, v181, s[24:27], s94 offen offset:672
buffer_load_ushort v122, v181, s[24:27], s94 offen offset:1056
buffer_load_ushort v123, v181, s[24:27], s94 offen offset:1440
buffer_load_ushort v124, v181, s[24:27], s95 offen offset:288
buffer_load_ushort v125, v181, s[24:27], s95 offen offset:672
buffer_load_ushort v126, v181, s[24:27], s95 offen offset:1056
buffer_load_ushort v127, v181, s[24:27], s95 offen offset:1440
buffer_load_ushort v128, v181, s[24:27], s94 offen offset:320
buffer_load_ushort v129, v181, s[24:27], s94 offen offset:704
buffer_load_ushort v130, v181, s[24:27], s94 offen offset:1088
buffer_load_ushort v131, v181, s[24:27], s94 offen offset:1472
buffer_load_ushort v132, v181, s[24:27], s95 offen offset:320
buffer_load_ushort v133, v181, s[24:27], s95 offen offset:704
buffer_load_ushort v134, v181, s[24:27], s95 offen offset:1088
buffer_load_ushort v135, v181, s[24:27], s95 offen offset:1472
buffer_load_ushort v136, v181, s[24:27], s94 offen offset:352
buffer_load_ushort v137, v181, s[24:27], s94 offen offset:736
buffer_load_ushort v138, v181, s[24:27], s94 offen offset:1120
buffer_load_ushort v139, v181, s[24:27], s94 offen offset:1504
buffer_load_ushort v140, v181, s[24:27], s95 offen offset:352
buffer_load_ushort v141, v181, s[24:27], s95 offen offset:736
buffer_load_ushort v142, v181, s[24:27], s95 offen offset:1120
buffer_load_ushort v143, v181, s[24:27], s95 offen offset:1504
s_waitcnt vmcnt(0)
v_lshl_or_b32 v96, v97, 16, v96
v_lshl_or_b32 v97, v99, 16, v98
v_lshl_or_b32 v98, v101, 16, v100
v_lshl_or_b32 v99, v103, 16, v102
v_lshl_or_b32 v104, v105, 16, v104
v_lshl_or_b32 v105, v107, 16, v106
v_lshl_or_b32 v106, v109, 16, v108
v_lshl_or_b32 v107, v111, 16, v110
v_lshl_or_b32 v112, v113, 16, v112
v_lshl_or_b32 v113, v115, 16, v114
v_lshl_or_b32 v114, v117, 16, v116
v_lshl_or_b32 v115, v119, 16, v118
v_lshl_or_b32 v120, v121, 16, v120
v_lshl_or_b32 v121, v123, 16, v122
v_lshl_or_b32 v122, v125, 16, v124
v_lshl_or_b32 v123, v127, 16, v126
v_lshl_or_b32 v128, v129, 16, v128
v_lshl_or_b32 v129, v131, 16, v130
v_lshl_or_b32 v130, v133, 16, v132
v_lshl_or_b32 v131, v135, 16, v134
v_lshl_or_b32 v136, v137, 16, v136
v_lshl_or_b32 v137, v139, 16, v138
v_lshl_or_b32 v138, v141, 16, v140
v_lshl_or_b32 v139, v143, 16, v142
v_mfma_f32_16x16x32_bf16 a[96:99], v[96:99], v[144:147], a[96:99]
v_mfma_f32_16x16x32_bf16 a[100:103], v[96:99], v[148:151], a[100:103]
v_mfma_f32_16x16x32_bf16 a[104:107], v[96:99], v[152:155], a[104:107]
v_mfma_f32_16x16x32_bf16 a[108:111], v[96:99], v[156:159], a[108:111]
v_mfma_f32_16x16x32_bf16 a[112:115], v[104:107], v[144:147], a[112:115]
v_mfma_f32_16x16x32_bf16 a[116:119], v[104:107], v[148:151], a[116:119]
v_mfma_f32_16x16x32_bf16 a[120:123], v[104:107], v[152:155], a[120:123]
v_mfma_f32_16x16x32_bf16 a[124:127], v[104:107], v[156:159], a[124:127]
v_mfma_f32_16x16x32_bf16 a[128:131], v[112:115], v[144:147], a[128:131]
v_mfma_f32_16x16x32_bf16 a[132:135], v[112:115], v[148:151], a[132:135]
v_mfma_f32_16x16x32_bf16 a[136:139], v[112:115], v[152:155], a[136:139]
v_mfma_f32_16x16x32_bf16 a[140:143], v[112:115], v[156:159], a[140:143]
v_mfma_f32_16x16x32_bf16 a[144:147], v[120:123], v[144:147], a[144:147]
v_mfma_f32_16x16x32_bf16 a[148:151], v[120:123], v[148:151], a[148:151]
v_mfma_f32_16x16x32_bf16 a[152:155], v[120:123], v[152:155], a[152:155]
v_mfma_f32_16x16x32_bf16 a[156:159], v[120:123], v[156:159], a[156:159]
v_mfma_f32_16x16x32_bf16 a[160:163], v[128:131], v[144:147], a[160:163]
v_mfma_f32_16x16x32_bf16 a[164:167], v[128:131], v[148:151], a[164:167]
v_mfma_f32_16x16x32_bf16 a[168:171], v[128:131], v[152:155], a[168:171]
v_mfma_f32_16x16x32_bf16 a[172:175], v[128:131], v[156:159], a[172:175]
v_mfma_f32_16x16x32_bf16 a[176:179], v[136:139], v[144:147], a[176:179]
v_mfma_f32_16x16x32_bf16 a[180:183], v[136:139], v[148:151], a[180:183]
v_mfma_f32_16x16x32_bf16 a[184:187], v[136:139], v[152:155], a[184:187]
v_mfma_f32_16x16x32_bf16 a[188:191], v[136:139], v[156:159], a[188:191]
s_nop 15
s_add_u32 s94, s94, 12288
s_cmp_lt_u32 s94, 196608
s_cbranch_scc1 L_fb3
v_mov_b32 v96, 0
v_mov_b32 v97, 0
v_mov_b32 v98, 0
v_mov_b32 v99, 0
v_mov_b32 v100, 0
v_mov_b32 v101, 0
v_mov_b32 v102, 0
v_mov_b32 v103, 0
v_mov_b32 v104, 0
v_mov_b32 v105, 0
v_mov_b32 v106, 0
v_mov_b32 v107, 0
v_mov_b32 v108, 0
v_mov_b32 v109, 0
v_mov_b32 v110, 0
v_mov_b32 v111, 0
v_mov_b32 v112, 0
v_mov_b32 v113, 0
v_mov_b32 v114, 0
v_mov_b32 v115, 0
v_mov_b32 v116, 0
v_mov_b32 v117, 0
v_mov_b32 v118, 0
v_mov_b32 v119, 0
v_mov_b32 v120, 0
v_mov_b32 v121, 0
v_mov_b32 v122, 0
v_mov_b32 v123, 0
v_mov_b32 v124, 0
v_mov_b32 v125, 0
v_mov_b32 v126, 0
v_mov_b32 v127, 0
v_mov_b32 v128, 0
v_mov_b32 v129, 0
v_mov_b32 v130, 0
v_mov_b32 v131, 0
v_mov_b32 v132, 0
v_mov_b32 v133, 0
v_mov_b32 v134, 0
v_mov_b32 v135, 0
v_mov_b32 v136, 0
v_mov_b32 v137, 0
v_mov_b32 v138, 0
v_mov_b32 v139, 0
v_mov_b32 v140, 0
v_mov_b32 v141, 0
v_mov_b32 v142, 0
v_mov_b32 v143, 0
v_mov_b32 v144, 0
v_mov_b32 v145, 0
v_mov_b32 v146, 0
v_mov_b32 v147, 0
v_mov_b32 v148, 0
v_mov_b32 v149, 0
v_mov_b32 v150, 0
v_mov_b32 v151, 0
v_mov_b32 v152, 0
v_mov_b32 v153, 0
v_mov_b32 v154, 0
v_mov_b32 v155, 0
v_mov_b32 v156, 0
v_mov_b32 v157, 0
v_mov_b32 v158, 0
v_mov_b32 v159, 0
v_mov_b32 v182, v228
s_nop 1
v_permlane16_swap_b32 v182, v228
v_add_f32 v228, v182, v228
v_mov_b32 v182, v228
s_nop 1
v_permlane32_swap_b32 v182, v228
v_add_f32 v228, v182, v228
v_mov_b32 v182, v229
s_nop 1
v_permlane16_swap_b32 v182, v229
v_add_f32 v229, v182, v229
v_mov_b32 v182, v229
s_nop 1
v_permlane32_swap_b32 v182, v229
v_add_f32 v229, v182, v229
v_mov_b32 v182, v230
s_nop 1
v_permlane16_swap_b32 v182, v230
v_add_f32 v230, v182, v230
v_mov_b32 v182, v230
s_nop 1
v_permlane32_swap_b32 v182, v230
v_add_f32 v230, v182, v230
v_mov_b32 v182, v231
s_nop 1
v_permlane16_swap_b32 v182, v231
v_add_f32 v231, v182, v231
v_mov_b32 v182, v231
s_nop 1
v_permlane32_swap_b32 v182, v231
v_add_f32 v231, v182, v231
v_rcp_f32 v228, v228
v_rcp_f32 v229, v229
v_rcp_f32 v230, v230
v_rcp_f32 v231, v231
s_nop 15
s_branch L_join
.section .rodata,"a"
.p2align 6
.amdhsa_kernel recurrent_scan__sliding_block_cached__swiglu_ffn__prompt_kernel
  .amdhsa_next_free_vgpr 512
  .amdhsa_next_free_sgpr 102
  .amdhsa_accum_offset 256
  .amdhsa_group_segment_fixed_size 0
  .amdhsa_kernarg_size 96
  .amdhsa_user_sgpr_count 2
  .amdhsa_user_sgpr_kernarg_segment_ptr 1
  .amdhsa_system_sgpr_workgroup_id_x 1
.end_amdhsa_kernel
```
